```python
import torch

def _softmax(x, axis=-1):
    return torch.softmax(x, dim=axis)

def _gelu(x):
    return torch.nn.functional.gelu(x, approximate='tanh')

def _silu(x):
    return torch.nn.functional.silu(x)

def _sigmoid(x):
    return torch.sigmoid(x)

def _layernorm(x, axis=-1, eps=1e-05):
    m = x.mean(dim=axis, keepdim=True)
    v = x.var(dim=axis, keepdim=True, unbiased=False)
    return (x - m) / torch.sqrt(v + eps)

def _scatter_add(tgt, idx, src, axis=0):
    return tgt.clone().index_add_(axis, idx, src)

def _segment_sum(src, seg, n):
    out = torch.zeros((n,) + src.shape[1:], dtype=src.dtype)
    return out.index_add_(0, seg, src)

def _pad(x, pw):
    flat = tuple((v for pair in reversed(pw) for v in pair))
    return torch.nn.functional.pad(x, flat)
kernel_name = 'adaLN_cond__memory_aug_recurrent_mem_tr__dense_activation_squared_relu__prompt'

def setup_inputs():

    _w = lambda a: (lambda t: t.to(torch.bfloat16) if t.is_floating_point() else t)(torch.as_tensor(a))

    def _A_setup():
        B, S, Dm = (1, 2048, 640)
        H, Dh = (32, 192)
        M, seg = (8, 32)
        seg = min(seg, S)
        S = S // seg * seg
        return {'x': _w((lambda *s: torch.randn(*s, dtype=torch.bfloat16) * 0.05)(B, S, Dm)), 'mem0': _w((lambda *s: torch.randn(*s, dtype=torch.bfloat16) * 0.4)(B, M, Dm)), 'Wq': _w((lambda *s: torch.randn(*s, dtype=torch.bfloat16) * 3.2)(Dm, H, Dh) * Dm ** (-0.5)), 'Wk': _w((lambda *s: torch.randn(*s, dtype=torch.bfloat16) * 3.2)(Dm, H, Dh) * Dm ** (-0.5)), 'Wv': _w((lambda *s: torch.randn(*s, dtype=torch.bfloat16) * 0.4)(Dm, H, Dh) * Dm ** (-0.5)), 'Wo': _w((lambda *s: torch.randn(*s, dtype=torch.bfloat16) * 0.4)(H, Dh, Dm) * (H * Dh) ** (-0.5)), 'seg_len': seg}
    _A_in = _A_setup()

    def _B_setup():
        B, S, D, F = (1, 2048, 640, 1536)
        return {'x': _w((lambda *s: torch.randn(*s, dtype=torch.bfloat16) * 0.05)(B, S, D)), 'w1': _w((lambda *s: torch.randn(*s, dtype=torch.bfloat16) * 0.05)(D, F)), 'b1': _w((lambda *s: torch.randn(*s, dtype=torch.bfloat16) * 0.4)(F)), 'w2': _w((lambda *s: torch.randn(*s, dtype=torch.bfloat16) * 0.05)(F, D)), 'b2': _w((lambda *s: torch.randn(*s, dtype=torch.bfloat16) * 3.2)(D))}
    _B_in = _B_setup()
    return {'A_x': _A_in['x'], 'A_mem0': _A_in['mem0'], 'A_Wq': _A_in['Wq'], 'A_Wk': _A_in['Wk'], 'A_Wv': _A_in['Wv'], 'A_Wo': _A_in['Wo'], 'A_seg_len': _A_in['seg_len'], 'B_x': _B_in['x'], 'B_w1': _B_in['w1'], 'B_b1': _B_in['b1'], 'B_w2': _B_in['w2'], 'B_b2': _B_in['b2'], 'c': _w((lambda *s: torch.randn(*s, dtype=torch.bfloat16) * 0.1)(1, 640) * 8.0), 'w_mod': _w((lambda *s: torch.randn(*s, dtype=torch.bfloat16) * 0.1)(640, 6 * 640) * 640 ** (-0.5) * 8.0)}

def reference(A_x, A_mem0, A_Wq, A_Wk, A_Wv, A_Wo, A_seg_len, B_x, B_w1, B_b1, B_w2, B_b2, c, w_mod):

    def _A_ref(x, mem0, Wq, Wk, Wv, Wo, seg_len):
        B, S, Dm = x.shape
        H, Dh = (Wq.shape[1], Wq.shape[2])
        M = mem0.shape[1]
        scale = Dh ** (-0.5)
        n_seg = S // seg_len
        L = M + seg_len
        idx = torch.arange(L)
        mask = (idx[:, None] < M) | (idx[:, None] >= idx[None, :])
        mem = mem0
        outs = []
        for s in range(n_seg):
            xs = x[:, s * seg_len:(s + 1) * seg_len, :].clone()
            h = torch.concatenate([mem, xs], axis=1)
            q = torch.einsum('btd,dhe->bhte', h, Wq)
            k = torch.einsum('btd,dhe->bhte', h, Wk)
            v = torch.einsum('btd,dhe->bhte', h, Wv)
            scores = torch.einsum('bhqe,bhke->bhqk', q, k) * scale
            scores = torch.where(mask[None, None], scores, -1000000000.0)
            p = _softmax(scores, axis=-1)
            o = torch.einsum('bhqk,bhke->bhqe', p, v)
            o = torch.einsum('bhte,hed->btd', o, Wo)
            mem = o[:, :M, :].clone()
            outs.append(o[:, M:, :])
        return torch.concatenate(outs, axis=1)

    def _B_ref(x, w1, b1, w2, b2):
        h = torch.einsum('bsd,df->bsf', x, w1) + b1
        zero = torch.zeros_like(h)
        r = torch.where(h > zero, h, zero)
        h = r * r
        out = torch.einsum('bsf,fd->bsd', h, w2) + b2
        return out
    x = A_x
    mod = (_silu(c) @ w_mod).reshape(c.shape[0], 6, 1, -1)
    sa, ca, ga, sb, cb, gb = (mod[:, 0].clone(), mod[:, 1].clone(), mod[:, 2].clone(), mod[:, 3].clone(), mod[:, 4].clone(), mod[:, 5].clone())
    h = _layernorm(x, axis=-1) * (1 + ca) + sa
    x = x + ga * _A_ref(h, A_mem0, A_Wq, A_Wk, A_Wv, A_Wo, A_seg_len)
    h = _layernorm(x, axis=-1) * (1 + cb) + sb
    x = x + gb * _B_ref(h, B_w1, B_b1, B_w2, B_b2)
    return x
```

```asm
; @launch kernel=k_prep_kernel grid=(544,1,1) block=(256,1,1) lds=8192
; @launch kernel=k_chain_kernel grid=(256,1,1) block=(256,1,1) lds=106496
.amdgcn_target "amdgcn-amd-amdhsa--gfx950"
.text
.globl k_prep_kernel
.p2align 8
.type k_prep_kernel,@function
k_prep_kernel:
    s_cmp_ge_u32 s2, 544
    s_cbranch_scc1 L_prep_end
    s_cmp_lt_u32 s2, 60
    s_cbranch_scc1 L_mod
    s_cmp_lt_u32 s2, 92
    s_cbranch_scc1 L_prep_ln
    s_load_dwordx2 s[4:5], s[0:1], 128
    s_load_dwordx2 s[8:9], s[0:1], 16
    s_load_dwordx2 s[12:13], s[0:1], 24
    s_load_dwordx2 s[16:17], s[0:1], 32
    s_load_dwordx2 s[20:21], s[0:1], 40
    s_load_dwordx2 s[24:25], s[0:1], 64
    s_load_dwordx2 s[28:29], s[0:1], 80
    s_load_dwordx2 s[32:33], s[0:1], 8
    s_waitcnt lgkmcnt(0)
    s_and_b32 s5, s5, 0xffff
    s_mov_b32 s6, 268435456
    s_mov_b32 s7, 0x00020000
    s_and_b32 s9, s9, 0xffff
    s_mov_b32 s10, 7864320
    s_mov_b32 s11, 0x00020000
    s_and_b32 s13, s13, 0xffff
    s_mov_b32 s14, 7864320
    s_mov_b32 s15, 0x00020000
    s_and_b32 s17, s17, 0xffff
    s_mov_b32 s18, 7864320
    s_mov_b32 s19, 0x00020000
    s_and_b32 s21, s21, 0xffff
    s_mov_b32 s22, 7864320
    s_mov_b32 s23, 0x00020000
    s_and_b32 s25, s25, 0xffff
    s_mov_b32 s26, 1966080
    s_mov_b32 s27, 0x00020000
    s_and_b32 s29, s29, 0xffff
    s_mov_b32 s30, 1966080
    s_mov_b32 s31, 0x00020000
    s_and_b32 s33, s33, 0xffff
    s_mov_b32 s34, 10240
    s_mov_b32 s35, 0x00020000
    v_lshrrev_b32 v1, 6, v0
    v_and_b32 v2, 63, v0
    s_nop 0
    v_readfirstlane_b32 s40, v1
    s_sub_u32 s41, s2, 92
    s_lshl_b32 s41, s41, 2
    s_add_u32 s40, s40, s41
    v_and_b32 v3, 15, v2
    v_lshrrev_b32 v4, 4, v2
    v_lshlrev_b32 v5, 4, v2
    v_lshlrev_b32 v3, 1, v3
    s_mov_b32 s42, 12288
    v_lshlrev_b32 v6, 3, v4
    v_add_u32 v6, 0, v6
    v_mul_lo_u32 v6, v6, s42
    v_add_u32 v8, v6, v3
    v_lshlrev_b32 v6, 3, v4
    v_add_u32 v6, 1, v6
    v_mul_lo_u32 v6, v6, s42
    v_add_u32 v9, v6, v3
    v_lshlrev_b32 v6, 3, v4
    v_add_u32 v6, 2, v6
    v_mul_lo_u32 v6, v6, s42
    v_add_u32 v10, v6, v3
    v_lshlrev_b32 v6, 3, v4
    v_add_u32 v6, 3, v6
    v_mul_lo_u32 v6, v6, s42
    v_add_u32 v11, v6, v3
    v_lshlrev_b32 v6, 3, v4
    v_add_u32 v6, 4, v6
    v_mul_lo_u32 v6, v6, s42
    v_add_u32 v12, v6, v3
    v_lshlrev_b32 v6, 3, v4
    v_add_u32 v6, 5, v6
    v_mul_lo_u32 v6, v6, s42
    v_add_u32 v13, v6, v3
    v_lshlrev_b32 v6, 3, v4
    v_add_u32 v6, 6, v6
    v_mul_lo_u32 v6, v6, s42
    v_add_u32 v14, v6, v3
    v_lshlrev_b32 v6, 3, v4
    v_add_u32 v6, 7, v6
    v_mul_lo_u32 v6, v6, s42
    v_add_u32 v15, v6, v3
    s_add_u32 s43, s40, 0
    s_cmp_ge_u32 s43, 1808
    s_cselect_b32 s44, 1808, 0
    s_sub_u32 s43, s43, s44
L_prep_loop0:
    s_cmp_ge_u32 s43, 1920
    s_cbranch_scc1 L_prep_done0
    s_mov_b32 s45, 0
    s_mov_b32 s46, s43
    s_mul_hi_u32 s47, s46, 214748365
    s_mul_i32 s48, s47, 20
    s_sub_u32 s48, s46, s48
    s_mul_i32 s49, s45, 0
    s_mul_i32 s50, s48, 393216
    s_add_u32 s49, s49, s50
    s_lshl_b32 s50, s47, 7
    s_add_u32 s49, s49, s50
    s_mul_i32 s50, s45, 7680
    s_mul_i32 s51, s47, 80
    s_add_u32 s50, s50, s51
    s_add_u32 s50, s50, s48
    s_lshl_b32 s50, s50, 10
    s_add_u32 s50, s50, 4673536
    buffer_load_ushort v32, v8, s[8:11], s49 offen offset:0
    buffer_load_ushort v33, v9, s[8:11], s49 offen offset:0
    buffer_load_ushort v34, v10, s[8:11], s49 offen offset:0
    buffer_load_ushort v35, v11, s[8:11], s49 offen offset:0
    buffer_load_ushort v36, v12, s[8:11], s49 offen offset:0
    buffer_load_ushort v37, v13, s[8:11], s49 offen offset:0
    buffer_load_ushort v38, v14, s[8:11], s49 offen offset:0
    buffer_load_ushort v39, v15, s[8:11], s49 offen offset:0
    buffer_load_ushort v40, v8, s[8:11], s49 offen offset:32
    buffer_load_ushort v41, v9, s[8:11], s49 offen offset:32
    buffer_load_ushort v42, v10, s[8:11], s49 offen offset:32
    buffer_load_ushort v43, v11, s[8:11], s49 offen offset:32
    buffer_load_ushort v44, v12, s[8:11], s49 offen offset:32
    buffer_load_ushort v45, v13, s[8:11], s49 offen offset:32
    buffer_load_ushort v46, v14, s[8:11], s49 offen offset:32
    buffer_load_ushort v47, v15, s[8:11], s49 offen offset:32
    buffer_load_ushort v48, v8, s[8:11], s49 offen offset:64
    buffer_load_ushort v49, v9, s[8:11], s49 offen offset:64
    buffer_load_ushort v50, v10, s[8:11], s49 offen offset:64
    buffer_load_ushort v51, v11, s[8:11], s49 offen offset:64
    buffer_load_ushort v52, v12, s[8:11], s49 offen offset:64
    buffer_load_ushort v53, v13, s[8:11], s49 offen offset:64
    buffer_load_ushort v54, v14, s[8:11], s49 offen offset:64
    buffer_load_ushort v55, v15, s[8:11], s49 offen offset:64
    buffer_load_ushort v56, v8, s[8:11], s49 offen offset:96
    buffer_load_ushort v57, v9, s[8:11], s49 offen offset:96
    buffer_load_ushort v58, v10, s[8:11], s49 offen offset:96
    buffer_load_ushort v59, v11, s[8:11], s49 offen offset:96
    buffer_load_ushort v60, v12, s[8:11], s49 offen offset:96
    buffer_load_ushort v61, v13, s[8:11], s49 offen offset:96
    buffer_load_ushort v62, v14, s[8:11], s49 offen offset:96
    buffer_load_ushort v63, v15, s[8:11], s49 offen offset:96
    s_waitcnt vmcnt(0)
    v_lshl_or_b32 v16, v33, 16, v32
    v_lshl_or_b32 v17, v35, 16, v34
    v_lshl_or_b32 v18, v37, 16, v36
    v_lshl_or_b32 v19, v39, 16, v38
    v_lshl_or_b32 v20, v41, 16, v40
    v_lshl_or_b32 v21, v43, 16, v42
    v_lshl_or_b32 v22, v45, 16, v44
    v_lshl_or_b32 v23, v47, 16, v46
    v_lshl_or_b32 v24, v49, 16, v48
    v_lshl_or_b32 v25, v51, 16, v50
    v_lshl_or_b32 v26, v53, 16, v52
    v_lshl_or_b32 v27, v55, 16, v54
    v_lshl_or_b32 v28, v57, 16, v56
    v_lshl_or_b32 v29, v59, 16, v58
    v_lshl_or_b32 v30, v61, 16, v60
    v_lshl_or_b32 v31, v63, 16, v62
    buffer_store_dwordx4 v[16:19], v5, s[4:7], s50 offen
    s_add_u32 s50, s50, 20480
    buffer_store_dwordx4 v[20:23], v5, s[4:7], s50 offen
    s_add_u32 s50, s50, 20480
    buffer_store_dwordx4 v[24:27], v5, s[4:7], s50 offen
    s_add_u32 s50, s50, 20480
    buffer_store_dwordx4 v[28:31], v5, s[4:7], s50 offen
    s_add_u32 s43, s43, 1808
    s_branch L_prep_loop0
L_prep_done0:
    s_mov_b32 s42, 12288
    v_lshlrev_b32 v6, 3, v4
    v_add_u32 v6, 0, v6
    v_mul_lo_u32 v6, v6, s42
    v_add_u32 v8, v6, v3
    v_lshlrev_b32 v6, 3, v4
    v_add_u32 v6, 1, v6
    v_mul_lo_u32 v6, v6, s42
    v_add_u32 v9, v6, v3
    v_lshlrev_b32 v6, 3, v4
    v_add_u32 v6, 2, v6
    v_mul_lo_u32 v6, v6, s42
    v_add_u32 v10, v6, v3
    v_lshlrev_b32 v6, 3, v4
    v_add_u32 v6, 3, v6
    v_mul_lo_u32 v6, v6, s42
    v_add_u32 v11, v6, v3
    v_lshlrev_b32 v6, 3, v4
    v_add_u32 v6, 4, v6
    v_mul_lo_u32 v6, v6, s42
    v_add_u32 v12, v6, v3
    v_lshlrev_b32 v6, 3, v4
    v_add_u32 v6, 5, v6
    v_mul_lo_u32 v6, v6, s42
    v_add_u32 v13, v6, v3
    v_lshlrev_b32 v6, 3, v4
    v_add_u32 v6, 6, v6
    v_mul_lo_u32 v6, v6, s42
    v_add_u32 v14, v6, v3
    v_lshlrev_b32 v6, 3, v4
    v_add_u32 v6, 7, v6
    v_mul_lo_u32 v6, v6, s42
    v_add_u32 v15, v6, v3
    s_add_u32 s43, s40, 701
    s_cmp_ge_u32 s43, 1808
    s_cselect_b32 s44, 1808, 0
    s_sub_u32 s43, s43, s44
L_prep_loop1:
    s_cmp_ge_u32 s43, 1920
    s_cbranch_scc1 L_prep_done1
    s_mov_b32 s45, 0
    s_mov_b32 s46, s43
    s_mul_hi_u32 s47, s46, 214748365
    s_mul_i32 s48, s47, 20
    s_sub_u32 s48, s46, s48
    s_mul_i32 s49, s45, 0
    s_mul_i32 s50, s48, 393216
    s_add_u32 s49, s49, s50
    s_lshl_b32 s50, s47, 7
    s_add_u32 s49, s49, s50
    s_mul_i32 s50, s45, 7680
    s_mul_i32 s51, s47, 80
    s_add_u32 s50, s50, s51
    s_add_u32 s50, s50, s48
    s_lshl_b32 s50, s50, 10
    s_add_u32 s50, s50, 12537856
    buffer_load_ushort v32, v8, s[12:15], s49 offen offset:0
    buffer_load_ushort v33, v9, s[12:15], s49 offen offset:0
    buffer_load_ushort v34, v10, s[12:15], s49 offen offset:0
    buffer_load_ushort v35, v11, s[12:15], s49 offen offset:0
    buffer_load_ushort v36, v12, s[12:15], s49 offen offset:0
    buffer_load_ushort v37, v13, s[12:15], s49 offen offset:0
    buffer_load_ushort v38, v14, s[12:15], s49 offen offset:0
    buffer_load_ushort v39, v15, s[12:15], s49 offen offset:0
    buffer_load_ushort v40, v8, s[12:15], s49 offen offset:32
    buffer_load_ushort v41, v9, s[12:15], s49 offen offset:32
    buffer_load_ushort v42, v10, s[12:15], s49 offen offset:32
    buffer_load_ushort v43, v11, s[12:15], s49 offen offset:32
    buffer_load_ushort v44, v12, s[12:15], s49 offen offset:32
    buffer_load_ushort v45, v13, s[12:15], s49 offen offset:32
    buffer_load_ushort v46, v14, s[12:15], s49 offen offset:32
    buffer_load_ushort v47, v15, s[12:15], s49 offen offset:32
    buffer_load_ushort v48, v8, s[12:15], s49 offen offset:64
    buffer_load_ushort v49, v9, s[12:15], s49 offen offset:64
    buffer_load_ushort v50, v10, s[12:15], s49 offen offset:64
    buffer_load_ushort v51, v11, s[12:15], s49 offen offset:64
    buffer_load_ushort v52, v12, s[12:15], s49 offen offset:64
    buffer_load_ushort v53, v13, s[12:15], s49 offen offset:64
    buffer_load_ushort v54, v14, s[12:15], s49 offen offset:64
    buffer_load_ushort v55, v15, s[12:15], s49 offen offset:64
    buffer_load_ushort v56, v8, s[12:15], s49 offen offset:96
    buffer_load_ushort v57, v9, s[12:15], s49 offen offset:96
    buffer_load_ushort v58, v10, s[12:15], s49 offen offset:96
    buffer_load_ushort v59, v11, s[12:15], s49 offen offset:96
    buffer_load_ushort v60, v12, s[12:15], s49 offen offset:96
    buffer_load_ushort v61, v13, s[12:15], s49 offen offset:96
    buffer_load_ushort v62, v14, s[12:15], s49 offen offset:96
    buffer_load_ushort v63, v15, s[12:15], s49 offen offset:96
    s_waitcnt vmcnt(0)
    v_lshl_or_b32 v16, v33, 16, v32
    v_lshl_or_b32 v17, v35, 16, v34
    v_lshl_or_b32 v18, v37, 16, v36
    v_lshl_or_b32 v19, v39, 16, v38
    v_lshl_or_b32 v20, v41, 16, v40
    v_lshl_or_b32 v21, v43, 16, v42
    v_lshl_or_b32 v22, v45, 16, v44
    v_lshl_or_b32 v23, v47, 16, v46
    v_lshl_or_b32 v24, v49, 16, v48
    v_lshl_or_b32 v25, v51, 16, v50
    v_lshl_or_b32 v26, v53, 16, v52
    v_lshl_or_b32 v27, v55, 16, v54
    v_lshl_or_b32 v28, v57, 16, v56
    v_lshl_or_b32 v29, v59, 16, v58
    v_lshl_or_b32 v30, v61, 16, v60
    v_lshl_or_b32 v31, v63, 16, v62
    buffer_store_dwordx4 v[16:19], v5, s[4:7], s50 offen
    s_add_u32 s50, s50, 20480
    buffer_store_dwordx4 v[20:23], v5, s[4:7], s50 offen
    s_add_u32 s50, s50, 20480
    buffer_store_dwordx4 v[24:27], v5, s[4:7], s50 offen
    s_add_u32 s50, s50, 20480
    buffer_store_dwordx4 v[28:31], v5, s[4:7], s50 offen
    s_add_u32 s43, s43, 1808
    s_branch L_prep_loop1
L_prep_done1:
    s_mov_b32 s42, 12288
    v_lshlrev_b32 v6, 3, v4
    v_add_u32 v6, 0, v6
    v_mul_lo_u32 v6, v6, s42
    v_add_u32 v8, v6, v3
    v_lshlrev_b32 v6, 3, v4
    v_add_u32 v6, 1, v6
    v_mul_lo_u32 v6, v6, s42
    v_add_u32 v9, v6, v3
    v_lshlrev_b32 v6, 3, v4
    v_add_u32 v6, 2, v6
    v_mul_lo_u32 v6, v6, s42
    v_add_u32 v10, v6, v3
    v_lshlrev_b32 v6, 3, v4
    v_add_u32 v6, 3, v6
    v_mul_lo_u32 v6, v6, s42
    v_add_u32 v11, v6, v3
    v_lshlrev_b32 v6, 3, v4
    v_add_u32 v6, 4, v6
    v_mul_lo_u32 v6, v6, s42
    v_add_u32 v12, v6, v3
    v_lshlrev_b32 v6, 3, v4
    v_add_u32 v6, 5, v6
    v_mul_lo_u32 v6, v6, s42
    v_add_u32 v13, v6, v3
    v_lshlrev_b32 v6, 3, v4
    v_add_u32 v6, 6, v6
    v_mul_lo_u32 v6, v6, s42
    v_add_u32 v14, v6, v3
    v_lshlrev_b32 v6, 3, v4
    v_add_u32 v6, 7, v6
    v_mul_lo_u32 v6, v6, s42
    v_add_u32 v15, v6, v3
    s_add_u32 s43, s40, 1402
    s_cmp_ge_u32 s43, 1808
    s_cselect_b32 s44, 1808, 0
    s_sub_u32 s43, s43, s44
L_prep_loop2:
    s_cmp_ge_u32 s43, 1920
    s_cbranch_scc1 L_prep_done2
    s_mov_b32 s45, 0
    s_mov_b32 s46, s43
    s_mul_hi_u32 s47, s46, 214748365
    s_mul_i32 s48, s47, 20
    s_sub_u32 s48, s46, s48
    s_mul_i32 s49, s45, 0
    s_mul_i32 s50, s48, 393216
    s_add_u32 s49, s49, s50
    s_lshl_b32 s50, s47, 7
    s_add_u32 s49, s49, s50
    s_mul_i32 s50, s45, 7680
    s_mul_i32 s51, s47, 80
    s_add_u32 s50, s50, s51
    s_add_u32 s50, s50, s48
    s_lshl_b32 s50, s50, 10
    s_add_u32 s50, s50, 20402176
    buffer_load_ushort v32, v8, s[16:19], s49 offen offset:0
    buffer_load_ushort v33, v9, s[16:19], s49 offen offset:0
    buffer_load_ushort v34, v10, s[16:19], s49 offen offset:0
    buffer_load_ushort v35, v11, s[16:19], s49 offen offset:0
    buffer_load_ushort v36, v12, s[16:19], s49 offen offset:0
    buffer_load_ushort v37, v13, s[16:19], s49 offen offset:0
    buffer_load_ushort v38, v14, s[16:19], s49 offen offset:0
    buffer_load_ushort v39, v15, s[16:19], s49 offen offset:0
    buffer_load_ushort v40, v8, s[16:19], s49 offen offset:32
    buffer_load_ushort v41, v9, s[16:19], s49 offen offset:32
    buffer_load_ushort v42, v10, s[16:19], s49 offen offset:32
    buffer_load_ushort v43, v11, s[16:19], s49 offen offset:32
    buffer_load_ushort v44, v12, s[16:19], s49 offen offset:32
    buffer_load_ushort v45, v13, s[16:19], s49 offen offset:32
    buffer_load_ushort v46, v14, s[16:19], s49 offen offset:32
    buffer_load_ushort v47, v15, s[16:19], s49 offen offset:32
    buffer_load_ushort v48, v8, s[16:19], s49 offen offset:64
    buffer_load_ushort v49, v9, s[16:19], s49 offen offset:64
    buffer_load_ushort v50, v10, s[16:19], s49 offen offset:64
    buffer_load_ushort v51, v11, s[16:19], s49 offen offset:64
    buffer_load_ushort v52, v12, s[16:19], s49 offen offset:64
    buffer_load_ushort v53, v13, s[16:19], s49 offen offset:64
    buffer_load_ushort v54, v14, s[16:19], s49 offen offset:64
    buffer_load_ushort v55, v15, s[16:19], s49 offen offset:64
    buffer_load_ushort v56, v8, s[16:19], s49 offen offset:96
    buffer_load_ushort v57, v9, s[16:19], s49 offen offset:96
    buffer_load_ushort v58, v10, s[16:19], s49 offen offset:96
    buffer_load_ushort v59, v11, s[16:19], s49 offen offset:96
    buffer_load_ushort v60, v12, s[16:19], s49 offen offset:96
    buffer_load_ushort v61, v13, s[16:19], s49 offen offset:96
    buffer_load_ushort v62, v14, s[16:19], s49 offen offset:96
    buffer_load_ushort v63, v15, s[16:19], s49 offen offset:96
    s_waitcnt vmcnt(0)
    v_lshl_or_b32 v16, v33, 16, v32
    v_lshl_or_b32 v17, v35, 16, v34
    v_lshl_or_b32 v18, v37, 16, v36
    v_lshl_or_b32 v19, v39, 16, v38
    v_lshl_or_b32 v20, v41, 16, v40
    v_lshl_or_b32 v21, v43, 16, v42
    v_lshl_or_b32 v22, v45, 16, v44
    v_lshl_or_b32 v23, v47, 16, v46
    v_lshl_or_b32 v24, v49, 16, v48
    v_lshl_or_b32 v25, v51, 16, v50
    v_lshl_or_b32 v26, v53, 16, v52
    v_lshl_or_b32 v27, v55, 16, v54
    v_lshl_or_b32 v28, v57, 16, v56
    v_lshl_or_b32 v29, v59, 16, v58
    v_lshl_or_b32 v30, v61, 16, v60
    v_lshl_or_b32 v31, v63, 16, v62
    buffer_store_dwordx4 v[16:19], v5, s[4:7], s50 offen
    s_add_u32 s50, s50, 20480
    buffer_store_dwordx4 v[20:23], v5, s[4:7], s50 offen
    s_add_u32 s50, s50, 20480
    buffer_store_dwordx4 v[24:27], v5, s[4:7], s50 offen
    s_add_u32 s50, s50, 20480
    buffer_store_dwordx4 v[28:31], v5, s[4:7], s50 offen
    s_add_u32 s43, s43, 1808
    s_branch L_prep_loop2
L_prep_done2:
    s_mov_b32 s42, 1280
    v_lshlrev_b32 v6, 2, v4
    v_add_u32 v6, 0, v6
    v_mul_lo_u32 v6, v6, s42
    v_add_u32 v8, v6, v3
    v_lshlrev_b32 v6, 2, v4
    v_add_u32 v6, 1, v6
    v_mul_lo_u32 v6, v6, s42
    v_add_u32 v9, v6, v3
    v_lshlrev_b32 v6, 2, v4
    v_add_u32 v6, 2, v6
    v_mul_lo_u32 v6, v6, s42
    v_add_u32 v10, v6, v3
    v_lshlrev_b32 v6, 2, v4
    v_add_u32 v6, 3, v6
    v_mul_lo_u32 v6, v6, s42
    v_add_u32 v11, v6, v3
    v_lshlrev_b32 v6, 2, v4
    v_add_u32 v6, 16, v6
    v_mul_lo_u32 v6, v6, s42
    v_add_u32 v12, v6, v3
    v_lshlrev_b32 v6, 2, v4
    v_add_u32 v6, 17, v6
    v_mul_lo_u32 v6, v6, s42
    v_add_u32 v13, v6, v3
    v_lshlrev_b32 v6, 2, v4
    v_add_u32 v6, 18, v6
    v_mul_lo_u32 v6, v6, s42
    v_add_u32 v14, v6, v3
    v_lshlrev_b32 v6, 2, v4
    v_add_u32 v6, 19, v6
    v_mul_lo_u32 v6, v6, s42
    v_add_u32 v15, v6, v3
    s_add_u32 s43, s40, 295
    s_cmp_ge_u32 s43, 1808
    s_cselect_b32 s44, 1808, 0
    s_sub_u32 s43, s43, s44
L_prep_loop3:
    s_cmp_ge_u32 s43, 1920
    s_cbranch_scc1 L_prep_done3
    s_mul_hi_u32 s45, s43, 71582789
    s_mul_i32 s46, s45, 60
    s_sub_u32 s46, s43, s46
    s_mul_hi_u32 s47, s46, 715827883
    s_mul_i32 s48, s47, 6
    s_sub_u32 s48, s46, s48
    s_mul_i32 s49, s45, 245760
    s_mul_i32 s50, s48, 40960
    s_add_u32 s49, s49, s50
    s_lshl_b32 s50, s47, 7
    s_add_u32 s49, s49, s50
    s_mul_i32 s50, s45, 240
    s_mul_i32 s51, s47, 24
    s_add_u32 s50, s50, s51
    s_add_u32 s50, s50, s48
    s_lshl_b32 s50, s50, 10
    s_add_u32 s50, s50, 28266496
    buffer_load_ushort v32, v8, s[20:23], s49 offen offset:0
    buffer_load_ushort v33, v9, s[20:23], s49 offen offset:0
    buffer_load_ushort v34, v10, s[20:23], s49 offen offset:0
    buffer_load_ushort v35, v11, s[20:23], s49 offen offset:0
    buffer_load_ushort v36, v12, s[20:23], s49 offen offset:0
    buffer_load_ushort v37, v13, s[20:23], s49 offen offset:0
    buffer_load_ushort v38, v14, s[20:23], s49 offen offset:0
    buffer_load_ushort v39, v15, s[20:23], s49 offen offset:0
    buffer_load_ushort v40, v8, s[20:23], s49 offen offset:32
    buffer_load_ushort v41, v9, s[20:23], s49 offen offset:32
    buffer_load_ushort v42, v10, s[20:23], s49 offen offset:32
    buffer_load_ushort v43, v11, s[20:23], s49 offen offset:32
    buffer_load_ushort v44, v12, s[20:23], s49 offen offset:32
    buffer_load_ushort v45, v13, s[20:23], s49 offen offset:32
    buffer_load_ushort v46, v14, s[20:23], s49 offen offset:32
    buffer_load_ushort v47, v15, s[20:23], s49 offen offset:32
    buffer_load_ushort v48, v8, s[20:23], s49 offen offset:64
    buffer_load_ushort v49, v9, s[20:23], s49 offen offset:64
    buffer_load_ushort v50, v10, s[20:23], s49 offen offset:64
    buffer_load_ushort v51, v11, s[20:23], s49 offen offset:64
    buffer_load_ushort v52, v12, s[20:23], s49 offen offset:64
    buffer_load_ushort v53, v13, s[20:23], s49 offen offset:64
    buffer_load_ushort v54, v14, s[20:23], s49 offen offset:64
    buffer_load_ushort v55, v15, s[20:23], s49 offen offset:64
    buffer_load_ushort v56, v8, s[20:23], s49 offen offset:96
    buffer_load_ushort v57, v9, s[20:23], s49 offen offset:96
    buffer_load_ushort v58, v10, s[20:23], s49 offen offset:96
    buffer_load_ushort v59, v11, s[20:23], s49 offen offset:96
    buffer_load_ushort v60, v12, s[20:23], s49 offen offset:96
    buffer_load_ushort v61, v13, s[20:23], s49 offen offset:96
    buffer_load_ushort v62, v14, s[20:23], s49 offen offset:96
    buffer_load_ushort v63, v15, s[20:23], s49 offen offset:96
    s_waitcnt vmcnt(0)
    v_lshl_or_b32 v16, v33, 16, v32
    v_lshl_or_b32 v17, v35, 16, v34
    v_lshl_or_b32 v18, v37, 16, v36
    v_lshl_or_b32 v19, v39, 16, v38
    v_lshl_or_b32 v20, v41, 16, v40
    v_lshl_or_b32 v21, v43, 16, v42
    v_lshl_or_b32 v22, v45, 16, v44
    v_lshl_or_b32 v23, v47, 16, v46
    v_lshl_or_b32 v24, v49, 16, v48
    v_lshl_or_b32 v25, v51, 16, v50
    v_lshl_or_b32 v26, v53, 16, v52
    v_lshl_or_b32 v27, v55, 16, v54
    v_lshl_or_b32 v28, v57, 16, v56
    v_lshl_or_b32 v29, v59, 16, v58
    v_lshl_or_b32 v30, v61, 16, v60
    v_lshl_or_b32 v31, v63, 16, v62
    buffer_store_dwordx4 v[16:19], v5, s[4:7], s50 offen
    s_add_u32 s50, s50, 6144
    buffer_store_dwordx4 v[20:23], v5, s[4:7], s50 offen
    s_add_u32 s50, s50, 6144
    buffer_store_dwordx4 v[24:27], v5, s[4:7], s50 offen
    s_add_u32 s50, s50, 6144
    buffer_store_dwordx4 v[28:31], v5, s[4:7], s50 offen
    s_add_u32 s43, s43, 1808
    s_branch L_prep_loop3
L_prep_done3:
    s_mov_b32 s42, 3072
    v_lshlrev_b32 v6, 3, v4
    v_add_u32 v6, 0, v6
    v_mul_lo_u32 v6, v6, s42
    v_add_u32 v8, v6, v3
    v_lshlrev_b32 v6, 3, v4
    v_add_u32 v6, 1, v6
    v_mul_lo_u32 v6, v6, s42
    v_add_u32 v9, v6, v3
    v_lshlrev_b32 v6, 3, v4
    v_add_u32 v6, 2, v6
    v_mul_lo_u32 v6, v6, s42
    v_add_u32 v10, v6, v3
    v_lshlrev_b32 v6, 3, v4
    v_add_u32 v6, 3, v6
    v_mul_lo_u32 v6, v6, s42
    v_add_u32 v11, v6, v3
    v_lshlrev_b32 v6, 3, v4
    v_add_u32 v6, 4, v6
    v_mul_lo_u32 v6, v6, s42
    v_add_u32 v12, v6, v3
    v_lshlrev_b32 v6, 3, v4
    v_add_u32 v6, 5, v6
    v_mul_lo_u32 v6, v6, s42
    v_add_u32 v13, v6, v3
    v_lshlrev_b32 v6, 3, v4
    v_add_u32 v6, 6, v6
    v_mul_lo_u32 v6, v6, s42
    v_add_u32 v14, v6, v3
    v_lshlrev_b32 v6, 3, v4
    v_add_u32 v6, 7, v6
    v_mul_lo_u32 v6, v6, s42
    v_add_u32 v15, v6, v3
    s_add_u32 s43, s40, 996
    s_cmp_ge_u32 s43, 1808
    s_cselect_b32 s44, 1808, 0
    s_sub_u32 s43, s43, s44
L_prep_loop4:
    s_cmp_ge_u32 s43, 480
    s_cbranch_scc1 L_prep_done4
    s_mov_b32 s45, 0
    s_mov_b32 s46, s43
    s_mul_hi_u32 s47, s46, 214748365
    s_mul_i32 s48, s47, 20
    s_sub_u32 s48, s46, s48
    s_mul_i32 s49, s45, 0
    s_mul_i32 s50, s48, 98304
    s_add_u32 s49, s49, s50
    s_lshl_b32 s50, s47, 7
    s_add_u32 s49, s49, s50
    s_mul_i32 s50, s45, 1920
    s_mul_i32 s51, s47, 80
    s_add_u32 s50, s50, s51
    s_add_u32 s50, s50, s48
    s_lshl_b32 s50, s50, 10
    s_add_u32 s50, s50, 36130816
    buffer_load_ushort v32, v8, s[24:27], s49 offen offset:0
    buffer_load_ushort v33, v9, s[24:27], s49 offen offset:0
    buffer_load_ushort v34, v10, s[24:27], s49 offen offset:0
    buffer_load_ushort v35, v11, s[24:27], s49 offen offset:0
    buffer_load_ushort v36, v12, s[24:27], s49 offen offset:0
    buffer_load_ushort v37, v13, s[24:27], s49 offen offset:0
    buffer_load_ushort v38, v14, s[24:27], s49 offen offset:0
    buffer_load_ushort v39, v15, s[24:27], s49 offen offset:0
    buffer_load_ushort v40, v8, s[24:27], s49 offen offset:32
    buffer_load_ushort v41, v9, s[24:27], s49 offen offset:32
    buffer_load_ushort v42, v10, s[24:27], s49 offen offset:32
    buffer_load_ushort v43, v11, s[24:27], s49 offen offset:32
    buffer_load_ushort v44, v12, s[24:27], s49 offen offset:32
    buffer_load_ushort v45, v13, s[24:27], s49 offen offset:32
    buffer_load_ushort v46, v14, s[24:27], s49 offen offset:32
    buffer_load_ushort v47, v15, s[24:27], s49 offen offset:32
    buffer_load_ushort v48, v8, s[24:27], s49 offen offset:64
    buffer_load_ushort v49, v9, s[24:27], s49 offen offset:64
    buffer_load_ushort v50, v10, s[24:27], s49 offen offset:64
    buffer_load_ushort v51, v11, s[24:27], s49 offen offset:64
    buffer_load_ushort v52, v12, s[24:27], s49 offen offset:64
    buffer_load_ushort v53, v13, s[24:27], s49 offen offset:64
    buffer_load_ushort v54, v14, s[24:27], s49 offen offset:64
    buffer_load_ushort v55, v15, s[24:27], s49 offen offset:64
    buffer_load_ushort v56, v8, s[24:27], s49 offen offset:96
    buffer_load_ushort v57, v9, s[24:27], s49 offen offset:96
    buffer_load_ushort v58, v10, s[24:27], s49 offen offset:96
    buffer_load_ushort v59, v11, s[24:27], s49 offen offset:96
    buffer_load_ushort v60, v12, s[24:27], s49 offen offset:96
    buffer_load_ushort v61, v13, s[24:27], s49 offen offset:96
    buffer_load_ushort v62, v14, s[24:27], s49 offen offset:96
    buffer_load_ushort v63, v15, s[24:27], s49 offen offset:96
    s_waitcnt vmcnt(0)
    v_lshl_or_b32 v16, v33, 16, v32
    v_lshl_or_b32 v17, v35, 16, v34
    v_lshl_or_b32 v18, v37, 16, v36
    v_lshl_or_b32 v19, v39, 16, v38
    v_lshl_or_b32 v20, v41, 16, v40
    v_lshl_or_b32 v21, v43, 16, v42
    v_lshl_or_b32 v22, v45, 16, v44
    v_lshl_or_b32 v23, v47, 16, v46
    v_lshl_or_b32 v24, v49, 16, v48
    v_lshl_or_b32 v25, v51, 16, v50
    v_lshl_or_b32 v26, v53, 16, v52
    v_lshl_or_b32 v27, v55, 16, v54
    v_lshl_or_b32 v28, v57, 16, v56
    v_lshl_or_b32 v29, v59, 16, v58
    v_lshl_or_b32 v30, v61, 16, v60
    v_lshl_or_b32 v31, v63, 16, v62
    buffer_store_dwordx4 v[16:19], v5, s[4:7], s50 offen
    s_add_u32 s50, s50, 20480
    buffer_store_dwordx4 v[20:23], v5, s[4:7], s50 offen
    s_add_u32 s50, s50, 20480
    buffer_store_dwordx4 v[24:27], v5, s[4:7], s50 offen
    s_add_u32 s50, s50, 20480
    buffer_store_dwordx4 v[28:31], v5, s[4:7], s50 offen
    s_add_u32 s43, s43, 1808
    s_branch L_prep_loop4
L_prep_done4:
    s_mov_b32 s42, 1280
    v_lshlrev_b32 v6, 2, v4
    v_add_u32 v6, 0, v6
    v_mul_lo_u32 v6, v6, s42
    v_add_u32 v8, v6, v3
    v_lshlrev_b32 v6, 2, v4
    v_add_u32 v6, 1, v6
    v_mul_lo_u32 v6, v6, s42
    v_add_u32 v9, v6, v3
    v_lshlrev_b32 v6, 2, v4
    v_add_u32 v6, 2, v6
    v_mul_lo_u32 v6, v6, s42
    v_add_u32 v10, v6, v3
    v_lshlrev_b32 v6, 2, v4
    v_add_u32 v6, 3, v6
    v_mul_lo_u32 v6, v6, s42
    v_add_u32 v11, v6, v3
    v_lshlrev_b32 v6, 2, v4
    v_add_u32 v6, 16, v6
    v_mul_lo_u32 v6, v6, s42
    v_add_u32 v12, v6, v3
    v_lshlrev_b32 v6, 2, v4
    v_add_u32 v6, 17, v6
    v_mul_lo_u32 v6, v6, s42
    v_add_u32 v13, v6, v3
    v_lshlrev_b32 v6, 2, v4
    v_add_u32 v6, 18, v6
    v_mul_lo_u32 v6, v6, s42
    v_add_u32 v14, v6, v3
    v_lshlrev_b32 v6, 2, v4
    v_add_u32 v6, 19, v6
    v_mul_lo_u32 v6, v6, s42
    v_add_u32 v15, v6, v3
    s_add_u32 s43, s40, 1697
    s_cmp_ge_u32 s43, 1808
    s_cselect_b32 s44, 1808, 0
    s_sub_u32 s43, s43, s44
L_prep_loop5:
    s_cmp_ge_u32 s43, 480
    s_cbranch_scc1 L_prep_done5
    s_mov_b32 s45, 0
    s_mov_b32 s46, s43
    s_mul_hi_u32 s47, s46, 89478486
    s_mul_i32 s48, s47, 48
    s_sub_u32 s48, s46, s48
    s_mul_i32 s49, s45, 0
    s_mul_i32 s50, s48, 40960
    s_add_u32 s49, s49, s50
    s_lshl_b32 s50, s47, 7
    s_add_u32 s49, s49, s50
    s_mul_i32 s50, s45, 1920
    s_mul_i32 s51, s47, 192
    s_add_u32 s50, s50, s51
    s_add_u32 s50, s50, s48
    s_lshl_b32 s50, s50, 10
    s_add_u32 s50, s50, 38096896
    buffer_load_ushort v32, v8, s[28:31], s49 offen offset:0
    buffer_load_ushort v33, v9, s[28:31], s49 offen offset:0
    buffer_load_ushort v34, v10, s[28:31], s49 offen offset:0
    buffer_load_ushort v35, v11, s[28:31], s49 offen offset:0
    buffer_load_ushort v36, v12, s[28:31], s49 offen offset:0
    buffer_load_ushort v37, v13, s[28:31], s49 offen offset:0
    buffer_load_ushort v38, v14, s[28:31], s49 offen offset:0
    buffer_load_ushort v39, v15, s[28:31], s49 offen offset:0
    buffer_load_ushort v40, v8, s[28:31], s49 offen offset:32
    buffer_load_ushort v41, v9, s[28:31], s49 offen offset:32
    buffer_load_ushort v42, v10, s[28:31], s49 offen offset:32
    buffer_load_ushort v43, v11, s[28:31], s49 offen offset:32
    buffer_load_ushort v44, v12, s[28:31], s49 offen offset:32
    buffer_load_ushort v45, v13, s[28:31], s49 offen offset:32
    buffer_load_ushort v46, v14, s[28:31], s49 offen offset:32
    buffer_load_ushort v47, v15, s[28:31], s49 offen offset:32
    buffer_load_ushort v48, v8, s[28:31], s49 offen offset:64
    buffer_load_ushort v49, v9, s[28:31], s49 offen offset:64
    buffer_load_ushort v50, v10, s[28:31], s49 offen offset:64
    buffer_load_ushort v51, v11, s[28:31], s49 offen offset:64
    buffer_load_ushort v52, v12, s[28:31], s49 offen offset:64
    buffer_load_ushort v53, v13, s[28:31], s49 offen offset:64
    buffer_load_ushort v54, v14, s[28:31], s49 offen offset:64
    buffer_load_ushort v55, v15, s[28:31], s49 offen offset:64
    buffer_load_ushort v56, v8, s[28:31], s49 offen offset:96
    buffer_load_ushort v57, v9, s[28:31], s49 offen offset:96
    buffer_load_ushort v58, v10, s[28:31], s49 offen offset:96
    buffer_load_ushort v59, v11, s[28:31], s49 offen offset:96
    buffer_load_ushort v60, v12, s[28:31], s49 offen offset:96
    buffer_load_ushort v61, v13, s[28:31], s49 offen offset:96
    buffer_load_ushort v62, v14, s[28:31], s49 offen offset:96
    buffer_load_ushort v63, v15, s[28:31], s49 offen offset:96
    s_waitcnt vmcnt(0)
    v_lshl_or_b32 v16, v33, 16, v32
    v_lshl_or_b32 v17, v35, 16, v34
    v_lshl_or_b32 v18, v37, 16, v36
    v_lshl_or_b32 v19, v39, 16, v38
    v_lshl_or_b32 v20, v41, 16, v40
    v_lshl_or_b32 v21, v43, 16, v42
    v_lshl_or_b32 v22, v45, 16, v44
    v_lshl_or_b32 v23, v47, 16, v46
    v_lshl_or_b32 v24, v49, 16, v48
    v_lshl_or_b32 v25, v51, 16, v50
    v_lshl_or_b32 v26, v53, 16, v52
    v_lshl_or_b32 v27, v55, 16, v54
    v_lshl_or_b32 v28, v57, 16, v56
    v_lshl_or_b32 v29, v59, 16, v58
    v_lshl_or_b32 v30, v61, 16, v60
    v_lshl_or_b32 v31, v63, 16, v62
    buffer_store_dwordx4 v[16:19], v5, s[4:7], s50 offen
    s_add_u32 s50, s50, 49152
    buffer_store_dwordx4 v[20:23], v5, s[4:7], s50 offen
    s_add_u32 s50, s50, 49152
    buffer_store_dwordx4 v[24:27], v5, s[4:7], s50 offen
    s_add_u32 s50, s50, 49152
    buffer_store_dwordx4 v[28:31], v5, s[4:7], s50 offen
    s_add_u32 s43, s43, 1808
    s_branch L_prep_loop5
L_prep_done5:
    v_mov_b32 v16, -1
    v_mov_b32 v17, -1
    v_mov_b32 v18, -1
    v_mov_b32 v19, -1
    s_mov_b32 s43, s40
L_fill_loop:
    s_cmp_ge_u32 s43, 1922
    s_cbranch_scc1 L_fill_done
    s_lshl_b32 s50, s43, 10
    s_add_u32 s50, s50, 18432
    buffer_store_dwordx4 v[16:19], v5, s[4:7], s50 offen
    s_add_u32 s43, s43, 1808
    s_branch L_fill_loop
L_fill_done:
    s_cmp_ge_u32 s40, 19
    s_cbranch_scc1 L_tf_done
    s_cmp_ge_u32 s40, 16
    s_cselect_b32 s50, 16, 40
    s_cmp_eq_u32 s40, 17
    s_cselect_b32 s50, 64, s50
    s_cmp_eq_u32 s40, 0
    s_cselect_b32 s50, 52, s50
    v_cmp_le_u32 vcc, s50, v2
    v_cndmask_b32 v20, 0, 1, vcc
    v_mov_b32 v21, v20
    v_lshlrev_b32 v22, 3, v2
    s_lshl_b32 s50, s40, 9
    s_add_u32 s50, s50, 2019328
    buffer_store_dwordx2 v[20:21], v22, s[4:7], s50 offen
L_tf_done:
    s_sub_u32 s43, s40, 32
    s_cmp_ge_u32 s43, 18
    s_cbranch_scc1 L_tf2_done
    v_mov_b32 v16, 0
    v_mov_b32 v17, 0
    v_mov_b32 v18, 0
    v_mov_b32 v19, 0
    s_lshl_b32 s50, s43, 10
    s_add_u32 s50, s50, 250826752
    buffer_store_dwordx4 v[16:19], v5, s[4:7], s50 offen
L_tf2_done:
    s_sub_u32 s43, s40, 64
    s_cmp_ge_u32 s43, 32
    s_cbranch_scc1 L_tf3_done
    v_mov_b32 v16, 0
    v_mov_b32 v17, 0
    v_mov_b32 v18, 0
    v_mov_b32 v19, 0
    s_lshl_b32 s50, s43, 10
    s_add_u32 s50, s50, 250859520
    buffer_store_dwordx4 v[16:19], v5, s[4:7], s50 offen
L_tf3_done:
    s_sub_u32 s43, s40, 1798
    s_cmp_ge_u32 s43, 10
    s_cbranch_scc1 L_prep_end
    s_lshl_b32 s50, s43, 6
    v_add_u32 v6, s50, v2
    v_and_b32 v7, 7, v6
    v_mul_u32_u24 v7, 1280, v7
    v_lshrrev_b32 v8, 3, v6
    v_lshlrev_b32 v8, 4, v8
    v_add_u32 v7, v7, v8
    v_lshlrev_b32 v6, 4, v6
    buffer_load_dwordx4 v[16:19], v7, s[32:35], 0 offen
    s_waitcnt vmcnt(0)
    s_mov_b32 s50, 8192
    buffer_store_dwordx4 v[16:19], v6, s[4:7], s50 offen
    s_branch L_prep_end
L_mod:
    s_load_dwordx2 s[4:5], s[0:1], 128
    s_load_dwordx2 s[8:9], s[0:1], 96
    s_load_dwordx2 s[12:13], s[0:1], 104
    s_load_dwordx2 s[24:25], s[0:1], 120
    s_waitcnt lgkmcnt(0)
    s_and_b32 s5, s5, 0xffff
    s_mov_b32 s6, 268435456
    s_mov_b32 s7, 0x00020000
    s_and_b32 s9, s9, 0xffff
    s_mov_b32 s10, 1280
    s_mov_b32 s11, 0x00020000
    s_and_b32 s13, s13, 0xffff
    s_mov_b32 s14, 4915200
    s_mov_b32 s15, 0x00020000
    s_and_b32 s25, s25, 0xffff
    s_mov_b32 s26, 256
    s_mov_b32 s27, 0x00020000
    v_lshrrev_b32 v1, 6, v0
    v_and_b32 v2, 63, v0
    v_and_b32 v3, 7, v2
    v_lshrrev_b32 v4, 3, v2
    v_mul_u32_u24 v5, 160, v1
    v_add_u32 v5, v5, v4
    v_lshlrev_b32 v6, 1, v5
    v_mul_u32_u24 v7, 7680, v5
    v_lshlrev_b32 v8, 4, v3
    v_add_u32 v7, v7, v8
    s_lshl_b32 s20, s2, 7
    buffer_load_ushort v20, v6, s[8:11], 0 offen offset:0
    buffer_load_ushort v21, v6, s[8:11], 0 offen offset:16
    buffer_load_ushort v22, v6, s[8:11], 0 offen offset:32
    buffer_load_ushort v23, v6, s[8:11], 0 offen offset:48
    buffer_load_ushort v24, v6, s[8:11], 0 offen offset:64
    buffer_load_ushort v25, v6, s[8:11], 0 offen offset:80
    buffer_load_ushort v26, v6, s[8:11], 0 offen offset:96
    buffer_load_ushort v27, v6, s[8:11], 0 offen offset:112
    buffer_load_ushort v28, v6, s[8:11], 0 offen offset:128
    buffer_load_ushort v29, v6, s[8:11], 0 offen offset:144
    buffer_load_ushort v30, v6, s[8:11], 0 offen offset:160
    buffer_load_ushort v31, v6, s[8:11], 0 offen offset:176
    buffer_load_ushort v32, v6, s[8:11], 0 offen offset:192
    buffer_load_ushort v33, v6, s[8:11], 0 offen offset:208
    buffer_load_ushort v34, v6, s[8:11], 0 offen offset:224
    buffer_load_ushort v35, v6, s[8:11], 0 offen offset:240
    buffer_load_ushort v36, v6, s[8:11], 0 offen offset:256
    buffer_load_ushort v37, v6, s[8:11], 0 offen offset:272
    buffer_load_ushort v38, v6, s[8:11], 0 offen offset:288
    buffer_load_ushort v39, v6, s[8:11], 0 offen offset:304
    v_add_u32 v7, s20, v7
    s_mov_b32 s21, 0
    buffer_load_dwordx4 v[40:43], v7, s[12:15], s21 offen
    s_mov_b32 s21, 61440
    buffer_load_dwordx4 v[44:47], v7, s[12:15], s21 offen
    s_mov_b32 s21, 122880
    buffer_load_dwordx4 v[48:51], v7, s[12:15], s21 offen
    s_mov_b32 s21, 184320
    buffer_load_dwordx4 v[52:55], v7, s[12:15], s21 offen
    s_mov_b32 s21, 245760
    buffer_load_dwordx4 v[56:59], v7, s[12:15], s21 offen
    s_mov_b32 s21, 307200
    buffer_load_dwordx4 v[60:63], v7, s[12:15], s21 offen
    s_mov_b32 s21, 368640
    buffer_load_dwordx4 v[64:67], v7, s[12:15], s21 offen
    s_mov_b32 s21, 430080
    buffer_load_dwordx4 v[68:71], v7, s[12:15], s21 offen
    s_mov_b32 s21, 491520
    buffer_load_dwordx4 v[72:75], v7, s[12:15], s21 offen
    s_mov_b32 s21, 552960
    buffer_load_dwordx4 v[76:79], v7, s[12:15], s21 offen
    s_mov_b32 s21, 614400
    buffer_load_dwordx4 v[80:83], v7, s[12:15], s21 offen
    s_mov_b32 s21, 675840
    buffer_load_dwordx4 v[84:87], v7, s[12:15], s21 offen
    s_mov_b32 s21, 737280
    buffer_load_dwordx4 v[88:91], v7, s[12:15], s21 offen
    s_mov_b32 s21, 798720
    buffer_load_dwordx4 v[92:95], v7, s[12:15], s21 offen
    s_mov_b32 s21, 860160
    buffer_load_dwordx4 v[96:99], v7, s[12:15], s21 offen
    s_mov_b32 s21, 921600
    buffer_load_dwordx4 v[100:103], v7, s[12:15], s21 offen
    s_mov_b32 s21, 983040
    buffer_load_dwordx4 v[104:107], v7, s[12:15], s21 offen
    s_mov_b32 s21, 1044480
    buffer_load_dwordx4 v[108:111], v7, s[12:15], s21 offen
    s_mov_b32 s21, 1105920
    buffer_load_dwordx4 v[112:115], v7, s[12:15], s21 offen
    s_mov_b32 s21, 1167360
    buffer_load_dwordx4 v[116:119], v7, s[12:15], s21 offen
    v_mov_b32 v10, 0
    v_mov_b32 v11, 0
    v_mov_b32 v12, 0
    v_mov_b32 v13, 0
    v_mov_b32 v14, 0
    v_mov_b32 v15, 0
    v_mov_b32 v16, 0
    v_mov_b32 v17, 0
    s_waitcnt vmcnt(20)
    v_lshlrev_b32 v20, 16, v20
    v_mul_f32 v18, 0xbfb8aa3b, v20
    v_exp_f32 v18, v18
    s_nop 0
    v_add_f32 v18, 1.0, v18
    v_rcp_f32 v18, v18
    s_nop 0
    v_mul_f32 v20, v20, v18
    v_cvt_pk_bf16_f32 v18, v20, v20
    v_lshlrev_b32 v20, 16, v18
    v_lshlrev_b32 v21, 16, v21
    v_mul_f32 v18, 0xbfb8aa3b, v21
    v_exp_f32 v18, v18
    s_nop 0
    v_add_f32 v18, 1.0, v18
    v_rcp_f32 v18, v18
    s_nop 0
    v_mul_f32 v21, v21, v18
    v_cvt_pk_bf16_f32 v18, v21, v21
    v_lshlrev_b32 v21, 16, v18
    v_lshlrev_b32 v22, 16, v22
    v_mul_f32 v18, 0xbfb8aa3b, v22
    v_exp_f32 v18, v18
    s_nop 0
    v_add_f32 v18, 1.0, v18
    v_rcp_f32 v18, v18
    s_nop 0
    v_mul_f32 v22, v22, v18
    v_cvt_pk_bf16_f32 v18, v22, v22
    v_lshlrev_b32 v22, 16, v18
    v_lshlrev_b32 v23, 16, v23
    v_mul_f32 v18, 0xbfb8aa3b, v23
    v_exp_f32 v18, v18
    s_nop 0
    v_add_f32 v18, 1.0, v18
    v_rcp_f32 v18, v18
    s_nop 0
    v_mul_f32 v23, v23, v18
    v_cvt_pk_bf16_f32 v18, v23, v23
    v_lshlrev_b32 v23, 16, v18
    v_lshlrev_b32 v24, 16, v24
    v_mul_f32 v18, 0xbfb8aa3b, v24
    v_exp_f32 v18, v18
    s_nop 0
    v_add_f32 v18, 1.0, v18
    v_rcp_f32 v18, v18
    s_nop 0
    v_mul_f32 v24, v24, v18
    v_cvt_pk_bf16_f32 v18, v24, v24
    v_lshlrev_b32 v24, 16, v18
    v_lshlrev_b32 v25, 16, v25
    v_mul_f32 v18, 0xbfb8aa3b, v25
    v_exp_f32 v18, v18
    s_nop 0
    v_add_f32 v18, 1.0, v18
    v_rcp_f32 v18, v18
    s_nop 0
    v_mul_f32 v25, v25, v18
    v_cvt_pk_bf16_f32 v18, v25, v25
    v_lshlrev_b32 v25, 16, v18
    v_lshlrev_b32 v26, 16, v26
    v_mul_f32 v18, 0xbfb8aa3b, v26
    v_exp_f32 v18, v18
    s_nop 0
    v_add_f32 v18, 1.0, v18
    v_rcp_f32 v18, v18
    s_nop 0
    v_mul_f32 v26, v26, v18
    v_cvt_pk_bf16_f32 v18, v26, v26
    v_lshlrev_b32 v26, 16, v18
    v_lshlrev_b32 v27, 16, v27
    v_mul_f32 v18, 0xbfb8aa3b, v27
    v_exp_f32 v18, v18
    s_nop 0
    v_add_f32 v18, 1.0, v18
    v_rcp_f32 v18, v18
    s_nop 0
    v_mul_f32 v27, v27, v18
    v_cvt_pk_bf16_f32 v18, v27, v27
    v_lshlrev_b32 v27, 16, v18
    v_lshlrev_b32 v28, 16, v28
    v_mul_f32 v18, 0xbfb8aa3b, v28
    v_exp_f32 v18, v18
    s_nop 0
    v_add_f32 v18, 1.0, v18
    v_rcp_f32 v18, v18
    s_nop 0
    v_mul_f32 v28, v28, v18
    v_cvt_pk_bf16_f32 v18, v28, v28
    v_lshlrev_b32 v28, 16, v18
    v_lshlrev_b32 v29, 16, v29
    v_mul_f32 v18, 0xbfb8aa3b, v29
    v_exp_f32 v18, v18
    s_nop 0
    v_add_f32 v18, 1.0, v18
    v_rcp_f32 v18, v18
    s_nop 0
    v_mul_f32 v29, v29, v18
    v_cvt_pk_bf16_f32 v18, v29, v29
    v_lshlrev_b32 v29, 16, v18
    v_lshlrev_b32 v30, 16, v30
    v_mul_f32 v18, 0xbfb8aa3b, v30
    v_exp_f32 v18, v18
    s_nop 0
    v_add_f32 v18, 1.0, v18
    v_rcp_f32 v18, v18
    s_nop 0
    v_mul_f32 v30, v30, v18
    v_cvt_pk_bf16_f32 v18, v30, v30
    v_lshlrev_b32 v30, 16, v18
    v_lshlrev_b32 v31, 16, v31
    v_mul_f32 v18, 0xbfb8aa3b, v31
    v_exp_f32 v18, v18
    s_nop 0
    v_add_f32 v18, 1.0, v18
    v_rcp_f32 v18, v18
    s_nop 0
    v_mul_f32 v31, v31, v18
    v_cvt_pk_bf16_f32 v18, v31, v31
    v_lshlrev_b32 v31, 16, v18
    v_lshlrev_b32 v32, 16, v32
    v_mul_f32 v18, 0xbfb8aa3b, v32
    v_exp_f32 v18, v18
    s_nop 0
    v_add_f32 v18, 1.0, v18
    v_rcp_f32 v18, v18
    s_nop 0
    v_mul_f32 v32, v32, v18
    v_cvt_pk_bf16_f32 v18, v32, v32
    v_lshlrev_b32 v32, 16, v18
    v_lshlrev_b32 v33, 16, v33
    v_mul_f32 v18, 0xbfb8aa3b, v33
    v_exp_f32 v18, v18
    s_nop 0
    v_add_f32 v18, 1.0, v18
    v_rcp_f32 v18, v18
    s_nop 0
    v_mul_f32 v33, v33, v18
    v_cvt_pk_bf16_f32 v18, v33, v33
    v_lshlrev_b32 v33, 16, v18
    v_lshlrev_b32 v34, 16, v34
    v_mul_f32 v18, 0xbfb8aa3b, v34
    v_exp_f32 v18, v18
    s_nop 0
    v_add_f32 v18, 1.0, v18
    v_rcp_f32 v18, v18
    s_nop 0
    v_mul_f32 v34, v34, v18
    v_cvt_pk_bf16_f32 v18, v34, v34
    v_lshlrev_b32 v34, 16, v18
    v_lshlrev_b32 v35, 16, v35
    v_mul_f32 v18, 0xbfb8aa3b, v35
    v_exp_f32 v18, v18
    s_nop 0
    v_add_f32 v18, 1.0, v18
    v_rcp_f32 v18, v18
    s_nop 0
    v_mul_f32 v35, v35, v18
    v_cvt_pk_bf16_f32 v18, v35, v35
    v_lshlrev_b32 v35, 16, v18
    v_lshlrev_b32 v36, 16, v36
    v_mul_f32 v18, 0xbfb8aa3b, v36
    v_exp_f32 v18, v18
    s_nop 0
    v_add_f32 v18, 1.0, v18
    v_rcp_f32 v18, v18
    s_nop 0
    v_mul_f32 v36, v36, v18
    v_cvt_pk_bf16_f32 v18, v36, v36
    v_lshlrev_b32 v36, 16, v18
    v_lshlrev_b32 v37, 16, v37
    v_mul_f32 v18, 0xbfb8aa3b, v37
    v_exp_f32 v18, v18
    s_nop 0
    v_add_f32 v18, 1.0, v18
    v_rcp_f32 v18, v18
    s_nop 0
    v_mul_f32 v37, v37, v18
    v_cvt_pk_bf16_f32 v18, v37, v37
    v_lshlrev_b32 v37, 16, v18
    v_lshlrev_b32 v38, 16, v38
    v_mul_f32 v18, 0xbfb8aa3b, v38
    v_exp_f32 v18, v18
    s_nop 0
    v_add_f32 v18, 1.0, v18
    v_rcp_f32 v18, v18
    s_nop 0
    v_mul_f32 v38, v38, v18
    v_cvt_pk_bf16_f32 v18, v38, v38
    v_lshlrev_b32 v38, 16, v18
    v_lshlrev_b32 v39, 16, v39
    v_mul_f32 v18, 0xbfb8aa3b, v39
    v_exp_f32 v18, v18
    s_nop 0
    v_add_f32 v18, 1.0, v18
    v_rcp_f32 v18, v18
    s_nop 0
    v_mul_f32 v39, v39, v18
    v_cvt_pk_bf16_f32 v18, v39, v39
    v_lshlrev_b32 v39, 16, v18
    s_waitcnt vmcnt(19)
    v_lshlrev_b32 v18, 16, v40
    v_and_b32 v19, 0xffff0000, v40
    v_fmac_f32 v10, v20, v18
    v_fmac_f32 v11, v20, v19
    v_lshlrev_b32 v18, 16, v41
    v_and_b32 v19, 0xffff0000, v41
    v_fmac_f32 v12, v20, v18
    v_fmac_f32 v13, v20, v19
    v_lshlrev_b32 v18, 16, v42
    v_and_b32 v19, 0xffff0000, v42
    v_fmac_f32 v14, v20, v18
    v_fmac_f32 v15, v20, v19
    v_lshlrev_b32 v18, 16, v43
    v_and_b32 v19, 0xffff0000, v43
    v_fmac_f32 v16, v20, v18
    v_fmac_f32 v17, v20, v19
    s_waitcnt vmcnt(18)
    v_lshlrev_b32 v18, 16, v44
    v_and_b32 v19, 0xffff0000, v44
    v_fmac_f32 v10, v21, v18
    v_fmac_f32 v11, v21, v19
    v_lshlrev_b32 v18, 16, v45
    v_and_b32 v19, 0xffff0000, v45
    v_fmac_f32 v12, v21, v18
    v_fmac_f32 v13, v21, v19
    v_lshlrev_b32 v18, 16, v46
    v_and_b32 v19, 0xffff0000, v46
    v_fmac_f32 v14, v21, v18
    v_fmac_f32 v15, v21, v19
    v_lshlrev_b32 v18, 16, v47
    v_and_b32 v19, 0xffff0000, v47
    v_fmac_f32 v16, v21, v18
    v_fmac_f32 v17, v21, v19
    s_waitcnt vmcnt(17)
    v_lshlrev_b32 v18, 16, v48
    v_and_b32 v19, 0xffff0000, v48
    v_fmac_f32 v10, v22, v18
    v_fmac_f32 v11, v22, v19
    v_lshlrev_b32 v18, 16, v49
    v_and_b32 v19, 0xffff0000, v49
    v_fmac_f32 v12, v22, v18
    v_fmac_f32 v13, v22, v19
    v_lshlrev_b32 v18, 16, v50
    v_and_b32 v19, 0xffff0000, v50
    v_fmac_f32 v14, v22, v18
    v_fmac_f32 v15, v22, v19
    v_lshlrev_b32 v18, 16, v51
    v_and_b32 v19, 0xffff0000, v51
    v_fmac_f32 v16, v22, v18
    v_fmac_f32 v17, v22, v19
    s_waitcnt vmcnt(16)
    v_lshlrev_b32 v18, 16, v52
    v_and_b32 v19, 0xffff0000, v52
    v_fmac_f32 v10, v23, v18
    v_fmac_f32 v11, v23, v19
    v_lshlrev_b32 v18, 16, v53
    v_and_b32 v19, 0xffff0000, v53
    v_fmac_f32 v12, v23, v18
    v_fmac_f32 v13, v23, v19
    v_lshlrev_b32 v18, 16, v54
    v_and_b32 v19, 0xffff0000, v54
    v_fmac_f32 v14, v23, v18
    v_fmac_f32 v15, v23, v19
    v_lshlrev_b32 v18, 16, v55
    v_and_b32 v19, 0xffff0000, v55
    v_fmac_f32 v16, v23, v18
    v_fmac_f32 v17, v23, v19
    s_waitcnt vmcnt(15)
    v_lshlrev_b32 v18, 16, v56
    v_and_b32 v19, 0xffff0000, v56
    v_fmac_f32 v10, v24, v18
    v_fmac_f32 v11, v24, v19
    v_lshlrev_b32 v18, 16, v57
    v_and_b32 v19, 0xffff0000, v57
    v_fmac_f32 v12, v24, v18
    v_fmac_f32 v13, v24, v19
    v_lshlrev_b32 v18, 16, v58
    v_and_b32 v19, 0xffff0000, v58
    v_fmac_f32 v14, v24, v18
    v_fmac_f32 v15, v24, v19
    v_lshlrev_b32 v18, 16, v59
    v_and_b32 v19, 0xffff0000, v59
    v_fmac_f32 v16, v24, v18
    v_fmac_f32 v17, v24, v19
    s_waitcnt vmcnt(14)
    v_lshlrev_b32 v18, 16, v60
    v_and_b32 v19, 0xffff0000, v60
    v_fmac_f32 v10, v25, v18
    v_fmac_f32 v11, v25, v19
    v_lshlrev_b32 v18, 16, v61
    v_and_b32 v19, 0xffff0000, v61
    v_fmac_f32 v12, v25, v18
    v_fmac_f32 v13, v25, v19
    v_lshlrev_b32 v18, 16, v62
    v_and_b32 v19, 0xffff0000, v62
    v_fmac_f32 v14, v25, v18
    v_fmac_f32 v15, v25, v19
    v_lshlrev_b32 v18, 16, v63
    v_and_b32 v19, 0xffff0000, v63
    v_fmac_f32 v16, v25, v18
    v_fmac_f32 v17, v25, v19
    s_waitcnt vmcnt(13)
    v_lshlrev_b32 v18, 16, v64
    v_and_b32 v19, 0xffff0000, v64
    v_fmac_f32 v10, v26, v18
    v_fmac_f32 v11, v26, v19
    v_lshlrev_b32 v18, 16, v65
    v_and_b32 v19, 0xffff0000, v65
    v_fmac_f32 v12, v26, v18
    v_fmac_f32 v13, v26, v19
    v_lshlrev_b32 v18, 16, v66
    v_and_b32 v19, 0xffff0000, v66
    v_fmac_f32 v14, v26, v18
    v_fmac_f32 v15, v26, v19
    v_lshlrev_b32 v18, 16, v67
    v_and_b32 v19, 0xffff0000, v67
    v_fmac_f32 v16, v26, v18
    v_fmac_f32 v17, v26, v19
    s_waitcnt vmcnt(12)
    v_lshlrev_b32 v18, 16, v68
    v_and_b32 v19, 0xffff0000, v68
    v_fmac_f32 v10, v27, v18
    v_fmac_f32 v11, v27, v19
    v_lshlrev_b32 v18, 16, v69
    v_and_b32 v19, 0xffff0000, v69
    v_fmac_f32 v12, v27, v18
    v_fmac_f32 v13, v27, v19
    v_lshlrev_b32 v18, 16, v70
    v_and_b32 v19, 0xffff0000, v70
    v_fmac_f32 v14, v27, v18
    v_fmac_f32 v15, v27, v19
    v_lshlrev_b32 v18, 16, v71
    v_and_b32 v19, 0xffff0000, v71
    v_fmac_f32 v16, v27, v18
    v_fmac_f32 v17, v27, v19
    s_waitcnt vmcnt(11)
    v_lshlrev_b32 v18, 16, v72
    v_and_b32 v19, 0xffff0000, v72
    v_fmac_f32 v10, v28, v18
    v_fmac_f32 v11, v28, v19
    v_lshlrev_b32 v18, 16, v73
    v_and_b32 v19, 0xffff0000, v73
    v_fmac_f32 v12, v28, v18
    v_fmac_f32 v13, v28, v19
    v_lshlrev_b32 v18, 16, v74
    v_and_b32 v19, 0xffff0000, v74
    v_fmac_f32 v14, v28, v18
    v_fmac_f32 v15, v28, v19
    v_lshlrev_b32 v18, 16, v75
    v_and_b32 v19, 0xffff0000, v75
    v_fmac_f32 v16, v28, v18
    v_fmac_f32 v17, v28, v19
    s_waitcnt vmcnt(10)
    v_lshlrev_b32 v18, 16, v76
    v_and_b32 v19, 0xffff0000, v76
    v_fmac_f32 v10, v29, v18
    v_fmac_f32 v11, v29, v19
    v_lshlrev_b32 v18, 16, v77
    v_and_b32 v19, 0xffff0000, v77
    v_fmac_f32 v12, v29, v18
    v_fmac_f32 v13, v29, v19
    v_lshlrev_b32 v18, 16, v78
    v_and_b32 v19, 0xffff0000, v78
    v_fmac_f32 v14, v29, v18
    v_fmac_f32 v15, v29, v19
    v_lshlrev_b32 v18, 16, v79
    v_and_b32 v19, 0xffff0000, v79
    v_fmac_f32 v16, v29, v18
    v_fmac_f32 v17, v29, v19
    s_waitcnt vmcnt(9)
    v_lshlrev_b32 v18, 16, v80
    v_and_b32 v19, 0xffff0000, v80
    v_fmac_f32 v10, v30, v18
    v_fmac_f32 v11, v30, v19
    v_lshlrev_b32 v18, 16, v81
    v_and_b32 v19, 0xffff0000, v81
    v_fmac_f32 v12, v30, v18
    v_fmac_f32 v13, v30, v19
    v_lshlrev_b32 v18, 16, v82
    v_and_b32 v19, 0xffff0000, v82
    v_fmac_f32 v14, v30, v18
    v_fmac_f32 v15, v30, v19
    v_lshlrev_b32 v18, 16, v83
    v_and_b32 v19, 0xffff0000, v83
    v_fmac_f32 v16, v30, v18
    v_fmac_f32 v17, v30, v19
    s_waitcnt vmcnt(8)
    v_lshlrev_b32 v18, 16, v84
    v_and_b32 v19, 0xffff0000, v84
    v_fmac_f32 v10, v31, v18
    v_fmac_f32 v11, v31, v19
    v_lshlrev_b32 v18, 16, v85
    v_and_b32 v19, 0xffff0000, v85
    v_fmac_f32 v12, v31, v18
    v_fmac_f32 v13, v31, v19
    v_lshlrev_b32 v18, 16, v86
    v_and_b32 v19, 0xffff0000, v86
    v_fmac_f32 v14, v31, v18
    v_fmac_f32 v15, v31, v19
    v_lshlrev_b32 v18, 16, v87
    v_and_b32 v19, 0xffff0000, v87
    v_fmac_f32 v16, v31, v18
    v_fmac_f32 v17, v31, v19
    s_waitcnt vmcnt(7)
    v_lshlrev_b32 v18, 16, v88
    v_and_b32 v19, 0xffff0000, v88
    v_fmac_f32 v10, v32, v18
    v_fmac_f32 v11, v32, v19
    v_lshlrev_b32 v18, 16, v89
    v_and_b32 v19, 0xffff0000, v89
    v_fmac_f32 v12, v32, v18
    v_fmac_f32 v13, v32, v19
    v_lshlrev_b32 v18, 16, v90
    v_and_b32 v19, 0xffff0000, v90
    v_fmac_f32 v14, v32, v18
    v_fmac_f32 v15, v32, v19
    v_lshlrev_b32 v18, 16, v91
    v_and_b32 v19, 0xffff0000, v91
    v_fmac_f32 v16, v32, v18
    v_fmac_f32 v17, v32, v19
    s_waitcnt vmcnt(6)
    v_lshlrev_b32 v18, 16, v92
    v_and_b32 v19, 0xffff0000, v92
    v_fmac_f32 v10, v33, v18
    v_fmac_f32 v11, v33, v19
    v_lshlrev_b32 v18, 16, v93
    v_and_b32 v19, 0xffff0000, v93
    v_fmac_f32 v12, v33, v18
    v_fmac_f32 v13, v33, v19
    v_lshlrev_b32 v18, 16, v94
    v_and_b32 v19, 0xffff0000, v94
    v_fmac_f32 v14, v33, v18
    v_fmac_f32 v15, v33, v19
    v_lshlrev_b32 v18, 16, v95
    v_and_b32 v19, 0xffff0000, v95
    v_fmac_f32 v16, v33, v18
    v_fmac_f32 v17, v33, v19
    s_waitcnt vmcnt(5)
    v_lshlrev_b32 v18, 16, v96
    v_and_b32 v19, 0xffff0000, v96
    v_fmac_f32 v10, v34, v18
    v_fmac_f32 v11, v34, v19
    v_lshlrev_b32 v18, 16, v97
    v_and_b32 v19, 0xffff0000, v97
    v_fmac_f32 v12, v34, v18
    v_fmac_f32 v13, v34, v19
    v_lshlrev_b32 v18, 16, v98
    v_and_b32 v19, 0xffff0000, v98
    v_fmac_f32 v14, v34, v18
    v_fmac_f32 v15, v34, v19
    v_lshlrev_b32 v18, 16, v99
    v_and_b32 v19, 0xffff0000, v99
    v_fmac_f32 v16, v34, v18
    v_fmac_f32 v17, v34, v19
    s_waitcnt vmcnt(4)
    v_lshlrev_b32 v18, 16, v100
    v_and_b32 v19, 0xffff0000, v100
    v_fmac_f32 v10, v35, v18
    v_fmac_f32 v11, v35, v19
    v_lshlrev_b32 v18, 16, v101
    v_and_b32 v19, 0xffff0000, v101
    v_fmac_f32 v12, v35, v18
    v_fmac_f32 v13, v35, v19
    v_lshlrev_b32 v18, 16, v102
    v_and_b32 v19, 0xffff0000, v102
    v_fmac_f32 v14, v35, v18
    v_fmac_f32 v15, v35, v19
    v_lshlrev_b32 v18, 16, v103
    v_and_b32 v19, 0xffff0000, v103
    v_fmac_f32 v16, v35, v18
    v_fmac_f32 v17, v35, v19
    s_waitcnt vmcnt(3)
    v_lshlrev_b32 v18, 16, v104
    v_and_b32 v19, 0xffff0000, v104
    v_fmac_f32 v10, v36, v18
    v_fmac_f32 v11, v36, v19
    v_lshlrev_b32 v18, 16, v105
    v_and_b32 v19, 0xffff0000, v105
    v_fmac_f32 v12, v36, v18
    v_fmac_f32 v13, v36, v19
    v_lshlrev_b32 v18, 16, v106
    v_and_b32 v19, 0xffff0000, v106
    v_fmac_f32 v14, v36, v18
    v_fmac_f32 v15, v36, v19
    v_lshlrev_b32 v18, 16, v107
    v_and_b32 v19, 0xffff0000, v107
    v_fmac_f32 v16, v36, v18
    v_fmac_f32 v17, v36, v19
    s_waitcnt vmcnt(2)
    v_lshlrev_b32 v18, 16, v108
    v_and_b32 v19, 0xffff0000, v108
    v_fmac_f32 v10, v37, v18
    v_fmac_f32 v11, v37, v19
    v_lshlrev_b32 v18, 16, v109
    v_and_b32 v19, 0xffff0000, v109
    v_fmac_f32 v12, v37, v18
    v_fmac_f32 v13, v37, v19
    v_lshlrev_b32 v18, 16, v110
    v_and_b32 v19, 0xffff0000, v110
    v_fmac_f32 v14, v37, v18
    v_fmac_f32 v15, v37, v19
    v_lshlrev_b32 v18, 16, v111
    v_and_b32 v19, 0xffff0000, v111
    v_fmac_f32 v16, v37, v18
    v_fmac_f32 v17, v37, v19
    s_waitcnt vmcnt(1)
    v_lshlrev_b32 v18, 16, v112
    v_and_b32 v19, 0xffff0000, v112
    v_fmac_f32 v10, v38, v18
    v_fmac_f32 v11, v38, v19
    v_lshlrev_b32 v18, 16, v113
    v_and_b32 v19, 0xffff0000, v113
    v_fmac_f32 v12, v38, v18
    v_fmac_f32 v13, v38, v19
    v_lshlrev_b32 v18, 16, v114
    v_and_b32 v19, 0xffff0000, v114
    v_fmac_f32 v14, v38, v18
    v_fmac_f32 v15, v38, v19
    v_lshlrev_b32 v18, 16, v115
    v_and_b32 v19, 0xffff0000, v115
    v_fmac_f32 v16, v38, v18
    v_fmac_f32 v17, v38, v19
    s_waitcnt vmcnt(0)
    v_lshlrev_b32 v18, 16, v116
    v_and_b32 v19, 0xffff0000, v116
    v_fmac_f32 v10, v39, v18
    v_fmac_f32 v11, v39, v19
    v_lshlrev_b32 v18, 16, v117
    v_and_b32 v19, 0xffff0000, v117
    v_fmac_f32 v12, v39, v18
    v_fmac_f32 v13, v39, v19
    v_lshlrev_b32 v18, 16, v118
    v_and_b32 v19, 0xffff0000, v118
    v_fmac_f32 v14, v39, v18
    v_fmac_f32 v15, v39, v19
    v_lshlrev_b32 v18, 16, v119
    v_and_b32 v19, 0xffff0000, v119
    v_fmac_f32 v16, v39, v18
    v_fmac_f32 v17, v39, v19
    v_lshlrev_b32 v5, 3, v1
    v_add_u32 v5, v5, v4
    v_lshlrev_b32 v5, 8, v5
    v_lshlrev_b32 v6, 5, v3
    v_add_u32 v5, v5, v6
    ds_write_b128 v5, v[10:13]
    ds_write_b128 v5, v[14:17] offset:16
    s_waitcnt lgkmcnt(0)
    s_barrier
    v_cmp_gt_u32 vcc, 64, v0
    s_and_saveexec_b64 s[22:23], vcc
    s_cbranch_execz L_prep_end
    v_lshlrev_b32 v5, 2, v0
    ds_read_b32 v20, v5 offset:0
    ds_read_b32 v21, v5 offset:256
    ds_read_b32 v22, v5 offset:512
    ds_read_b32 v23, v5 offset:768
    ds_read_b32 v24, v5 offset:1024
    ds_read_b32 v25, v5 offset:1280
    ds_read_b32 v26, v5 offset:1536
    ds_read_b32 v27, v5 offset:1792
    ds_read_b32 v28, v5 offset:2048
    ds_read_b32 v29, v5 offset:2304
    ds_read_b32 v30, v5 offset:2560
    ds_read_b32 v31, v5 offset:2816
    ds_read_b32 v32, v5 offset:3072
    ds_read_b32 v33, v5 offset:3328
    ds_read_b32 v34, v5 offset:3584
    ds_read_b32 v35, v5 offset:3840
    ds_read_b32 v36, v5 offset:4096
    ds_read_b32 v37, v5 offset:4352
    ds_read_b32 v38, v5 offset:4608
    ds_read_b32 v39, v5 offset:4864
    ds_read_b32 v40, v5 offset:5120
    ds_read_b32 v41, v5 offset:5376
    ds_read_b32 v42, v5 offset:5632
    ds_read_b32 v43, v5 offset:5888
    ds_read_b32 v44, v5 offset:6144
    ds_read_b32 v45, v5 offset:6400
    ds_read_b32 v46, v5 offset:6656
    ds_read_b32 v47, v5 offset:6912
    ds_read_b32 v48, v5 offset:7168
    ds_read_b32 v49, v5 offset:7424
    ds_read_b32 v50, v5 offset:7680
    ds_read_b32 v51, v5 offset:7936
    s_waitcnt lgkmcnt(0)
    v_add_f32 v20, v20, v21
    v_add_f32 v20, v20, v22
    v_add_f32 v20, v20, v23
    v_add_f32 v20, v20, v24
    v_add_f32 v20, v20, v25
    v_add_f32 v20, v20, v26
    v_add_f32 v20, v20, v27
    v_add_f32 v20, v20, v28
    v_add_f32 v20, v20, v29
    v_add_f32 v20, v20, v30
    v_add_f32 v20, v20, v31
    v_add_f32 v20, v20, v32
    v_add_f32 v20, v20, v33
    v_add_f32 v20, v20, v34
    v_add_f32 v20, v20, v35
    v_add_f32 v20, v20, v36
    v_add_f32 v20, v20, v37
    v_add_f32 v20, v20, v38
    v_add_f32 v20, v20, v39
    v_add_f32 v20, v20, v40
    v_add_f32 v20, v20, v41
    v_add_f32 v20, v20, v42
    v_add_f32 v20, v20, v43
    v_add_f32 v20, v20, v44
    v_add_f32 v20, v20, v45
    v_add_f32 v20, v20, v46
    v_add_f32 v20, v20, v47
    v_add_f32 v20, v20, v48
    v_add_f32 v20, v20, v49
    v_add_f32 v20, v20, v50
    v_add_f32 v20, v20, v51
    v_cvt_pk_bf16_f32 v20, v20, v20
    v_lshlrev_b32 v5, 1, v0
    v_add_u32 v5, s20, v5
    buffer_store_short v20, v5, s[4:7], 0 offen offset:0 sc1
    s_waitcnt vmcnt(0)
    v_mov_b32 v20, 1
    v_mov_b32 v21, 0
    s_lshl_b32 s21, s2, 2
    s_mov_b64 exec, 1
    buffer_store_dword v20, v21, s[24:27], s21 offen sc1
    s_endpgm
L_prep_ln:
    s_load_dwordx2 s[4:5], s[0:1], 128
    s_load_dwordx2 s[8:9], s[0:1], 0
    s_load_dwordx2 s[24:25], s[0:1], 120
    s_waitcnt lgkmcnt(0)
    s_and_b32 s5, s5, 0xffff
    s_mov_b32 s6, 268435456
    s_mov_b32 s7, 0x00020000
    s_and_b32 s9, s9, 0xffff
    s_mov_b32 s10, 2621440
    s_mov_b32 s11, 0x00020000
    s_and_b32 s25, s25, 0xffff
    s_mov_b32 s26, 256
    s_mov_b32 s27, 0x00020000
    v_lshrrev_b32 v1, 6, v0
    s_nop 0
    v_readfirstlane_b32 s40, v1
    v_and_b32 v0, 63, v0
    s_sub_u32 s2, s2, 60
    s_lshl_b32 s2, s2, 2
    s_add_u32 s2, s2, s40
    v_and_b32 v1, 15, v0
    v_lshrrev_b32 v2, 4, v0
    v_mul_u32_u24 v3, 1280, v1
    v_lshlrev_b32 v4, 4, v2
    v_add_u32 v3, v3, v4
    s_mul_i32 s20, s2, 20480
    buffer_load_dwordx4 v[16:19], v3, s[8:11], s20 offen offset:0
    buffer_load_dwordx4 v[20:23], v3, s[8:11], s20 offen offset:64
    buffer_load_dwordx4 v[24:27], v3, s[8:11], s20 offen offset:128
    buffer_load_dwordx4 v[28:31], v3, s[8:11], s20 offen offset:192
    buffer_load_dwordx4 v[32:35], v3, s[8:11], s20 offen offset:256
    buffer_load_dwordx4 v[36:39], v3, s[8:11], s20 offen offset:320
    buffer_load_dwordx4 v[40:43], v3, s[8:11], s20 offen offset:384
    buffer_load_dwordx4 v[44:47], v3, s[8:11], s20 offen offset:448
    buffer_load_dwordx4 v[48:51], v3, s[8:11], s20 offen offset:512
    buffer_load_dwordx4 v[52:55], v3, s[8:11], s20 offen offset:576
    buffer_load_dwordx4 v[56:59], v3, s[8:11], s20 offen offset:640
    buffer_load_dwordx4 v[60:63], v3, s[8:11], s20 offen offset:704
    buffer_load_dwordx4 v[64:67], v3, s[8:11], s20 offen offset:768
    buffer_load_dwordx4 v[68:71], v3, s[8:11], s20 offen offset:832
    buffer_load_dwordx4 v[72:75], v3, s[8:11], s20 offen offset:896
    buffer_load_dwordx4 v[76:79], v3, s[8:11], s20 offen offset:960
    buffer_load_dwordx4 v[80:83], v3, s[8:11], s20 offen offset:1024
    buffer_load_dwordx4 v[84:87], v3, s[8:11], s20 offen offset:1088
    buffer_load_dwordx4 v[88:91], v3, s[8:11], s20 offen offset:1152
    buffer_load_dwordx4 v[92:95], v3, s[8:11], s20 offen offset:1216
    v_mov_b32 v5, 0
    s_waitcnt vmcnt(19)
    v_lshlrev_b32 v96, 16, v16
    v_and_b32 v97, 0xffff0000, v16
    v_add_f32 v5, v5, v96
    v_add_f32 v5, v5, v97
    v_lshlrev_b32 v98, 16, v17
    v_and_b32 v99, 0xffff0000, v17
    v_add_f32 v5, v5, v98
    v_add_f32 v5, v5, v99
    v_lshlrev_b32 v100, 16, v18
    v_and_b32 v101, 0xffff0000, v18
    v_add_f32 v5, v5, v100
    v_add_f32 v5, v5, v101
    v_lshlrev_b32 v102, 16, v19
    v_and_b32 v103, 0xffff0000, v19
    v_add_f32 v5, v5, v102
    v_add_f32 v5, v5, v103
    s_waitcnt vmcnt(18)
    v_lshlrev_b32 v104, 16, v20
    v_and_b32 v105, 0xffff0000, v20
    v_add_f32 v5, v5, v104
    v_add_f32 v5, v5, v105
    v_lshlrev_b32 v106, 16, v21
    v_and_b32 v107, 0xffff0000, v21
    v_add_f32 v5, v5, v106
    v_add_f32 v5, v5, v107
    v_lshlrev_b32 v108, 16, v22
    v_and_b32 v109, 0xffff0000, v22
    v_add_f32 v5, v5, v108
    v_add_f32 v5, v5, v109
    v_lshlrev_b32 v110, 16, v23
    v_and_b32 v111, 0xffff0000, v23
    v_add_f32 v5, v5, v110
    v_add_f32 v5, v5, v111
    s_waitcnt vmcnt(17)
    v_lshlrev_b32 v112, 16, v24
    v_and_b32 v113, 0xffff0000, v24
    v_add_f32 v5, v5, v112
    v_add_f32 v5, v5, v113
    v_lshlrev_b32 v114, 16, v25
    v_and_b32 v115, 0xffff0000, v25
    v_add_f32 v5, v5, v114
    v_add_f32 v5, v5, v115
    v_lshlrev_b32 v116, 16, v26
    v_and_b32 v117, 0xffff0000, v26
    v_add_f32 v5, v5, v116
    v_add_f32 v5, v5, v117
    v_lshlrev_b32 v118, 16, v27
    v_and_b32 v119, 0xffff0000, v27
    v_add_f32 v5, v5, v118
    v_add_f32 v5, v5, v119
    s_waitcnt vmcnt(16)
    v_lshlrev_b32 v120, 16, v28
    v_and_b32 v121, 0xffff0000, v28
    v_add_f32 v5, v5, v120
    v_add_f32 v5, v5, v121
    v_lshlrev_b32 v122, 16, v29
    v_and_b32 v123, 0xffff0000, v29
    v_add_f32 v5, v5, v122
    v_add_f32 v5, v5, v123
    v_lshlrev_b32 v124, 16, v30
    v_and_b32 v125, 0xffff0000, v30
    v_add_f32 v5, v5, v124
    v_add_f32 v5, v5, v125
    v_lshlrev_b32 v126, 16, v31
    v_and_b32 v127, 0xffff0000, v31
    v_add_f32 v5, v5, v126
    v_add_f32 v5, v5, v127
    s_waitcnt vmcnt(15)
    v_lshlrev_b32 v128, 16, v32
    v_and_b32 v129, 0xffff0000, v32
    v_add_f32 v5, v5, v128
    v_add_f32 v5, v5, v129
    v_lshlrev_b32 v130, 16, v33
    v_and_b32 v131, 0xffff0000, v33
    v_add_f32 v5, v5, v130
    v_add_f32 v5, v5, v131
    v_lshlrev_b32 v132, 16, v34
    v_and_b32 v133, 0xffff0000, v34
    v_add_f32 v5, v5, v132
    v_add_f32 v5, v5, v133
    v_lshlrev_b32 v134, 16, v35
    v_and_b32 v135, 0xffff0000, v35
    v_add_f32 v5, v5, v134
    v_add_f32 v5, v5, v135
    s_waitcnt vmcnt(14)
    v_lshlrev_b32 v136, 16, v36
    v_and_b32 v137, 0xffff0000, v36
    v_add_f32 v5, v5, v136
    v_add_f32 v5, v5, v137
    v_lshlrev_b32 v138, 16, v37
    v_and_b32 v139, 0xffff0000, v37
    v_add_f32 v5, v5, v138
    v_add_f32 v5, v5, v139
    v_lshlrev_b32 v140, 16, v38
    v_and_b32 v141, 0xffff0000, v38
    v_add_f32 v5, v5, v140
    v_add_f32 v5, v5, v141
    v_lshlrev_b32 v142, 16, v39
    v_and_b32 v143, 0xffff0000, v39
    v_add_f32 v5, v5, v142
    v_add_f32 v5, v5, v143
    s_waitcnt vmcnt(13)
    v_lshlrev_b32 v144, 16, v40
    v_and_b32 v145, 0xffff0000, v40
    v_add_f32 v5, v5, v144
    v_add_f32 v5, v5, v145
    v_lshlrev_b32 v146, 16, v41
    v_and_b32 v147, 0xffff0000, v41
    v_add_f32 v5, v5, v146
    v_add_f32 v5, v5, v147
    v_lshlrev_b32 v148, 16, v42
    v_and_b32 v149, 0xffff0000, v42
    v_add_f32 v5, v5, v148
    v_add_f32 v5, v5, v149
    v_lshlrev_b32 v150, 16, v43
    v_and_b32 v151, 0xffff0000, v43
    v_add_f32 v5, v5, v150
    v_add_f32 v5, v5, v151
    s_waitcnt vmcnt(12)
    v_lshlrev_b32 v152, 16, v44
    v_and_b32 v153, 0xffff0000, v44
    v_add_f32 v5, v5, v152
    v_add_f32 v5, v5, v153
    v_lshlrev_b32 v154, 16, v45
    v_and_b32 v155, 0xffff0000, v45
    v_add_f32 v5, v5, v154
    v_add_f32 v5, v5, v155
    v_lshlrev_b32 v156, 16, v46
    v_and_b32 v157, 0xffff0000, v46
    v_add_f32 v5, v5, v156
    v_add_f32 v5, v5, v157
    v_lshlrev_b32 v158, 16, v47
    v_and_b32 v159, 0xffff0000, v47
    v_add_f32 v5, v5, v158
    v_add_f32 v5, v5, v159
    s_waitcnt vmcnt(11)
    v_lshlrev_b32 v160, 16, v48
    v_and_b32 v161, 0xffff0000, v48
    v_add_f32 v5, v5, v160
    v_add_f32 v5, v5, v161
    v_lshlrev_b32 v162, 16, v49
    v_and_b32 v163, 0xffff0000, v49
    v_add_f32 v5, v5, v162
    v_add_f32 v5, v5, v163
    v_lshlrev_b32 v164, 16, v50
    v_and_b32 v165, 0xffff0000, v50
    v_add_f32 v5, v5, v164
    v_add_f32 v5, v5, v165
    v_lshlrev_b32 v166, 16, v51
    v_and_b32 v167, 0xffff0000, v51
    v_add_f32 v5, v5, v166
    v_add_f32 v5, v5, v167
    s_waitcnt vmcnt(10)
    v_lshlrev_b32 v168, 16, v52
    v_and_b32 v169, 0xffff0000, v52
    v_add_f32 v5, v5, v168
    v_add_f32 v5, v5, v169
    v_lshlrev_b32 v170, 16, v53
    v_and_b32 v171, 0xffff0000, v53
    v_add_f32 v5, v5, v170
    v_add_f32 v5, v5, v171
    v_lshlrev_b32 v172, 16, v54
    v_and_b32 v173, 0xffff0000, v54
    v_add_f32 v5, v5, v172
    v_add_f32 v5, v5, v173
    v_lshlrev_b32 v174, 16, v55
    v_and_b32 v175, 0xffff0000, v55
    v_add_f32 v5, v5, v174
    v_add_f32 v5, v5, v175
    s_waitcnt vmcnt(9)
    v_lshlrev_b32 v176, 16, v56
    v_and_b32 v177, 0xffff0000, v56
    v_add_f32 v5, v5, v176
    v_add_f32 v5, v5, v177
    v_lshlrev_b32 v178, 16, v57
    v_and_b32 v179, 0xffff0000, v57
    v_add_f32 v5, v5, v178
    v_add_f32 v5, v5, v179
    v_lshlrev_b32 v180, 16, v58
    v_and_b32 v181, 0xffff0000, v58
    v_add_f32 v5, v5, v180
    v_add_f32 v5, v5, v181
    v_lshlrev_b32 v182, 16, v59
    v_and_b32 v183, 0xffff0000, v59
    v_add_f32 v5, v5, v182
    v_add_f32 v5, v5, v183
    s_waitcnt vmcnt(8)
    v_lshlrev_b32 v184, 16, v60
    v_and_b32 v185, 0xffff0000, v60
    v_add_f32 v5, v5, v184
    v_add_f32 v5, v5, v185
    v_lshlrev_b32 v186, 16, v61
    v_and_b32 v187, 0xffff0000, v61
    v_add_f32 v5, v5, v186
    v_add_f32 v5, v5, v187
    v_lshlrev_b32 v188, 16, v62
    v_and_b32 v189, 0xffff0000, v62
    v_add_f32 v5, v5, v188
    v_add_f32 v5, v5, v189
    v_lshlrev_b32 v190, 16, v63
    v_and_b32 v191, 0xffff0000, v63
    v_add_f32 v5, v5, v190
    v_add_f32 v5, v5, v191
    s_waitcnt vmcnt(7)
    v_lshlrev_b32 v192, 16, v64
    v_and_b32 v193, 0xffff0000, v64
    v_add_f32 v5, v5, v192
    v_add_f32 v5, v5, v193
    v_lshlrev_b32 v194, 16, v65
    v_and_b32 v195, 0xffff0000, v65
    v_add_f32 v5, v5, v194
    v_add_f32 v5, v5, v195
    v_lshlrev_b32 v196, 16, v66
    v_and_b32 v197, 0xffff0000, v66
    v_add_f32 v5, v5, v196
    v_add_f32 v5, v5, v197
    v_lshlrev_b32 v198, 16, v67
    v_and_b32 v199, 0xffff0000, v67
    v_add_f32 v5, v5, v198
    v_add_f32 v5, v5, v199
    s_waitcnt vmcnt(6)
    v_lshlrev_b32 v200, 16, v68
    v_and_b32 v201, 0xffff0000, v68
    v_add_f32 v5, v5, v200
    v_add_f32 v5, v5, v201
    v_lshlrev_b32 v202, 16, v69
    v_and_b32 v203, 0xffff0000, v69
    v_add_f32 v5, v5, v202
    v_add_f32 v5, v5, v203
    v_lshlrev_b32 v204, 16, v70
    v_and_b32 v205, 0xffff0000, v70
    v_add_f32 v5, v5, v204
    v_add_f32 v5, v5, v205
    v_lshlrev_b32 v206, 16, v71
    v_and_b32 v207, 0xffff0000, v71
    v_add_f32 v5, v5, v206
    v_add_f32 v5, v5, v207
    s_waitcnt vmcnt(5)
    v_lshlrev_b32 v208, 16, v72
    v_and_b32 v209, 0xffff0000, v72
    v_add_f32 v5, v5, v208
    v_add_f32 v5, v5, v209
    v_lshlrev_b32 v210, 16, v73
    v_and_b32 v211, 0xffff0000, v73
    v_add_f32 v5, v5, v210
    v_add_f32 v5, v5, v211
    v_lshlrev_b32 v212, 16, v74
    v_and_b32 v213, 0xffff0000, v74
    v_add_f32 v5, v5, v212
    v_add_f32 v5, v5, v213
    v_lshlrev_b32 v214, 16, v75
    v_and_b32 v215, 0xffff0000, v75
    v_add_f32 v5, v5, v214
    v_add_f32 v5, v5, v215
    s_waitcnt vmcnt(4)
    v_lshlrev_b32 v216, 16, v76
    v_and_b32 v217, 0xffff0000, v76
    v_add_f32 v5, v5, v216
    v_add_f32 v5, v5, v217
    v_lshlrev_b32 v218, 16, v77
    v_and_b32 v219, 0xffff0000, v77
    v_add_f32 v5, v5, v218
    v_add_f32 v5, v5, v219
    v_lshlrev_b32 v220, 16, v78
    v_and_b32 v221, 0xffff0000, v78
    v_add_f32 v5, v5, v220
    v_add_f32 v5, v5, v221
    v_lshlrev_b32 v222, 16, v79
    v_and_b32 v223, 0xffff0000, v79
    v_add_f32 v5, v5, v222
    v_add_f32 v5, v5, v223
    s_waitcnt vmcnt(3)
    v_lshlrev_b32 v224, 16, v80
    v_and_b32 v225, 0xffff0000, v80
    v_add_f32 v5, v5, v224
    v_add_f32 v5, v5, v225
    v_lshlrev_b32 v226, 16, v81
    v_and_b32 v227, 0xffff0000, v81
    v_add_f32 v5, v5, v226
    v_add_f32 v5, v5, v227
    v_lshlrev_b32 v228, 16, v82
    v_and_b32 v229, 0xffff0000, v82
    v_add_f32 v5, v5, v228
    v_add_f32 v5, v5, v229
    v_lshlrev_b32 v230, 16, v83
    v_and_b32 v231, 0xffff0000, v83
    v_add_f32 v5, v5, v230
    v_add_f32 v5, v5, v231
    s_waitcnt vmcnt(2)
    v_lshlrev_b32 v232, 16, v84
    v_and_b32 v233, 0xffff0000, v84
    v_add_f32 v5, v5, v232
    v_add_f32 v5, v5, v233
    v_lshlrev_b32 v234, 16, v85
    v_and_b32 v235, 0xffff0000, v85
    v_add_f32 v5, v5, v234
    v_add_f32 v5, v5, v235
    v_lshlrev_b32 v236, 16, v86
    v_and_b32 v237, 0xffff0000, v86
    v_add_f32 v5, v5, v236
    v_add_f32 v5, v5, v237
    v_lshlrev_b32 v238, 16, v87
    v_and_b32 v239, 0xffff0000, v87
    v_add_f32 v5, v5, v238
    v_add_f32 v5, v5, v239
    s_waitcnt vmcnt(1)
    v_lshlrev_b32 v240, 16, v88
    v_and_b32 v241, 0xffff0000, v88
    v_add_f32 v5, v5, v240
    v_add_f32 v5, v5, v241
    v_lshlrev_b32 v242, 16, v89
    v_and_b32 v243, 0xffff0000, v89
    v_add_f32 v5, v5, v242
    v_add_f32 v5, v5, v243
    v_lshlrev_b32 v244, 16, v90
    v_and_b32 v245, 0xffff0000, v90
    v_add_f32 v5, v5, v244
    v_add_f32 v5, v5, v245
    v_lshlrev_b32 v246, 16, v91
    v_and_b32 v247, 0xffff0000, v91
    v_add_f32 v5, v5, v246
    v_add_f32 v5, v5, v247
    s_waitcnt vmcnt(0)
    v_lshlrev_b32 v248, 16, v92
    v_and_b32 v249, 0xffff0000, v92
    v_add_f32 v5, v5, v248
    v_add_f32 v5, v5, v249
    v_lshlrev_b32 v250, 16, v93
    v_and_b32 v251, 0xffff0000, v93
    v_add_f32 v5, v5, v250
    v_add_f32 v5, v5, v251
    v_lshlrev_b32 v252, 16, v94
    v_and_b32 v253, 0xffff0000, v94
    v_add_f32 v5, v5, v252
    v_add_f32 v5, v5, v253
    v_lshlrev_b32 v254, 16, v95
    v_and_b32 v255, 0xffff0000, v95
    v_add_f32 v5, v5, v254
    v_add_f32 v5, v5, v255
    v_xor_b32 v6, 16, v0
    v_lshlrev_b32 v6, 2, v6
    v_xor_b32 v7, 32, v0
    v_lshlrev_b32 v7, 2, v7
    ds_bpermute_b32 v8, v6, v5
    s_waitcnt lgkmcnt(0)
    v_add_f32 v5, v5, v8
    ds_bpermute_b32 v8, v7, v5
    s_waitcnt lgkmcnt(0)
    v_add_f32 v5, v5, v8
    v_mul_f32 v5, 0x3acccccd, v5
    v_mov_b32 v9, 0
    v_sub_f32 v8, v96, v5
    v_fmac_f32 v9, v8, v8
    v_sub_f32 v8, v97, v5
    v_fmac_f32 v9, v8, v8
    v_sub_f32 v8, v98, v5
    v_fmac_f32 v9, v8, v8
    v_sub_f32 v8, v99, v5
    v_fmac_f32 v9, v8, v8
    v_sub_f32 v8, v100, v5
    v_fmac_f32 v9, v8, v8
    v_sub_f32 v8, v101, v5
    v_fmac_f32 v9, v8, v8
    v_sub_f32 v8, v102, v5
    v_fmac_f32 v9, v8, v8
    v_sub_f32 v8, v103, v5
    v_fmac_f32 v9, v8, v8
    v_sub_f32 v8, v104, v5
    v_fmac_f32 v9, v8, v8
    v_sub_f32 v8, v105, v5
    v_fmac_f32 v9, v8, v8
    v_sub_f32 v8, v106, v5
    v_fmac_f32 v9, v8, v8
    v_sub_f32 v8, v107, v5
    v_fmac_f32 v9, v8, v8
    v_sub_f32 v8, v108, v5
    v_fmac_f32 v9, v8, v8
    v_sub_f32 v8, v109, v5
    v_fmac_f32 v9, v8, v8
    v_sub_f32 v8, v110, v5
    v_fmac_f32 v9, v8, v8
    v_sub_f32 v8, v111, v5
    v_fmac_f32 v9, v8, v8
    v_sub_f32 v8, v112, v5
    v_fmac_f32 v9, v8, v8
    v_sub_f32 v8, v113, v5
    v_fmac_f32 v9, v8, v8
    v_sub_f32 v8, v114, v5
    v_fmac_f32 v9, v8, v8
    v_sub_f32 v8, v115, v5
    v_fmac_f32 v9, v8, v8
    v_sub_f32 v8, v116, v5
    v_fmac_f32 v9, v8, v8
    v_sub_f32 v8, v117, v5
    v_fmac_f32 v9, v8, v8
    v_sub_f32 v8, v118, v5
    v_fmac_f32 v9, v8, v8
    v_sub_f32 v8, v119, v5
    v_fmac_f32 v9, v8, v8
    v_sub_f32 v8, v120, v5
    v_fmac_f32 v9, v8, v8
    v_sub_f32 v8, v121, v5
    v_fmac_f32 v9, v8, v8
    v_sub_f32 v8, v122, v5
    v_fmac_f32 v9, v8, v8
    v_sub_f32 v8, v123, v5
    v_fmac_f32 v9, v8, v8
    v_sub_f32 v8, v124, v5
    v_fmac_f32 v9, v8, v8
    v_sub_f32 v8, v125, v5
    v_fmac_f32 v9, v8, v8
    v_sub_f32 v8, v126, v5
    v_fmac_f32 v9, v8, v8
    v_sub_f32 v8, v127, v5
    v_fmac_f32 v9, v8, v8
    v_sub_f32 v8, v128, v5
    v_fmac_f32 v9, v8, v8
    v_sub_f32 v8, v129, v5
    v_fmac_f32 v9, v8, v8
    v_sub_f32 v8, v130, v5
    v_fmac_f32 v9, v8, v8
    v_sub_f32 v8, v131, v5
    v_fmac_f32 v9, v8, v8
    v_sub_f32 v8, v132, v5
    v_fmac_f32 v9, v8, v8
    v_sub_f32 v8, v133, v5
    v_fmac_f32 v9, v8, v8
    v_sub_f32 v8, v134, v5
    v_fmac_f32 v9, v8, v8
    v_sub_f32 v8, v135, v5
    v_fmac_f32 v9, v8, v8
    v_sub_f32 v8, v136, v5
    v_fmac_f32 v9, v8, v8
    v_sub_f32 v8, v137, v5
    v_fmac_f32 v9, v8, v8
    v_sub_f32 v8, v138, v5
    v_fmac_f32 v9, v8, v8
    v_sub_f32 v8, v139, v5
    v_fmac_f32 v9, v8, v8
    v_sub_f32 v8, v140, v5
    v_fmac_f32 v9, v8, v8
    v_sub_f32 v8, v141, v5
    v_fmac_f32 v9, v8, v8
    v_sub_f32 v8, v142, v5
    v_fmac_f32 v9, v8, v8
    v_sub_f32 v8, v143, v5
    v_fmac_f32 v9, v8, v8
    v_sub_f32 v8, v144, v5
    v_fmac_f32 v9, v8, v8
    v_sub_f32 v8, v145, v5
    v_fmac_f32 v9, v8, v8
    v_sub_f32 v8, v146, v5
    v_fmac_f32 v9, v8, v8
    v_sub_f32 v8, v147, v5
    v_fmac_f32 v9, v8, v8
    v_sub_f32 v8, v148, v5
    v_fmac_f32 v9, v8, v8
    v_sub_f32 v8, v149, v5
    v_fmac_f32 v9, v8, v8
    v_sub_f32 v8, v150, v5
    v_fmac_f32 v9, v8, v8
    v_sub_f32 v8, v151, v5
    v_fmac_f32 v9, v8, v8
    v_sub_f32 v8, v152, v5
    v_fmac_f32 v9, v8, v8
    v_sub_f32 v8, v153, v5
    v_fmac_f32 v9, v8, v8
    v_sub_f32 v8, v154, v5
    v_fmac_f32 v9, v8, v8
    v_sub_f32 v8, v155, v5
    v_fmac_f32 v9, v8, v8
    v_sub_f32 v8, v156, v5
    v_fmac_f32 v9, v8, v8
    v_sub_f32 v8, v157, v5
    v_fmac_f32 v9, v8, v8
    v_sub_f32 v8, v158, v5
    v_fmac_f32 v9, v8, v8
    v_sub_f32 v8, v159, v5
    v_fmac_f32 v9, v8, v8
    v_sub_f32 v8, v160, v5
    v_fmac_f32 v9, v8, v8
    v_sub_f32 v8, v161, v5
    v_fmac_f32 v9, v8, v8
    v_sub_f32 v8, v162, v5
    v_fmac_f32 v9, v8, v8
    v_sub_f32 v8, v163, v5
    v_fmac_f32 v9, v8, v8
    v_sub_f32 v8, v164, v5
    v_fmac_f32 v9, v8, v8
    v_sub_f32 v8, v165, v5
    v_fmac_f32 v9, v8, v8
    v_sub_f32 v8, v166, v5
    v_fmac_f32 v9, v8, v8
    v_sub_f32 v8, v167, v5
    v_fmac_f32 v9, v8, v8
    v_sub_f32 v8, v168, v5
    v_fmac_f32 v9, v8, v8
    v_sub_f32 v8, v169, v5
    v_fmac_f32 v9, v8, v8
    v_sub_f32 v8, v170, v5
    v_fmac_f32 v9, v8, v8
    v_sub_f32 v8, v171, v5
    v_fmac_f32 v9, v8, v8
    v_sub_f32 v8, v172, v5
    v_fmac_f32 v9, v8, v8
    v_sub_f32 v8, v173, v5
    v_fmac_f32 v9, v8, v8
    v_sub_f32 v8, v174, v5
    v_fmac_f32 v9, v8, v8
    v_sub_f32 v8, v175, v5
    v_fmac_f32 v9, v8, v8
    v_sub_f32 v8, v176, v5
    v_fmac_f32 v9, v8, v8
    v_sub_f32 v8, v177, v5
    v_fmac_f32 v9, v8, v8
    v_sub_f32 v8, v178, v5
    v_fmac_f32 v9, v8, v8
    v_sub_f32 v8, v179, v5
    v_fmac_f32 v9, v8, v8
    v_sub_f32 v8, v180, v5
    v_fmac_f32 v9, v8, v8
    v_sub_f32 v8, v181, v5
    v_fmac_f32 v9, v8, v8
    v_sub_f32 v8, v182, v5
    v_fmac_f32 v9, v8, v8
    v_sub_f32 v8, v183, v5
    v_fmac_f32 v9, v8, v8
    v_sub_f32 v8, v184, v5
    v_fmac_f32 v9, v8, v8
    v_sub_f32 v8, v185, v5
    v_fmac_f32 v9, v8, v8
    v_sub_f32 v8, v186, v5
    v_fmac_f32 v9, v8, v8
    v_sub_f32 v8, v187, v5
    v_fmac_f32 v9, v8, v8
    v_sub_f32 v8, v188, v5
    v_fmac_f32 v9, v8, v8
    v_sub_f32 v8, v189, v5
    v_fmac_f32 v9, v8, v8
    v_sub_f32 v8, v190, v5
    v_fmac_f32 v9, v8, v8
    v_sub_f32 v8, v191, v5
    v_fmac_f32 v9, v8, v8
    v_sub_f32 v8, v192, v5
    v_fmac_f32 v9, v8, v8
    v_sub_f32 v8, v193, v5
    v_fmac_f32 v9, v8, v8
    v_sub_f32 v8, v194, v5
    v_fmac_f32 v9, v8, v8
    v_sub_f32 v8, v195, v5
    v_fmac_f32 v9, v8, v8
    v_sub_f32 v8, v196, v5
    v_fmac_f32 v9, v8, v8
    v_sub_f32 v8, v197, v5
    v_fmac_f32 v9, v8, v8
    v_sub_f32 v8, v198, v5
    v_fmac_f32 v9, v8, v8
    v_sub_f32 v8, v199, v5
    v_fmac_f32 v9, v8, v8
    v_sub_f32 v8, v200, v5
    v_fmac_f32 v9, v8, v8
    v_sub_f32 v8, v201, v5
    v_fmac_f32 v9, v8, v8
    v_sub_f32 v8, v202, v5
    v_fmac_f32 v9, v8, v8
    v_sub_f32 v8, v203, v5
    v_fmac_f32 v9, v8, v8
    v_sub_f32 v8, v204, v5
    v_fmac_f32 v9, v8, v8
    v_sub_f32 v8, v205, v5
    v_fmac_f32 v9, v8, v8
    v_sub_f32 v8, v206, v5
    v_fmac_f32 v9, v8, v8
    v_sub_f32 v8, v207, v5
    v_fmac_f32 v9, v8, v8
    v_sub_f32 v8, v208, v5
    v_fmac_f32 v9, v8, v8
    v_sub_f32 v8, v209, v5
    v_fmac_f32 v9, v8, v8
    v_sub_f32 v8, v210, v5
    v_fmac_f32 v9, v8, v8
    v_sub_f32 v8, v211, v5
    v_fmac_f32 v9, v8, v8
    v_sub_f32 v8, v212, v5
    v_fmac_f32 v9, v8, v8
    v_sub_f32 v8, v213, v5
    v_fmac_f32 v9, v8, v8
    v_sub_f32 v8, v214, v5
    v_fmac_f32 v9, v8, v8
    v_sub_f32 v8, v215, v5
    v_fmac_f32 v9, v8, v8
    v_sub_f32 v8, v216, v5
    v_fmac_f32 v9, v8, v8
    v_sub_f32 v8, v217, v5
    v_fmac_f32 v9, v8, v8
    v_sub_f32 v8, v218, v5
    v_fmac_f32 v9, v8, v8
    v_sub_f32 v8, v219, v5
    v_fmac_f32 v9, v8, v8
    v_sub_f32 v8, v220, v5
    v_fmac_f32 v9, v8, v8
    v_sub_f32 v8, v221, v5
    v_fmac_f32 v9, v8, v8
    v_sub_f32 v8, v222, v5
    v_fmac_f32 v9, v8, v8
    v_sub_f32 v8, v223, v5
    v_fmac_f32 v9, v8, v8
    v_sub_f32 v8, v224, v5
    v_fmac_f32 v9, v8, v8
    v_sub_f32 v8, v225, v5
    v_fmac_f32 v9, v8, v8
    v_sub_f32 v8, v226, v5
    v_fmac_f32 v9, v8, v8
    v_sub_f32 v8, v227, v5
    v_fmac_f32 v9, v8, v8
    v_sub_f32 v8, v228, v5
    v_fmac_f32 v9, v8, v8
    v_sub_f32 v8, v229, v5
    v_fmac_f32 v9, v8, v8
    v_sub_f32 v8, v230, v5
    v_fmac_f32 v9, v8, v8
    v_sub_f32 v8, v231, v5
    v_fmac_f32 v9, v8, v8
    v_sub_f32 v8, v232, v5
    v_fmac_f32 v9, v8, v8
    v_sub_f32 v8, v233, v5
    v_fmac_f32 v9, v8, v8
    v_sub_f32 v8, v234, v5
    v_fmac_f32 v9, v8, v8
    v_sub_f32 v8, v235, v5
    v_fmac_f32 v9, v8, v8
    v_sub_f32 v8, v236, v5
    v_fmac_f32 v9, v8, v8
    v_sub_f32 v8, v237, v5
    v_fmac_f32 v9, v8, v8
    v_sub_f32 v8, v238, v5
    v_fmac_f32 v9, v8, v8
    v_sub_f32 v8, v239, v5
    v_fmac_f32 v9, v8, v8
    v_sub_f32 v8, v240, v5
    v_fmac_f32 v9, v8, v8
    v_sub_f32 v8, v241, v5
    v_fmac_f32 v9, v8, v8
    v_sub_f32 v8, v242, v5
    v_fmac_f32 v9, v8, v8
    v_sub_f32 v8, v243, v5
    v_fmac_f32 v9, v8, v8
    v_sub_f32 v8, v244, v5
    v_fmac_f32 v9, v8, v8
    v_sub_f32 v8, v245, v5
    v_fmac_f32 v9, v8, v8
    v_sub_f32 v8, v246, v5
    v_fmac_f32 v9, v8, v8
    v_sub_f32 v8, v247, v5
    v_fmac_f32 v9, v8, v8
    v_sub_f32 v8, v248, v5
    v_fmac_f32 v9, v8, v8
    v_sub_f32 v8, v249, v5
    v_fmac_f32 v9, v8, v8
    v_sub_f32 v8, v250, v5
    v_fmac_f32 v9, v8, v8
    v_sub_f32 v8, v251, v5
    v_fmac_f32 v9, v8, v8
    v_sub_f32 v8, v252, v5
    v_fmac_f32 v9, v8, v8
    v_sub_f32 v8, v253, v5
    v_fmac_f32 v9, v8, v8
    v_sub_f32 v8, v254, v5
    v_fmac_f32 v9, v8, v8
    v_sub_f32 v8, v255, v5
    v_fmac_f32 v9, v8, v8
    ds_bpermute_b32 v8, v6, v9
    s_waitcnt lgkmcnt(0)
    v_add_f32 v9, v9, v8
    ds_bpermute_b32 v8, v7, v9
    s_waitcnt lgkmcnt(0)
    v_add_f32 v9, v9, v8
    v_mul_f32 v9, 0x3acccccd, v9
    v_cvt_pk_bf16_f32 v8, v9, v9
    v_lshlrev_b32 v9, 16, v8
    v_add_f32 v9, 0x3727c5ac, v9
    v_cvt_pk_bf16_f32 v8, v9, v9
    v_lshlrev_b32 v9, 16, v8
    v_sqrt_f32 v9, v9
    s_nop 0
    v_cvt_pk_bf16_f32 v8, v9, v9
    v_lshlrev_b32 v9, 16, v8
    v_rcp_f32 v9, v9
    v_cvt_pk_bf16_f32 v8, v5, v5
    v_lshlrev_b32 v5, 16, v8
    v_lshlrev_b32 v10, 4, v2
    v_lshlrev_b32 v11, 2, v0
    s_mov_b32 s42, 0
    s_mov_b32 exec_hi, 0x0fffffff
L_prep_wm:
    buffer_load_dword v12, v11, s[24:27], 0 offen sc1
    s_waitcnt vmcnt(0)
    v_cmp_ne_u32 vcc, 1, v12
    s_cbranch_vccz L_prep_wmok
    s_add_u32 s42, s42, 1
    s_cmp_lt_u32 s42, 400000
    s_cbranch_scc1 L_prep_wm
L_prep_wmok:
    s_mov_b64 exec, -1
    buffer_load_dwordx4 v[16:19], v10, s[4:7], 0 offen offset:1280
    buffer_load_dwordx4 v[20:23], v10, s[4:7], 0 offen offset:1344
    buffer_load_dwordx4 v[24:27], v10, s[4:7], 0 offen offset:1408
    buffer_load_dwordx4 v[28:31], v10, s[4:7], 0 offen offset:1472
    buffer_load_dwordx4 v[32:35], v10, s[4:7], 0 offen offset:1536
    buffer_load_dwordx4 v[36:39], v10, s[4:7], 0 offen offset:1600
    buffer_load_dwordx4 v[40:43], v10, s[4:7], 0 offen offset:1664
    buffer_load_dwordx4 v[44:47], v10, s[4:7], 0 offen offset:1728
    buffer_load_dwordx4 v[48:51], v10, s[4:7], 0 offen offset:1792
    buffer_load_dwordx4 v[52:55], v10, s[4:7], 0 offen offset:1856
    buffer_load_dwordx4 v[56:59], v10, s[4:7], 0 offen offset:1920
    buffer_load_dwordx4 v[60:63], v10, s[4:7], 0 offen offset:1984
    buffer_load_dwordx4 v[64:67], v10, s[4:7], 0 offen offset:2048
    buffer_load_dwordx4 v[68:71], v10, s[4:7], 0 offen offset:2112
    buffer_load_dwordx4 v[72:75], v10, s[4:7], 0 offen offset:2176
    buffer_load_dwordx4 v[76:79], v10, s[4:7], 0 offen offset:2240
    buffer_load_dwordx4 v[80:83], v10, s[4:7], 0 offen offset:2304
    buffer_load_dwordx4 v[84:87], v10, s[4:7], 0 offen offset:2368
    buffer_load_dwordx4 v[88:91], v10, s[4:7], 0 offen offset:2432
    buffer_load_dwordx4 v[92:95], v10, s[4:7], 0 offen offset:2496
    v_sub_f32 v96, v96, v5
    v_sub_f32 v97, v97, v5
    v_cvt_pk_bf16_f32 v8, v96, v97
    v_lshlrev_b32 v96, 16, v8
    v_and_b32 v97, 0xffff0000, v8
    v_mul_f32 v96, v96, v9
    v_mul_f32 v97, v97, v9
    v_cvt_pk_bf16_f32 v8, v96, v97
    v_lshlrev_b32 v96, 16, v8
    v_and_b32 v97, 0xffff0000, v8
    v_sub_f32 v98, v98, v5
    v_sub_f32 v99, v99, v5
    v_cvt_pk_bf16_f32 v8, v98, v99
    v_lshlrev_b32 v98, 16, v8
    v_and_b32 v99, 0xffff0000, v8
    v_mul_f32 v98, v98, v9
    v_mul_f32 v99, v99, v9
    v_cvt_pk_bf16_f32 v8, v98, v99
    v_lshlrev_b32 v98, 16, v8
    v_and_b32 v99, 0xffff0000, v8
    v_sub_f32 v100, v100, v5
    v_sub_f32 v101, v101, v5
    v_cvt_pk_bf16_f32 v8, v100, v101
    v_lshlrev_b32 v100, 16, v8
    v_and_b32 v101, 0xffff0000, v8
    v_mul_f32 v100, v100, v9
    v_mul_f32 v101, v101, v9
    v_cvt_pk_bf16_f32 v8, v100, v101
    v_lshlrev_b32 v100, 16, v8
    v_and_b32 v101, 0xffff0000, v8
    v_sub_f32 v102, v102, v5
    v_sub_f32 v103, v103, v5
    v_cvt_pk_bf16_f32 v8, v102, v103
    v_lshlrev_b32 v102, 16, v8
    v_and_b32 v103, 0xffff0000, v8
    v_mul_f32 v102, v102, v9
    v_mul_f32 v103, v103, v9
    v_cvt_pk_bf16_f32 v8, v102, v103
    v_lshlrev_b32 v102, 16, v8
    v_and_b32 v103, 0xffff0000, v8
    v_sub_f32 v104, v104, v5
    v_sub_f32 v105, v105, v5
    v_cvt_pk_bf16_f32 v8, v104, v105
    v_lshlrev_b32 v104, 16, v8
    v_and_b32 v105, 0xffff0000, v8
    v_mul_f32 v104, v104, v9
    v_mul_f32 v105, v105, v9
    v_cvt_pk_bf16_f32 v8, v104, v105
    v_lshlrev_b32 v104, 16, v8
    v_and_b32 v105, 0xffff0000, v8
    v_sub_f32 v106, v106, v5
    v_sub_f32 v107, v107, v5
    v_cvt_pk_bf16_f32 v8, v106, v107
    v_lshlrev_b32 v106, 16, v8
    v_and_b32 v107, 0xffff0000, v8
    v_mul_f32 v106, v106, v9
    v_mul_f32 v107, v107, v9
    v_cvt_pk_bf16_f32 v8, v106, v107
    v_lshlrev_b32 v106, 16, v8
    v_and_b32 v107, 0xffff0000, v8
    v_sub_f32 v108, v108, v5
    v_sub_f32 v109, v109, v5
    v_cvt_pk_bf16_f32 v8, v108, v109
    v_lshlrev_b32 v108, 16, v8
    v_and_b32 v109, 0xffff0000, v8
    v_mul_f32 v108, v108, v9
    v_mul_f32 v109, v109, v9
    v_cvt_pk_bf16_f32 v8, v108, v109
    v_lshlrev_b32 v108, 16, v8
    v_and_b32 v109, 0xffff0000, v8
    v_sub_f32 v110, v110, v5
    v_sub_f32 v111, v111, v5
    v_cvt_pk_bf16_f32 v8, v110, v111
    v_lshlrev_b32 v110, 16, v8
    v_and_b32 v111, 0xffff0000, v8
    v_mul_f32 v110, v110, v9
    v_mul_f32 v111, v111, v9
    v_cvt_pk_bf16_f32 v8, v110, v111
    v_lshlrev_b32 v110, 16, v8
    v_and_b32 v111, 0xffff0000, v8
    v_sub_f32 v112, v112, v5
    v_sub_f32 v113, v113, v5
    v_cvt_pk_bf16_f32 v8, v112, v113
    v_lshlrev_b32 v112, 16, v8
    v_and_b32 v113, 0xffff0000, v8
    v_mul_f32 v112, v112, v9
    v_mul_f32 v113, v113, v9
    v_cvt_pk_bf16_f32 v8, v112, v113
    v_lshlrev_b32 v112, 16, v8
    v_and_b32 v113, 0xffff0000, v8
    v_sub_f32 v114, v114, v5
    v_sub_f32 v115, v115, v5
    v_cvt_pk_bf16_f32 v8, v114, v115
    v_lshlrev_b32 v114, 16, v8
    v_and_b32 v115, 0xffff0000, v8
    v_mul_f32 v114, v114, v9
    v_mul_f32 v115, v115, v9
    v_cvt_pk_bf16_f32 v8, v114, v115
    v_lshlrev_b32 v114, 16, v8
    v_and_b32 v115, 0xffff0000, v8
    v_sub_f32 v116, v116, v5
    v_sub_f32 v117, v117, v5
    v_cvt_pk_bf16_f32 v8, v116, v117
    v_lshlrev_b32 v116, 16, v8
    v_and_b32 v117, 0xffff0000, v8
    v_mul_f32 v116, v116, v9
    v_mul_f32 v117, v117, v9
    v_cvt_pk_bf16_f32 v8, v116, v117
    v_lshlrev_b32 v116, 16, v8
    v_and_b32 v117, 0xffff0000, v8
    v_sub_f32 v118, v118, v5
    v_sub_f32 v119, v119, v5
    v_cvt_pk_bf16_f32 v8, v118, v119
    v_lshlrev_b32 v118, 16, v8
    v_and_b32 v119, 0xffff0000, v8
    v_mul_f32 v118, v118, v9
    v_mul_f32 v119, v119, v9
    v_cvt_pk_bf16_f32 v8, v118, v119
    v_lshlrev_b32 v118, 16, v8
    v_and_b32 v119, 0xffff0000, v8
    v_sub_f32 v120, v120, v5
    v_sub_f32 v121, v121, v5
    v_cvt_pk_bf16_f32 v8, v120, v121
    v_lshlrev_b32 v120, 16, v8
    v_and_b32 v121, 0xffff0000, v8
    v_mul_f32 v120, v120, v9
    v_mul_f32 v121, v121, v9
    v_cvt_pk_bf16_f32 v8, v120, v121
    v_lshlrev_b32 v120, 16, v8
    v_and_b32 v121, 0xffff0000, v8
    v_sub_f32 v122, v122, v5
    v_sub_f32 v123, v123, v5
    v_cvt_pk_bf16_f32 v8, v122, v123
    v_lshlrev_b32 v122, 16, v8
    v_and_b32 v123, 0xffff0000, v8
    v_mul_f32 v122, v122, v9
    v_mul_f32 v123, v123, v9
    v_cvt_pk_bf16_f32 v8, v122, v123
    v_lshlrev_b32 v122, 16, v8
    v_and_b32 v123, 0xffff0000, v8
    v_sub_f32 v124, v124, v5
    v_sub_f32 v125, v125, v5
    v_cvt_pk_bf16_f32 v8, v124, v125
    v_lshlrev_b32 v124, 16, v8
    v_and_b32 v125, 0xffff0000, v8
    v_mul_f32 v124, v124, v9
    v_mul_f32 v125, v125, v9
    v_cvt_pk_bf16_f32 v8, v124, v125
    v_lshlrev_b32 v124, 16, v8
    v_and_b32 v125, 0xffff0000, v8
    v_sub_f32 v126, v126, v5
    v_sub_f32 v127, v127, v5
    v_cvt_pk_bf16_f32 v8, v126, v127
    v_lshlrev_b32 v126, 16, v8
    v_and_b32 v127, 0xffff0000, v8
    v_mul_f32 v126, v126, v9
    v_mul_f32 v127, v127, v9
    v_cvt_pk_bf16_f32 v8, v126, v127
    v_lshlrev_b32 v126, 16, v8
    v_and_b32 v127, 0xffff0000, v8
    v_sub_f32 v128, v128, v5
    v_sub_f32 v129, v129, v5
    v_cvt_pk_bf16_f32 v8, v128, v129
    v_lshlrev_b32 v128, 16, v8
    v_and_b32 v129, 0xffff0000, v8
    v_mul_f32 v128, v128, v9
    v_mul_f32 v129, v129, v9
    v_cvt_pk_bf16_f32 v8, v128, v129
    v_lshlrev_b32 v128, 16, v8
    v_and_b32 v129, 0xffff0000, v8
    v_sub_f32 v130, v130, v5
    v_sub_f32 v131, v131, v5
    v_cvt_pk_bf16_f32 v8, v130, v131
    v_lshlrev_b32 v130, 16, v8
    v_and_b32 v131, 0xffff0000, v8
    v_mul_f32 v130, v130, v9
    v_mul_f32 v131, v131, v9
    v_cvt_pk_bf16_f32 v8, v130, v131
    v_lshlrev_b32 v130, 16, v8
    v_and_b32 v131, 0xffff0000, v8
    v_sub_f32 v132, v132, v5
    v_sub_f32 v133, v133, v5
    v_cvt_pk_bf16_f32 v8, v132, v133
    v_lshlrev_b32 v132, 16, v8
    v_and_b32 v133, 0xffff0000, v8
    v_mul_f32 v132, v132, v9
    v_mul_f32 v133, v133, v9
    v_cvt_pk_bf16_f32 v8, v132, v133
    v_lshlrev_b32 v132, 16, v8
    v_and_b32 v133, 0xffff0000, v8
    v_sub_f32 v134, v134, v5
    v_sub_f32 v135, v135, v5
    v_cvt_pk_bf16_f32 v8, v134, v135
    v_lshlrev_b32 v134, 16, v8
    v_and_b32 v135, 0xffff0000, v8
    v_mul_f32 v134, v134, v9
    v_mul_f32 v135, v135, v9
    v_cvt_pk_bf16_f32 v8, v134, v135
    v_lshlrev_b32 v134, 16, v8
    v_and_b32 v135, 0xffff0000, v8
    v_sub_f32 v136, v136, v5
    v_sub_f32 v137, v137, v5
    v_cvt_pk_bf16_f32 v8, v136, v137
    v_lshlrev_b32 v136, 16, v8
    v_and_b32 v137, 0xffff0000, v8
    v_mul_f32 v136, v136, v9
    v_mul_f32 v137, v137, v9
    v_cvt_pk_bf16_f32 v8, v136, v137
    v_lshlrev_b32 v136, 16, v8
    v_and_b32 v137, 0xffff0000, v8
    v_sub_f32 v138, v138, v5
    v_sub_f32 v139, v139, v5
    v_cvt_pk_bf16_f32 v8, v138, v139
    v_lshlrev_b32 v138, 16, v8
    v_and_b32 v139, 0xffff0000, v8
    v_mul_f32 v138, v138, v9
    v_mul_f32 v139, v139, v9
    v_cvt_pk_bf16_f32 v8, v138, v139
    v_lshlrev_b32 v138, 16, v8
    v_and_b32 v139, 0xffff0000, v8
    v_sub_f32 v140, v140, v5
    v_sub_f32 v141, v141, v5
    v_cvt_pk_bf16_f32 v8, v140, v141
    v_lshlrev_b32 v140, 16, v8
    v_and_b32 v141, 0xffff0000, v8
    v_mul_f32 v140, v140, v9
    v_mul_f32 v141, v141, v9
    v_cvt_pk_bf16_f32 v8, v140, v141
    v_lshlrev_b32 v140, 16, v8
    v_and_b32 v141, 0xffff0000, v8
    v_sub_f32 v142, v142, v5
    v_sub_f32 v143, v143, v5
    v_cvt_pk_bf16_f32 v8, v142, v143
    v_lshlrev_b32 v142, 16, v8
    v_and_b32 v143, 0xffff0000, v8
    v_mul_f32 v142, v142, v9
    v_mul_f32 v143, v143, v9
    v_cvt_pk_bf16_f32 v8, v142, v143
    v_lshlrev_b32 v142, 16, v8
    v_and_b32 v143, 0xffff0000, v8
    v_sub_f32 v144, v144, v5
    v_sub_f32 v145, v145, v5
    v_cvt_pk_bf16_f32 v8, v144, v145
    v_lshlrev_b32 v144, 16, v8
    v_and_b32 v145, 0xffff0000, v8
    v_mul_f32 v144, v144, v9
    v_mul_f32 v145, v145, v9
    v_cvt_pk_bf16_f32 v8, v144, v145
    v_lshlrev_b32 v144, 16, v8
    v_and_b32 v145, 0xffff0000, v8
    v_sub_f32 v146, v146, v5
    v_sub_f32 v147, v147, v5
    v_cvt_pk_bf16_f32 v8, v146, v147
    v_lshlrev_b32 v146, 16, v8
    v_and_b32 v147, 0xffff0000, v8
    v_mul_f32 v146, v146, v9
    v_mul_f32 v147, v147, v9
    v_cvt_pk_bf16_f32 v8, v146, v147
    v_lshlrev_b32 v146, 16, v8
    v_and_b32 v147, 0xffff0000, v8
    v_sub_f32 v148, v148, v5
    v_sub_f32 v149, v149, v5
    v_cvt_pk_bf16_f32 v8, v148, v149
    v_lshlrev_b32 v148, 16, v8
    v_and_b32 v149, 0xffff0000, v8
    v_mul_f32 v148, v148, v9
    v_mul_f32 v149, v149, v9
    v_cvt_pk_bf16_f32 v8, v148, v149
    v_lshlrev_b32 v148, 16, v8
    v_and_b32 v149, 0xffff0000, v8
    v_sub_f32 v150, v150, v5
    v_sub_f32 v151, v151, v5
    v_cvt_pk_bf16_f32 v8, v150, v151
    v_lshlrev_b32 v150, 16, v8
    v_and_b32 v151, 0xffff0000, v8
    v_mul_f32 v150, v150, v9
    v_mul_f32 v151, v151, v9
    v_cvt_pk_bf16_f32 v8, v150, v151
    v_lshlrev_b32 v150, 16, v8
    v_and_b32 v151, 0xffff0000, v8
    v_sub_f32 v152, v152, v5
    v_sub_f32 v153, v153, v5
    v_cvt_pk_bf16_f32 v8, v152, v153
    v_lshlrev_b32 v152, 16, v8
    v_and_b32 v153, 0xffff0000, v8
    v_mul_f32 v152, v152, v9
    v_mul_f32 v153, v153, v9
    v_cvt_pk_bf16_f32 v8, v152, v153
    v_lshlrev_b32 v152, 16, v8
    v_and_b32 v153, 0xffff0000, v8
    v_sub_f32 v154, v154, v5
    v_sub_f32 v155, v155, v5
    v_cvt_pk_bf16_f32 v8, v154, v155
    v_lshlrev_b32 v154, 16, v8
    v_and_b32 v155, 0xffff0000, v8
    v_mul_f32 v154, v154, v9
    v_mul_f32 v155, v155, v9
    v_cvt_pk_bf16_f32 v8, v154, v155
    v_lshlrev_b32 v154, 16, v8
    v_and_b32 v155, 0xffff0000, v8
    v_sub_f32 v156, v156, v5
    v_sub_f32 v157, v157, v5
    v_cvt_pk_bf16_f32 v8, v156, v157
    v_lshlrev_b32 v156, 16, v8
    v_and_b32 v157, 0xffff0000, v8
    v_mul_f32 v156, v156, v9
    v_mul_f32 v157, v157, v9
    v_cvt_pk_bf16_f32 v8, v156, v157
    v_lshlrev_b32 v156, 16, v8
    v_and_b32 v157, 0xffff0000, v8
    v_sub_f32 v158, v158, v5
    v_sub_f32 v159, v159, v5
    v_cvt_pk_bf16_f32 v8, v158, v159
    v_lshlrev_b32 v158, 16, v8
    v_and_b32 v159, 0xffff0000, v8
    v_mul_f32 v158, v158, v9
    v_mul_f32 v159, v159, v9
    v_cvt_pk_bf16_f32 v8, v158, v159
    v_lshlrev_b32 v158, 16, v8
    v_and_b32 v159, 0xffff0000, v8
    v_sub_f32 v160, v160, v5
    v_sub_f32 v161, v161, v5
    v_cvt_pk_bf16_f32 v8, v160, v161
    v_lshlrev_b32 v160, 16, v8
    v_and_b32 v161, 0xffff0000, v8
    v_mul_f32 v160, v160, v9
    v_mul_f32 v161, v161, v9
    v_cvt_pk_bf16_f32 v8, v160, v161
    v_lshlrev_b32 v160, 16, v8
    v_and_b32 v161, 0xffff0000, v8
    v_sub_f32 v162, v162, v5
    v_sub_f32 v163, v163, v5
    v_cvt_pk_bf16_f32 v8, v162, v163
    v_lshlrev_b32 v162, 16, v8
    v_and_b32 v163, 0xffff0000, v8
    v_mul_f32 v162, v162, v9
    v_mul_f32 v163, v163, v9
    v_cvt_pk_bf16_f32 v8, v162, v163
    v_lshlrev_b32 v162, 16, v8
    v_and_b32 v163, 0xffff0000, v8
    v_sub_f32 v164, v164, v5
    v_sub_f32 v165, v165, v5
    v_cvt_pk_bf16_f32 v8, v164, v165
    v_lshlrev_b32 v164, 16, v8
    v_and_b32 v165, 0xffff0000, v8
    v_mul_f32 v164, v164, v9
    v_mul_f32 v165, v165, v9
    v_cvt_pk_bf16_f32 v8, v164, v165
    v_lshlrev_b32 v164, 16, v8
    v_and_b32 v165, 0xffff0000, v8
    v_sub_f32 v166, v166, v5
    v_sub_f32 v167, v167, v5
    v_cvt_pk_bf16_f32 v8, v166, v167
    v_lshlrev_b32 v166, 16, v8
    v_and_b32 v167, 0xffff0000, v8
    v_mul_f32 v166, v166, v9
    v_mul_f32 v167, v167, v9
    v_cvt_pk_bf16_f32 v8, v166, v167
    v_lshlrev_b32 v166, 16, v8
    v_and_b32 v167, 0xffff0000, v8
    v_sub_f32 v168, v168, v5
    v_sub_f32 v169, v169, v5
    v_cvt_pk_bf16_f32 v8, v168, v169
    v_lshlrev_b32 v168, 16, v8
    v_and_b32 v169, 0xffff0000, v8
    v_mul_f32 v168, v168, v9
    v_mul_f32 v169, v169, v9
    v_cvt_pk_bf16_f32 v8, v168, v169
    v_lshlrev_b32 v168, 16, v8
    v_and_b32 v169, 0xffff0000, v8
    v_sub_f32 v170, v170, v5
    v_sub_f32 v171, v171, v5
    v_cvt_pk_bf16_f32 v8, v170, v171
    v_lshlrev_b32 v170, 16, v8
    v_and_b32 v171, 0xffff0000, v8
    v_mul_f32 v170, v170, v9
    v_mul_f32 v171, v171, v9
    v_cvt_pk_bf16_f32 v8, v170, v171
    v_lshlrev_b32 v170, 16, v8
    v_and_b32 v171, 0xffff0000, v8
    v_sub_f32 v172, v172, v5
    v_sub_f32 v173, v173, v5
    v_cvt_pk_bf16_f32 v8, v172, v173
    v_lshlrev_b32 v172, 16, v8
    v_and_b32 v173, 0xffff0000, v8
    v_mul_f32 v172, v172, v9
    v_mul_f32 v173, v173, v9
    v_cvt_pk_bf16_f32 v8, v172, v173
    v_lshlrev_b32 v172, 16, v8
    v_and_b32 v173, 0xffff0000, v8
    v_sub_f32 v174, v174, v5
    v_sub_f32 v175, v175, v5
    v_cvt_pk_bf16_f32 v8, v174, v175
    v_lshlrev_b32 v174, 16, v8
    v_and_b32 v175, 0xffff0000, v8
    v_mul_f32 v174, v174, v9
    v_mul_f32 v175, v175, v9
    v_cvt_pk_bf16_f32 v8, v174, v175
    v_lshlrev_b32 v174, 16, v8
    v_and_b32 v175, 0xffff0000, v8
    v_sub_f32 v176, v176, v5
    v_sub_f32 v177, v177, v5
    v_cvt_pk_bf16_f32 v8, v176, v177
    v_lshlrev_b32 v176, 16, v8
    v_and_b32 v177, 0xffff0000, v8
    v_mul_f32 v176, v176, v9
    v_mul_f32 v177, v177, v9
    v_cvt_pk_bf16_f32 v8, v176, v177
    v_lshlrev_b32 v176, 16, v8
    v_and_b32 v177, 0xffff0000, v8
    v_sub_f32 v178, v178, v5
    v_sub_f32 v179, v179, v5
    v_cvt_pk_bf16_f32 v8, v178, v179
    v_lshlrev_b32 v178, 16, v8
    v_and_b32 v179, 0xffff0000, v8
    v_mul_f32 v178, v178, v9
    v_mul_f32 v179, v179, v9
    v_cvt_pk_bf16_f32 v8, v178, v179
    v_lshlrev_b32 v178, 16, v8
    v_and_b32 v179, 0xffff0000, v8
    v_sub_f32 v180, v180, v5
    v_sub_f32 v181, v181, v5
    v_cvt_pk_bf16_f32 v8, v180, v181
    v_lshlrev_b32 v180, 16, v8
    v_and_b32 v181, 0xffff0000, v8
    v_mul_f32 v180, v180, v9
    v_mul_f32 v181, v181, v9
    v_cvt_pk_bf16_f32 v8, v180, v181
    v_lshlrev_b32 v180, 16, v8
    v_and_b32 v181, 0xffff0000, v8
    v_sub_f32 v182, v182, v5
    v_sub_f32 v183, v183, v5
    v_cvt_pk_bf16_f32 v8, v182, v183
    v_lshlrev_b32 v182, 16, v8
    v_and_b32 v183, 0xffff0000, v8
    v_mul_f32 v182, v182, v9
    v_mul_f32 v183, v183, v9
    v_cvt_pk_bf16_f32 v8, v182, v183
    v_lshlrev_b32 v182, 16, v8
    v_and_b32 v183, 0xffff0000, v8
    v_sub_f32 v184, v184, v5
    v_sub_f32 v185, v185, v5
    v_cvt_pk_bf16_f32 v8, v184, v185
    v_lshlrev_b32 v184, 16, v8
    v_and_b32 v185, 0xffff0000, v8
    v_mul_f32 v184, v184, v9
    v_mul_f32 v185, v185, v9
    v_cvt_pk_bf16_f32 v8, v184, v185
    v_lshlrev_b32 v184, 16, v8
    v_and_b32 v185, 0xffff0000, v8
    v_sub_f32 v186, v186, v5
    v_sub_f32 v187, v187, v5
    v_cvt_pk_bf16_f32 v8, v186, v187
    v_lshlrev_b32 v186, 16, v8
    v_and_b32 v187, 0xffff0000, v8
    v_mul_f32 v186, v186, v9
    v_mul_f32 v187, v187, v9
    v_cvt_pk_bf16_f32 v8, v186, v187
    v_lshlrev_b32 v186, 16, v8
    v_and_b32 v187, 0xffff0000, v8
    v_sub_f32 v188, v188, v5
    v_sub_f32 v189, v189, v5
    v_cvt_pk_bf16_f32 v8, v188, v189
    v_lshlrev_b32 v188, 16, v8
    v_and_b32 v189, 0xffff0000, v8
    v_mul_f32 v188, v188, v9
    v_mul_f32 v189, v189, v9
    v_cvt_pk_bf16_f32 v8, v188, v189
    v_lshlrev_b32 v188, 16, v8
    v_and_b32 v189, 0xffff0000, v8
    v_sub_f32 v190, v190, v5
    v_sub_f32 v191, v191, v5
    v_cvt_pk_bf16_f32 v8, v190, v191
    v_lshlrev_b32 v190, 16, v8
    v_and_b32 v191, 0xffff0000, v8
    v_mul_f32 v190, v190, v9
    v_mul_f32 v191, v191, v9
    v_cvt_pk_bf16_f32 v8, v190, v191
    v_lshlrev_b32 v190, 16, v8
    v_and_b32 v191, 0xffff0000, v8
    v_sub_f32 v192, v192, v5
    v_sub_f32 v193, v193, v5
    v_cvt_pk_bf16_f32 v8, v192, v193
    v_lshlrev_b32 v192, 16, v8
    v_and_b32 v193, 0xffff0000, v8
    v_mul_f32 v192, v192, v9
    v_mul_f32 v193, v193, v9
    v_cvt_pk_bf16_f32 v8, v192, v193
    v_lshlrev_b32 v192, 16, v8
    v_and_b32 v193, 0xffff0000, v8
    v_sub_f32 v194, v194, v5
    v_sub_f32 v195, v195, v5
    v_cvt_pk_bf16_f32 v8, v194, v195
    v_lshlrev_b32 v194, 16, v8
    v_and_b32 v195, 0xffff0000, v8
    v_mul_f32 v194, v194, v9
    v_mul_f32 v195, v195, v9
    v_cvt_pk_bf16_f32 v8, v194, v195
    v_lshlrev_b32 v194, 16, v8
    v_and_b32 v195, 0xffff0000, v8
    v_sub_f32 v196, v196, v5
    v_sub_f32 v197, v197, v5
    v_cvt_pk_bf16_f32 v8, v196, v197
    v_lshlrev_b32 v196, 16, v8
    v_and_b32 v197, 0xffff0000, v8
    v_mul_f32 v196, v196, v9
    v_mul_f32 v197, v197, v9
    v_cvt_pk_bf16_f32 v8, v196, v197
    v_lshlrev_b32 v196, 16, v8
    v_and_b32 v197, 0xffff0000, v8
    v_sub_f32 v198, v198, v5
    v_sub_f32 v199, v199, v5
    v_cvt_pk_bf16_f32 v8, v198, v199
    v_lshlrev_b32 v198, 16, v8
    v_and_b32 v199, 0xffff0000, v8
    v_mul_f32 v198, v198, v9
    v_mul_f32 v199, v199, v9
    v_cvt_pk_bf16_f32 v8, v198, v199
    v_lshlrev_b32 v198, 16, v8
    v_and_b32 v199, 0xffff0000, v8
    v_sub_f32 v200, v200, v5
    v_sub_f32 v201, v201, v5
    v_cvt_pk_bf16_f32 v8, v200, v201
    v_lshlrev_b32 v200, 16, v8
    v_and_b32 v201, 0xffff0000, v8
    v_mul_f32 v200, v200, v9
    v_mul_f32 v201, v201, v9
    v_cvt_pk_bf16_f32 v8, v200, v201
    v_lshlrev_b32 v200, 16, v8
    v_and_b32 v201, 0xffff0000, v8
    v_sub_f32 v202, v202, v5
    v_sub_f32 v203, v203, v5
    v_cvt_pk_bf16_f32 v8, v202, v203
    v_lshlrev_b32 v202, 16, v8
    v_and_b32 v203, 0xffff0000, v8
    v_mul_f32 v202, v202, v9
    v_mul_f32 v203, v203, v9
    v_cvt_pk_bf16_f32 v8, v202, v203
    v_lshlrev_b32 v202, 16, v8
    v_and_b32 v203, 0xffff0000, v8
    v_sub_f32 v204, v204, v5
    v_sub_f32 v205, v205, v5
    v_cvt_pk_bf16_f32 v8, v204, v205
    v_lshlrev_b32 v204, 16, v8
    v_and_b32 v205, 0xffff0000, v8
    v_mul_f32 v204, v204, v9
    v_mul_f32 v205, v205, v9
    v_cvt_pk_bf16_f32 v8, v204, v205
    v_lshlrev_b32 v204, 16, v8
    v_and_b32 v205, 0xffff0000, v8
    v_sub_f32 v206, v206, v5
    v_sub_f32 v207, v207, v5
    v_cvt_pk_bf16_f32 v8, v206, v207
    v_lshlrev_b32 v206, 16, v8
    v_and_b32 v207, 0xffff0000, v8
    v_mul_f32 v206, v206, v9
    v_mul_f32 v207, v207, v9
    v_cvt_pk_bf16_f32 v8, v206, v207
    v_lshlrev_b32 v206, 16, v8
    v_and_b32 v207, 0xffff0000, v8
    v_sub_f32 v208, v208, v5
    v_sub_f32 v209, v209, v5
    v_cvt_pk_bf16_f32 v8, v208, v209
    v_lshlrev_b32 v208, 16, v8
    v_and_b32 v209, 0xffff0000, v8
    v_mul_f32 v208, v208, v9
    v_mul_f32 v209, v209, v9
    v_cvt_pk_bf16_f32 v8, v208, v209
    v_lshlrev_b32 v208, 16, v8
    v_and_b32 v209, 0xffff0000, v8
    v_sub_f32 v210, v210, v5
    v_sub_f32 v211, v211, v5
    v_cvt_pk_bf16_f32 v8, v210, v211
    v_lshlrev_b32 v210, 16, v8
    v_and_b32 v211, 0xffff0000, v8
    v_mul_f32 v210, v210, v9
    v_mul_f32 v211, v211, v9
    v_cvt_pk_bf16_f32 v8, v210, v211
    v_lshlrev_b32 v210, 16, v8
    v_and_b32 v211, 0xffff0000, v8
    v_sub_f32 v212, v212, v5
    v_sub_f32 v213, v213, v5
    v_cvt_pk_bf16_f32 v8, v212, v213
    v_lshlrev_b32 v212, 16, v8
    v_and_b32 v213, 0xffff0000, v8
    v_mul_f32 v212, v212, v9
    v_mul_f32 v213, v213, v9
    v_cvt_pk_bf16_f32 v8, v212, v213
    v_lshlrev_b32 v212, 16, v8
    v_and_b32 v213, 0xffff0000, v8
    v_sub_f32 v214, v214, v5
    v_sub_f32 v215, v215, v5
    v_cvt_pk_bf16_f32 v8, v214, v215
    v_lshlrev_b32 v214, 16, v8
    v_and_b32 v215, 0xffff0000, v8
    v_mul_f32 v214, v214, v9
    v_mul_f32 v215, v215, v9
    v_cvt_pk_bf16_f32 v8, v214, v215
    v_lshlrev_b32 v214, 16, v8
    v_and_b32 v215, 0xffff0000, v8
    v_sub_f32 v216, v216, v5
    v_sub_f32 v217, v217, v5
    v_cvt_pk_bf16_f32 v8, v216, v217
    v_lshlrev_b32 v216, 16, v8
    v_and_b32 v217, 0xffff0000, v8
    v_mul_f32 v216, v216, v9
    v_mul_f32 v217, v217, v9
    v_cvt_pk_bf16_f32 v8, v216, v217
    v_lshlrev_b32 v216, 16, v8
    v_and_b32 v217, 0xffff0000, v8
    v_sub_f32 v218, v218, v5
    v_sub_f32 v219, v219, v5
    v_cvt_pk_bf16_f32 v8, v218, v219
    v_lshlrev_b32 v218, 16, v8
    v_and_b32 v219, 0xffff0000, v8
    v_mul_f32 v218, v218, v9
    v_mul_f32 v219, v219, v9
    v_cvt_pk_bf16_f32 v8, v218, v219
    v_lshlrev_b32 v218, 16, v8
    v_and_b32 v219, 0xffff0000, v8
    v_sub_f32 v220, v220, v5
    v_sub_f32 v221, v221, v5
    v_cvt_pk_bf16_f32 v8, v220, v221
    v_lshlrev_b32 v220, 16, v8
    v_and_b32 v221, 0xffff0000, v8
    v_mul_f32 v220, v220, v9
    v_mul_f32 v221, v221, v9
    v_cvt_pk_bf16_f32 v8, v220, v221
    v_lshlrev_b32 v220, 16, v8
    v_and_b32 v221, 0xffff0000, v8
    v_sub_f32 v222, v222, v5
    v_sub_f32 v223, v223, v5
    v_cvt_pk_bf16_f32 v8, v222, v223
    v_lshlrev_b32 v222, 16, v8
    v_and_b32 v223, 0xffff0000, v8
    v_mul_f32 v222, v222, v9
    v_mul_f32 v223, v223, v9
    v_cvt_pk_bf16_f32 v8, v222, v223
    v_lshlrev_b32 v222, 16, v8
    v_and_b32 v223, 0xffff0000, v8
    v_sub_f32 v224, v224, v5
    v_sub_f32 v225, v225, v5
    v_cvt_pk_bf16_f32 v8, v224, v225
    v_lshlrev_b32 v224, 16, v8
    v_and_b32 v225, 0xffff0000, v8
    v_mul_f32 v224, v224, v9
    v_mul_f32 v225, v225, v9
    v_cvt_pk_bf16_f32 v8, v224, v225
    v_lshlrev_b32 v224, 16, v8
    v_and_b32 v225, 0xffff0000, v8
    v_sub_f32 v226, v226, v5
    v_sub_f32 v227, v227, v5
    v_cvt_pk_bf16_f32 v8, v226, v227
    v_lshlrev_b32 v226, 16, v8
    v_and_b32 v227, 0xffff0000, v8
    v_mul_f32 v226, v226, v9
    v_mul_f32 v227, v227, v9
    v_cvt_pk_bf16_f32 v8, v226, v227
    v_lshlrev_b32 v226, 16, v8
    v_and_b32 v227, 0xffff0000, v8
    v_sub_f32 v228, v228, v5
    v_sub_f32 v229, v229, v5
    v_cvt_pk_bf16_f32 v8, v228, v229
    v_lshlrev_b32 v228, 16, v8
    v_and_b32 v229, 0xffff0000, v8
    v_mul_f32 v228, v228, v9
    v_mul_f32 v229, v229, v9
    v_cvt_pk_bf16_f32 v8, v228, v229
    v_lshlrev_b32 v228, 16, v8
    v_and_b32 v229, 0xffff0000, v8
    v_sub_f32 v230, v230, v5
    v_sub_f32 v231, v231, v5
    v_cvt_pk_bf16_f32 v8, v230, v231
    v_lshlrev_b32 v230, 16, v8
    v_and_b32 v231, 0xffff0000, v8
    v_mul_f32 v230, v230, v9
    v_mul_f32 v231, v231, v9
    v_cvt_pk_bf16_f32 v8, v230, v231
    v_lshlrev_b32 v230, 16, v8
    v_and_b32 v231, 0xffff0000, v8
    v_sub_f32 v232, v232, v5
    v_sub_f32 v233, v233, v5
    v_cvt_pk_bf16_f32 v8, v232, v233
    v_lshlrev_b32 v232, 16, v8
    v_and_b32 v233, 0xffff0000, v8
    v_mul_f32 v232, v232, v9
    v_mul_f32 v233, v233, v9
    v_cvt_pk_bf16_f32 v8, v232, v233
    v_lshlrev_b32 v232, 16, v8
    v_and_b32 v233, 0xffff0000, v8
    v_sub_f32 v234, v234, v5
    v_sub_f32 v235, v235, v5
    v_cvt_pk_bf16_f32 v8, v234, v235
    v_lshlrev_b32 v234, 16, v8
    v_and_b32 v235, 0xffff0000, v8
    v_mul_f32 v234, v234, v9
    v_mul_f32 v235, v235, v9
    v_cvt_pk_bf16_f32 v8, v234, v235
    v_lshlrev_b32 v234, 16, v8
    v_and_b32 v235, 0xffff0000, v8
    v_sub_f32 v236, v236, v5
    v_sub_f32 v237, v237, v5
    v_cvt_pk_bf16_f32 v8, v236, v237
    v_lshlrev_b32 v236, 16, v8
    v_and_b32 v237, 0xffff0000, v8
    v_mul_f32 v236, v236, v9
    v_mul_f32 v237, v237, v9
    v_cvt_pk_bf16_f32 v8, v236, v237
    v_lshlrev_b32 v236, 16, v8
    v_and_b32 v237, 0xffff0000, v8
    v_sub_f32 v238, v238, v5
    v_sub_f32 v239, v239, v5
    v_cvt_pk_bf16_f32 v8, v238, v239
    v_lshlrev_b32 v238, 16, v8
    v_and_b32 v239, 0xffff0000, v8
    v_mul_f32 v238, v238, v9
    v_mul_f32 v239, v239, v9
    v_cvt_pk_bf16_f32 v8, v238, v239
    v_lshlrev_b32 v238, 16, v8
    v_and_b32 v239, 0xffff0000, v8
    v_sub_f32 v240, v240, v5
    v_sub_f32 v241, v241, v5
    v_cvt_pk_bf16_f32 v8, v240, v241
    v_lshlrev_b32 v240, 16, v8
    v_and_b32 v241, 0xffff0000, v8
    v_mul_f32 v240, v240, v9
    v_mul_f32 v241, v241, v9
    v_cvt_pk_bf16_f32 v8, v240, v241
    v_lshlrev_b32 v240, 16, v8
    v_and_b32 v241, 0xffff0000, v8
    v_sub_f32 v242, v242, v5
    v_sub_f32 v243, v243, v5
    v_cvt_pk_bf16_f32 v8, v242, v243
    v_lshlrev_b32 v242, 16, v8
    v_and_b32 v243, 0xffff0000, v8
    v_mul_f32 v242, v242, v9
    v_mul_f32 v243, v243, v9
    v_cvt_pk_bf16_f32 v8, v242, v243
    v_lshlrev_b32 v242, 16, v8
    v_and_b32 v243, 0xffff0000, v8
    v_sub_f32 v244, v244, v5
    v_sub_f32 v245, v245, v5
    v_cvt_pk_bf16_f32 v8, v244, v245
    v_lshlrev_b32 v244, 16, v8
    v_and_b32 v245, 0xffff0000, v8
    v_mul_f32 v244, v244, v9
    v_mul_f32 v245, v245, v9
    v_cvt_pk_bf16_f32 v8, v244, v245
    v_lshlrev_b32 v244, 16, v8
    v_and_b32 v245, 0xffff0000, v8
    v_sub_f32 v246, v246, v5
    v_sub_f32 v247, v247, v5
    v_cvt_pk_bf16_f32 v8, v246, v247
    v_lshlrev_b32 v246, 16, v8
    v_and_b32 v247, 0xffff0000, v8
    v_mul_f32 v246, v246, v9
    v_mul_f32 v247, v247, v9
    v_cvt_pk_bf16_f32 v8, v246, v247
    v_lshlrev_b32 v246, 16, v8
    v_and_b32 v247, 0xffff0000, v8
    v_sub_f32 v248, v248, v5
    v_sub_f32 v249, v249, v5
    v_cvt_pk_bf16_f32 v8, v248, v249
    v_lshlrev_b32 v248, 16, v8
    v_and_b32 v249, 0xffff0000, v8
    v_mul_f32 v248, v248, v9
    v_mul_f32 v249, v249, v9
    v_cvt_pk_bf16_f32 v8, v248, v249
    v_lshlrev_b32 v248, 16, v8
    v_and_b32 v249, 0xffff0000, v8
    v_sub_f32 v250, v250, v5
    v_sub_f32 v251, v251, v5
    v_cvt_pk_bf16_f32 v8, v250, v251
    v_lshlrev_b32 v250, 16, v8
    v_and_b32 v251, 0xffff0000, v8
    v_mul_f32 v250, v250, v9
    v_mul_f32 v251, v251, v9
    v_cvt_pk_bf16_f32 v8, v250, v251
    v_lshlrev_b32 v250, 16, v8
    v_and_b32 v251, 0xffff0000, v8
    v_sub_f32 v252, v252, v5
    v_sub_f32 v253, v253, v5
    v_cvt_pk_bf16_f32 v8, v252, v253
    v_lshlrev_b32 v252, 16, v8
    v_and_b32 v253, 0xffff0000, v8
    v_mul_f32 v252, v252, v9
    v_mul_f32 v253, v253, v9
    v_cvt_pk_bf16_f32 v8, v252, v253
    v_lshlrev_b32 v252, 16, v8
    v_and_b32 v253, 0xffff0000, v8
    v_sub_f32 v254, v254, v5
    v_sub_f32 v255, v255, v5
    v_cvt_pk_bf16_f32 v8, v254, v255
    v_lshlrev_b32 v254, 16, v8
    v_and_b32 v255, 0xffff0000, v8
    v_mul_f32 v254, v254, v9
    v_mul_f32 v255, v255, v9
    v_cvt_pk_bf16_f32 v8, v254, v255
    v_lshlrev_b32 v254, 16, v8
    v_and_b32 v255, 0xffff0000, v8
    s_waitcnt vmcnt(19)
    v_lshlrev_b32 v11, 16, v16
    v_and_b32 v12, 0xffff0000, v16
    v_add_f32 v11, 1.0, v11
    v_add_f32 v12, 1.0, v12
    v_cvt_pk_bf16_f32 v8, v11, v12
    v_lshlrev_b32 v11, 16, v8
    v_and_b32 v12, 0xffff0000, v8
    v_mul_f32 v96, v96, v11
    v_mul_f32 v97, v97, v12
    v_cvt_pk_bf16_f32 v8, v96, v97
    v_lshlrev_b32 v96, 16, v8
    v_and_b32 v97, 0xffff0000, v8
    v_lshlrev_b32 v11, 16, v17
    v_and_b32 v12, 0xffff0000, v17
    v_add_f32 v11, 1.0, v11
    v_add_f32 v12, 1.0, v12
    v_cvt_pk_bf16_f32 v8, v11, v12
    v_lshlrev_b32 v11, 16, v8
    v_and_b32 v12, 0xffff0000, v8
    v_mul_f32 v98, v98, v11
    v_mul_f32 v99, v99, v12
    v_cvt_pk_bf16_f32 v8, v98, v99
    v_lshlrev_b32 v98, 16, v8
    v_and_b32 v99, 0xffff0000, v8
    v_lshlrev_b32 v11, 16, v18
    v_and_b32 v12, 0xffff0000, v18
    v_add_f32 v11, 1.0, v11
    v_add_f32 v12, 1.0, v12
    v_cvt_pk_bf16_f32 v8, v11, v12
    v_lshlrev_b32 v11, 16, v8
    v_and_b32 v12, 0xffff0000, v8
    v_mul_f32 v100, v100, v11
    v_mul_f32 v101, v101, v12
    v_cvt_pk_bf16_f32 v8, v100, v101
    v_lshlrev_b32 v100, 16, v8
    v_and_b32 v101, 0xffff0000, v8
    v_lshlrev_b32 v11, 16, v19
    v_and_b32 v12, 0xffff0000, v19
    v_add_f32 v11, 1.0, v11
    v_add_f32 v12, 1.0, v12
    v_cvt_pk_bf16_f32 v8, v11, v12
    v_lshlrev_b32 v11, 16, v8
    v_and_b32 v12, 0xffff0000, v8
    v_mul_f32 v102, v102, v11
    v_mul_f32 v103, v103, v12
    v_cvt_pk_bf16_f32 v8, v102, v103
    v_lshlrev_b32 v102, 16, v8
    v_and_b32 v103, 0xffff0000, v8
    s_waitcnt vmcnt(18)
    v_lshlrev_b32 v11, 16, v20
    v_and_b32 v12, 0xffff0000, v20
    v_add_f32 v11, 1.0, v11
    v_add_f32 v12, 1.0, v12
    v_cvt_pk_bf16_f32 v8, v11, v12
    v_lshlrev_b32 v11, 16, v8
    v_and_b32 v12, 0xffff0000, v8
    v_mul_f32 v104, v104, v11
    v_mul_f32 v105, v105, v12
    v_cvt_pk_bf16_f32 v8, v104, v105
    v_lshlrev_b32 v104, 16, v8
    v_and_b32 v105, 0xffff0000, v8
    v_lshlrev_b32 v11, 16, v21
    v_and_b32 v12, 0xffff0000, v21
    v_add_f32 v11, 1.0, v11
    v_add_f32 v12, 1.0, v12
    v_cvt_pk_bf16_f32 v8, v11, v12
    v_lshlrev_b32 v11, 16, v8
    v_and_b32 v12, 0xffff0000, v8
    v_mul_f32 v106, v106, v11
    v_mul_f32 v107, v107, v12
    v_cvt_pk_bf16_f32 v8, v106, v107
    v_lshlrev_b32 v106, 16, v8
    v_and_b32 v107, 0xffff0000, v8
    v_lshlrev_b32 v11, 16, v22
    v_and_b32 v12, 0xffff0000, v22
    v_add_f32 v11, 1.0, v11
    v_add_f32 v12, 1.0, v12
    v_cvt_pk_bf16_f32 v8, v11, v12
    v_lshlrev_b32 v11, 16, v8
    v_and_b32 v12, 0xffff0000, v8
    v_mul_f32 v108, v108, v11
    v_mul_f32 v109, v109, v12
    v_cvt_pk_bf16_f32 v8, v108, v109
    v_lshlrev_b32 v108, 16, v8
    v_and_b32 v109, 0xffff0000, v8
    v_lshlrev_b32 v11, 16, v23
    v_and_b32 v12, 0xffff0000, v23
    v_add_f32 v11, 1.0, v11
    v_add_f32 v12, 1.0, v12
    v_cvt_pk_bf16_f32 v8, v11, v12
    v_lshlrev_b32 v11, 16, v8
    v_and_b32 v12, 0xffff0000, v8
    v_mul_f32 v110, v110, v11
    v_mul_f32 v111, v111, v12
    v_cvt_pk_bf16_f32 v8, v110, v111
    v_lshlrev_b32 v110, 16, v8
    v_and_b32 v111, 0xffff0000, v8
    s_waitcnt vmcnt(17)
    v_lshlrev_b32 v11, 16, v24
    v_and_b32 v12, 0xffff0000, v24
    v_add_f32 v11, 1.0, v11
    v_add_f32 v12, 1.0, v12
    v_cvt_pk_bf16_f32 v8, v11, v12
    v_lshlrev_b32 v11, 16, v8
    v_and_b32 v12, 0xffff0000, v8
    v_mul_f32 v112, v112, v11
    v_mul_f32 v113, v113, v12
    v_cvt_pk_bf16_f32 v8, v112, v113
    v_lshlrev_b32 v112, 16, v8
    v_and_b32 v113, 0xffff0000, v8
    v_lshlrev_b32 v11, 16, v25
    v_and_b32 v12, 0xffff0000, v25
    v_add_f32 v11, 1.0, v11
    v_add_f32 v12, 1.0, v12
    v_cvt_pk_bf16_f32 v8, v11, v12
    v_lshlrev_b32 v11, 16, v8
    v_and_b32 v12, 0xffff0000, v8
    v_mul_f32 v114, v114, v11
    v_mul_f32 v115, v115, v12
    v_cvt_pk_bf16_f32 v8, v114, v115
    v_lshlrev_b32 v114, 16, v8
    v_and_b32 v115, 0xffff0000, v8
    v_lshlrev_b32 v11, 16, v26
    v_and_b32 v12, 0xffff0000, v26
    v_add_f32 v11, 1.0, v11
    v_add_f32 v12, 1.0, v12
    v_cvt_pk_bf16_f32 v8, v11, v12
    v_lshlrev_b32 v11, 16, v8
    v_and_b32 v12, 0xffff0000, v8
    v_mul_f32 v116, v116, v11
    v_mul_f32 v117, v117, v12
    v_cvt_pk_bf16_f32 v8, v116, v117
    v_lshlrev_b32 v116, 16, v8
    v_and_b32 v117, 0xffff0000, v8
    v_lshlrev_b32 v11, 16, v27
    v_and_b32 v12, 0xffff0000, v27
    v_add_f32 v11, 1.0, v11
    v_add_f32 v12, 1.0, v12
    v_cvt_pk_bf16_f32 v8, v11, v12
    v_lshlrev_b32 v11, 16, v8
    v_and_b32 v12, 0xffff0000, v8
    v_mul_f32 v118, v118, v11
    v_mul_f32 v119, v119, v12
    v_cvt_pk_bf16_f32 v8, v118, v119
    v_lshlrev_b32 v118, 16, v8
    v_and_b32 v119, 0xffff0000, v8
    s_waitcnt vmcnt(16)
    v_lshlrev_b32 v11, 16, v28
    v_and_b32 v12, 0xffff0000, v28
    v_add_f32 v11, 1.0, v11
    v_add_f32 v12, 1.0, v12
    v_cvt_pk_bf16_f32 v8, v11, v12
    v_lshlrev_b32 v11, 16, v8
    v_and_b32 v12, 0xffff0000, v8
    v_mul_f32 v120, v120, v11
    v_mul_f32 v121, v121, v12
    v_cvt_pk_bf16_f32 v8, v120, v121
    v_lshlrev_b32 v120, 16, v8
    v_and_b32 v121, 0xffff0000, v8
    v_lshlrev_b32 v11, 16, v29
    v_and_b32 v12, 0xffff0000, v29
    v_add_f32 v11, 1.0, v11
    v_add_f32 v12, 1.0, v12
    v_cvt_pk_bf16_f32 v8, v11, v12
    v_lshlrev_b32 v11, 16, v8
    v_and_b32 v12, 0xffff0000, v8
    v_mul_f32 v122, v122, v11
    v_mul_f32 v123, v123, v12
    v_cvt_pk_bf16_f32 v8, v122, v123
    v_lshlrev_b32 v122, 16, v8
    v_and_b32 v123, 0xffff0000, v8
    v_lshlrev_b32 v11, 16, v30
    v_and_b32 v12, 0xffff0000, v30
    v_add_f32 v11, 1.0, v11
    v_add_f32 v12, 1.0, v12
    v_cvt_pk_bf16_f32 v8, v11, v12
    v_lshlrev_b32 v11, 16, v8
    v_and_b32 v12, 0xffff0000, v8
    v_mul_f32 v124, v124, v11
    v_mul_f32 v125, v125, v12
    v_cvt_pk_bf16_f32 v8, v124, v125
    v_lshlrev_b32 v124, 16, v8
    v_and_b32 v125, 0xffff0000, v8
    v_lshlrev_b32 v11, 16, v31
    v_and_b32 v12, 0xffff0000, v31
    v_add_f32 v11, 1.0, v11
    v_add_f32 v12, 1.0, v12
    v_cvt_pk_bf16_f32 v8, v11, v12
    v_lshlrev_b32 v11, 16, v8
    v_and_b32 v12, 0xffff0000, v8
    v_mul_f32 v126, v126, v11
    v_mul_f32 v127, v127, v12
    v_cvt_pk_bf16_f32 v8, v126, v127
    v_lshlrev_b32 v126, 16, v8
    v_and_b32 v127, 0xffff0000, v8
    s_waitcnt vmcnt(15)
    v_lshlrev_b32 v11, 16, v32
    v_and_b32 v12, 0xffff0000, v32
    v_add_f32 v11, 1.0, v11
    v_add_f32 v12, 1.0, v12
    v_cvt_pk_bf16_f32 v8, v11, v12
    v_lshlrev_b32 v11, 16, v8
    v_and_b32 v12, 0xffff0000, v8
    v_mul_f32 v128, v128, v11
    v_mul_f32 v129, v129, v12
    v_cvt_pk_bf16_f32 v8, v128, v129
    v_lshlrev_b32 v128, 16, v8
    v_and_b32 v129, 0xffff0000, v8
    v_lshlrev_b32 v11, 16, v33
    v_and_b32 v12, 0xffff0000, v33
    v_add_f32 v11, 1.0, v11
    v_add_f32 v12, 1.0, v12
    v_cvt_pk_bf16_f32 v8, v11, v12
    v_lshlrev_b32 v11, 16, v8
    v_and_b32 v12, 0xffff0000, v8
    v_mul_f32 v130, v130, v11
    v_mul_f32 v131, v131, v12
    v_cvt_pk_bf16_f32 v8, v130, v131
    v_lshlrev_b32 v130, 16, v8
    v_and_b32 v131, 0xffff0000, v8
    v_lshlrev_b32 v11, 16, v34
    v_and_b32 v12, 0xffff0000, v34
    v_add_f32 v11, 1.0, v11
    v_add_f32 v12, 1.0, v12
    v_cvt_pk_bf16_f32 v8, v11, v12
    v_lshlrev_b32 v11, 16, v8
    v_and_b32 v12, 0xffff0000, v8
    v_mul_f32 v132, v132, v11
    v_mul_f32 v133, v133, v12
    v_cvt_pk_bf16_f32 v8, v132, v133
    v_lshlrev_b32 v132, 16, v8
    v_and_b32 v133, 0xffff0000, v8
    v_lshlrev_b32 v11, 16, v35
    v_and_b32 v12, 0xffff0000, v35
    v_add_f32 v11, 1.0, v11
    v_add_f32 v12, 1.0, v12
    v_cvt_pk_bf16_f32 v8, v11, v12
    v_lshlrev_b32 v11, 16, v8
    v_and_b32 v12, 0xffff0000, v8
    v_mul_f32 v134, v134, v11
    v_mul_f32 v135, v135, v12
    v_cvt_pk_bf16_f32 v8, v134, v135
    v_lshlrev_b32 v134, 16, v8
    v_and_b32 v135, 0xffff0000, v8
    s_waitcnt vmcnt(14)
    v_lshlrev_b32 v11, 16, v36
    v_and_b32 v12, 0xffff0000, v36
    v_add_f32 v11, 1.0, v11
    v_add_f32 v12, 1.0, v12
    v_cvt_pk_bf16_f32 v8, v11, v12
    v_lshlrev_b32 v11, 16, v8
    v_and_b32 v12, 0xffff0000, v8
    v_mul_f32 v136, v136, v11
    v_mul_f32 v137, v137, v12
    v_cvt_pk_bf16_f32 v8, v136, v137
    v_lshlrev_b32 v136, 16, v8
    v_and_b32 v137, 0xffff0000, v8
    v_lshlrev_b32 v11, 16, v37
    v_and_b32 v12, 0xffff0000, v37
    v_add_f32 v11, 1.0, v11
    v_add_f32 v12, 1.0, v12
    v_cvt_pk_bf16_f32 v8, v11, v12
    v_lshlrev_b32 v11, 16, v8
    v_and_b32 v12, 0xffff0000, v8
    v_mul_f32 v138, v138, v11
    v_mul_f32 v139, v139, v12
    v_cvt_pk_bf16_f32 v8, v138, v139
    v_lshlrev_b32 v138, 16, v8
    v_and_b32 v139, 0xffff0000, v8
    v_lshlrev_b32 v11, 16, v38
    v_and_b32 v12, 0xffff0000, v38
    v_add_f32 v11, 1.0, v11
    v_add_f32 v12, 1.0, v12
    v_cvt_pk_bf16_f32 v8, v11, v12
    v_lshlrev_b32 v11, 16, v8
    v_and_b32 v12, 0xffff0000, v8
    v_mul_f32 v140, v140, v11
    v_mul_f32 v141, v141, v12
    v_cvt_pk_bf16_f32 v8, v140, v141
    v_lshlrev_b32 v140, 16, v8
    v_and_b32 v141, 0xffff0000, v8
    v_lshlrev_b32 v11, 16, v39
    v_and_b32 v12, 0xffff0000, v39
    v_add_f32 v11, 1.0, v11
    v_add_f32 v12, 1.0, v12
    v_cvt_pk_bf16_f32 v8, v11, v12
    v_lshlrev_b32 v11, 16, v8
    v_and_b32 v12, 0xffff0000, v8
    v_mul_f32 v142, v142, v11
    v_mul_f32 v143, v143, v12
    v_cvt_pk_bf16_f32 v8, v142, v143
    v_lshlrev_b32 v142, 16, v8
    v_and_b32 v143, 0xffff0000, v8
    s_waitcnt vmcnt(13)
    v_lshlrev_b32 v11, 16, v40
    v_and_b32 v12, 0xffff0000, v40
    v_add_f32 v11, 1.0, v11
    v_add_f32 v12, 1.0, v12
    v_cvt_pk_bf16_f32 v8, v11, v12
    v_lshlrev_b32 v11, 16, v8
    v_and_b32 v12, 0xffff0000, v8
    v_mul_f32 v144, v144, v11
    v_mul_f32 v145, v145, v12
    v_cvt_pk_bf16_f32 v8, v144, v145
    v_lshlrev_b32 v144, 16, v8
    v_and_b32 v145, 0xffff0000, v8
    v_lshlrev_b32 v11, 16, v41
    v_and_b32 v12, 0xffff0000, v41
    v_add_f32 v11, 1.0, v11
    v_add_f32 v12, 1.0, v12
    v_cvt_pk_bf16_f32 v8, v11, v12
    v_lshlrev_b32 v11, 16, v8
    v_and_b32 v12, 0xffff0000, v8
    v_mul_f32 v146, v146, v11
    v_mul_f32 v147, v147, v12
    v_cvt_pk_bf16_f32 v8, v146, v147
    v_lshlrev_b32 v146, 16, v8
    v_and_b32 v147, 0xffff0000, v8
    v_lshlrev_b32 v11, 16, v42
    v_and_b32 v12, 0xffff0000, v42
    v_add_f32 v11, 1.0, v11
    v_add_f32 v12, 1.0, v12
    v_cvt_pk_bf16_f32 v8, v11, v12
    v_lshlrev_b32 v11, 16, v8
    v_and_b32 v12, 0xffff0000, v8
    v_mul_f32 v148, v148, v11
    v_mul_f32 v149, v149, v12
    v_cvt_pk_bf16_f32 v8, v148, v149
    v_lshlrev_b32 v148, 16, v8
    v_and_b32 v149, 0xffff0000, v8
    v_lshlrev_b32 v11, 16, v43
    v_and_b32 v12, 0xffff0000, v43
    v_add_f32 v11, 1.0, v11
    v_add_f32 v12, 1.0, v12
    v_cvt_pk_bf16_f32 v8, v11, v12
    v_lshlrev_b32 v11, 16, v8
    v_and_b32 v12, 0xffff0000, v8
    v_mul_f32 v150, v150, v11
    v_mul_f32 v151, v151, v12
    v_cvt_pk_bf16_f32 v8, v150, v151
    v_lshlrev_b32 v150, 16, v8
    v_and_b32 v151, 0xffff0000, v8
    s_waitcnt vmcnt(12)
    v_lshlrev_b32 v11, 16, v44
    v_and_b32 v12, 0xffff0000, v44
    v_add_f32 v11, 1.0, v11
    v_add_f32 v12, 1.0, v12
    v_cvt_pk_bf16_f32 v8, v11, v12
    v_lshlrev_b32 v11, 16, v8
    v_and_b32 v12, 0xffff0000, v8
    v_mul_f32 v152, v152, v11
    v_mul_f32 v153, v153, v12
    v_cvt_pk_bf16_f32 v8, v152, v153
    v_lshlrev_b32 v152, 16, v8
    v_and_b32 v153, 0xffff0000, v8
    v_lshlrev_b32 v11, 16, v45
    v_and_b32 v12, 0xffff0000, v45
    v_add_f32 v11, 1.0, v11
    v_add_f32 v12, 1.0, v12
    v_cvt_pk_bf16_f32 v8, v11, v12
    v_lshlrev_b32 v11, 16, v8
    v_and_b32 v12, 0xffff0000, v8
    v_mul_f32 v154, v154, v11
    v_mul_f32 v155, v155, v12
    v_cvt_pk_bf16_f32 v8, v154, v155
    v_lshlrev_b32 v154, 16, v8
    v_and_b32 v155, 0xffff0000, v8
    v_lshlrev_b32 v11, 16, v46
    v_and_b32 v12, 0xffff0000, v46
    v_add_f32 v11, 1.0, v11
    v_add_f32 v12, 1.0, v12
    v_cvt_pk_bf16_f32 v8, v11, v12
    v_lshlrev_b32 v11, 16, v8
    v_and_b32 v12, 0xffff0000, v8
    v_mul_f32 v156, v156, v11
    v_mul_f32 v157, v157, v12
    v_cvt_pk_bf16_f32 v8, v156, v157
    v_lshlrev_b32 v156, 16, v8
    v_and_b32 v157, 0xffff0000, v8
    v_lshlrev_b32 v11, 16, v47
    v_and_b32 v12, 0xffff0000, v47
    v_add_f32 v11, 1.0, v11
    v_add_f32 v12, 1.0, v12
    v_cvt_pk_bf16_f32 v8, v11, v12
    v_lshlrev_b32 v11, 16, v8
    v_and_b32 v12, 0xffff0000, v8
    v_mul_f32 v158, v158, v11
    v_mul_f32 v159, v159, v12
    v_cvt_pk_bf16_f32 v8, v158, v159
    v_lshlrev_b32 v158, 16, v8
    v_and_b32 v159, 0xffff0000, v8
    s_waitcnt vmcnt(11)
    v_lshlrev_b32 v11, 16, v48
    v_and_b32 v12, 0xffff0000, v48
    v_add_f32 v11, 1.0, v11
    v_add_f32 v12, 1.0, v12
    v_cvt_pk_bf16_f32 v8, v11, v12
    v_lshlrev_b32 v11, 16, v8
    v_and_b32 v12, 0xffff0000, v8
    v_mul_f32 v160, v160, v11
    v_mul_f32 v161, v161, v12
    v_cvt_pk_bf16_f32 v8, v160, v161
    v_lshlrev_b32 v160, 16, v8
    v_and_b32 v161, 0xffff0000, v8
    v_lshlrev_b32 v11, 16, v49
    v_and_b32 v12, 0xffff0000, v49
    v_add_f32 v11, 1.0, v11
    v_add_f32 v12, 1.0, v12
    v_cvt_pk_bf16_f32 v8, v11, v12
    v_lshlrev_b32 v11, 16, v8
    v_and_b32 v12, 0xffff0000, v8
    v_mul_f32 v162, v162, v11
    v_mul_f32 v163, v163, v12
    v_cvt_pk_bf16_f32 v8, v162, v163
    v_lshlrev_b32 v162, 16, v8
    v_and_b32 v163, 0xffff0000, v8
    v_lshlrev_b32 v11, 16, v50
    v_and_b32 v12, 0xffff0000, v50
    v_add_f32 v11, 1.0, v11
    v_add_f32 v12, 1.0, v12
    v_cvt_pk_bf16_f32 v8, v11, v12
    v_lshlrev_b32 v11, 16, v8
    v_and_b32 v12, 0xffff0000, v8
    v_mul_f32 v164, v164, v11
    v_mul_f32 v165, v165, v12
    v_cvt_pk_bf16_f32 v8, v164, v165
    v_lshlrev_b32 v164, 16, v8
    v_and_b32 v165, 0xffff0000, v8
    v_lshlrev_b32 v11, 16, v51
    v_and_b32 v12, 0xffff0000, v51
    v_add_f32 v11, 1.0, v11
    v_add_f32 v12, 1.0, v12
    v_cvt_pk_bf16_f32 v8, v11, v12
    v_lshlrev_b32 v11, 16, v8
    v_and_b32 v12, 0xffff0000, v8
    v_mul_f32 v166, v166, v11
    v_mul_f32 v167, v167, v12
    v_cvt_pk_bf16_f32 v8, v166, v167
    v_lshlrev_b32 v166, 16, v8
    v_and_b32 v167, 0xffff0000, v8
    s_waitcnt vmcnt(10)
    v_lshlrev_b32 v11, 16, v52
    v_and_b32 v12, 0xffff0000, v52
    v_add_f32 v11, 1.0, v11
    v_add_f32 v12, 1.0, v12
    v_cvt_pk_bf16_f32 v8, v11, v12
    v_lshlrev_b32 v11, 16, v8
    v_and_b32 v12, 0xffff0000, v8
    v_mul_f32 v168, v168, v11
    v_mul_f32 v169, v169, v12
    v_cvt_pk_bf16_f32 v8, v168, v169
    v_lshlrev_b32 v168, 16, v8
    v_and_b32 v169, 0xffff0000, v8
    v_lshlrev_b32 v11, 16, v53
    v_and_b32 v12, 0xffff0000, v53
    v_add_f32 v11, 1.0, v11
    v_add_f32 v12, 1.0, v12
    v_cvt_pk_bf16_f32 v8, v11, v12
    v_lshlrev_b32 v11, 16, v8
    v_and_b32 v12, 0xffff0000, v8
    v_mul_f32 v170, v170, v11
    v_mul_f32 v171, v171, v12
    v_cvt_pk_bf16_f32 v8, v170, v171
    v_lshlrev_b32 v170, 16, v8
    v_and_b32 v171, 0xffff0000, v8
    v_lshlrev_b32 v11, 16, v54
    v_and_b32 v12, 0xffff0000, v54
    v_add_f32 v11, 1.0, v11
    v_add_f32 v12, 1.0, v12
    v_cvt_pk_bf16_f32 v8, v11, v12
    v_lshlrev_b32 v11, 16, v8
    v_and_b32 v12, 0xffff0000, v8
    v_mul_f32 v172, v172, v11
    v_mul_f32 v173, v173, v12
    v_cvt_pk_bf16_f32 v8, v172, v173
    v_lshlrev_b32 v172, 16, v8
    v_and_b32 v173, 0xffff0000, v8
    v_lshlrev_b32 v11, 16, v55
    v_and_b32 v12, 0xffff0000, v55
    v_add_f32 v11, 1.0, v11
    v_add_f32 v12, 1.0, v12
    v_cvt_pk_bf16_f32 v8, v11, v12
    v_lshlrev_b32 v11, 16, v8
    v_and_b32 v12, 0xffff0000, v8
    v_mul_f32 v174, v174, v11
    v_mul_f32 v175, v175, v12
    v_cvt_pk_bf16_f32 v8, v174, v175
    v_lshlrev_b32 v174, 16, v8
    v_and_b32 v175, 0xffff0000, v8
    s_waitcnt vmcnt(9)
    v_lshlrev_b32 v11, 16, v56
    v_and_b32 v12, 0xffff0000, v56
    v_add_f32 v11, 1.0, v11
    v_add_f32 v12, 1.0, v12
    v_cvt_pk_bf16_f32 v8, v11, v12
    v_lshlrev_b32 v11, 16, v8
    v_and_b32 v12, 0xffff0000, v8
    v_mul_f32 v176, v176, v11
    v_mul_f32 v177, v177, v12
    v_cvt_pk_bf16_f32 v8, v176, v177
    v_lshlrev_b32 v176, 16, v8
    v_and_b32 v177, 0xffff0000, v8
    v_lshlrev_b32 v11, 16, v57
    v_and_b32 v12, 0xffff0000, v57
    v_add_f32 v11, 1.0, v11
    v_add_f32 v12, 1.0, v12
    v_cvt_pk_bf16_f32 v8, v11, v12
    v_lshlrev_b32 v11, 16, v8
    v_and_b32 v12, 0xffff0000, v8
    v_mul_f32 v178, v178, v11
    v_mul_f32 v179, v179, v12
    v_cvt_pk_bf16_f32 v8, v178, v179
    v_lshlrev_b32 v178, 16, v8
    v_and_b32 v179, 0xffff0000, v8
    v_lshlrev_b32 v11, 16, v58
    v_and_b32 v12, 0xffff0000, v58
    v_add_f32 v11, 1.0, v11
    v_add_f32 v12, 1.0, v12
    v_cvt_pk_bf16_f32 v8, v11, v12
    v_lshlrev_b32 v11, 16, v8
    v_and_b32 v12, 0xffff0000, v8
    v_mul_f32 v180, v180, v11
    v_mul_f32 v181, v181, v12
    v_cvt_pk_bf16_f32 v8, v180, v181
    v_lshlrev_b32 v180, 16, v8
    v_and_b32 v181, 0xffff0000, v8
    v_lshlrev_b32 v11, 16, v59
    v_and_b32 v12, 0xffff0000, v59
    v_add_f32 v11, 1.0, v11
    v_add_f32 v12, 1.0, v12
    v_cvt_pk_bf16_f32 v8, v11, v12
    v_lshlrev_b32 v11, 16, v8
    v_and_b32 v12, 0xffff0000, v8
    v_mul_f32 v182, v182, v11
    v_mul_f32 v183, v183, v12
    v_cvt_pk_bf16_f32 v8, v182, v183
    v_lshlrev_b32 v182, 16, v8
    v_and_b32 v183, 0xffff0000, v8
    s_waitcnt vmcnt(8)
    v_lshlrev_b32 v11, 16, v60
    v_and_b32 v12, 0xffff0000, v60
    v_add_f32 v11, 1.0, v11
    v_add_f32 v12, 1.0, v12
    v_cvt_pk_bf16_f32 v8, v11, v12
    v_lshlrev_b32 v11, 16, v8
    v_and_b32 v12, 0xffff0000, v8
    v_mul_f32 v184, v184, v11
    v_mul_f32 v185, v185, v12
    v_cvt_pk_bf16_f32 v8, v184, v185
    v_lshlrev_b32 v184, 16, v8
    v_and_b32 v185, 0xffff0000, v8
    v_lshlrev_b32 v11, 16, v61
    v_and_b32 v12, 0xffff0000, v61
    v_add_f32 v11, 1.0, v11
    v_add_f32 v12, 1.0, v12
    v_cvt_pk_bf16_f32 v8, v11, v12
    v_lshlrev_b32 v11, 16, v8
    v_and_b32 v12, 0xffff0000, v8
    v_mul_f32 v186, v186, v11
    v_mul_f32 v187, v187, v12
    v_cvt_pk_bf16_f32 v8, v186, v187
    v_lshlrev_b32 v186, 16, v8
    v_and_b32 v187, 0xffff0000, v8
    v_lshlrev_b32 v11, 16, v62
    v_and_b32 v12, 0xffff0000, v62
    v_add_f32 v11, 1.0, v11
    v_add_f32 v12, 1.0, v12
    v_cvt_pk_bf16_f32 v8, v11, v12
    v_lshlrev_b32 v11, 16, v8
    v_and_b32 v12, 0xffff0000, v8
    v_mul_f32 v188, v188, v11
    v_mul_f32 v189, v189, v12
    v_cvt_pk_bf16_f32 v8, v188, v189
    v_lshlrev_b32 v188, 16, v8
    v_and_b32 v189, 0xffff0000, v8
    v_lshlrev_b32 v11, 16, v63
    v_and_b32 v12, 0xffff0000, v63
    v_add_f32 v11, 1.0, v11
    v_add_f32 v12, 1.0, v12
    v_cvt_pk_bf16_f32 v8, v11, v12
    v_lshlrev_b32 v11, 16, v8
    v_and_b32 v12, 0xffff0000, v8
    v_mul_f32 v190, v190, v11
    v_mul_f32 v191, v191, v12
    v_cvt_pk_bf16_f32 v8, v190, v191
    v_lshlrev_b32 v190, 16, v8
    v_and_b32 v191, 0xffff0000, v8
    s_waitcnt vmcnt(7)
    v_lshlrev_b32 v11, 16, v64
    v_and_b32 v12, 0xffff0000, v64
    v_add_f32 v11, 1.0, v11
    v_add_f32 v12, 1.0, v12
    v_cvt_pk_bf16_f32 v8, v11, v12
    v_lshlrev_b32 v11, 16, v8
    v_and_b32 v12, 0xffff0000, v8
    v_mul_f32 v192, v192, v11
    v_mul_f32 v193, v193, v12
    v_cvt_pk_bf16_f32 v8, v192, v193
    v_lshlrev_b32 v192, 16, v8
    v_and_b32 v193, 0xffff0000, v8
    v_lshlrev_b32 v11, 16, v65
    v_and_b32 v12, 0xffff0000, v65
    v_add_f32 v11, 1.0, v11
    v_add_f32 v12, 1.0, v12
    v_cvt_pk_bf16_f32 v8, v11, v12
    v_lshlrev_b32 v11, 16, v8
    v_and_b32 v12, 0xffff0000, v8
    v_mul_f32 v194, v194, v11
    v_mul_f32 v195, v195, v12
    v_cvt_pk_bf16_f32 v8, v194, v195
    v_lshlrev_b32 v194, 16, v8
    v_and_b32 v195, 0xffff0000, v8
    v_lshlrev_b32 v11, 16, v66
    v_and_b32 v12, 0xffff0000, v66
    v_add_f32 v11, 1.0, v11
    v_add_f32 v12, 1.0, v12
    v_cvt_pk_bf16_f32 v8, v11, v12
    v_lshlrev_b32 v11, 16, v8
    v_and_b32 v12, 0xffff0000, v8
    v_mul_f32 v196, v196, v11
    v_mul_f32 v197, v197, v12
    v_cvt_pk_bf16_f32 v8, v196, v197
    v_lshlrev_b32 v196, 16, v8
    v_and_b32 v197, 0xffff0000, v8
    v_lshlrev_b32 v11, 16, v67
    v_and_b32 v12, 0xffff0000, v67
    v_add_f32 v11, 1.0, v11
    v_add_f32 v12, 1.0, v12
    v_cvt_pk_bf16_f32 v8, v11, v12
    v_lshlrev_b32 v11, 16, v8
    v_and_b32 v12, 0xffff0000, v8
    v_mul_f32 v198, v198, v11
    v_mul_f32 v199, v199, v12
    v_cvt_pk_bf16_f32 v8, v198, v199
    v_lshlrev_b32 v198, 16, v8
    v_and_b32 v199, 0xffff0000, v8
    s_waitcnt vmcnt(6)
    v_lshlrev_b32 v11, 16, v68
    v_and_b32 v12, 0xffff0000, v68
    v_add_f32 v11, 1.0, v11
    v_add_f32 v12, 1.0, v12
    v_cvt_pk_bf16_f32 v8, v11, v12
    v_lshlrev_b32 v11, 16, v8
    v_and_b32 v12, 0xffff0000, v8
    v_mul_f32 v200, v200, v11
    v_mul_f32 v201, v201, v12
    v_cvt_pk_bf16_f32 v8, v200, v201
    v_lshlrev_b32 v200, 16, v8
    v_and_b32 v201, 0xffff0000, v8
    v_lshlrev_b32 v11, 16, v69
    v_and_b32 v12, 0xffff0000, v69
    v_add_f32 v11, 1.0, v11
    v_add_f32 v12, 1.0, v12
    v_cvt_pk_bf16_f32 v8, v11, v12
    v_lshlrev_b32 v11, 16, v8
    v_and_b32 v12, 0xffff0000, v8
    v_mul_f32 v202, v202, v11
    v_mul_f32 v203, v203, v12
    v_cvt_pk_bf16_f32 v8, v202, v203
    v_lshlrev_b32 v202, 16, v8
    v_and_b32 v203, 0xffff0000, v8
    v_lshlrev_b32 v11, 16, v70
    v_and_b32 v12, 0xffff0000, v70
    v_add_f32 v11, 1.0, v11
    v_add_f32 v12, 1.0, v12
    v_cvt_pk_bf16_f32 v8, v11, v12
    v_lshlrev_b32 v11, 16, v8
    v_and_b32 v12, 0xffff0000, v8
    v_mul_f32 v204, v204, v11
    v_mul_f32 v205, v205, v12
    v_cvt_pk_bf16_f32 v8, v204, v205
    v_lshlrev_b32 v204, 16, v8
    v_and_b32 v205, 0xffff0000, v8
    v_lshlrev_b32 v11, 16, v71
    v_and_b32 v12, 0xffff0000, v71
    v_add_f32 v11, 1.0, v11
    v_add_f32 v12, 1.0, v12
    v_cvt_pk_bf16_f32 v8, v11, v12
    v_lshlrev_b32 v11, 16, v8
    v_and_b32 v12, 0xffff0000, v8
    v_mul_f32 v206, v206, v11
    v_mul_f32 v207, v207, v12
    v_cvt_pk_bf16_f32 v8, v206, v207
    v_lshlrev_b32 v206, 16, v8
    v_and_b32 v207, 0xffff0000, v8
    s_waitcnt vmcnt(5)
    v_lshlrev_b32 v11, 16, v72
    v_and_b32 v12, 0xffff0000, v72
    v_add_f32 v11, 1.0, v11
    v_add_f32 v12, 1.0, v12
    v_cvt_pk_bf16_f32 v8, v11, v12
    v_lshlrev_b32 v11, 16, v8
    v_and_b32 v12, 0xffff0000, v8
    v_mul_f32 v208, v208, v11
    v_mul_f32 v209, v209, v12
    v_cvt_pk_bf16_f32 v8, v208, v209
    v_lshlrev_b32 v208, 16, v8
    v_and_b32 v209, 0xffff0000, v8
    v_lshlrev_b32 v11, 16, v73
    v_and_b32 v12, 0xffff0000, v73
    v_add_f32 v11, 1.0, v11
    v_add_f32 v12, 1.0, v12
    v_cvt_pk_bf16_f32 v8, v11, v12
    v_lshlrev_b32 v11, 16, v8
    v_and_b32 v12, 0xffff0000, v8
    v_mul_f32 v210, v210, v11
    v_mul_f32 v211, v211, v12
    v_cvt_pk_bf16_f32 v8, v210, v211
    v_lshlrev_b32 v210, 16, v8
    v_and_b32 v211, 0xffff0000, v8
    v_lshlrev_b32 v11, 16, v74
    v_and_b32 v12, 0xffff0000, v74
    v_add_f32 v11, 1.0, v11
    v_add_f32 v12, 1.0, v12
    v_cvt_pk_bf16_f32 v8, v11, v12
    v_lshlrev_b32 v11, 16, v8
    v_and_b32 v12, 0xffff0000, v8
    v_mul_f32 v212, v212, v11
    v_mul_f32 v213, v213, v12
    v_cvt_pk_bf16_f32 v8, v212, v213
    v_lshlrev_b32 v212, 16, v8
    v_and_b32 v213, 0xffff0000, v8
    v_lshlrev_b32 v11, 16, v75
    v_and_b32 v12, 0xffff0000, v75
    v_add_f32 v11, 1.0, v11
    v_add_f32 v12, 1.0, v12
    v_cvt_pk_bf16_f32 v8, v11, v12
    v_lshlrev_b32 v11, 16, v8
    v_and_b32 v12, 0xffff0000, v8
    v_mul_f32 v214, v214, v11
    v_mul_f32 v215, v215, v12
    v_cvt_pk_bf16_f32 v8, v214, v215
    v_lshlrev_b32 v214, 16, v8
    v_and_b32 v215, 0xffff0000, v8
    s_waitcnt vmcnt(4)
    v_lshlrev_b32 v11, 16, v76
    v_and_b32 v12, 0xffff0000, v76
    v_add_f32 v11, 1.0, v11
    v_add_f32 v12, 1.0, v12
    v_cvt_pk_bf16_f32 v8, v11, v12
    v_lshlrev_b32 v11, 16, v8
    v_and_b32 v12, 0xffff0000, v8
    v_mul_f32 v216, v216, v11
    v_mul_f32 v217, v217, v12
    v_cvt_pk_bf16_f32 v8, v216, v217
    v_lshlrev_b32 v216, 16, v8
    v_and_b32 v217, 0xffff0000, v8
    v_lshlrev_b32 v11, 16, v77
    v_and_b32 v12, 0xffff0000, v77
    v_add_f32 v11, 1.0, v11
    v_add_f32 v12, 1.0, v12
    v_cvt_pk_bf16_f32 v8, v11, v12
    v_lshlrev_b32 v11, 16, v8
    v_and_b32 v12, 0xffff0000, v8
    v_mul_f32 v218, v218, v11
    v_mul_f32 v219, v219, v12
    v_cvt_pk_bf16_f32 v8, v218, v219
    v_lshlrev_b32 v218, 16, v8
    v_and_b32 v219, 0xffff0000, v8
    v_lshlrev_b32 v11, 16, v78
    v_and_b32 v12, 0xffff0000, v78
    v_add_f32 v11, 1.0, v11
    v_add_f32 v12, 1.0, v12
    v_cvt_pk_bf16_f32 v8, v11, v12
    v_lshlrev_b32 v11, 16, v8
    v_and_b32 v12, 0xffff0000, v8
    v_mul_f32 v220, v220, v11
    v_mul_f32 v221, v221, v12
    v_cvt_pk_bf16_f32 v8, v220, v221
    v_lshlrev_b32 v220, 16, v8
    v_and_b32 v221, 0xffff0000, v8
    v_lshlrev_b32 v11, 16, v79
    v_and_b32 v12, 0xffff0000, v79
    v_add_f32 v11, 1.0, v11
    v_add_f32 v12, 1.0, v12
    v_cvt_pk_bf16_f32 v8, v11, v12
    v_lshlrev_b32 v11, 16, v8
    v_and_b32 v12, 0xffff0000, v8
    v_mul_f32 v222, v222, v11
    v_mul_f32 v223, v223, v12
    v_cvt_pk_bf16_f32 v8, v222, v223
    v_lshlrev_b32 v222, 16, v8
    v_and_b32 v223, 0xffff0000, v8
    s_waitcnt vmcnt(3)
    v_lshlrev_b32 v11, 16, v80
    v_and_b32 v12, 0xffff0000, v80
    v_add_f32 v11, 1.0, v11
    v_add_f32 v12, 1.0, v12
    v_cvt_pk_bf16_f32 v8, v11, v12
    v_lshlrev_b32 v11, 16, v8
    v_and_b32 v12, 0xffff0000, v8
    v_mul_f32 v224, v224, v11
    v_mul_f32 v225, v225, v12
    v_cvt_pk_bf16_f32 v8, v224, v225
    v_lshlrev_b32 v224, 16, v8
    v_and_b32 v225, 0xffff0000, v8
    v_lshlrev_b32 v11, 16, v81
    v_and_b32 v12, 0xffff0000, v81
    v_add_f32 v11, 1.0, v11
    v_add_f32 v12, 1.0, v12
    v_cvt_pk_bf16_f32 v8, v11, v12
    v_lshlrev_b32 v11, 16, v8
    v_and_b32 v12, 0xffff0000, v8
    v_mul_f32 v226, v226, v11
    v_mul_f32 v227, v227, v12
    v_cvt_pk_bf16_f32 v8, v226, v227
    v_lshlrev_b32 v226, 16, v8
    v_and_b32 v227, 0xffff0000, v8
    v_lshlrev_b32 v11, 16, v82
    v_and_b32 v12, 0xffff0000, v82
    v_add_f32 v11, 1.0, v11
    v_add_f32 v12, 1.0, v12
    v_cvt_pk_bf16_f32 v8, v11, v12
    v_lshlrev_b32 v11, 16, v8
    v_and_b32 v12, 0xffff0000, v8
    v_mul_f32 v228, v228, v11
    v_mul_f32 v229, v229, v12
    v_cvt_pk_bf16_f32 v8, v228, v229
    v_lshlrev_b32 v228, 16, v8
    v_and_b32 v229, 0xffff0000, v8
    v_lshlrev_b32 v11, 16, v83
    v_and_b32 v12, 0xffff0000, v83
    v_add_f32 v11, 1.0, v11
    v_add_f32 v12, 1.0, v12
    v_cvt_pk_bf16_f32 v8, v11, v12
    v_lshlrev_b32 v11, 16, v8
    v_and_b32 v12, 0xffff0000, v8
    v_mul_f32 v230, v230, v11
    v_mul_f32 v231, v231, v12
    v_cvt_pk_bf16_f32 v8, v230, v231
    v_lshlrev_b32 v230, 16, v8
    v_and_b32 v231, 0xffff0000, v8
    s_waitcnt vmcnt(2)
    v_lshlrev_b32 v11, 16, v84
    v_and_b32 v12, 0xffff0000, v84
    v_add_f32 v11, 1.0, v11
    v_add_f32 v12, 1.0, v12
    v_cvt_pk_bf16_f32 v8, v11, v12
    v_lshlrev_b32 v11, 16, v8
    v_and_b32 v12, 0xffff0000, v8
    v_mul_f32 v232, v232, v11
    v_mul_f32 v233, v233, v12
    v_cvt_pk_bf16_f32 v8, v232, v233
    v_lshlrev_b32 v232, 16, v8
    v_and_b32 v233, 0xffff0000, v8
    v_lshlrev_b32 v11, 16, v85
    v_and_b32 v12, 0xffff0000, v85
    v_add_f32 v11, 1.0, v11
    v_add_f32 v12, 1.0, v12
    v_cvt_pk_bf16_f32 v8, v11, v12
    v_lshlrev_b32 v11, 16, v8
    v_and_b32 v12, 0xffff0000, v8
    v_mul_f32 v234, v234, v11
    v_mul_f32 v235, v235, v12
    v_cvt_pk_bf16_f32 v8, v234, v235
    v_lshlrev_b32 v234, 16, v8
    v_and_b32 v235, 0xffff0000, v8
    v_lshlrev_b32 v11, 16, v86
    v_and_b32 v12, 0xffff0000, v86
    v_add_f32 v11, 1.0, v11
    v_add_f32 v12, 1.0, v12
    v_cvt_pk_bf16_f32 v8, v11, v12
    v_lshlrev_b32 v11, 16, v8
    v_and_b32 v12, 0xffff0000, v8
    v_mul_f32 v236, v236, v11
    v_mul_f32 v237, v237, v12
    v_cvt_pk_bf16_f32 v8, v236, v237
    v_lshlrev_b32 v236, 16, v8
    v_and_b32 v237, 0xffff0000, v8
    v_lshlrev_b32 v11, 16, v87
    v_and_b32 v12, 0xffff0000, v87
    v_add_f32 v11, 1.0, v11
    v_add_f32 v12, 1.0, v12
    v_cvt_pk_bf16_f32 v8, v11, v12
    v_lshlrev_b32 v11, 16, v8
    v_and_b32 v12, 0xffff0000, v8
    v_mul_f32 v238, v238, v11
    v_mul_f32 v239, v239, v12
    v_cvt_pk_bf16_f32 v8, v238, v239
    v_lshlrev_b32 v238, 16, v8
    v_and_b32 v239, 0xffff0000, v8
    s_waitcnt vmcnt(1)
    v_lshlrev_b32 v11, 16, v88
    v_and_b32 v12, 0xffff0000, v88
    v_add_f32 v11, 1.0, v11
    v_add_f32 v12, 1.0, v12
    v_cvt_pk_bf16_f32 v8, v11, v12
    v_lshlrev_b32 v11, 16, v8
    v_and_b32 v12, 0xffff0000, v8
    v_mul_f32 v240, v240, v11
    v_mul_f32 v241, v241, v12
    v_cvt_pk_bf16_f32 v8, v240, v241
    v_lshlrev_b32 v240, 16, v8
    v_and_b32 v241, 0xffff0000, v8
    v_lshlrev_b32 v11, 16, v89
    v_and_b32 v12, 0xffff0000, v89
    v_add_f32 v11, 1.0, v11
    v_add_f32 v12, 1.0, v12
    v_cvt_pk_bf16_f32 v8, v11, v12
    v_lshlrev_b32 v11, 16, v8
    v_and_b32 v12, 0xffff0000, v8
    v_mul_f32 v242, v242, v11
    v_mul_f32 v243, v243, v12
    v_cvt_pk_bf16_f32 v8, v242, v243
    v_lshlrev_b32 v242, 16, v8
    v_and_b32 v243, 0xffff0000, v8
    v_lshlrev_b32 v11, 16, v90
    v_and_b32 v12, 0xffff0000, v90
    v_add_f32 v11, 1.0, v11
    v_add_f32 v12, 1.0, v12
    v_cvt_pk_bf16_f32 v8, v11, v12
    v_lshlrev_b32 v11, 16, v8
    v_and_b32 v12, 0xffff0000, v8
    v_mul_f32 v244, v244, v11
    v_mul_f32 v245, v245, v12
    v_cvt_pk_bf16_f32 v8, v244, v245
    v_lshlrev_b32 v244, 16, v8
    v_and_b32 v245, 0xffff0000, v8
    v_lshlrev_b32 v11, 16, v91
    v_and_b32 v12, 0xffff0000, v91
    v_add_f32 v11, 1.0, v11
    v_add_f32 v12, 1.0, v12
    v_cvt_pk_bf16_f32 v8, v11, v12
    v_lshlrev_b32 v11, 16, v8
    v_and_b32 v12, 0xffff0000, v8
    v_mul_f32 v246, v246, v11
    v_mul_f32 v247, v247, v12
    v_cvt_pk_bf16_f32 v8, v246, v247
    v_lshlrev_b32 v246, 16, v8
    v_and_b32 v247, 0xffff0000, v8
    s_waitcnt vmcnt(0)
    v_lshlrev_b32 v11, 16, v92
    v_and_b32 v12, 0xffff0000, v92
    v_add_f32 v11, 1.0, v11
    v_add_f32 v12, 1.0, v12
    v_cvt_pk_bf16_f32 v8, v11, v12
    v_lshlrev_b32 v11, 16, v8
    v_and_b32 v12, 0xffff0000, v8
    v_mul_f32 v248, v248, v11
    v_mul_f32 v249, v249, v12
    v_cvt_pk_bf16_f32 v8, v248, v249
    v_lshlrev_b32 v248, 16, v8
    v_and_b32 v249, 0xffff0000, v8
    v_lshlrev_b32 v11, 16, v93
    v_and_b32 v12, 0xffff0000, v93
    v_add_f32 v11, 1.0, v11
    v_add_f32 v12, 1.0, v12
    v_cvt_pk_bf16_f32 v8, v11, v12
    v_lshlrev_b32 v11, 16, v8
    v_and_b32 v12, 0xffff0000, v8
    v_mul_f32 v250, v250, v11
    v_mul_f32 v251, v251, v12
    v_cvt_pk_bf16_f32 v8, v250, v251
    v_lshlrev_b32 v250, 16, v8
    v_and_b32 v251, 0xffff0000, v8
    v_lshlrev_b32 v11, 16, v94
    v_and_b32 v12, 0xffff0000, v94
    v_add_f32 v11, 1.0, v11
    v_add_f32 v12, 1.0, v12
    v_cvt_pk_bf16_f32 v8, v11, v12
    v_lshlrev_b32 v11, 16, v8
    v_and_b32 v12, 0xffff0000, v8
    v_mul_f32 v252, v252, v11
    v_mul_f32 v253, v253, v12
    v_cvt_pk_bf16_f32 v8, v252, v253
    v_lshlrev_b32 v252, 16, v8
    v_and_b32 v253, 0xffff0000, v8
    v_lshlrev_b32 v11, 16, v95
    v_and_b32 v12, 0xffff0000, v95
    v_add_f32 v11, 1.0, v11
    v_add_f32 v12, 1.0, v12
    v_cvt_pk_bf16_f32 v8, v11, v12
    v_lshlrev_b32 v11, 16, v8
    v_and_b32 v12, 0xffff0000, v8
    v_mul_f32 v254, v254, v11
    v_mul_f32 v255, v255, v12
    v_cvt_pk_bf16_f32 v8, v254, v255
    v_lshlrev_b32 v254, 16, v8
    v_and_b32 v255, 0xffff0000, v8
    s_mov_b32 s21, 0
    buffer_load_dwordx4 v[16:19], v10, s[4:7], s21 offen
    s_mov_b32 s21, 64
    buffer_load_dwordx4 v[20:23], v10, s[4:7], s21 offen
    s_mov_b32 s21, 128
    buffer_load_dwordx4 v[24:27], v10, s[4:7], s21 offen
    s_mov_b32 s21, 192
    buffer_load_dwordx4 v[28:31], v10, s[4:7], s21 offen
    s_mov_b32 s21, 256
    buffer_load_dwordx4 v[32:35], v10, s[4:7], s21 offen
    s_mov_b32 s21, 320
    buffer_load_dwordx4 v[36:39], v10, s[4:7], s21 offen
    s_mov_b32 s21, 384
    buffer_load_dwordx4 v[40:43], v10, s[4:7], s21 offen
    s_mov_b32 s21, 448
    buffer_load_dwordx4 v[44:47], v10, s[4:7], s21 offen
    s_mov_b32 s21, 512
    buffer_load_dwordx4 v[48:51], v10, s[4:7], s21 offen
    s_mov_b32 s21, 576
    buffer_load_dwordx4 v[52:55], v10, s[4:7], s21 offen
    s_mov_b32 s21, 640
    buffer_load_dwordx4 v[56:59], v10, s[4:7], s21 offen
    s_mov_b32 s21, 704
    buffer_load_dwordx4 v[60:63], v10, s[4:7], s21 offen
    s_mov_b32 s21, 768
    buffer_load_dwordx4 v[64:67], v10, s[4:7], s21 offen
    s_mov_b32 s21, 832
    buffer_load_dwordx4 v[68:71], v10, s[4:7], s21 offen
    s_mov_b32 s21, 896
    buffer_load_dwordx4 v[72:75], v10, s[4:7], s21 offen
    s_mov_b32 s21, 960
    buffer_load_dwordx4 v[76:79], v10, s[4:7], s21 offen
    s_mov_b32 s21, 1024
    buffer_load_dwordx4 v[80:83], v10, s[4:7], s21 offen
    s_mov_b32 s21, 1088
    buffer_load_dwordx4 v[84:87], v10, s[4:7], s21 offen
    s_mov_b32 s21, 1152
    buffer_load_dwordx4 v[88:91], v10, s[4:7], s21 offen
    s_mov_b32 s21, 1216
    buffer_load_dwordx4 v[92:95], v10, s[4:7], s21 offen
    v_lshlrev_b32 v13, 4, v0
    s_mul_i32 s22, s2, 20480
    s_add_u32 s22, s22, 2052096
    s_waitcnt vmcnt(19)
    v_lshlrev_b32 v11, 16, v16
    v_and_b32 v12, 0xffff0000, v16
    v_add_f32 v96, v96, v11
    v_add_f32 v97, v97, v12
    v_cvt_pk_bf16_f32 v16, v96, v97
    v_lshlrev_b32 v11, 16, v17
    v_and_b32 v12, 0xffff0000, v17
    v_add_f32 v98, v98, v11
    v_add_f32 v99, v99, v12
    v_cvt_pk_bf16_f32 v17, v98, v99
    v_lshlrev_b32 v11, 16, v18
    v_and_b32 v12, 0xffff0000, v18
    v_add_f32 v100, v100, v11
    v_add_f32 v101, v101, v12
    v_cvt_pk_bf16_f32 v18, v100, v101
    v_lshlrev_b32 v11, 16, v19
    v_and_b32 v12, 0xffff0000, v19
    v_add_f32 v102, v102, v11
    v_add_f32 v103, v103, v12
    v_cvt_pk_bf16_f32 v19, v102, v103
    buffer_store_dwordx4 v[16:19], v13, s[4:7], s22 offen
    s_add_u32 s22, s22, 1024
    s_waitcnt vmcnt(19)
    v_lshlrev_b32 v11, 16, v20
    v_and_b32 v12, 0xffff0000, v20
    v_add_f32 v104, v104, v11
    v_add_f32 v105, v105, v12
    v_cvt_pk_bf16_f32 v20, v104, v105
    v_lshlrev_b32 v11, 16, v21
    v_and_b32 v12, 0xffff0000, v21
    v_add_f32 v106, v106, v11
    v_add_f32 v107, v107, v12
    v_cvt_pk_bf16_f32 v21, v106, v107
    v_lshlrev_b32 v11, 16, v22
    v_and_b32 v12, 0xffff0000, v22
    v_add_f32 v108, v108, v11
    v_add_f32 v109, v109, v12
    v_cvt_pk_bf16_f32 v22, v108, v109
    v_lshlrev_b32 v11, 16, v23
    v_and_b32 v12, 0xffff0000, v23
    v_add_f32 v110, v110, v11
    v_add_f32 v111, v111, v12
    v_cvt_pk_bf16_f32 v23, v110, v111
    buffer_store_dwordx4 v[20:23], v13, s[4:7], s22 offen
    s_add_u32 s22, s22, 1024
    s_waitcnt vmcnt(19)
    v_lshlrev_b32 v11, 16, v24
    v_and_b32 v12, 0xffff0000, v24
    v_add_f32 v112, v112, v11
    v_add_f32 v113, v113, v12
    v_cvt_pk_bf16_f32 v24, v112, v113
    v_lshlrev_b32 v11, 16, v25
    v_and_b32 v12, 0xffff0000, v25
    v_add_f32 v114, v114, v11
    v_add_f32 v115, v115, v12
    v_cvt_pk_bf16_f32 v25, v114, v115
    v_lshlrev_b32 v11, 16, v26
    v_and_b32 v12, 0xffff0000, v26
    v_add_f32 v116, v116, v11
    v_add_f32 v117, v117, v12
    v_cvt_pk_bf16_f32 v26, v116, v117
    v_lshlrev_b32 v11, 16, v27
    v_and_b32 v12, 0xffff0000, v27
    v_add_f32 v118, v118, v11
    v_add_f32 v119, v119, v12
    v_cvt_pk_bf16_f32 v27, v118, v119
    buffer_store_dwordx4 v[24:27], v13, s[4:7], s22 offen
    s_add_u32 s22, s22, 1024
    s_waitcnt vmcnt(19)
    v_lshlrev_b32 v11, 16, v28
    v_and_b32 v12, 0xffff0000, v28
    v_add_f32 v120, v120, v11
    v_add_f32 v121, v121, v12
    v_cvt_pk_bf16_f32 v28, v120, v121
    v_lshlrev_b32 v11, 16, v29
    v_and_b32 v12, 0xffff0000, v29
    v_add_f32 v122, v122, v11
    v_add_f32 v123, v123, v12
    v_cvt_pk_bf16_f32 v29, v122, v123
    v_lshlrev_b32 v11, 16, v30
    v_and_b32 v12, 0xffff0000, v30
    v_add_f32 v124, v124, v11
    v_add_f32 v125, v125, v12
    v_cvt_pk_bf16_f32 v30, v124, v125
    v_lshlrev_b32 v11, 16, v31
    v_and_b32 v12, 0xffff0000, v31
    v_add_f32 v126, v126, v11
    v_add_f32 v127, v127, v12
    v_cvt_pk_bf16_f32 v31, v126, v127
    buffer_store_dwordx4 v[28:31], v13, s[4:7], s22 offen
    s_add_u32 s22, s22, 1024
    s_waitcnt vmcnt(19)
    v_lshlrev_b32 v11, 16, v32
    v_and_b32 v12, 0xffff0000, v32
    v_add_f32 v128, v128, v11
    v_add_f32 v129, v129, v12
    v_cvt_pk_bf16_f32 v32, v128, v129
    v_lshlrev_b32 v11, 16, v33
    v_and_b32 v12, 0xffff0000, v33
    v_add_f32 v130, v130, v11
    v_add_f32 v131, v131, v12
    v_cvt_pk_bf16_f32 v33, v130, v131
    v_lshlrev_b32 v11, 16, v34
    v_and_b32 v12, 0xffff0000, v34
    v_add_f32 v132, v132, v11
    v_add_f32 v133, v133, v12
    v_cvt_pk_bf16_f32 v34, v132, v133
    v_lshlrev_b32 v11, 16, v35
    v_and_b32 v12, 0xffff0000, v35
    v_add_f32 v134, v134, v11
    v_add_f32 v135, v135, v12
    v_cvt_pk_bf16_f32 v35, v134, v135
    buffer_store_dwordx4 v[32:35], v13, s[4:7], s22 offen
    s_add_u32 s22, s22, 1024
    s_waitcnt vmcnt(19)
    v_lshlrev_b32 v11, 16, v36
    v_and_b32 v12, 0xffff0000, v36
    v_add_f32 v136, v136, v11
    v_add_f32 v137, v137, v12
    v_cvt_pk_bf16_f32 v36, v136, v137
    v_lshlrev_b32 v11, 16, v37
    v_and_b32 v12, 0xffff0000, v37
    v_add_f32 v138, v138, v11
    v_add_f32 v139, v139, v12
    v_cvt_pk_bf16_f32 v37, v138, v139
    v_lshlrev_b32 v11, 16, v38
    v_and_b32 v12, 0xffff0000, v38
    v_add_f32 v140, v140, v11
    v_add_f32 v141, v141, v12
    v_cvt_pk_bf16_f32 v38, v140, v141
    v_lshlrev_b32 v11, 16, v39
    v_and_b32 v12, 0xffff0000, v39
    v_add_f32 v142, v142, v11
    v_add_f32 v143, v143, v12
    v_cvt_pk_bf16_f32 v39, v142, v143
    buffer_store_dwordx4 v[36:39], v13, s[4:7], s22 offen
    s_add_u32 s22, s22, 1024
    s_waitcnt vmcnt(19)
    v_lshlrev_b32 v11, 16, v40
    v_and_b32 v12, 0xffff0000, v40
    v_add_f32 v144, v144, v11
    v_add_f32 v145, v145, v12
    v_cvt_pk_bf16_f32 v40, v144, v145
    v_lshlrev_b32 v11, 16, v41
    v_and_b32 v12, 0xffff0000, v41
    v_add_f32 v146, v146, v11
    v_add_f32 v147, v147, v12
    v_cvt_pk_bf16_f32 v41, v146, v147
    v_lshlrev_b32 v11, 16, v42
    v_and_b32 v12, 0xffff0000, v42
    v_add_f32 v148, v148, v11
    v_add_f32 v149, v149, v12
    v_cvt_pk_bf16_f32 v42, v148, v149
    v_lshlrev_b32 v11, 16, v43
    v_and_b32 v12, 0xffff0000, v43
    v_add_f32 v150, v150, v11
    v_add_f32 v151, v151, v12
    v_cvt_pk_bf16_f32 v43, v150, v151
    buffer_store_dwordx4 v[40:43], v13, s[4:7], s22 offen
    s_add_u32 s22, s22, 1024
    s_waitcnt vmcnt(19)
    v_lshlrev_b32 v11, 16, v44
    v_and_b32 v12, 0xffff0000, v44
    v_add_f32 v152, v152, v11
    v_add_f32 v153, v153, v12
    v_cvt_pk_bf16_f32 v44, v152, v153
    v_lshlrev_b32 v11, 16, v45
    v_and_b32 v12, 0xffff0000, v45
    v_add_f32 v154, v154, v11
    v_add_f32 v155, v155, v12
    v_cvt_pk_bf16_f32 v45, v154, v155
    v_lshlrev_b32 v11, 16, v46
    v_and_b32 v12, 0xffff0000, v46
    v_add_f32 v156, v156, v11
    v_add_f32 v157, v157, v12
    v_cvt_pk_bf16_f32 v46, v156, v157
    v_lshlrev_b32 v11, 16, v47
    v_and_b32 v12, 0xffff0000, v47
    v_add_f32 v158, v158, v11
    v_add_f32 v159, v159, v12
    v_cvt_pk_bf16_f32 v47, v158, v159
    buffer_store_dwordx4 v[44:47], v13, s[4:7], s22 offen
    s_add_u32 s22, s22, 1024
    s_waitcnt vmcnt(19)
    v_lshlrev_b32 v11, 16, v48
    v_and_b32 v12, 0xffff0000, v48
    v_add_f32 v160, v160, v11
    v_add_f32 v161, v161, v12
    v_cvt_pk_bf16_f32 v48, v160, v161
    v_lshlrev_b32 v11, 16, v49
    v_and_b32 v12, 0xffff0000, v49
    v_add_f32 v162, v162, v11
    v_add_f32 v163, v163, v12
    v_cvt_pk_bf16_f32 v49, v162, v163
    v_lshlrev_b32 v11, 16, v50
    v_and_b32 v12, 0xffff0000, v50
    v_add_f32 v164, v164, v11
    v_add_f32 v165, v165, v12
    v_cvt_pk_bf16_f32 v50, v164, v165
    v_lshlrev_b32 v11, 16, v51
    v_and_b32 v12, 0xffff0000, v51
    v_add_f32 v166, v166, v11
    v_add_f32 v167, v167, v12
    v_cvt_pk_bf16_f32 v51, v166, v167
    buffer_store_dwordx4 v[48:51], v13, s[4:7], s22 offen
    s_add_u32 s22, s22, 1024
    s_waitcnt vmcnt(19)
    v_lshlrev_b32 v11, 16, v52
    v_and_b32 v12, 0xffff0000, v52
    v_add_f32 v168, v168, v11
    v_add_f32 v169, v169, v12
    v_cvt_pk_bf16_f32 v52, v168, v169
    v_lshlrev_b32 v11, 16, v53
    v_and_b32 v12, 0xffff0000, v53
    v_add_f32 v170, v170, v11
    v_add_f32 v171, v171, v12
    v_cvt_pk_bf16_f32 v53, v170, v171
    v_lshlrev_b32 v11, 16, v54
    v_and_b32 v12, 0xffff0000, v54
    v_add_f32 v172, v172, v11
    v_add_f32 v173, v173, v12
    v_cvt_pk_bf16_f32 v54, v172, v173
    v_lshlrev_b32 v11, 16, v55
    v_and_b32 v12, 0xffff0000, v55
    v_add_f32 v174, v174, v11
    v_add_f32 v175, v175, v12
    v_cvt_pk_bf16_f32 v55, v174, v175
    buffer_store_dwordx4 v[52:55], v13, s[4:7], s22 offen
    s_add_u32 s22, s22, 1024
    s_waitcnt vmcnt(19)
    v_lshlrev_b32 v11, 16, v56
    v_and_b32 v12, 0xffff0000, v56
    v_add_f32 v176, v176, v11
    v_add_f32 v177, v177, v12
    v_cvt_pk_bf16_f32 v56, v176, v177
    v_lshlrev_b32 v11, 16, v57
    v_and_b32 v12, 0xffff0000, v57
    v_add_f32 v178, v178, v11
    v_add_f32 v179, v179, v12
    v_cvt_pk_bf16_f32 v57, v178, v179
    v_lshlrev_b32 v11, 16, v58
    v_and_b32 v12, 0xffff0000, v58
    v_add_f32 v180, v180, v11
    v_add_f32 v181, v181, v12
    v_cvt_pk_bf16_f32 v58, v180, v181
    v_lshlrev_b32 v11, 16, v59
    v_and_b32 v12, 0xffff0000, v59
    v_add_f32 v182, v182, v11
    v_add_f32 v183, v183, v12
    v_cvt_pk_bf16_f32 v59, v182, v183
    buffer_store_dwordx4 v[56:59], v13, s[4:7], s22 offen
    s_add_u32 s22, s22, 1024
    s_waitcnt vmcnt(19)
    v_lshlrev_b32 v11, 16, v60
    v_and_b32 v12, 0xffff0000, v60
    v_add_f32 v184, v184, v11
    v_add_f32 v185, v185, v12
    v_cvt_pk_bf16_f32 v60, v184, v185
    v_lshlrev_b32 v11, 16, v61
    v_and_b32 v12, 0xffff0000, v61
    v_add_f32 v186, v186, v11
    v_add_f32 v187, v187, v12
    v_cvt_pk_bf16_f32 v61, v186, v187
    v_lshlrev_b32 v11, 16, v62
    v_and_b32 v12, 0xffff0000, v62
    v_add_f32 v188, v188, v11
    v_add_f32 v189, v189, v12
    v_cvt_pk_bf16_f32 v62, v188, v189
    v_lshlrev_b32 v11, 16, v63
    v_and_b32 v12, 0xffff0000, v63
    v_add_f32 v190, v190, v11
    v_add_f32 v191, v191, v12
    v_cvt_pk_bf16_f32 v63, v190, v191
    buffer_store_dwordx4 v[60:63], v13, s[4:7], s22 offen
    s_add_u32 s22, s22, 1024
    s_waitcnt vmcnt(19)
    v_lshlrev_b32 v11, 16, v64
    v_and_b32 v12, 0xffff0000, v64
    v_add_f32 v192, v192, v11
    v_add_f32 v193, v193, v12
    v_cvt_pk_bf16_f32 v64, v192, v193
    v_lshlrev_b32 v11, 16, v65
    v_and_b32 v12, 0xffff0000, v65
    v_add_f32 v194, v194, v11
    v_add_f32 v195, v195, v12
    v_cvt_pk_bf16_f32 v65, v194, v195
    v_lshlrev_b32 v11, 16, v66
    v_and_b32 v12, 0xffff0000, v66
    v_add_f32 v196, v196, v11
    v_add_f32 v197, v197, v12
    v_cvt_pk_bf16_f32 v66, v196, v197
    v_lshlrev_b32 v11, 16, v67
    v_and_b32 v12, 0xffff0000, v67
    v_add_f32 v198, v198, v11
    v_add_f32 v199, v199, v12
    v_cvt_pk_bf16_f32 v67, v198, v199
    buffer_store_dwordx4 v[64:67], v13, s[4:7], s22 offen
    s_add_u32 s22, s22, 1024
    s_waitcnt vmcnt(19)
    v_lshlrev_b32 v11, 16, v68
    v_and_b32 v12, 0xffff0000, v68
    v_add_f32 v200, v200, v11
    v_add_f32 v201, v201, v12
    v_cvt_pk_bf16_f32 v68, v200, v201
    v_lshlrev_b32 v11, 16, v69
    v_and_b32 v12, 0xffff0000, v69
    v_add_f32 v202, v202, v11
    v_add_f32 v203, v203, v12
    v_cvt_pk_bf16_f32 v69, v202, v203
    v_lshlrev_b32 v11, 16, v70
    v_and_b32 v12, 0xffff0000, v70
    v_add_f32 v204, v204, v11
    v_add_f32 v205, v205, v12
    v_cvt_pk_bf16_f32 v70, v204, v205
    v_lshlrev_b32 v11, 16, v71
    v_and_b32 v12, 0xffff0000, v71
    v_add_f32 v206, v206, v11
    v_add_f32 v207, v207, v12
    v_cvt_pk_bf16_f32 v71, v206, v207
    buffer_store_dwordx4 v[68:71], v13, s[4:7], s22 offen
    s_add_u32 s22, s22, 1024
    s_waitcnt vmcnt(19)
    v_lshlrev_b32 v11, 16, v72
    v_and_b32 v12, 0xffff0000, v72
    v_add_f32 v208, v208, v11
    v_add_f32 v209, v209, v12
    v_cvt_pk_bf16_f32 v72, v208, v209
    v_lshlrev_b32 v11, 16, v73
    v_and_b32 v12, 0xffff0000, v73
    v_add_f32 v210, v210, v11
    v_add_f32 v211, v211, v12
    v_cvt_pk_bf16_f32 v73, v210, v211
    v_lshlrev_b32 v11, 16, v74
    v_and_b32 v12, 0xffff0000, v74
    v_add_f32 v212, v212, v11
    v_add_f32 v213, v213, v12
    v_cvt_pk_bf16_f32 v74, v212, v213
    v_lshlrev_b32 v11, 16, v75
    v_and_b32 v12, 0xffff0000, v75
    v_add_f32 v214, v214, v11
    v_add_f32 v215, v215, v12
    v_cvt_pk_bf16_f32 v75, v214, v215
    buffer_store_dwordx4 v[72:75], v13, s[4:7], s22 offen
    s_add_u32 s22, s22, 1024
    s_waitcnt vmcnt(19)
    v_lshlrev_b32 v11, 16, v76
    v_and_b32 v12, 0xffff0000, v76
    v_add_f32 v216, v216, v11
    v_add_f32 v217, v217, v12
    v_cvt_pk_bf16_f32 v76, v216, v217
    v_lshlrev_b32 v11, 16, v77
    v_and_b32 v12, 0xffff0000, v77
    v_add_f32 v218, v218, v11
    v_add_f32 v219, v219, v12
    v_cvt_pk_bf16_f32 v77, v218, v219
    v_lshlrev_b32 v11, 16, v78
    v_and_b32 v12, 0xffff0000, v78
    v_add_f32 v220, v220, v11
    v_add_f32 v221, v221, v12
    v_cvt_pk_bf16_f32 v78, v220, v221
    v_lshlrev_b32 v11, 16, v79
    v_and_b32 v12, 0xffff0000, v79
    v_add_f32 v222, v222, v11
    v_add_f32 v223, v223, v12
    v_cvt_pk_bf16_f32 v79, v222, v223
    buffer_store_dwordx4 v[76:79], v13, s[4:7], s22 offen
    s_add_u32 s22, s22, 1024
    s_waitcnt vmcnt(19)
    v_lshlrev_b32 v11, 16, v80
    v_and_b32 v12, 0xffff0000, v80
    v_add_f32 v224, v224, v11
    v_add_f32 v225, v225, v12
    v_cvt_pk_bf16_f32 v80, v224, v225
    v_lshlrev_b32 v11, 16, v81
    v_and_b32 v12, 0xffff0000, v81
    v_add_f32 v226, v226, v11
    v_add_f32 v227, v227, v12
    v_cvt_pk_bf16_f32 v81, v226, v227
    v_lshlrev_b32 v11, 16, v82
    v_and_b32 v12, 0xffff0000, v82
    v_add_f32 v228, v228, v11
    v_add_f32 v229, v229, v12
    v_cvt_pk_bf16_f32 v82, v228, v229
    v_lshlrev_b32 v11, 16, v83
    v_and_b32 v12, 0xffff0000, v83
    v_add_f32 v230, v230, v11
    v_add_f32 v231, v231, v12
    v_cvt_pk_bf16_f32 v83, v230, v231
    buffer_store_dwordx4 v[80:83], v13, s[4:7], s22 offen
    s_add_u32 s22, s22, 1024
    s_waitcnt vmcnt(19)
    v_lshlrev_b32 v11, 16, v84
    v_and_b32 v12, 0xffff0000, v84
    v_add_f32 v232, v232, v11
    v_add_f32 v233, v233, v12
    v_cvt_pk_bf16_f32 v84, v232, v233
    v_lshlrev_b32 v11, 16, v85
    v_and_b32 v12, 0xffff0000, v85
    v_add_f32 v234, v234, v11
    v_add_f32 v235, v235, v12
    v_cvt_pk_bf16_f32 v85, v234, v235
    v_lshlrev_b32 v11, 16, v86
    v_and_b32 v12, 0xffff0000, v86
    v_add_f32 v236, v236, v11
    v_add_f32 v237, v237, v12
    v_cvt_pk_bf16_f32 v86, v236, v237
    v_lshlrev_b32 v11, 16, v87
    v_and_b32 v12, 0xffff0000, v87
    v_add_f32 v238, v238, v11
    v_add_f32 v239, v239, v12
    v_cvt_pk_bf16_f32 v87, v238, v239
    buffer_store_dwordx4 v[84:87], v13, s[4:7], s22 offen
    s_add_u32 s22, s22, 1024
    s_waitcnt vmcnt(19)
    v_lshlrev_b32 v11, 16, v88
    v_and_b32 v12, 0xffff0000, v88
    v_add_f32 v240, v240, v11
    v_add_f32 v241, v241, v12
    v_cvt_pk_bf16_f32 v88, v240, v241
    v_lshlrev_b32 v11, 16, v89
    v_and_b32 v12, 0xffff0000, v89
    v_add_f32 v242, v242, v11
    v_add_f32 v243, v243, v12
    v_cvt_pk_bf16_f32 v89, v242, v243
    v_lshlrev_b32 v11, 16, v90
    v_and_b32 v12, 0xffff0000, v90
    v_add_f32 v244, v244, v11
    v_add_f32 v245, v245, v12
    v_cvt_pk_bf16_f32 v90, v244, v245
    v_lshlrev_b32 v11, 16, v91
    v_and_b32 v12, 0xffff0000, v91
    v_add_f32 v246, v246, v11
    v_add_f32 v247, v247, v12
    v_cvt_pk_bf16_f32 v91, v246, v247
    buffer_store_dwordx4 v[88:91], v13, s[4:7], s22 offen
    s_add_u32 s22, s22, 1024
    s_waitcnt vmcnt(19)
    v_lshlrev_b32 v11, 16, v92
    v_and_b32 v12, 0xffff0000, v92
    v_add_f32 v248, v248, v11
    v_add_f32 v249, v249, v12
    v_cvt_pk_bf16_f32 v92, v248, v249
    v_lshlrev_b32 v11, 16, v93
    v_and_b32 v12, 0xffff0000, v93
    v_add_f32 v250, v250, v11
    v_add_f32 v251, v251, v12
    v_cvt_pk_bf16_f32 v93, v250, v251
    v_lshlrev_b32 v11, 16, v94
    v_and_b32 v12, 0xffff0000, v94
    v_add_f32 v252, v252, v11
    v_add_f32 v253, v253, v12
    v_cvt_pk_bf16_f32 v94, v252, v253
    v_lshlrev_b32 v11, 16, v95
    v_and_b32 v12, 0xffff0000, v95
    v_add_f32 v254, v254, v11
    v_add_f32 v255, v255, v12
    v_cvt_pk_bf16_f32 v95, v254, v255
    buffer_store_dwordx4 v[92:95], v13, s[4:7], s22 offen
    s_add_u32 s22, s22, 1024
L_prep_end:
    s_endpgm
.globl k_chain_kernel
.p2align 8
.type k_chain_kernel,@function
k_chain_kernel:
    s_cmp_ge_u32 s2, 256
    s_cbranch_scc1 L_ch_end
    s_load_dwordx2 s[4:5], s[0:1], 128
    s_load_dwordx2 s[8:9], s[0:1], 0
    s_load_dwordx2 s[12:13], s[0:1], 32
    s_waitcnt lgkmcnt(0)
    s_and_b32 s5, s5, 0xffff
    s_mov_b32 s6, 268435456
    s_mov_b32 s7, 0x00020000
    s_and_b32 s9, s9, 0xffff
    s_mov_b32 s10, 2621440
    s_mov_b32 s11, 0x00020000
    s_and_b32 s13, s13, 0xffff
    s_mov_b32 s14, 7864320
    s_mov_b32 s15, 0x00020000
    v_lshrrev_b32 v1, 6, v0
    s_nop 0
    v_readfirstlane_b32 s20, v1
    v_and_b32 v1, 63, v0
    v_lshlrev_b32 v2, 4, v1
    s_mov_b32 s44, 400000
    s_mov_b32 s40, 0
    s_cmp_ge_u32 s2, 192
    s_cbranch_scc1 L_pre_done
    s_cmp_ge_u32 s2, 32
    s_cbranch_scc0 L_pre_done
L_pre_wvo:
    s_getreg_b32 s66, hwreg(HW_REG_XCC_ID, 0, 4)
    s_and_b32 s66, s66, 7
    s_mov_b32 s67, 0
L_pre_q:
    s_cmp_lg_u32 s20, 0
    s_cbranch_scc1 L_pre_nq
    v_mov_b32 v4, 1
    v_mov_b32 v5, 0
    s_lshl_b32 s22, s66, 7
    s_add_u32 s22, s22, 250844224
    s_mov_b64 exec, 1
    buffer_atomic_add v4, v5, s[4:7], s22 offen sc0
    s_waitcnt vmcnt(0)
    v_mov_b32 v5, 49216
    ds_write_b32 v5, v4
    s_mov_b64 exec, -1
    s_waitcnt lgkmcnt(0)
L_pre_nq:
    s_barrier
    v_mov_b32 v5, 49216
    ds_read_b32 v4, v5
    s_waitcnt lgkmcnt(0)
    v_readfirstlane_b32 s70, v4
    s_barrier
    s_cmp_lt_u32 s70, 20
    s_cbranch_scc1 L_pre_got
    s_add_u32 s66, s66, 1
    s_and_b32 s66, s66, 7
    s_add_u32 s67, s67, 1
    s_cmp_lt_u32 s67, 8
    s_cbranch_scc1 L_pre_q
    s_branch L_pre_done
L_pre_got:
    s_mul_i32 s72, s66, 20
    s_add_u32 s72, s72, s70
    s_mul_hi_u32 s22, s72, 858993460
    s_mul_i32 s21, s22, 5
    s_sub_u32 s21, s72, s21
    s_lshl_b32 s23, s21, 2
    s_add_u32 s23, s23, 64
    s_sub_u32 s27, s23, 64
    s_add_u32 s27, s27, s20
    s_mul_i32 s27, s27, 393216
    s_mul_i32 s28, s22, 384
    s_add_u32 s27, s27, s28
    v_and_b32 v4, 15, v1
    v_lshrrev_b32 v5, 4, v1
    v_mul_u32_u24 v4, 12288, v4
    v_lshlrev_b32 v5, 3, v5
    v_add_u32 v4, v4, v5
    buffer_load_dwordx2 v[132:133], v4, s[12:15], s27 offen offset:0
    buffer_load_dwordx2 v[134:135], v4, s[12:15], s27 offen offset:32
    buffer_load_dwordx2 v[136:137], v4, s[12:15], s27 offen offset:64
    buffer_load_dwordx2 v[138:139], v4, s[12:15], s27 offen offset:96
    buffer_load_dwordx2 v[140:141], v4, s[12:15], s27 offen offset:128
    buffer_load_dwordx2 v[142:143], v4, s[12:15], s27 offen offset:160
    buffer_load_dwordx2 v[144:145], v4, s[12:15], s27 offen offset:192
    buffer_load_dwordx2 v[146:147], v4, s[12:15], s27 offen offset:224
    buffer_load_dwordx2 v[148:149], v4, s[12:15], s27 offen offset:256
    buffer_load_dwordx2 v[150:151], v4, s[12:15], s27 offen offset:288
    buffer_load_dwordx2 v[152:153], v4, s[12:15], s27 offen offset:320
    buffer_load_dwordx2 v[154:155], v4, s[12:15], s27 offen offset:352
    s_add_u32 s27, s27, 196608
    buffer_load_dwordx2 v[156:157], v4, s[12:15], s27 offen offset:0
    buffer_load_dwordx2 v[158:159], v4, s[12:15], s27 offen offset:32
    buffer_load_dwordx2 v[160:161], v4, s[12:15], s27 offen offset:64
    buffer_load_dwordx2 v[162:163], v4, s[12:15], s27 offen offset:96
    buffer_load_dwordx2 v[164:165], v4, s[12:15], s27 offen offset:128
    buffer_load_dwordx2 v[166:167], v4, s[12:15], s27 offen offset:160
    buffer_load_dwordx2 v[168:169], v4, s[12:15], s27 offen offset:192
    buffer_load_dwordx2 v[170:171], v4, s[12:15], s27 offen offset:224
    buffer_load_dwordx2 v[172:173], v4, s[12:15], s27 offen offset:256
    buffer_load_dwordx2 v[174:175], v4, s[12:15], s27 offen offset:288
    buffer_load_dwordx2 v[176:177], v4, s[12:15], s27 offen offset:320
    buffer_load_dwordx2 v[178:179], v4, s[12:15], s27 offen offset:352
    s_mul_i32 s26, s20, 12288
    v_add_u32 v4, s26, v2
    s_mul_i32 s27, s22, 40
    s_mul_i32 s26, s20, 10
    s_add_u32 s27, s27, s26
    s_mul_i32 s27, s27, 6144
    s_add_u32 s27, s27, 28266496
    s_lshl_b32 s28, s23, 5
    s_add_u32 s28, s28, s22
    s_mul_i32 s28, s28, 40
    s_add_u32 s28, s28, s26
    s_lshl_b32 s28, s28, 10
    s_add_u32 s28, s28, 90394624
    v_add_u32 v3, 4096, v2
    buffer_load_dwordx4 v[20:23], v2, s[4:7], s27 offen offset:0
    buffer_load_dwordx4 v[24:27], v2, s[4:7], s27 offen offset:1024
    buffer_load_dwordx4 v[28:31], v2, s[4:7], s27 offen offset:2048
    buffer_load_dwordx4 v[32:35], v2, s[4:7], s27 offen offset:3072
    buffer_load_dwordx4 v[36:39], v3, s[4:7], s27 offen offset:0
    buffer_load_dwordx4 v[40:43], v3, s[4:7], s27 offen offset:1024
    s_add_u32 s27, s27, 6144
    buffer_load_dwordx4 v[44:47], v2, s[4:7], s27 offen offset:0
    buffer_load_dwordx4 v[48:51], v2, s[4:7], s27 offen offset:1024
    buffer_load_dwordx4 v[52:55], v2, s[4:7], s27 offen offset:2048
    buffer_load_dwordx4 v[56:59], v2, s[4:7], s27 offen offset:3072
    buffer_load_dwordx4 v[60:63], v3, s[4:7], s27 offen offset:0
    buffer_load_dwordx4 v[64:67], v3, s[4:7], s27 offen offset:1024
    s_add_u32 s27, s27, 6144
    buffer_load_dwordx4 v[68:71], v2, s[4:7], s27 offen offset:0
    buffer_load_dwordx4 v[72:75], v2, s[4:7], s27 offen offset:1024
    buffer_load_dwordx4 v[76:79], v2, s[4:7], s27 offen offset:2048
    buffer_load_dwordx4 v[80:83], v2, s[4:7], s27 offen offset:3072
    buffer_load_dwordx4 v[84:87], v3, s[4:7], s27 offen offset:0
    buffer_load_dwordx4 v[88:91], v3, s[4:7], s27 offen offset:1024
    s_add_u32 s27, s27, 6144
    buffer_load_dwordx4 v[92:95], v2, s[4:7], s27 offen offset:0
    buffer_load_dwordx4 v[96:99], v2, s[4:7], s27 offen offset:1024
    buffer_load_dwordx4 v[100:103], v2, s[4:7], s27 offen offset:2048
    buffer_load_dwordx4 v[104:107], v2, s[4:7], s27 offen offset:3072
    buffer_load_dwordx4 v[108:111], v3, s[4:7], s27 offen offset:0
    buffer_load_dwordx4 v[112:115], v3, s[4:7], s27 offen offset:1024
    s_add_u32 s27, s27, 6144
    buffer_load_dwordx4 v[180:183], v2, s[4:7], s27 offen offset:0
    buffer_load_dwordx4 v[184:187], v2, s[4:7], s27 offen offset:1024
    buffer_load_dwordx4 v[188:191], v2, s[4:7], s27 offen offset:2048
    buffer_load_dwordx4 v[192:195], v2, s[4:7], s27 offen offset:3072
    buffer_load_dwordx4 v[196:199], v3, s[4:7], s27 offen offset:0
    buffer_load_dwordx4 v[200:203], v3, s[4:7], s27 offen offset:1024
    s_add_u32 s27, s27, 6144
    buffer_load_dwordx4 v[204:207], v2, s[4:7], s27 offen offset:0
    buffer_load_dwordx4 v[208:211], v2, s[4:7], s27 offen offset:1024
    buffer_load_dwordx4 v[212:215], v2, s[4:7], s27 offen offset:2048
    buffer_load_dwordx4 v[216:219], v2, s[4:7], s27 offen offset:3072
    buffer_load_dwordx4 v[220:223], v3, s[4:7], s27 offen offset:0
    buffer_load_dwordx4 v[224:227], v3, s[4:7], s27 offen offset:1024
    s_add_u32 s27, s27, 6144
    s_waitcnt vmcnt(36)
    ds_write_b128 v4, v[132:135] offset:0
    ds_write_b128 v4, v[136:139] offset:1024
    ds_write_b128 v4, v[140:143] offset:2048
    ds_write_b128 v4, v[144:147] offset:3072
    ds_write_b128 v4, v[148:151] offset:4096
    ds_write_b128 v4, v[152:155] offset:5120
    ds_write_b128 v4, v[156:159] offset:6144
    ds_write_b128 v4, v[160:163] offset:7168
    ds_write_b128 v4, v[164:167] offset:8192
    ds_write_b128 v4, v[168:171] offset:9216
    ds_write_b128 v4, v[172:175] offset:10240
    ds_write_b128 v4, v[176:179] offset:11264
    s_waitcnt lgkmcnt(0)
    s_barrier
    v_add_u32 v4, 16384, v2
    v_add_u32 v5, 32768, v2
    ds_read_b128 a[0:3], v2 offset:0
    ds_read_b128 a[4:7], v2 offset:1024
    ds_read_b128 a[8:11], v2 offset:2048
    ds_read_b128 a[12:15], v2 offset:3072
    ds_read_b128 a[16:19], v2 offset:4096
    ds_read_b128 a[20:23], v2 offset:5120
    ds_read_b128 a[24:27], v2 offset:6144
    ds_read_b128 a[28:31], v2 offset:7168
    ds_read_b128 a[32:35], v2 offset:8192
    ds_read_b128 a[36:39], v2 offset:9216
    ds_read_b128 a[40:43], v2 offset:10240
    ds_read_b128 a[44:47], v2 offset:11264
    ds_read_b128 a[48:51], v2 offset:12288
    ds_read_b128 a[52:55], v2 offset:13312
    ds_read_b128 a[56:59], v2 offset:14336
    ds_read_b128 a[60:63], v2 offset:15360
    ds_read_b128 a[64:67], v4 offset:0
    ds_read_b128 a[68:71], v4 offset:1024
    ds_read_b128 a[72:75], v4 offset:2048
    ds_read_b128 a[76:79], v4 offset:3072
    ds_read_b128 a[80:83], v4 offset:4096
    ds_read_b128 a[84:87], v4 offset:5120
    ds_read_b128 a[88:91], v4 offset:6144
    ds_read_b128 a[92:95], v4 offset:7168
    ds_read_b128 a[96:99], v4 offset:8192
    ds_read_b128 a[100:103], v4 offset:9216
    ds_read_b128 a[104:107], v4 offset:10240
    ds_read_b128 a[108:111], v4 offset:11264
    ds_read_b128 a[112:115], v4 offset:12288
    ds_read_b128 a[116:119], v4 offset:13312
    ds_read_b128 a[120:123], v4 offset:14336
    ds_read_b128 a[124:127], v4 offset:15360
    ds_read_b128 a[128:131], v5 offset:0
    ds_read_b128 a[132:135], v5 offset:1024
    ds_read_b128 a[136:139], v5 offset:2048
    ds_read_b128 a[140:143], v5 offset:3072
    ds_read_b128 a[144:147], v5 offset:4096
    ds_read_b128 a[148:151], v5 offset:5120
    ds_read_b128 a[152:155], v5 offset:6144
    ds_read_b128 a[156:159], v5 offset:7168
    ds_read_b128 a[160:163], v5 offset:8192
    ds_read_b128 a[164:167], v5 offset:9216
    ds_read_b128 a[168:171], v5 offset:10240
    ds_read_b128 a[172:175], v5 offset:11264
    ds_read_b128 a[176:179], v5 offset:12288
    ds_read_b128 a[180:183], v5 offset:13312
    ds_read_b128 a[184:187], v5 offset:14336
    ds_read_b128 a[188:191], v5 offset:15360
    s_waitcnt lgkmcnt(0)
    buffer_load_dwordx4 v[228:231], v2, s[4:7], s27 offen offset:0
    buffer_load_dwordx4 v[232:235], v2, s[4:7], s27 offen offset:1024
    buffer_load_dwordx4 v[236:239], v2, s[4:7], s27 offen offset:2048
    buffer_load_dwordx4 v[240:243], v2, s[4:7], s27 offen offset:3072
    buffer_load_dwordx4 v[244:247], v3, s[4:7], s27 offen offset:0
    buffer_load_dwordx4 v[248:251], v3, s[4:7], s27 offen offset:1024
    s_add_u32 s27, s27, 6144
    s_waitcnt vmcnt(36)
    v_mfma_f32_16x16x32_bf16 v[116:119], a[0:3], v[20:23], 0
    v_mfma_f32_16x16x32_bf16 v[116:119], a[4:7], v[24:27], v[116:119]
    v_mfma_f32_16x16x32_bf16 v[116:119], a[8:11], v[28:31], v[116:119]
    v_mfma_f32_16x16x32_bf16 v[116:119], a[12:15], v[32:35], v[116:119]
    v_mfma_f32_16x16x32_bf16 v[116:119], a[16:19], v[36:39], v[116:119]
    v_mfma_f32_16x16x32_bf16 v[116:119], a[20:23], v[40:43], v[116:119]
    v_mfma_f32_16x16x32_bf16 v[120:123], a[24:27], v[20:23], 0
    v_mfma_f32_16x16x32_bf16 v[120:123], a[28:31], v[24:27], v[120:123]
    v_mfma_f32_16x16x32_bf16 v[120:123], a[32:35], v[28:31], v[120:123]
    v_mfma_f32_16x16x32_bf16 v[120:123], a[36:39], v[32:35], v[120:123]
    v_mfma_f32_16x16x32_bf16 v[120:123], a[40:43], v[36:39], v[120:123]
    v_mfma_f32_16x16x32_bf16 v[120:123], a[44:47], v[40:43], v[120:123]
    v_mfma_f32_16x16x32_bf16 v[124:127], a[48:51], v[20:23], 0
    v_mfma_f32_16x16x32_bf16 v[124:127], a[52:55], v[24:27], v[124:127]
    v_mfma_f32_16x16x32_bf16 v[124:127], a[56:59], v[28:31], v[124:127]
    v_mfma_f32_16x16x32_bf16 v[124:127], a[60:63], v[32:35], v[124:127]
    v_mfma_f32_16x16x32_bf16 v[124:127], a[64:67], v[36:39], v[124:127]
    v_mfma_f32_16x16x32_bf16 v[124:127], a[68:71], v[40:43], v[124:127]
    v_mfma_f32_16x16x32_bf16 v[128:131], a[72:75], v[20:23], 0
    v_mfma_f32_16x16x32_bf16 v[128:131], a[76:79], v[24:27], v[128:131]
    v_mfma_f32_16x16x32_bf16 v[128:131], a[80:83], v[28:31], v[128:131]
    v_mfma_f32_16x16x32_bf16 v[128:131], a[84:87], v[32:35], v[128:131]
    v_mfma_f32_16x16x32_bf16 v[128:131], a[88:91], v[36:39], v[128:131]
    v_mfma_f32_16x16x32_bf16 v[128:131], a[92:95], v[40:43], v[128:131]
    v_cvt_pk_bf16_f32 v132, v116, v117
    v_cvt_pk_bf16_f32 v133, v118, v119
    v_cvt_pk_bf16_f32 v134, v120, v121
    v_cvt_pk_bf16_f32 v135, v122, v123
    s_add_u32 s29, s28, 0
    buffer_store_dwordx4 v[132:135], v2, s[4:7], s29 offen sc1
    v_mfma_f32_16x16x32_bf16 v[116:119], a[96:99], v[20:23], 0
    v_mfma_f32_16x16x32_bf16 v[116:119], a[100:103], v[24:27], v[116:119]
    v_mfma_f32_16x16x32_bf16 v[116:119], a[104:107], v[28:31], v[116:119]
    v_mfma_f32_16x16x32_bf16 v[116:119], a[108:111], v[32:35], v[116:119]
    v_mfma_f32_16x16x32_bf16 v[116:119], a[112:115], v[36:39], v[116:119]
    v_mfma_f32_16x16x32_bf16 v[116:119], a[116:119], v[40:43], v[116:119]
    v_mfma_f32_16x16x32_bf16 v[120:123], a[120:123], v[20:23], 0
    v_mfma_f32_16x16x32_bf16 v[120:123], a[124:127], v[24:27], v[120:123]
    v_mfma_f32_16x16x32_bf16 v[120:123], a[128:131], v[28:31], v[120:123]
    v_mfma_f32_16x16x32_bf16 v[120:123], a[132:135], v[32:35], v[120:123]
    v_mfma_f32_16x16x32_bf16 v[120:123], a[136:139], v[36:39], v[120:123]
    v_mfma_f32_16x16x32_bf16 v[120:123], a[140:143], v[40:43], v[120:123]
    v_cvt_pk_bf16_f32 v136, v124, v125
    v_cvt_pk_bf16_f32 v137, v126, v127
    v_cvt_pk_bf16_f32 v138, v128, v129
    v_cvt_pk_bf16_f32 v139, v130, v131
    s_add_u32 s29, s28, 1310720
    buffer_store_dwordx4 v[136:139], v2, s[4:7], s29 offen sc1
    v_mfma_f32_16x16x32_bf16 v[124:127], a[144:147], v[20:23], 0
    v_mfma_f32_16x16x32_bf16 v[124:127], a[148:151], v[24:27], v[124:127]
    v_mfma_f32_16x16x32_bf16 v[124:127], a[152:155], v[28:31], v[124:127]
    v_mfma_f32_16x16x32_bf16 v[124:127], a[156:159], v[32:35], v[124:127]
    v_mfma_f32_16x16x32_bf16 v[124:127], a[160:163], v[36:39], v[124:127]
    v_mfma_f32_16x16x32_bf16 v[124:127], a[164:167], v[40:43], v[124:127]
    v_mfma_f32_16x16x32_bf16 v[128:131], a[168:171], v[20:23], 0
    v_mfma_f32_16x16x32_bf16 v[128:131], a[172:175], v[24:27], v[128:131]
    v_mfma_f32_16x16x32_bf16 v[128:131], a[176:179], v[28:31], v[128:131]
    v_mfma_f32_16x16x32_bf16 v[128:131], a[180:183], v[32:35], v[128:131]
    v_mfma_f32_16x16x32_bf16 v[128:131], a[184:187], v[36:39], v[128:131]
    v_mfma_f32_16x16x32_bf16 v[128:131], a[188:191], v[40:43], v[128:131]
    v_cvt_pk_bf16_f32 v140, v116, v117
    v_cvt_pk_bf16_f32 v141, v118, v119
    v_cvt_pk_bf16_f32 v142, v120, v121
    v_cvt_pk_bf16_f32 v143, v122, v123
    s_add_u32 s29, s28, 2621440
    buffer_store_dwordx4 v[140:143], v2, s[4:7], s29 offen sc1
    buffer_load_dwordx4 v[20:23], v2, s[4:7], s27 offen offset:0
    buffer_load_dwordx4 v[24:27], v2, s[4:7], s27 offen offset:1024
    buffer_load_dwordx4 v[28:31], v2, s[4:7], s27 offen offset:2048
    buffer_load_dwordx4 v[32:35], v2, s[4:7], s27 offen offset:3072
    buffer_load_dwordx4 v[36:39], v3, s[4:7], s27 offen offset:0
    buffer_load_dwordx4 v[40:43], v3, s[4:7], s27 offen offset:1024
    s_add_u32 s27, s27, 6144
    s_waitcnt vmcnt(36)
    v_mfma_f32_16x16x32_bf16 v[116:119], a[0:3], v[44:47], 0
    v_mfma_f32_16x16x32_bf16 v[116:119], a[4:7], v[48:51], v[116:119]
    v_mfma_f32_16x16x32_bf16 v[116:119], a[8:11], v[52:55], v[116:119]
    v_mfma_f32_16x16x32_bf16 v[116:119], a[12:15], v[56:59], v[116:119]
    v_mfma_f32_16x16x32_bf16 v[116:119], a[16:19], v[60:63], v[116:119]
    v_mfma_f32_16x16x32_bf16 v[116:119], a[20:23], v[64:67], v[116:119]
    v_mfma_f32_16x16x32_bf16 v[120:123], a[24:27], v[44:47], 0
    v_mfma_f32_16x16x32_bf16 v[120:123], a[28:31], v[48:51], v[120:123]
    v_mfma_f32_16x16x32_bf16 v[120:123], a[32:35], v[52:55], v[120:123]
    v_mfma_f32_16x16x32_bf16 v[120:123], a[36:39], v[56:59], v[120:123]
    v_mfma_f32_16x16x32_bf16 v[120:123], a[40:43], v[60:63], v[120:123]
    v_mfma_f32_16x16x32_bf16 v[120:123], a[44:47], v[64:67], v[120:123]
    v_cvt_pk_bf16_f32 v144, v124, v125
    v_cvt_pk_bf16_f32 v145, v126, v127
    v_cvt_pk_bf16_f32 v146, v128, v129
    v_cvt_pk_bf16_f32 v147, v130, v131
    s_add_u32 s29, s28, 3932160
    buffer_store_dwordx4 v[144:147], v2, s[4:7], s29 offen sc1
    v_mfma_f32_16x16x32_bf16 v[124:127], a[48:51], v[44:47], 0
    v_mfma_f32_16x16x32_bf16 v[124:127], a[52:55], v[48:51], v[124:127]
    v_mfma_f32_16x16x32_bf16 v[124:127], a[56:59], v[52:55], v[124:127]
    v_mfma_f32_16x16x32_bf16 v[124:127], a[60:63], v[56:59], v[124:127]
    v_mfma_f32_16x16x32_bf16 v[124:127], a[64:67], v[60:63], v[124:127]
    v_mfma_f32_16x16x32_bf16 v[124:127], a[68:71], v[64:67], v[124:127]
    v_mfma_f32_16x16x32_bf16 v[128:131], a[72:75], v[44:47], 0
    v_mfma_f32_16x16x32_bf16 v[128:131], a[76:79], v[48:51], v[128:131]
    v_mfma_f32_16x16x32_bf16 v[128:131], a[80:83], v[52:55], v[128:131]
    v_mfma_f32_16x16x32_bf16 v[128:131], a[84:87], v[56:59], v[128:131]
    v_mfma_f32_16x16x32_bf16 v[128:131], a[88:91], v[60:63], v[128:131]
    v_mfma_f32_16x16x32_bf16 v[128:131], a[92:95], v[64:67], v[128:131]
    v_cvt_pk_bf16_f32 v132, v116, v117
    v_cvt_pk_bf16_f32 v133, v118, v119
    v_cvt_pk_bf16_f32 v134, v120, v121
    v_cvt_pk_bf16_f32 v135, v122, v123
    s_add_u32 s29, s28, 1024
    buffer_store_dwordx4 v[132:135], v2, s[4:7], s29 offen sc1
    v_mfma_f32_16x16x32_bf16 v[116:119], a[96:99], v[44:47], 0
    v_mfma_f32_16x16x32_bf16 v[116:119], a[100:103], v[48:51], v[116:119]
    v_mfma_f32_16x16x32_bf16 v[116:119], a[104:107], v[52:55], v[116:119]
    v_mfma_f32_16x16x32_bf16 v[116:119], a[108:111], v[56:59], v[116:119]
    v_mfma_f32_16x16x32_bf16 v[116:119], a[112:115], v[60:63], v[116:119]
    v_mfma_f32_16x16x32_bf16 v[116:119], a[116:119], v[64:67], v[116:119]
    v_mfma_f32_16x16x32_bf16 v[120:123], a[120:123], v[44:47], 0
    v_mfma_f32_16x16x32_bf16 v[120:123], a[124:127], v[48:51], v[120:123]
    v_mfma_f32_16x16x32_bf16 v[120:123], a[128:131], v[52:55], v[120:123]
    v_mfma_f32_16x16x32_bf16 v[120:123], a[132:135], v[56:59], v[120:123]
    v_mfma_f32_16x16x32_bf16 v[120:123], a[136:139], v[60:63], v[120:123]
    v_mfma_f32_16x16x32_bf16 v[120:123], a[140:143], v[64:67], v[120:123]
    v_cvt_pk_bf16_f32 v136, v124, v125
    v_cvt_pk_bf16_f32 v137, v126, v127
    v_cvt_pk_bf16_f32 v138, v128, v129
    v_cvt_pk_bf16_f32 v139, v130, v131
    s_add_u32 s29, s28, 1311744
    buffer_store_dwordx4 v[136:139], v2, s[4:7], s29 offen sc1
    v_mfma_f32_16x16x32_bf16 v[124:127], a[144:147], v[44:47], 0
    v_mfma_f32_16x16x32_bf16 v[124:127], a[148:151], v[48:51], v[124:127]
    v_mfma_f32_16x16x32_bf16 v[124:127], a[152:155], v[52:55], v[124:127]
    v_mfma_f32_16x16x32_bf16 v[124:127], a[156:159], v[56:59], v[124:127]
    v_mfma_f32_16x16x32_bf16 v[124:127], a[160:163], v[60:63], v[124:127]
    v_mfma_f32_16x16x32_bf16 v[124:127], a[164:167], v[64:67], v[124:127]
    v_mfma_f32_16x16x32_bf16 v[128:131], a[168:171], v[44:47], 0
    v_mfma_f32_16x16x32_bf16 v[128:131], a[172:175], v[48:51], v[128:131]
    v_mfma_f32_16x16x32_bf16 v[128:131], a[176:179], v[52:55], v[128:131]
    v_mfma_f32_16x16x32_bf16 v[128:131], a[180:183], v[56:59], v[128:131]
    v_mfma_f32_16x16x32_bf16 v[128:131], a[184:187], v[60:63], v[128:131]
    v_mfma_f32_16x16x32_bf16 v[128:131], a[188:191], v[64:67], v[128:131]
    v_cvt_pk_bf16_f32 v140, v116, v117
    v_cvt_pk_bf16_f32 v141, v118, v119
    v_cvt_pk_bf16_f32 v142, v120, v121
    v_cvt_pk_bf16_f32 v143, v122, v123
    s_add_u32 s29, s28, 2622464
    buffer_store_dwordx4 v[140:143], v2, s[4:7], s29 offen sc1
    buffer_load_dwordx4 v[44:47], v2, s[4:7], s27 offen offset:0
    buffer_load_dwordx4 v[48:51], v2, s[4:7], s27 offen offset:1024
    buffer_load_dwordx4 v[52:55], v2, s[4:7], s27 offen offset:2048
    buffer_load_dwordx4 v[56:59], v2, s[4:7], s27 offen offset:3072
    buffer_load_dwordx4 v[60:63], v3, s[4:7], s27 offen offset:0
    buffer_load_dwordx4 v[64:67], v3, s[4:7], s27 offen offset:1024
    s_add_u32 s27, s27, 6144
    s_waitcnt vmcnt(36)
    v_mfma_f32_16x16x32_bf16 v[116:119], a[0:3], v[68:71], 0
    v_mfma_f32_16x16x32_bf16 v[116:119], a[4:7], v[72:75], v[116:119]
    v_mfma_f32_16x16x32_bf16 v[116:119], a[8:11], v[76:79], v[116:119]
    v_mfma_f32_16x16x32_bf16 v[116:119], a[12:15], v[80:83], v[116:119]
    v_mfma_f32_16x16x32_bf16 v[116:119], a[16:19], v[84:87], v[116:119]
    v_mfma_f32_16x16x32_bf16 v[116:119], a[20:23], v[88:91], v[116:119]
    v_mfma_f32_16x16x32_bf16 v[120:123], a[24:27], v[68:71], 0
    v_mfma_f32_16x16x32_bf16 v[120:123], a[28:31], v[72:75], v[120:123]
    v_mfma_f32_16x16x32_bf16 v[120:123], a[32:35], v[76:79], v[120:123]
    v_mfma_f32_16x16x32_bf16 v[120:123], a[36:39], v[80:83], v[120:123]
    v_mfma_f32_16x16x32_bf16 v[120:123], a[40:43], v[84:87], v[120:123]
    v_mfma_f32_16x16x32_bf16 v[120:123], a[44:47], v[88:91], v[120:123]
    v_cvt_pk_bf16_f32 v144, v124, v125
    v_cvt_pk_bf16_f32 v145, v126, v127
    v_cvt_pk_bf16_f32 v146, v128, v129
    v_cvt_pk_bf16_f32 v147, v130, v131
    s_add_u32 s29, s28, 3933184
    buffer_store_dwordx4 v[144:147], v2, s[4:7], s29 offen sc1
    v_mfma_f32_16x16x32_bf16 v[124:127], a[48:51], v[68:71], 0
    v_mfma_f32_16x16x32_bf16 v[124:127], a[52:55], v[72:75], v[124:127]
    v_mfma_f32_16x16x32_bf16 v[124:127], a[56:59], v[76:79], v[124:127]
    v_mfma_f32_16x16x32_bf16 v[124:127], a[60:63], v[80:83], v[124:127]
    v_mfma_f32_16x16x32_bf16 v[124:127], a[64:67], v[84:87], v[124:127]
    v_mfma_f32_16x16x32_bf16 v[124:127], a[68:71], v[88:91], v[124:127]
    v_mfma_f32_16x16x32_bf16 v[128:131], a[72:75], v[68:71], 0
    v_mfma_f32_16x16x32_bf16 v[128:131], a[76:79], v[72:75], v[128:131]
    v_mfma_f32_16x16x32_bf16 v[128:131], a[80:83], v[76:79], v[128:131]
    v_mfma_f32_16x16x32_bf16 v[128:131], a[84:87], v[80:83], v[128:131]
    v_mfma_f32_16x16x32_bf16 v[128:131], a[88:91], v[84:87], v[128:131]
    v_mfma_f32_16x16x32_bf16 v[128:131], a[92:95], v[88:91], v[128:131]
    v_cvt_pk_bf16_f32 v132, v116, v117
    v_cvt_pk_bf16_f32 v133, v118, v119
    v_cvt_pk_bf16_f32 v134, v120, v121
    v_cvt_pk_bf16_f32 v135, v122, v123
    s_add_u32 s29, s28, 2048
    buffer_store_dwordx4 v[132:135], v2, s[4:7], s29 offen sc1
    v_mfma_f32_16x16x32_bf16 v[116:119], a[96:99], v[68:71], 0
    v_mfma_f32_16x16x32_bf16 v[116:119], a[100:103], v[72:75], v[116:119]
    v_mfma_f32_16x16x32_bf16 v[116:119], a[104:107], v[76:79], v[116:119]
    v_mfma_f32_16x16x32_bf16 v[116:119], a[108:111], v[80:83], v[116:119]
    v_mfma_f32_16x16x32_bf16 v[116:119], a[112:115], v[84:87], v[116:119]
    v_mfma_f32_16x16x32_bf16 v[116:119], a[116:119], v[88:91], v[116:119]
    v_mfma_f32_16x16x32_bf16 v[120:123], a[120:123], v[68:71], 0
    v_mfma_f32_16x16x32_bf16 v[120:123], a[124:127], v[72:75], v[120:123]
    v_mfma_f32_16x16x32_bf16 v[120:123], a[128:131], v[76:79], v[120:123]
    v_mfma_f32_16x16x32_bf16 v[120:123], a[132:135], v[80:83], v[120:123]
    v_mfma_f32_16x16x32_bf16 v[120:123], a[136:139], v[84:87], v[120:123]
    v_mfma_f32_16x16x32_bf16 v[120:123], a[140:143], v[88:91], v[120:123]
    v_cvt_pk_bf16_f32 v136, v124, v125
    v_cvt_pk_bf16_f32 v137, v126, v127
    v_cvt_pk_bf16_f32 v138, v128, v129
    v_cvt_pk_bf16_f32 v139, v130, v131
    s_add_u32 s29, s28, 1312768
    buffer_store_dwordx4 v[136:139], v2, s[4:7], s29 offen sc1
    v_mfma_f32_16x16x32_bf16 v[124:127], a[144:147], v[68:71], 0
    v_mfma_f32_16x16x32_bf16 v[124:127], a[148:151], v[72:75], v[124:127]
    v_mfma_f32_16x16x32_bf16 v[124:127], a[152:155], v[76:79], v[124:127]
    v_mfma_f32_16x16x32_bf16 v[124:127], a[156:159], v[80:83], v[124:127]
    v_mfma_f32_16x16x32_bf16 v[124:127], a[160:163], v[84:87], v[124:127]
    v_mfma_f32_16x16x32_bf16 v[124:127], a[164:167], v[88:91], v[124:127]
    v_mfma_f32_16x16x32_bf16 v[128:131], a[168:171], v[68:71], 0
    v_mfma_f32_16x16x32_bf16 v[128:131], a[172:175], v[72:75], v[128:131]
    v_mfma_f32_16x16x32_bf16 v[128:131], a[176:179], v[76:79], v[128:131]
    v_mfma_f32_16x16x32_bf16 v[128:131], a[180:183], v[80:83], v[128:131]
    v_mfma_f32_16x16x32_bf16 v[128:131], a[184:187], v[84:87], v[128:131]
    v_mfma_f32_16x16x32_bf16 v[128:131], a[188:191], v[88:91], v[128:131]
    v_cvt_pk_bf16_f32 v140, v116, v117
    v_cvt_pk_bf16_f32 v141, v118, v119
    v_cvt_pk_bf16_f32 v142, v120, v121
    v_cvt_pk_bf16_f32 v143, v122, v123
    s_add_u32 s29, s28, 2623488
    buffer_store_dwordx4 v[140:143], v2, s[4:7], s29 offen sc1
    buffer_load_dwordx4 v[68:71], v2, s[4:7], s27 offen offset:0
    buffer_load_dwordx4 v[72:75], v2, s[4:7], s27 offen offset:1024
    buffer_load_dwordx4 v[76:79], v2, s[4:7], s27 offen offset:2048
    buffer_load_dwordx4 v[80:83], v2, s[4:7], s27 offen offset:3072
    buffer_load_dwordx4 v[84:87], v3, s[4:7], s27 offen offset:0
    buffer_load_dwordx4 v[88:91], v3, s[4:7], s27 offen offset:1024
    s_add_u32 s27, s27, 6144
    s_waitcnt vmcnt(36)
    v_mfma_f32_16x16x32_bf16 v[116:119], a[0:3], v[92:95], 0
    v_mfma_f32_16x16x32_bf16 v[116:119], a[4:7], v[96:99], v[116:119]
    v_mfma_f32_16x16x32_bf16 v[116:119], a[8:11], v[100:103], v[116:119]
    v_mfma_f32_16x16x32_bf16 v[116:119], a[12:15], v[104:107], v[116:119]
    v_mfma_f32_16x16x32_bf16 v[116:119], a[16:19], v[108:111], v[116:119]
    v_mfma_f32_16x16x32_bf16 v[116:119], a[20:23], v[112:115], v[116:119]
    v_mfma_f32_16x16x32_bf16 v[120:123], a[24:27], v[92:95], 0
    v_mfma_f32_16x16x32_bf16 v[120:123], a[28:31], v[96:99], v[120:123]
    v_mfma_f32_16x16x32_bf16 v[120:123], a[32:35], v[100:103], v[120:123]
    v_mfma_f32_16x16x32_bf16 v[120:123], a[36:39], v[104:107], v[120:123]
    v_mfma_f32_16x16x32_bf16 v[120:123], a[40:43], v[108:111], v[120:123]
    v_mfma_f32_16x16x32_bf16 v[120:123], a[44:47], v[112:115], v[120:123]
    v_cvt_pk_bf16_f32 v144, v124, v125
    v_cvt_pk_bf16_f32 v145, v126, v127
    v_cvt_pk_bf16_f32 v146, v128, v129
    v_cvt_pk_bf16_f32 v147, v130, v131
    s_add_u32 s29, s28, 3934208
    buffer_store_dwordx4 v[144:147], v2, s[4:7], s29 offen sc1
    v_mfma_f32_16x16x32_bf16 v[124:127], a[48:51], v[92:95], 0
    v_mfma_f32_16x16x32_bf16 v[124:127], a[52:55], v[96:99], v[124:127]
    v_mfma_f32_16x16x32_bf16 v[124:127], a[56:59], v[100:103], v[124:127]
    v_mfma_f32_16x16x32_bf16 v[124:127], a[60:63], v[104:107], v[124:127]
    v_mfma_f32_16x16x32_bf16 v[124:127], a[64:67], v[108:111], v[124:127]
    v_mfma_f32_16x16x32_bf16 v[124:127], a[68:71], v[112:115], v[124:127]
    v_mfma_f32_16x16x32_bf16 v[128:131], a[72:75], v[92:95], 0
    v_mfma_f32_16x16x32_bf16 v[128:131], a[76:79], v[96:99], v[128:131]
    v_mfma_f32_16x16x32_bf16 v[128:131], a[80:83], v[100:103], v[128:131]
    v_mfma_f32_16x16x32_bf16 v[128:131], a[84:87], v[104:107], v[128:131]
    v_mfma_f32_16x16x32_bf16 v[128:131], a[88:91], v[108:111], v[128:131]
    v_mfma_f32_16x16x32_bf16 v[128:131], a[92:95], v[112:115], v[128:131]
    v_cvt_pk_bf16_f32 v132, v116, v117
    v_cvt_pk_bf16_f32 v133, v118, v119
    v_cvt_pk_bf16_f32 v134, v120, v121
    v_cvt_pk_bf16_f32 v135, v122, v123
    s_add_u32 s29, s28, 3072
    buffer_store_dwordx4 v[132:135], v2, s[4:7], s29 offen sc1
    v_mfma_f32_16x16x32_bf16 v[116:119], a[96:99], v[92:95], 0
    v_mfma_f32_16x16x32_bf16 v[116:119], a[100:103], v[96:99], v[116:119]
    v_mfma_f32_16x16x32_bf16 v[116:119], a[104:107], v[100:103], v[116:119]
    v_mfma_f32_16x16x32_bf16 v[116:119], a[108:111], v[104:107], v[116:119]
    v_mfma_f32_16x16x32_bf16 v[116:119], a[112:115], v[108:111], v[116:119]
    v_mfma_f32_16x16x32_bf16 v[116:119], a[116:119], v[112:115], v[116:119]
    v_mfma_f32_16x16x32_bf16 v[120:123], a[120:123], v[92:95], 0
    v_mfma_f32_16x16x32_bf16 v[120:123], a[124:127], v[96:99], v[120:123]
    v_mfma_f32_16x16x32_bf16 v[120:123], a[128:131], v[100:103], v[120:123]
    v_mfma_f32_16x16x32_bf16 v[120:123], a[132:135], v[104:107], v[120:123]
    v_mfma_f32_16x16x32_bf16 v[120:123], a[136:139], v[108:111], v[120:123]
    v_mfma_f32_16x16x32_bf16 v[120:123], a[140:143], v[112:115], v[120:123]
    v_cvt_pk_bf16_f32 v136, v124, v125
    v_cvt_pk_bf16_f32 v137, v126, v127
    v_cvt_pk_bf16_f32 v138, v128, v129
    v_cvt_pk_bf16_f32 v139, v130, v131
    s_add_u32 s29, s28, 1313792
    buffer_store_dwordx4 v[136:139], v2, s[4:7], s29 offen sc1
    v_mfma_f32_16x16x32_bf16 v[124:127], a[144:147], v[92:95], 0
    v_mfma_f32_16x16x32_bf16 v[124:127], a[148:151], v[96:99], v[124:127]
    v_mfma_f32_16x16x32_bf16 v[124:127], a[152:155], v[100:103], v[124:127]
    v_mfma_f32_16x16x32_bf16 v[124:127], a[156:159], v[104:107], v[124:127]
    v_mfma_f32_16x16x32_bf16 v[124:127], a[160:163], v[108:111], v[124:127]
    v_mfma_f32_16x16x32_bf16 v[124:127], a[164:167], v[112:115], v[124:127]
    v_mfma_f32_16x16x32_bf16 v[128:131], a[168:171], v[92:95], 0
    v_mfma_f32_16x16x32_bf16 v[128:131], a[172:175], v[96:99], v[128:131]
    v_mfma_f32_16x16x32_bf16 v[128:131], a[176:179], v[100:103], v[128:131]
    v_mfma_f32_16x16x32_bf16 v[128:131], a[180:183], v[104:107], v[128:131]
    v_mfma_f32_16x16x32_bf16 v[128:131], a[184:187], v[108:111], v[128:131]
    v_mfma_f32_16x16x32_bf16 v[128:131], a[188:191], v[112:115], v[128:131]
    v_cvt_pk_bf16_f32 v140, v116, v117
    v_cvt_pk_bf16_f32 v141, v118, v119
    v_cvt_pk_bf16_f32 v142, v120, v121
    v_cvt_pk_bf16_f32 v143, v122, v123
    s_add_u32 s29, s28, 2624512
    buffer_store_dwordx4 v[140:143], v2, s[4:7], s29 offen sc1
    s_waitcnt vmcnt(30)
    v_mfma_f32_16x16x32_bf16 v[116:119], a[0:3], v[180:183], 0
    v_mfma_f32_16x16x32_bf16 v[116:119], a[4:7], v[184:187], v[116:119]
    v_mfma_f32_16x16x32_bf16 v[116:119], a[8:11], v[188:191], v[116:119]
    v_mfma_f32_16x16x32_bf16 v[116:119], a[12:15], v[192:195], v[116:119]
    v_mfma_f32_16x16x32_bf16 v[116:119], a[16:19], v[196:199], v[116:119]
    v_mfma_f32_16x16x32_bf16 v[116:119], a[20:23], v[200:203], v[116:119]
    v_mfma_f32_16x16x32_bf16 v[120:123], a[24:27], v[180:183], 0
    v_mfma_f32_16x16x32_bf16 v[120:123], a[28:31], v[184:187], v[120:123]
    v_mfma_f32_16x16x32_bf16 v[120:123], a[32:35], v[188:191], v[120:123]
    v_mfma_f32_16x16x32_bf16 v[120:123], a[36:39], v[192:195], v[120:123]
    v_mfma_f32_16x16x32_bf16 v[120:123], a[40:43], v[196:199], v[120:123]
    v_mfma_f32_16x16x32_bf16 v[120:123], a[44:47], v[200:203], v[120:123]
    v_cvt_pk_bf16_f32 v144, v124, v125
    v_cvt_pk_bf16_f32 v145, v126, v127
    v_cvt_pk_bf16_f32 v146, v128, v129
    v_cvt_pk_bf16_f32 v147, v130, v131
    s_add_u32 s29, s28, 3935232
    buffer_store_dwordx4 v[144:147], v2, s[4:7], s29 offen sc1
    v_mfma_f32_16x16x32_bf16 v[124:127], a[48:51], v[180:183], 0
    v_mfma_f32_16x16x32_bf16 v[124:127], a[52:55], v[184:187], v[124:127]
    v_mfma_f32_16x16x32_bf16 v[124:127], a[56:59], v[188:191], v[124:127]
    v_mfma_f32_16x16x32_bf16 v[124:127], a[60:63], v[192:195], v[124:127]
    v_mfma_f32_16x16x32_bf16 v[124:127], a[64:67], v[196:199], v[124:127]
    v_mfma_f32_16x16x32_bf16 v[124:127], a[68:71], v[200:203], v[124:127]
    v_mfma_f32_16x16x32_bf16 v[128:131], a[72:75], v[180:183], 0
    v_mfma_f32_16x16x32_bf16 v[128:131], a[76:79], v[184:187], v[128:131]
    v_mfma_f32_16x16x32_bf16 v[128:131], a[80:83], v[188:191], v[128:131]
    v_mfma_f32_16x16x32_bf16 v[128:131], a[84:87], v[192:195], v[128:131]
    v_mfma_f32_16x16x32_bf16 v[128:131], a[88:91], v[196:199], v[128:131]
    v_mfma_f32_16x16x32_bf16 v[128:131], a[92:95], v[200:203], v[128:131]
    v_cvt_pk_bf16_f32 v132, v116, v117
    v_cvt_pk_bf16_f32 v133, v118, v119
    v_cvt_pk_bf16_f32 v134, v120, v121
    v_cvt_pk_bf16_f32 v135, v122, v123
    s_add_u32 s29, s28, 4096
    buffer_store_dwordx4 v[132:135], v2, s[4:7], s29 offen sc1
    v_mfma_f32_16x16x32_bf16 v[116:119], a[96:99], v[180:183], 0
    v_mfma_f32_16x16x32_bf16 v[116:119], a[100:103], v[184:187], v[116:119]
    v_mfma_f32_16x16x32_bf16 v[116:119], a[104:107], v[188:191], v[116:119]
    v_mfma_f32_16x16x32_bf16 v[116:119], a[108:111], v[192:195], v[116:119]
    v_mfma_f32_16x16x32_bf16 v[116:119], a[112:115], v[196:199], v[116:119]
    v_mfma_f32_16x16x32_bf16 v[116:119], a[116:119], v[200:203], v[116:119]
    v_mfma_f32_16x16x32_bf16 v[120:123], a[120:123], v[180:183], 0
    v_mfma_f32_16x16x32_bf16 v[120:123], a[124:127], v[184:187], v[120:123]
    v_mfma_f32_16x16x32_bf16 v[120:123], a[128:131], v[188:191], v[120:123]
    v_mfma_f32_16x16x32_bf16 v[120:123], a[132:135], v[192:195], v[120:123]
    v_mfma_f32_16x16x32_bf16 v[120:123], a[136:139], v[196:199], v[120:123]
    v_mfma_f32_16x16x32_bf16 v[120:123], a[140:143], v[200:203], v[120:123]
    v_cvt_pk_bf16_f32 v136, v124, v125
    v_cvt_pk_bf16_f32 v137, v126, v127
    v_cvt_pk_bf16_f32 v138, v128, v129
    v_cvt_pk_bf16_f32 v139, v130, v131
    s_add_u32 s29, s28, 1314816
    buffer_store_dwordx4 v[136:139], v2, s[4:7], s29 offen sc1
    v_mfma_f32_16x16x32_bf16 v[124:127], a[144:147], v[180:183], 0
    v_mfma_f32_16x16x32_bf16 v[124:127], a[148:151], v[184:187], v[124:127]
    v_mfma_f32_16x16x32_bf16 v[124:127], a[152:155], v[188:191], v[124:127]
    v_mfma_f32_16x16x32_bf16 v[124:127], a[156:159], v[192:195], v[124:127]
    v_mfma_f32_16x16x32_bf16 v[124:127], a[160:163], v[196:199], v[124:127]
    v_mfma_f32_16x16x32_bf16 v[124:127], a[164:167], v[200:203], v[124:127]
    v_mfma_f32_16x16x32_bf16 v[128:131], a[168:171], v[180:183], 0
    v_mfma_f32_16x16x32_bf16 v[128:131], a[172:175], v[184:187], v[128:131]
    v_mfma_f32_16x16x32_bf16 v[128:131], a[176:179], v[188:191], v[128:131]
    v_mfma_f32_16x16x32_bf16 v[128:131], a[180:183], v[192:195], v[128:131]
    v_mfma_f32_16x16x32_bf16 v[128:131], a[184:187], v[196:199], v[128:131]
    v_mfma_f32_16x16x32_bf16 v[128:131], a[188:191], v[200:203], v[128:131]
    v_cvt_pk_bf16_f32 v140, v116, v117
    v_cvt_pk_bf16_f32 v141, v118, v119
    v_cvt_pk_bf16_f32 v142, v120, v121
    v_cvt_pk_bf16_f32 v143, v122, v123
    s_add_u32 s29, s28, 2625536
    buffer_store_dwordx4 v[140:143], v2, s[4:7], s29 offen sc1
    s_waitcnt vmcnt(24)
    v_mfma_f32_16x16x32_bf16 v[116:119], a[0:3], v[204:207], 0
    v_mfma_f32_16x16x32_bf16 v[116:119], a[4:7], v[208:211], v[116:119]
    v_mfma_f32_16x16x32_bf16 v[116:119], a[8:11], v[212:215], v[116:119]
    v_mfma_f32_16x16x32_bf16 v[116:119], a[12:15], v[216:219], v[116:119]
    v_mfma_f32_16x16x32_bf16 v[116:119], a[16:19], v[220:223], v[116:119]
    v_mfma_f32_16x16x32_bf16 v[116:119], a[20:23], v[224:227], v[116:119]
    v_mfma_f32_16x16x32_bf16 v[120:123], a[24:27], v[204:207], 0
    v_mfma_f32_16x16x32_bf16 v[120:123], a[28:31], v[208:211], v[120:123]
    v_mfma_f32_16x16x32_bf16 v[120:123], a[32:35], v[212:215], v[120:123]
    v_mfma_f32_16x16x32_bf16 v[120:123], a[36:39], v[216:219], v[120:123]
    v_mfma_f32_16x16x32_bf16 v[120:123], a[40:43], v[220:223], v[120:123]
    v_mfma_f32_16x16x32_bf16 v[120:123], a[44:47], v[224:227], v[120:123]
    v_cvt_pk_bf16_f32 v144, v124, v125
    v_cvt_pk_bf16_f32 v145, v126, v127
    v_cvt_pk_bf16_f32 v146, v128, v129
    v_cvt_pk_bf16_f32 v147, v130, v131
    s_add_u32 s29, s28, 3936256
    buffer_store_dwordx4 v[144:147], v2, s[4:7], s29 offen sc1
    v_mfma_f32_16x16x32_bf16 v[124:127], a[48:51], v[204:207], 0
    v_mfma_f32_16x16x32_bf16 v[124:127], a[52:55], v[208:211], v[124:127]
    v_mfma_f32_16x16x32_bf16 v[124:127], a[56:59], v[212:215], v[124:127]
    v_mfma_f32_16x16x32_bf16 v[124:127], a[60:63], v[216:219], v[124:127]
    v_mfma_f32_16x16x32_bf16 v[124:127], a[64:67], v[220:223], v[124:127]
    v_mfma_f32_16x16x32_bf16 v[124:127], a[68:71], v[224:227], v[124:127]
    v_mfma_f32_16x16x32_bf16 v[128:131], a[72:75], v[204:207], 0
    v_mfma_f32_16x16x32_bf16 v[128:131], a[76:79], v[208:211], v[128:131]
    v_mfma_f32_16x16x32_bf16 v[128:131], a[80:83], v[212:215], v[128:131]
    v_mfma_f32_16x16x32_bf16 v[128:131], a[84:87], v[216:219], v[128:131]
    v_mfma_f32_16x16x32_bf16 v[128:131], a[88:91], v[220:223], v[128:131]
    v_mfma_f32_16x16x32_bf16 v[128:131], a[92:95], v[224:227], v[128:131]
    v_cvt_pk_bf16_f32 v132, v116, v117
    v_cvt_pk_bf16_f32 v133, v118, v119
    v_cvt_pk_bf16_f32 v134, v120, v121
    v_cvt_pk_bf16_f32 v135, v122, v123
    s_add_u32 s29, s28, 5120
    buffer_store_dwordx4 v[132:135], v2, s[4:7], s29 offen sc1
    v_mfma_f32_16x16x32_bf16 v[116:119], a[96:99], v[204:207], 0
    v_mfma_f32_16x16x32_bf16 v[116:119], a[100:103], v[208:211], v[116:119]
    v_mfma_f32_16x16x32_bf16 v[116:119], a[104:107], v[212:215], v[116:119]
    v_mfma_f32_16x16x32_bf16 v[116:119], a[108:111], v[216:219], v[116:119]
    v_mfma_f32_16x16x32_bf16 v[116:119], a[112:115], v[220:223], v[116:119]
    v_mfma_f32_16x16x32_bf16 v[116:119], a[116:119], v[224:227], v[116:119]
    v_mfma_f32_16x16x32_bf16 v[120:123], a[120:123], v[204:207], 0
    v_mfma_f32_16x16x32_bf16 v[120:123], a[124:127], v[208:211], v[120:123]
    v_mfma_f32_16x16x32_bf16 v[120:123], a[128:131], v[212:215], v[120:123]
    v_mfma_f32_16x16x32_bf16 v[120:123], a[132:135], v[216:219], v[120:123]
    v_mfma_f32_16x16x32_bf16 v[120:123], a[136:139], v[220:223], v[120:123]
    v_mfma_f32_16x16x32_bf16 v[120:123], a[140:143], v[224:227], v[120:123]
    v_cvt_pk_bf16_f32 v136, v124, v125
    v_cvt_pk_bf16_f32 v137, v126, v127
    v_cvt_pk_bf16_f32 v138, v128, v129
    v_cvt_pk_bf16_f32 v139, v130, v131
    s_add_u32 s29, s28, 1315840
    buffer_store_dwordx4 v[136:139], v2, s[4:7], s29 offen sc1
    v_mfma_f32_16x16x32_bf16 v[124:127], a[144:147], v[204:207], 0
    v_mfma_f32_16x16x32_bf16 v[124:127], a[148:151], v[208:211], v[124:127]
    v_mfma_f32_16x16x32_bf16 v[124:127], a[152:155], v[212:215], v[124:127]
    v_mfma_f32_16x16x32_bf16 v[124:127], a[156:159], v[216:219], v[124:127]
    v_mfma_f32_16x16x32_bf16 v[124:127], a[160:163], v[220:223], v[124:127]
    v_mfma_f32_16x16x32_bf16 v[124:127], a[164:167], v[224:227], v[124:127]
    v_mfma_f32_16x16x32_bf16 v[128:131], a[168:171], v[204:207], 0
    v_mfma_f32_16x16x32_bf16 v[128:131], a[172:175], v[208:211], v[128:131]
    v_mfma_f32_16x16x32_bf16 v[128:131], a[176:179], v[212:215], v[128:131]
    v_mfma_f32_16x16x32_bf16 v[128:131], a[180:183], v[216:219], v[128:131]
    v_mfma_f32_16x16x32_bf16 v[128:131], a[184:187], v[220:223], v[128:131]
    v_mfma_f32_16x16x32_bf16 v[128:131], a[188:191], v[224:227], v[128:131]
    v_cvt_pk_bf16_f32 v140, v116, v117
    v_cvt_pk_bf16_f32 v141, v118, v119
    v_cvt_pk_bf16_f32 v142, v120, v121
    v_cvt_pk_bf16_f32 v143, v122, v123
    s_add_u32 s29, s28, 2626560
    buffer_store_dwordx4 v[140:143], v2, s[4:7], s29 offen sc1
    s_waitcnt vmcnt(18)
    v_mfma_f32_16x16x32_bf16 v[116:119], a[0:3], v[228:231], 0
    v_mfma_f32_16x16x32_bf16 v[116:119], a[4:7], v[232:235], v[116:119]
    v_mfma_f32_16x16x32_bf16 v[116:119], a[8:11], v[236:239], v[116:119]
    v_mfma_f32_16x16x32_bf16 v[116:119], a[12:15], v[240:243], v[116:119]
    v_mfma_f32_16x16x32_bf16 v[116:119], a[16:19], v[244:247], v[116:119]
    v_mfma_f32_16x16x32_bf16 v[116:119], a[20:23], v[248:251], v[116:119]
    v_mfma_f32_16x16x32_bf16 v[120:123], a[24:27], v[228:231], 0
    v_mfma_f32_16x16x32_bf16 v[120:123], a[28:31], v[232:235], v[120:123]
    v_mfma_f32_16x16x32_bf16 v[120:123], a[32:35], v[236:239], v[120:123]
    v_mfma_f32_16x16x32_bf16 v[120:123], a[36:39], v[240:243], v[120:123]
    v_mfma_f32_16x16x32_bf16 v[120:123], a[40:43], v[244:247], v[120:123]
    v_mfma_f32_16x16x32_bf16 v[120:123], a[44:47], v[248:251], v[120:123]
    v_cvt_pk_bf16_f32 v144, v124, v125
    v_cvt_pk_bf16_f32 v145, v126, v127
    v_cvt_pk_bf16_f32 v146, v128, v129
    v_cvt_pk_bf16_f32 v147, v130, v131
    s_add_u32 s29, s28, 3937280
    buffer_store_dwordx4 v[144:147], v2, s[4:7], s29 offen sc1
    v_mfma_f32_16x16x32_bf16 v[124:127], a[48:51], v[228:231], 0
    v_mfma_f32_16x16x32_bf16 v[124:127], a[52:55], v[232:235], v[124:127]
    v_mfma_f32_16x16x32_bf16 v[124:127], a[56:59], v[236:239], v[124:127]
    v_mfma_f32_16x16x32_bf16 v[124:127], a[60:63], v[240:243], v[124:127]
    v_mfma_f32_16x16x32_bf16 v[124:127], a[64:67], v[244:247], v[124:127]
    v_mfma_f32_16x16x32_bf16 v[124:127], a[68:71], v[248:251], v[124:127]
    v_mfma_f32_16x16x32_bf16 v[128:131], a[72:75], v[228:231], 0
    v_mfma_f32_16x16x32_bf16 v[128:131], a[76:79], v[232:235], v[128:131]
    v_mfma_f32_16x16x32_bf16 v[128:131], a[80:83], v[236:239], v[128:131]
    v_mfma_f32_16x16x32_bf16 v[128:131], a[84:87], v[240:243], v[128:131]
    v_mfma_f32_16x16x32_bf16 v[128:131], a[88:91], v[244:247], v[128:131]
    v_mfma_f32_16x16x32_bf16 v[128:131], a[92:95], v[248:251], v[128:131]
    v_cvt_pk_bf16_f32 v132, v116, v117
    v_cvt_pk_bf16_f32 v133, v118, v119
    v_cvt_pk_bf16_f32 v134, v120, v121
    v_cvt_pk_bf16_f32 v135, v122, v123
    s_add_u32 s29, s28, 6144
    buffer_store_dwordx4 v[132:135], v2, s[4:7], s29 offen sc1
    v_mfma_f32_16x16x32_bf16 v[116:119], a[96:99], v[228:231], 0
    v_mfma_f32_16x16x32_bf16 v[116:119], a[100:103], v[232:235], v[116:119]
    v_mfma_f32_16x16x32_bf16 v[116:119], a[104:107], v[236:239], v[116:119]
    v_mfma_f32_16x16x32_bf16 v[116:119], a[108:111], v[240:243], v[116:119]
    v_mfma_f32_16x16x32_bf16 v[116:119], a[112:115], v[244:247], v[116:119]
    v_mfma_f32_16x16x32_bf16 v[116:119], a[116:119], v[248:251], v[116:119]
    v_mfma_f32_16x16x32_bf16 v[120:123], a[120:123], v[228:231], 0
    v_mfma_f32_16x16x32_bf16 v[120:123], a[124:127], v[232:235], v[120:123]
    v_mfma_f32_16x16x32_bf16 v[120:123], a[128:131], v[236:239], v[120:123]
    v_mfma_f32_16x16x32_bf16 v[120:123], a[132:135], v[240:243], v[120:123]
    v_mfma_f32_16x16x32_bf16 v[120:123], a[136:139], v[244:247], v[120:123]
    v_mfma_f32_16x16x32_bf16 v[120:123], a[140:143], v[248:251], v[120:123]
    v_cvt_pk_bf16_f32 v136, v124, v125
    v_cvt_pk_bf16_f32 v137, v126, v127
    v_cvt_pk_bf16_f32 v138, v128, v129
    v_cvt_pk_bf16_f32 v139, v130, v131
    s_add_u32 s29, s28, 1316864
    buffer_store_dwordx4 v[136:139], v2, s[4:7], s29 offen sc1
    v_mfma_f32_16x16x32_bf16 v[124:127], a[144:147], v[228:231], 0
    v_mfma_f32_16x16x32_bf16 v[124:127], a[148:151], v[232:235], v[124:127]
    v_mfma_f32_16x16x32_bf16 v[124:127], a[152:155], v[236:239], v[124:127]
    v_mfma_f32_16x16x32_bf16 v[124:127], a[156:159], v[240:243], v[124:127]
    v_mfma_f32_16x16x32_bf16 v[124:127], a[160:163], v[244:247], v[124:127]
    v_mfma_f32_16x16x32_bf16 v[124:127], a[164:167], v[248:251], v[124:127]
    v_mfma_f32_16x16x32_bf16 v[128:131], a[168:171], v[228:231], 0
    v_mfma_f32_16x16x32_bf16 v[128:131], a[172:175], v[232:235], v[128:131]
    v_mfma_f32_16x16x32_bf16 v[128:131], a[176:179], v[236:239], v[128:131]
    v_mfma_f32_16x16x32_bf16 v[128:131], a[180:183], v[240:243], v[128:131]
    v_mfma_f32_16x16x32_bf16 v[128:131], a[184:187], v[244:247], v[128:131]
    v_mfma_f32_16x16x32_bf16 v[128:131], a[188:191], v[248:251], v[128:131]
    v_cvt_pk_bf16_f32 v140, v116, v117
    v_cvt_pk_bf16_f32 v141, v118, v119
    v_cvt_pk_bf16_f32 v142, v120, v121
    v_cvt_pk_bf16_f32 v143, v122, v123
    s_add_u32 s29, s28, 2627584
    buffer_store_dwordx4 v[140:143], v2, s[4:7], s29 offen sc1
    s_waitcnt vmcnt(12)
    v_mfma_f32_16x16x32_bf16 v[116:119], a[0:3], v[20:23], 0
    v_mfma_f32_16x16x32_bf16 v[116:119], a[4:7], v[24:27], v[116:119]
    v_mfma_f32_16x16x32_bf16 v[116:119], a[8:11], v[28:31], v[116:119]
    v_mfma_f32_16x16x32_bf16 v[116:119], a[12:15], v[32:35], v[116:119]
    v_mfma_f32_16x16x32_bf16 v[116:119], a[16:19], v[36:39], v[116:119]
    v_mfma_f32_16x16x32_bf16 v[116:119], a[20:23], v[40:43], v[116:119]
    v_mfma_f32_16x16x32_bf16 v[120:123], a[24:27], v[20:23], 0
    v_mfma_f32_16x16x32_bf16 v[120:123], a[28:31], v[24:27], v[120:123]
    v_mfma_f32_16x16x32_bf16 v[120:123], a[32:35], v[28:31], v[120:123]
    v_mfma_f32_16x16x32_bf16 v[120:123], a[36:39], v[32:35], v[120:123]
    v_mfma_f32_16x16x32_bf16 v[120:123], a[40:43], v[36:39], v[120:123]
    v_mfma_f32_16x16x32_bf16 v[120:123], a[44:47], v[40:43], v[120:123]
    v_cvt_pk_bf16_f32 v144, v124, v125
    v_cvt_pk_bf16_f32 v145, v126, v127
    v_cvt_pk_bf16_f32 v146, v128, v129
    v_cvt_pk_bf16_f32 v147, v130, v131
    s_add_u32 s29, s28, 3938304
    buffer_store_dwordx4 v[144:147], v2, s[4:7], s29 offen sc1
    v_mfma_f32_16x16x32_bf16 v[124:127], a[48:51], v[20:23], 0
    v_mfma_f32_16x16x32_bf16 v[124:127], a[52:55], v[24:27], v[124:127]
    v_mfma_f32_16x16x32_bf16 v[124:127], a[56:59], v[28:31], v[124:127]
    v_mfma_f32_16x16x32_bf16 v[124:127], a[60:63], v[32:35], v[124:127]
    v_mfma_f32_16x16x32_bf16 v[124:127], a[64:67], v[36:39], v[124:127]
    v_mfma_f32_16x16x32_bf16 v[124:127], a[68:71], v[40:43], v[124:127]
    v_mfma_f32_16x16x32_bf16 v[128:131], a[72:75], v[20:23], 0
    v_mfma_f32_16x16x32_bf16 v[128:131], a[76:79], v[24:27], v[128:131]
    v_mfma_f32_16x16x32_bf16 v[128:131], a[80:83], v[28:31], v[128:131]
    v_mfma_f32_16x16x32_bf16 v[128:131], a[84:87], v[32:35], v[128:131]
    v_mfma_f32_16x16x32_bf16 v[128:131], a[88:91], v[36:39], v[128:131]
    v_mfma_f32_16x16x32_bf16 v[128:131], a[92:95], v[40:43], v[128:131]
    v_cvt_pk_bf16_f32 v132, v116, v117
    v_cvt_pk_bf16_f32 v133, v118, v119
    v_cvt_pk_bf16_f32 v134, v120, v121
    v_cvt_pk_bf16_f32 v135, v122, v123
    s_add_u32 s29, s28, 7168
    buffer_store_dwordx4 v[132:135], v2, s[4:7], s29 offen sc1
    v_mfma_f32_16x16x32_bf16 v[116:119], a[96:99], v[20:23], 0
    v_mfma_f32_16x16x32_bf16 v[116:119], a[100:103], v[24:27], v[116:119]
    v_mfma_f32_16x16x32_bf16 v[116:119], a[104:107], v[28:31], v[116:119]
    v_mfma_f32_16x16x32_bf16 v[116:119], a[108:111], v[32:35], v[116:119]
    v_mfma_f32_16x16x32_bf16 v[116:119], a[112:115], v[36:39], v[116:119]
    v_mfma_f32_16x16x32_bf16 v[116:119], a[116:119], v[40:43], v[116:119]
    v_mfma_f32_16x16x32_bf16 v[120:123], a[120:123], v[20:23], 0
    v_mfma_f32_16x16x32_bf16 v[120:123], a[124:127], v[24:27], v[120:123]
    v_mfma_f32_16x16x32_bf16 v[120:123], a[128:131], v[28:31], v[120:123]
    v_mfma_f32_16x16x32_bf16 v[120:123], a[132:135], v[32:35], v[120:123]
    v_mfma_f32_16x16x32_bf16 v[120:123], a[136:139], v[36:39], v[120:123]
    v_mfma_f32_16x16x32_bf16 v[120:123], a[140:143], v[40:43], v[120:123]
    v_cvt_pk_bf16_f32 v136, v124, v125
    v_cvt_pk_bf16_f32 v137, v126, v127
    v_cvt_pk_bf16_f32 v138, v128, v129
    v_cvt_pk_bf16_f32 v139, v130, v131
    s_add_u32 s29, s28, 1317888
    buffer_store_dwordx4 v[136:139], v2, s[4:7], s29 offen sc1
    v_mfma_f32_16x16x32_bf16 v[124:127], a[144:147], v[20:23], 0
    v_mfma_f32_16x16x32_bf16 v[124:127], a[148:151], v[24:27], v[124:127]
    v_mfma_f32_16x16x32_bf16 v[124:127], a[152:155], v[28:31], v[124:127]
    v_mfma_f32_16x16x32_bf16 v[124:127], a[156:159], v[32:35], v[124:127]
    v_mfma_f32_16x16x32_bf16 v[124:127], a[160:163], v[36:39], v[124:127]
    v_mfma_f32_16x16x32_bf16 v[124:127], a[164:167], v[40:43], v[124:127]
    v_mfma_f32_16x16x32_bf16 v[128:131], a[168:171], v[20:23], 0
    v_mfma_f32_16x16x32_bf16 v[128:131], a[172:175], v[24:27], v[128:131]
    v_mfma_f32_16x16x32_bf16 v[128:131], a[176:179], v[28:31], v[128:131]
    v_mfma_f32_16x16x32_bf16 v[128:131], a[180:183], v[32:35], v[128:131]
    v_mfma_f32_16x16x32_bf16 v[128:131], a[184:187], v[36:39], v[128:131]
    v_mfma_f32_16x16x32_bf16 v[128:131], a[188:191], v[40:43], v[128:131]
    v_cvt_pk_bf16_f32 v140, v116, v117
    v_cvt_pk_bf16_f32 v141, v118, v119
    v_cvt_pk_bf16_f32 v142, v120, v121
    v_cvt_pk_bf16_f32 v143, v122, v123
    s_add_u32 s29, s28, 2628608
    buffer_store_dwordx4 v[140:143], v2, s[4:7], s29 offen sc1
    s_waitcnt vmcnt(6)
    v_mfma_f32_16x16x32_bf16 v[116:119], a[0:3], v[44:47], 0
    v_mfma_f32_16x16x32_bf16 v[116:119], a[4:7], v[48:51], v[116:119]
    v_mfma_f32_16x16x32_bf16 v[116:119], a[8:11], v[52:55], v[116:119]
    v_mfma_f32_16x16x32_bf16 v[116:119], a[12:15], v[56:59], v[116:119]
    v_mfma_f32_16x16x32_bf16 v[116:119], a[16:19], v[60:63], v[116:119]
    v_mfma_f32_16x16x32_bf16 v[116:119], a[20:23], v[64:67], v[116:119]
    v_mfma_f32_16x16x32_bf16 v[120:123], a[24:27], v[44:47], 0
    v_mfma_f32_16x16x32_bf16 v[120:123], a[28:31], v[48:51], v[120:123]
    v_mfma_f32_16x16x32_bf16 v[120:123], a[32:35], v[52:55], v[120:123]
    v_mfma_f32_16x16x32_bf16 v[120:123], a[36:39], v[56:59], v[120:123]
    v_mfma_f32_16x16x32_bf16 v[120:123], a[40:43], v[60:63], v[120:123]
    v_mfma_f32_16x16x32_bf16 v[120:123], a[44:47], v[64:67], v[120:123]
    v_cvt_pk_bf16_f32 v144, v124, v125
    v_cvt_pk_bf16_f32 v145, v126, v127
    v_cvt_pk_bf16_f32 v146, v128, v129
    v_cvt_pk_bf16_f32 v147, v130, v131
    s_add_u32 s29, s28, 3939328
    buffer_store_dwordx4 v[144:147], v2, s[4:7], s29 offen sc1
    v_mfma_f32_16x16x32_bf16 v[124:127], a[48:51], v[44:47], 0
    v_mfma_f32_16x16x32_bf16 v[124:127], a[52:55], v[48:51], v[124:127]
    v_mfma_f32_16x16x32_bf16 v[124:127], a[56:59], v[52:55], v[124:127]
    v_mfma_f32_16x16x32_bf16 v[124:127], a[60:63], v[56:59], v[124:127]
    v_mfma_f32_16x16x32_bf16 v[124:127], a[64:67], v[60:63], v[124:127]
    v_mfma_f32_16x16x32_bf16 v[124:127], a[68:71], v[64:67], v[124:127]
    v_mfma_f32_16x16x32_bf16 v[128:131], a[72:75], v[44:47], 0
    v_mfma_f32_16x16x32_bf16 v[128:131], a[76:79], v[48:51], v[128:131]
    v_mfma_f32_16x16x32_bf16 v[128:131], a[80:83], v[52:55], v[128:131]
    v_mfma_f32_16x16x32_bf16 v[128:131], a[84:87], v[56:59], v[128:131]
    v_mfma_f32_16x16x32_bf16 v[128:131], a[88:91], v[60:63], v[128:131]
    v_mfma_f32_16x16x32_bf16 v[128:131], a[92:95], v[64:67], v[128:131]
    v_cvt_pk_bf16_f32 v132, v116, v117
    v_cvt_pk_bf16_f32 v133, v118, v119
    v_cvt_pk_bf16_f32 v134, v120, v121
    v_cvt_pk_bf16_f32 v135, v122, v123
    s_add_u32 s29, s28, 8192
    buffer_store_dwordx4 v[132:135], v2, s[4:7], s29 offen sc1
    v_mfma_f32_16x16x32_bf16 v[116:119], a[96:99], v[44:47], 0
    v_mfma_f32_16x16x32_bf16 v[116:119], a[100:103], v[48:51], v[116:119]
    v_mfma_f32_16x16x32_bf16 v[116:119], a[104:107], v[52:55], v[116:119]
    v_mfma_f32_16x16x32_bf16 v[116:119], a[108:111], v[56:59], v[116:119]
    v_mfma_f32_16x16x32_bf16 v[116:119], a[112:115], v[60:63], v[116:119]
    v_mfma_f32_16x16x32_bf16 v[116:119], a[116:119], v[64:67], v[116:119]
    v_mfma_f32_16x16x32_bf16 v[120:123], a[120:123], v[44:47], 0
    v_mfma_f32_16x16x32_bf16 v[120:123], a[124:127], v[48:51], v[120:123]
    v_mfma_f32_16x16x32_bf16 v[120:123], a[128:131], v[52:55], v[120:123]
    v_mfma_f32_16x16x32_bf16 v[120:123], a[132:135], v[56:59], v[120:123]
    v_mfma_f32_16x16x32_bf16 v[120:123], a[136:139], v[60:63], v[120:123]
    v_mfma_f32_16x16x32_bf16 v[120:123], a[140:143], v[64:67], v[120:123]
    v_cvt_pk_bf16_f32 v136, v124, v125
    v_cvt_pk_bf16_f32 v137, v126, v127
    v_cvt_pk_bf16_f32 v138, v128, v129
    v_cvt_pk_bf16_f32 v139, v130, v131
    s_add_u32 s29, s28, 1318912
    buffer_store_dwordx4 v[136:139], v2, s[4:7], s29 offen sc1
    v_mfma_f32_16x16x32_bf16 v[124:127], a[144:147], v[44:47], 0
    v_mfma_f32_16x16x32_bf16 v[124:127], a[148:151], v[48:51], v[124:127]
    v_mfma_f32_16x16x32_bf16 v[124:127], a[152:155], v[52:55], v[124:127]
    v_mfma_f32_16x16x32_bf16 v[124:127], a[156:159], v[56:59], v[124:127]
    v_mfma_f32_16x16x32_bf16 v[124:127], a[160:163], v[60:63], v[124:127]
    v_mfma_f32_16x16x32_bf16 v[124:127], a[164:167], v[64:67], v[124:127]
    v_mfma_f32_16x16x32_bf16 v[128:131], a[168:171], v[44:47], 0
    v_mfma_f32_16x16x32_bf16 v[128:131], a[172:175], v[48:51], v[128:131]
    v_mfma_f32_16x16x32_bf16 v[128:131], a[176:179], v[52:55], v[128:131]
    v_mfma_f32_16x16x32_bf16 v[128:131], a[180:183], v[56:59], v[128:131]
    v_mfma_f32_16x16x32_bf16 v[128:131], a[184:187], v[60:63], v[128:131]
    v_mfma_f32_16x16x32_bf16 v[128:131], a[188:191], v[64:67], v[128:131]
    v_cvt_pk_bf16_f32 v140, v116, v117
    v_cvt_pk_bf16_f32 v141, v118, v119
    v_cvt_pk_bf16_f32 v142, v120, v121
    v_cvt_pk_bf16_f32 v143, v122, v123
    s_add_u32 s29, s28, 2629632
    buffer_store_dwordx4 v[140:143], v2, s[4:7], s29 offen sc1
    s_waitcnt vmcnt(0)
    v_mfma_f32_16x16x32_bf16 v[116:119], a[0:3], v[68:71], 0
    v_mfma_f32_16x16x32_bf16 v[116:119], a[4:7], v[72:75], v[116:119]
    v_mfma_f32_16x16x32_bf16 v[116:119], a[8:11], v[76:79], v[116:119]
    v_mfma_f32_16x16x32_bf16 v[116:119], a[12:15], v[80:83], v[116:119]
    v_mfma_f32_16x16x32_bf16 v[116:119], a[16:19], v[84:87], v[116:119]
    v_mfma_f32_16x16x32_bf16 v[116:119], a[20:23], v[88:91], v[116:119]
    v_mfma_f32_16x16x32_bf16 v[120:123], a[24:27], v[68:71], 0
    v_mfma_f32_16x16x32_bf16 v[120:123], a[28:31], v[72:75], v[120:123]
    v_mfma_f32_16x16x32_bf16 v[120:123], a[32:35], v[76:79], v[120:123]
    v_mfma_f32_16x16x32_bf16 v[120:123], a[36:39], v[80:83], v[120:123]
    v_mfma_f32_16x16x32_bf16 v[120:123], a[40:43], v[84:87], v[120:123]
    v_mfma_f32_16x16x32_bf16 v[120:123], a[44:47], v[88:91], v[120:123]
    v_cvt_pk_bf16_f32 v144, v124, v125
    v_cvt_pk_bf16_f32 v145, v126, v127
    v_cvt_pk_bf16_f32 v146, v128, v129
    v_cvt_pk_bf16_f32 v147, v130, v131
    s_add_u32 s29, s28, 3940352
    buffer_store_dwordx4 v[144:147], v2, s[4:7], s29 offen sc1
    v_mfma_f32_16x16x32_bf16 v[124:127], a[48:51], v[68:71], 0
    v_mfma_f32_16x16x32_bf16 v[124:127], a[52:55], v[72:75], v[124:127]
    v_mfma_f32_16x16x32_bf16 v[124:127], a[56:59], v[76:79], v[124:127]
    v_mfma_f32_16x16x32_bf16 v[124:127], a[60:63], v[80:83], v[124:127]
    v_mfma_f32_16x16x32_bf16 v[124:127], a[64:67], v[84:87], v[124:127]
    v_mfma_f32_16x16x32_bf16 v[124:127], a[68:71], v[88:91], v[124:127]
    v_mfma_f32_16x16x32_bf16 v[128:131], a[72:75], v[68:71], 0
    v_mfma_f32_16x16x32_bf16 v[128:131], a[76:79], v[72:75], v[128:131]
    v_mfma_f32_16x16x32_bf16 v[128:131], a[80:83], v[76:79], v[128:131]
    v_mfma_f32_16x16x32_bf16 v[128:131], a[84:87], v[80:83], v[128:131]
    v_mfma_f32_16x16x32_bf16 v[128:131], a[88:91], v[84:87], v[128:131]
    v_mfma_f32_16x16x32_bf16 v[128:131], a[92:95], v[88:91], v[128:131]
    v_cvt_pk_bf16_f32 v132, v116, v117
    v_cvt_pk_bf16_f32 v133, v118, v119
    v_cvt_pk_bf16_f32 v134, v120, v121
    v_cvt_pk_bf16_f32 v135, v122, v123
    s_add_u32 s29, s28, 9216
    buffer_store_dwordx4 v[132:135], v2, s[4:7], s29 offen sc1
    v_mfma_f32_16x16x32_bf16 v[116:119], a[96:99], v[68:71], 0
    v_mfma_f32_16x16x32_bf16 v[116:119], a[100:103], v[72:75], v[116:119]
    v_mfma_f32_16x16x32_bf16 v[116:119], a[104:107], v[76:79], v[116:119]
    v_mfma_f32_16x16x32_bf16 v[116:119], a[108:111], v[80:83], v[116:119]
    v_mfma_f32_16x16x32_bf16 v[116:119], a[112:115], v[84:87], v[116:119]
    v_mfma_f32_16x16x32_bf16 v[116:119], a[116:119], v[88:91], v[116:119]
    v_mfma_f32_16x16x32_bf16 v[120:123], a[120:123], v[68:71], 0
    v_mfma_f32_16x16x32_bf16 v[120:123], a[124:127], v[72:75], v[120:123]
    v_mfma_f32_16x16x32_bf16 v[120:123], a[128:131], v[76:79], v[120:123]
    v_mfma_f32_16x16x32_bf16 v[120:123], a[132:135], v[80:83], v[120:123]
    v_mfma_f32_16x16x32_bf16 v[120:123], a[136:139], v[84:87], v[120:123]
    v_mfma_f32_16x16x32_bf16 v[120:123], a[140:143], v[88:91], v[120:123]
    v_cvt_pk_bf16_f32 v136, v124, v125
    v_cvt_pk_bf16_f32 v137, v126, v127
    v_cvt_pk_bf16_f32 v138, v128, v129
    v_cvt_pk_bf16_f32 v139, v130, v131
    s_add_u32 s29, s28, 1319936
    buffer_store_dwordx4 v[136:139], v2, s[4:7], s29 offen sc1
    v_mfma_f32_16x16x32_bf16 v[124:127], a[144:147], v[68:71], 0
    v_mfma_f32_16x16x32_bf16 v[124:127], a[148:151], v[72:75], v[124:127]
    v_mfma_f32_16x16x32_bf16 v[124:127], a[152:155], v[76:79], v[124:127]
    v_mfma_f32_16x16x32_bf16 v[124:127], a[156:159], v[80:83], v[124:127]
    v_mfma_f32_16x16x32_bf16 v[124:127], a[160:163], v[84:87], v[124:127]
    v_mfma_f32_16x16x32_bf16 v[124:127], a[164:167], v[88:91], v[124:127]
    v_mfma_f32_16x16x32_bf16 v[128:131], a[168:171], v[68:71], 0
    v_mfma_f32_16x16x32_bf16 v[128:131], a[172:175], v[72:75], v[128:131]
    v_mfma_f32_16x16x32_bf16 v[128:131], a[176:179], v[76:79], v[128:131]
    v_mfma_f32_16x16x32_bf16 v[128:131], a[180:183], v[80:83], v[128:131]
    v_mfma_f32_16x16x32_bf16 v[128:131], a[184:187], v[84:87], v[128:131]
    v_mfma_f32_16x16x32_bf16 v[128:131], a[188:191], v[88:91], v[128:131]
    v_cvt_pk_bf16_f32 v140, v116, v117
    v_cvt_pk_bf16_f32 v141, v118, v119
    v_cvt_pk_bf16_f32 v142, v120, v121
    v_cvt_pk_bf16_f32 v143, v122, v123
    s_add_u32 s29, s28, 2630656
    buffer_store_dwordx4 v[140:143], v2, s[4:7], s29 offen sc1
    s_nop 7
    s_nop 7
    v_cvt_pk_bf16_f32 v144, v124, v125
    v_cvt_pk_bf16_f32 v145, v126, v127
    v_cvt_pk_bf16_f32 v146, v128, v129
    v_cvt_pk_bf16_f32 v147, v130, v131
    s_add_u32 s29, s28, 3941376
    buffer_store_dwordx4 v[144:147], v2, s[4:7], s29 offen sc1
    s_lshl_b32 s22, s72, 2
    s_add_u32 s22, s22, 8704
    s_waitcnt vmcnt(0)
    s_barrier
    s_cmp_lg_u32 s20, 0
    s_cbranch_scc1 L_prewvo_nofl
    s_add_u32 s22, s22, 2019328
    v_mov_b32 v4, 1
    v_mov_b32 v5, 0
    s_mov_b64 exec, 1
    buffer_store_dword v4, v5, s[4:7], s22 offen sc1
    s_mov_b64 exec, -1
L_prewvo_nofl:
L_pre_done:
    v_and_b32 v1, 63, v0
    v_lshlrev_b32 v2, 4, v1
    s_mul_i32 s21, s20, 2560
    v_add_u32 v4, s21, v2
    v_mov_b32 v20, 0
    v_mov_b32 v21, 0
    v_mov_b32 v22, 0
    v_mov_b32 v23, 0
    s_mov_b32 s44, 400000
    s_mov_b32 s60, -1
    s_mov_b32 s61, 0
    s_mov_b32 s62, 0xffff
    s_mov_b32 s63, 0
    s_mov_b32 s64, 0xfffff
    s_mov_b32 s65, 0
    s_mov_b32 s40, 0
    s_cmp_ge_u32 s2, 112
    s_cbranch_scc1 L_ch_w
    s_cmp_ge_u32 s2, 32
    s_cbranch_scc1 L_ch_s2
    s_mul_i32 s22, s2, 12
    s_mul_i32 s51, s20, 3
    s_add_u32 s22, s22, s51
    s_mul_i32 s22, s22, 20480
    s_add_u32 s22, s22, 4673536
    s_mul_i32 s24, s20, 12288
    v_add_u32 v0, s24, v2
    s_add_u32 s23, s22, 0
    buffer_load_dwordx4 v[80:83], v2, s[4:7], s23 offen
    s_add_u32 s23, s22, 1024
    buffer_load_dwordx4 v[84:87], v2, s[4:7], s23 offen
    s_add_u32 s23, s22, 20480
    buffer_load_dwordx4 v[88:91], v2, s[4:7], s23 offen
    s_add_u32 s23, s22, 21504
    buffer_load_dwordx4 v[92:95], v2, s[4:7], s23 offen
    s_add_u32 s23, s22, 40960
    buffer_load_dwordx4 v[96:99], v2, s[4:7], s23 offen
    s_add_u32 s23, s22, 41984
    buffer_load_dwordx4 v[100:103], v2, s[4:7], s23 offen
    s_add_u32 s23, s22, 7864320
    buffer_load_dwordx4 v[104:107], v2, s[4:7], s23 offen
    s_add_u32 s23, s22, 7865344
    buffer_load_dwordx4 v[108:111], v2, s[4:7], s23 offen
    s_add_u32 s23, s22, 7884800
    buffer_load_dwordx4 v[112:115], v2, s[4:7], s23 offen
    s_add_u32 s23, s22, 7885824
    buffer_load_dwordx4 v[116:119], v2, s[4:7], s23 offen
    s_add_u32 s23, s22, 7905280
    buffer_load_dwordx4 v[120:123], v2, s[4:7], s23 offen
    s_add_u32 s23, s22, 7906304
    buffer_load_dwordx4 v[124:127], v2, s[4:7], s23 offen
    s_add_u32 s23, s22, 2048
    buffer_load_dwordx4 v[128:131], v2, s[4:7], s23 offen
    s_add_u32 s23, s22, 3072
    buffer_load_dwordx4 v[132:135], v2, s[4:7], s23 offen
    s_add_u32 s23, s22, 22528
    buffer_load_dwordx4 v[136:139], v2, s[4:7], s23 offen
    s_add_u32 s23, s22, 23552
    buffer_load_dwordx4 v[140:143], v2, s[4:7], s23 offen
    s_add_u32 s23, s22, 43008
    buffer_load_dwordx4 v[144:147], v2, s[4:7], s23 offen
    s_add_u32 s23, s22, 44032
    buffer_load_dwordx4 v[148:151], v2, s[4:7], s23 offen
    s_add_u32 s23, s22, 7866368
    buffer_load_dwordx4 v[152:155], v2, s[4:7], s23 offen
    s_add_u32 s23, s22, 7867392
    buffer_load_dwordx4 v[156:159], v2, s[4:7], s23 offen
    s_add_u32 s23, s22, 7886848
    buffer_load_dwordx4 v[160:163], v2, s[4:7], s23 offen
    s_add_u32 s23, s22, 7887872
    buffer_load_dwordx4 v[164:167], v2, s[4:7], s23 offen
    s_add_u32 s23, s22, 7907328
    buffer_load_dwordx4 v[168:171], v2, s[4:7], s23 offen
    s_add_u32 s23, s22, 7908352
    buffer_load_dwordx4 v[172:175], v2, s[4:7], s23 offen
    s_add_u32 s23, s22, 4096
    buffer_load_dwordx4 v[176:179], v2, s[4:7], s23 offen
    s_add_u32 s23, s22, 5120
    buffer_load_dwordx4 v[180:183], v2, s[4:7], s23 offen
    s_add_u32 s23, s22, 24576
    buffer_load_dwordx4 v[184:187], v2, s[4:7], s23 offen
    s_add_u32 s23, s22, 25600
    buffer_load_dwordx4 v[188:191], v2, s[4:7], s23 offen
    s_add_u32 s23, s22, 45056
    buffer_load_dwordx4 v[192:195], v2, s[4:7], s23 offen
    s_add_u32 s23, s22, 46080
    buffer_load_dwordx4 v[196:199], v2, s[4:7], s23 offen
    s_add_u32 s23, s22, 7868416
    buffer_load_dwordx4 v[200:203], v2, s[4:7], s23 offen
    s_add_u32 s23, s22, 7869440
    buffer_load_dwordx4 v[204:207], v2, s[4:7], s23 offen
    s_add_u32 s23, s22, 7888896
    buffer_load_dwordx4 v[208:211], v2, s[4:7], s23 offen
    s_add_u32 s23, s22, 7889920
    buffer_load_dwordx4 v[212:215], v2, s[4:7], s23 offen
    s_add_u32 s23, s22, 7909376
    buffer_load_dwordx4 v[216:219], v2, s[4:7], s23 offen
    s_add_u32 s23, s22, 7910400
    buffer_load_dwordx4 v[220:223], v2, s[4:7], s23 offen
    s_add_u32 s23, s22, 6144
    buffer_load_dwordx4 v[224:227], v2, s[4:7], s23 offen
    s_add_u32 s23, s22, 7168
    buffer_load_dwordx4 v[228:231], v2, s[4:7], s23 offen
    s_add_u32 s23, s22, 26624
    buffer_load_dwordx4 v[232:235], v2, s[4:7], s23 offen
    s_add_u32 s23, s22, 27648
    buffer_load_dwordx4 v[236:239], v2, s[4:7], s23 offen
    s_add_u32 s23, s22, 47104
    buffer_load_dwordx4 v[240:243], v2, s[4:7], s23 offen
    s_add_u32 s23, s22, 48128
    buffer_load_dwordx4 v[244:247], v2, s[4:7], s23 offen
    s_add_u32 s23, s22, 7870464
    buffer_load_dwordx4 v[248:251], v2, s[4:7], s23 offen
    s_add_u32 s23, s22, 7871488
    buffer_load_dwordx4 v[252:255], v2, s[4:7], s23 offen
    s_add_u32 s23, s22, 7890944
    buffer_load_dwordx4 v[12:15], v2, s[4:7], s23 offen
    s_add_u32 s23, s22, 7891968
    buffer_load_dwordx4 v[16:19], v2, s[4:7], s23 offen
    s_add_u32 s23, s22, 7911424
    buffer_load_dwordx4 v[20:23], v2, s[4:7], s23 offen
    s_add_u32 s23, s22, 7912448
    buffer_load_dwordx4 v[24:27], v2, s[4:7], s23 offen
    s_add_u32 s23, s22, 8192
    buffer_load_dwordx4 v[28:31], v2, s[4:7], s23 offen
    s_add_u32 s23, s22, 9216
    buffer_load_dwordx4 v[32:35], v2, s[4:7], s23 offen
    s_add_u32 s23, s22, 28672
    buffer_load_dwordx4 v[36:39], v2, s[4:7], s23 offen
    s_add_u32 s23, s22, 29696
    buffer_load_dwordx4 v[40:43], v2, s[4:7], s23 offen
    s_add_u32 s23, s22, 49152
    buffer_load_dwordx4 v[44:47], v2, s[4:7], s23 offen
    s_add_u32 s23, s22, 50176
    buffer_load_dwordx4 v[48:51], v2, s[4:7], s23 offen
    s_add_u32 s23, s22, 7872512
    buffer_load_dwordx4 v[52:55], v2, s[4:7], s23 offen
    s_add_u32 s23, s22, 7873536
    buffer_load_dwordx4 v[56:59], v2, s[4:7], s23 offen
    s_add_u32 s23, s22, 7892992
    buffer_load_dwordx4 v[60:63], v2, s[4:7], s23 offen
    s_add_u32 s23, s22, 7894016
    buffer_load_dwordx4 v[64:67], v2, s[4:7], s23 offen
    s_add_u32 s23, s22, 7913472
    buffer_load_dwordx4 v[68:71], v2, s[4:7], s23 offen
    s_add_u32 s23, s22, 7914496
    buffer_load_dwordx4 v[72:75], v2, s[4:7], s23 offen
    s_waitcnt vmcnt(16)
    v_permlane16_swap_b32 v80, v82
    v_permlane16_swap_b32 v81, v83
    s_nop 1
    v_swap_b32 v81, v82
    v_permlane16_swap_b32 v84, v86
    v_permlane16_swap_b32 v85, v87
    s_nop 1
    v_swap_b32 v85, v86
    v_permlane16_swap_b32 v88, v90
    v_permlane16_swap_b32 v89, v91
    s_nop 1
    v_swap_b32 v89, v90
    v_permlane16_swap_b32 v92, v94
    v_permlane16_swap_b32 v93, v95
    s_nop 1
    v_swap_b32 v93, v94
    v_permlane16_swap_b32 v96, v98
    v_permlane16_swap_b32 v97, v99
    s_nop 1
    v_swap_b32 v97, v98
    v_permlane16_swap_b32 v100, v102
    v_permlane16_swap_b32 v101, v103
    s_nop 1
    v_swap_b32 v101, v102
    v_permlane16_swap_b32 v104, v106
    v_permlane16_swap_b32 v105, v107
    s_nop 1
    v_swap_b32 v105, v106
    v_permlane16_swap_b32 v108, v110
    v_permlane16_swap_b32 v109, v111
    s_nop 1
    v_swap_b32 v109, v110
    v_permlane16_swap_b32 v112, v114
    v_permlane16_swap_b32 v113, v115
    s_nop 1
    v_swap_b32 v113, v114
    v_permlane16_swap_b32 v116, v118
    v_permlane16_swap_b32 v117, v119
    s_nop 1
    v_swap_b32 v117, v118
    v_permlane16_swap_b32 v120, v122
    v_permlane16_swap_b32 v121, v123
    s_nop 1
    v_swap_b32 v121, v122
    v_permlane16_swap_b32 v124, v126
    v_permlane16_swap_b32 v125, v127
    s_nop 1
    v_swap_b32 v125, v126
    v_permlane16_swap_b32 v128, v130
    v_permlane16_swap_b32 v129, v131
    s_nop 1
    v_swap_b32 v129, v130
    v_permlane16_swap_b32 v132, v134
    v_permlane16_swap_b32 v133, v135
    s_nop 1
    v_swap_b32 v133, v134
    v_permlane16_swap_b32 v136, v138
    v_permlane16_swap_b32 v137, v139
    s_nop 1
    v_swap_b32 v137, v138
    v_permlane16_swap_b32 v140, v142
    v_permlane16_swap_b32 v141, v143
    s_nop 1
    v_swap_b32 v141, v142
    v_permlane16_swap_b32 v144, v146
    v_permlane16_swap_b32 v145, v147
    s_nop 1
    v_swap_b32 v145, v146
    v_permlane16_swap_b32 v148, v150
    v_permlane16_swap_b32 v149, v151
    s_nop 1
    v_swap_b32 v149, v150
    v_permlane16_swap_b32 v152, v154
    v_permlane16_swap_b32 v153, v155
    s_nop 1
    v_swap_b32 v153, v154
    v_permlane16_swap_b32 v156, v158
    v_permlane16_swap_b32 v157, v159
    s_nop 1
    v_swap_b32 v157, v158
    v_permlane16_swap_b32 v160, v162
    v_permlane16_swap_b32 v161, v163
    s_nop 1
    v_swap_b32 v161, v162
    v_permlane16_swap_b32 v164, v166
    v_permlane16_swap_b32 v165, v167
    s_nop 1
    v_swap_b32 v165, v166
    v_permlane16_swap_b32 v168, v170
    v_permlane16_swap_b32 v169, v171
    s_nop 1
    v_swap_b32 v169, v170
    v_permlane16_swap_b32 v172, v174
    v_permlane16_swap_b32 v173, v175
    s_nop 1
    v_swap_b32 v173, v174
    v_permlane16_swap_b32 v176, v178
    v_permlane16_swap_b32 v177, v179
    s_nop 1
    v_swap_b32 v177, v178
    v_permlane16_swap_b32 v180, v182
    v_permlane16_swap_b32 v181, v183
    s_nop 1
    v_swap_b32 v181, v182
    v_permlane16_swap_b32 v184, v186
    v_permlane16_swap_b32 v185, v187
    s_nop 1
    v_swap_b32 v185, v186
    v_permlane16_swap_b32 v188, v190
    v_permlane16_swap_b32 v189, v191
    s_nop 1
    v_swap_b32 v189, v190
    v_permlane16_swap_b32 v192, v194
    v_permlane16_swap_b32 v193, v195
    s_nop 1
    v_swap_b32 v193, v194
    v_permlane16_swap_b32 v196, v198
    v_permlane16_swap_b32 v197, v199
    s_nop 1
    v_swap_b32 v197, v198
    v_permlane16_swap_b32 v200, v202
    v_permlane16_swap_b32 v201, v203
    s_nop 1
    v_swap_b32 v201, v202
    v_permlane16_swap_b32 v204, v206
    v_permlane16_swap_b32 v205, v207
    s_nop 1
    v_swap_b32 v205, v206
    v_permlane16_swap_b32 v208, v210
    v_permlane16_swap_b32 v209, v211
    s_nop 1
    v_swap_b32 v209, v210
    v_permlane16_swap_b32 v212, v214
    v_permlane16_swap_b32 v213, v215
    s_nop 1
    v_swap_b32 v213, v214
    v_permlane16_swap_b32 v216, v218
    v_permlane16_swap_b32 v217, v219
    s_nop 1
    v_swap_b32 v217, v218
    v_permlane16_swap_b32 v220, v222
    v_permlane16_swap_b32 v221, v223
    s_nop 1
    v_swap_b32 v221, v222
    v_permlane16_swap_b32 v224, v226
    v_permlane16_swap_b32 v225, v227
    s_nop 1
    v_swap_b32 v225, v226
    v_permlane16_swap_b32 v228, v230
    v_permlane16_swap_b32 v229, v231
    s_nop 1
    v_swap_b32 v229, v230
    v_permlane16_swap_b32 v232, v234
    v_permlane16_swap_b32 v233, v235
    s_nop 1
    v_swap_b32 v233, v234
    v_permlane16_swap_b32 v236, v238
    v_permlane16_swap_b32 v237, v239
    s_nop 1
    v_swap_b32 v237, v238
    v_permlane16_swap_b32 v240, v242
    v_permlane16_swap_b32 v241, v243
    s_nop 1
    v_swap_b32 v241, v242
    v_permlane16_swap_b32 v244, v246
    v_permlane16_swap_b32 v245, v247
    s_nop 1
    v_swap_b32 v245, v246
    v_permlane16_swap_b32 v248, v250
    v_permlane16_swap_b32 v249, v251
    s_nop 1
    v_swap_b32 v249, v250
    v_permlane16_swap_b32 v252, v254
    v_permlane16_swap_b32 v253, v255
    s_nop 1
    v_swap_b32 v253, v254
    s_waitcnt vmcnt(0)
    v_permlane16_swap_b32 v12, v14
    v_permlane16_swap_b32 v13, v15
    v_permlane16_swap_b32 v16, v18
    v_permlane16_swap_b32 v17, v19
    v_permlane16_swap_b32 v20, v22
    v_permlane16_swap_b32 v21, v23
    v_permlane16_swap_b32 v24, v26
    v_permlane16_swap_b32 v25, v27
    v_permlane16_swap_b32 v28, v30
    v_permlane16_swap_b32 v29, v31
    v_permlane16_swap_b32 v32, v34
    v_permlane16_swap_b32 v33, v35
    v_permlane16_swap_b32 v36, v38
    v_permlane16_swap_b32 v37, v39
    v_permlane16_swap_b32 v40, v42
    v_permlane16_swap_b32 v41, v43
    v_permlane16_swap_b32 v44, v46
    v_permlane16_swap_b32 v45, v47
    v_permlane16_swap_b32 v48, v50
    v_permlane16_swap_b32 v49, v51
    v_permlane16_swap_b32 v52, v54
    v_permlane16_swap_b32 v53, v55
    v_permlane16_swap_b32 v56, v58
    v_permlane16_swap_b32 v57, v59
    v_permlane16_swap_b32 v60, v62
    v_permlane16_swap_b32 v61, v63
    v_permlane16_swap_b32 v64, v66
    v_permlane16_swap_b32 v65, v67
    v_permlane16_swap_b32 v68, v70
    v_permlane16_swap_b32 v69, v71
    v_permlane16_swap_b32 v72, v74
    v_permlane16_swap_b32 v73, v75
    s_nop 1
    v_accvgpr_write_b32 a0, v12
    v_accvgpr_write_b32 a1, v14
    v_accvgpr_write_b32 a2, v13
    v_accvgpr_write_b32 a3, v15
    v_accvgpr_write_b32 a4, v16
    v_accvgpr_write_b32 a5, v18
    v_accvgpr_write_b32 a6, v17
    v_accvgpr_write_b32 a7, v19
    v_accvgpr_write_b32 a8, v20
    v_accvgpr_write_b32 a9, v22
    v_accvgpr_write_b32 a10, v21
    v_accvgpr_write_b32 a11, v23
    v_accvgpr_write_b32 a12, v24
    v_accvgpr_write_b32 a13, v26
    v_accvgpr_write_b32 a14, v25
    v_accvgpr_write_b32 a15, v27
    v_accvgpr_write_b32 a16, v28
    v_accvgpr_write_b32 a17, v30
    v_accvgpr_write_b32 a18, v29
    v_accvgpr_write_b32 a19, v31
    v_accvgpr_write_b32 a20, v32
    v_accvgpr_write_b32 a21, v34
    v_accvgpr_write_b32 a22, v33
    v_accvgpr_write_b32 a23, v35
    v_accvgpr_write_b32 a24, v36
    v_accvgpr_write_b32 a25, v38
    v_accvgpr_write_b32 a26, v37
    v_accvgpr_write_b32 a27, v39
    v_accvgpr_write_b32 a28, v40
    v_accvgpr_write_b32 a29, v42
    v_accvgpr_write_b32 a30, v41
    v_accvgpr_write_b32 a31, v43
    v_accvgpr_write_b32 a32, v44
    v_accvgpr_write_b32 a33, v46
    v_accvgpr_write_b32 a34, v45
    v_accvgpr_write_b32 a35, v47
    v_accvgpr_write_b32 a36, v48
    v_accvgpr_write_b32 a37, v50
    v_accvgpr_write_b32 a38, v49
    v_accvgpr_write_b32 a39, v51
    v_accvgpr_write_b32 a40, v52
    v_accvgpr_write_b32 a41, v54
    v_accvgpr_write_b32 a42, v53
    v_accvgpr_write_b32 a43, v55
    v_accvgpr_write_b32 a44, v56
    v_accvgpr_write_b32 a45, v58
    v_accvgpr_write_b32 a46, v57
    v_accvgpr_write_b32 a47, v59
    v_accvgpr_write_b32 a48, v60
    v_accvgpr_write_b32 a49, v62
    v_accvgpr_write_b32 a50, v61
    v_accvgpr_write_b32 a51, v63
    v_accvgpr_write_b32 a52, v64
    v_accvgpr_write_b32 a53, v66
    v_accvgpr_write_b32 a54, v65
    v_accvgpr_write_b32 a55, v67
    v_accvgpr_write_b32 a56, v68
    v_accvgpr_write_b32 a57, v70
    v_accvgpr_write_b32 a58, v69
    v_accvgpr_write_b32 a59, v71
    v_accvgpr_write_b32 a60, v72
    v_accvgpr_write_b32 a61, v74
    v_accvgpr_write_b32 a62, v73
    v_accvgpr_write_b32 a63, v75
    s_waitcnt lgkmcnt(0)
    s_add_u32 s23, s22, 10240
    buffer_load_dwordx4 v[12:15], v2, s[4:7], s23 offen
    s_add_u32 s23, s22, 11264
    buffer_load_dwordx4 v[16:19], v2, s[4:7], s23 offen
    s_add_u32 s23, s22, 30720
    buffer_load_dwordx4 v[20:23], v2, s[4:7], s23 offen
    s_add_u32 s23, s22, 31744
    buffer_load_dwordx4 v[24:27], v2, s[4:7], s23 offen
    s_add_u32 s23, s22, 51200
    buffer_load_dwordx4 v[28:31], v2, s[4:7], s23 offen
    s_add_u32 s23, s22, 52224
    buffer_load_dwordx4 v[32:35], v2, s[4:7], s23 offen
    s_add_u32 s23, s22, 7874560
    buffer_load_dwordx4 v[36:39], v2, s[4:7], s23 offen
    s_add_u32 s23, s22, 7875584
    buffer_load_dwordx4 v[40:43], v2, s[4:7], s23 offen
    s_add_u32 s23, s22, 7895040
    buffer_load_dwordx4 v[44:47], v2, s[4:7], s23 offen
    s_add_u32 s23, s22, 7896064
    buffer_load_dwordx4 v[48:51], v2, s[4:7], s23 offen
    s_add_u32 s23, s22, 7915520
    buffer_load_dwordx4 v[52:55], v2, s[4:7], s23 offen
    s_add_u32 s23, s22, 7916544
    buffer_load_dwordx4 v[56:59], v2, s[4:7], s23 offen
    s_add_u32 s23, s22, 12288
    buffer_load_dwordx4 v[60:63], v2, s[4:7], s23 offen
    s_add_u32 s23, s22, 13312
    buffer_load_dwordx4 v[64:67], v2, s[4:7], s23 offen
    s_add_u32 s23, s22, 32768
    buffer_load_dwordx4 v[68:71], v2, s[4:7], s23 offen
    s_add_u32 s23, s22, 33792
    buffer_load_dwordx4 v[72:75], v2, s[4:7], s23 offen
    s_waitcnt vmcnt(0)
    v_permlane16_swap_b32 v12, v14
    v_permlane16_swap_b32 v13, v15
    v_permlane16_swap_b32 v16, v18
    v_permlane16_swap_b32 v17, v19
    v_permlane16_swap_b32 v20, v22
    v_permlane16_swap_b32 v21, v23
    v_permlane16_swap_b32 v24, v26
    v_permlane16_swap_b32 v25, v27
    v_permlane16_swap_b32 v28, v30
    v_permlane16_swap_b32 v29, v31
    v_permlane16_swap_b32 v32, v34
    v_permlane16_swap_b32 v33, v35
    v_permlane16_swap_b32 v36, v38
    v_permlane16_swap_b32 v37, v39
    v_permlane16_swap_b32 v40, v42
    v_permlane16_swap_b32 v41, v43
    v_permlane16_swap_b32 v44, v46
    v_permlane16_swap_b32 v45, v47
    v_permlane16_swap_b32 v48, v50
    v_permlane16_swap_b32 v49, v51
    v_permlane16_swap_b32 v52, v54
    v_permlane16_swap_b32 v53, v55
    v_permlane16_swap_b32 v56, v58
    v_permlane16_swap_b32 v57, v59
    v_permlane16_swap_b32 v60, v62
    v_permlane16_swap_b32 v61, v63
    v_permlane16_swap_b32 v64, v66
    v_permlane16_swap_b32 v65, v67
    v_permlane16_swap_b32 v68, v70
    v_permlane16_swap_b32 v69, v71
    v_permlane16_swap_b32 v72, v74
    v_permlane16_swap_b32 v73, v75
    s_nop 1
    v_accvgpr_write_b32 a64, v12
    v_accvgpr_write_b32 a65, v14
    v_accvgpr_write_b32 a66, v13
    v_accvgpr_write_b32 a67, v15
    v_accvgpr_write_b32 a68, v16
    v_accvgpr_write_b32 a69, v18
    v_accvgpr_write_b32 a70, v17
    v_accvgpr_write_b32 a71, v19
    v_accvgpr_write_b32 a72, v20
    v_accvgpr_write_b32 a73, v22
    v_accvgpr_write_b32 a74, v21
    v_accvgpr_write_b32 a75, v23
    v_accvgpr_write_b32 a76, v24
    v_accvgpr_write_b32 a77, v26
    v_accvgpr_write_b32 a78, v25
    v_accvgpr_write_b32 a79, v27
    v_accvgpr_write_b32 a80, v28
    v_accvgpr_write_b32 a81, v30
    v_accvgpr_write_b32 a82, v29
    v_accvgpr_write_b32 a83, v31
    v_accvgpr_write_b32 a84, v32
    v_accvgpr_write_b32 a85, v34
    v_accvgpr_write_b32 a86, v33
    v_accvgpr_write_b32 a87, v35
    v_accvgpr_write_b32 a88, v36
    v_accvgpr_write_b32 a89, v38
    v_accvgpr_write_b32 a90, v37
    v_accvgpr_write_b32 a91, v39
    v_accvgpr_write_b32 a92, v40
    v_accvgpr_write_b32 a93, v42
    v_accvgpr_write_b32 a94, v41
    v_accvgpr_write_b32 a95, v43
    v_accvgpr_write_b32 a96, v44
    v_accvgpr_write_b32 a97, v46
    v_accvgpr_write_b32 a98, v45
    v_accvgpr_write_b32 a99, v47
    v_accvgpr_write_b32 a100, v48
    v_accvgpr_write_b32 a101, v50
    v_accvgpr_write_b32 a102, v49
    v_accvgpr_write_b32 a103, v51
    v_accvgpr_write_b32 a104, v52
    v_accvgpr_write_b32 a105, v54
    v_accvgpr_write_b32 a106, v53
    v_accvgpr_write_b32 a107, v55
    v_accvgpr_write_b32 a108, v56
    v_accvgpr_write_b32 a109, v58
    v_accvgpr_write_b32 a110, v57
    v_accvgpr_write_b32 a111, v59
    v_accvgpr_write_b32 a112, v60
    v_accvgpr_write_b32 a113, v62
    v_accvgpr_write_b32 a114, v61
    v_accvgpr_write_b32 a115, v63
    v_accvgpr_write_b32 a116, v64
    v_accvgpr_write_b32 a117, v66
    v_accvgpr_write_b32 a118, v65
    v_accvgpr_write_b32 a119, v67
    v_accvgpr_write_b32 a120, v68
    v_accvgpr_write_b32 a121, v70
    v_accvgpr_write_b32 a122, v69
    v_accvgpr_write_b32 a123, v71
    v_accvgpr_write_b32 a124, v72
    v_accvgpr_write_b32 a125, v74
    v_accvgpr_write_b32 a126, v73
    v_accvgpr_write_b32 a127, v75
    s_waitcnt lgkmcnt(0)
    s_add_u32 s23, s22, 53248
    buffer_load_dwordx4 v[12:15], v2, s[4:7], s23 offen
    s_add_u32 s23, s22, 54272
    buffer_load_dwordx4 v[16:19], v2, s[4:7], s23 offen
    s_add_u32 s23, s22, 7876608
    buffer_load_dwordx4 v[20:23], v2, s[4:7], s23 offen
    s_add_u32 s23, s22, 7877632
    buffer_load_dwordx4 v[24:27], v2, s[4:7], s23 offen
    s_add_u32 s23, s22, 7897088
    buffer_load_dwordx4 v[28:31], v2, s[4:7], s23 offen
    s_add_u32 s23, s22, 7898112
    buffer_load_dwordx4 v[32:35], v2, s[4:7], s23 offen
    s_add_u32 s23, s22, 7917568
    buffer_load_dwordx4 v[36:39], v2, s[4:7], s23 offen
    s_add_u32 s23, s22, 7918592
    buffer_load_dwordx4 v[40:43], v2, s[4:7], s23 offen
    s_add_u32 s23, s22, 14336
    buffer_load_dwordx4 v[44:47], v2, s[4:7], s23 offen
    s_add_u32 s23, s22, 15360
    buffer_load_dwordx4 v[48:51], v2, s[4:7], s23 offen
    s_add_u32 s23, s22, 34816
    buffer_load_dwordx4 v[52:55], v2, s[4:7], s23 offen
    s_add_u32 s23, s22, 35840
    buffer_load_dwordx4 v[56:59], v2, s[4:7], s23 offen
    s_add_u32 s23, s22, 55296
    buffer_load_dwordx4 v[60:63], v2, s[4:7], s23 offen
    s_add_u32 s23, s22, 56320
    buffer_load_dwordx4 v[64:67], v2, s[4:7], s23 offen
    s_add_u32 s23, s22, 7878656
    buffer_load_dwordx4 v[68:71], v2, s[4:7], s23 offen
    s_add_u32 s23, s22, 7879680
    buffer_load_dwordx4 v[72:75], v2, s[4:7], s23 offen
    s_waitcnt vmcnt(0)
    v_permlane16_swap_b32 v12, v14
    v_permlane16_swap_b32 v13, v15
    v_permlane16_swap_b32 v16, v18
    v_permlane16_swap_b32 v17, v19
    v_permlane16_swap_b32 v20, v22
    v_permlane16_swap_b32 v21, v23
    v_permlane16_swap_b32 v24, v26
    v_permlane16_swap_b32 v25, v27
    v_permlane16_swap_b32 v28, v30
    v_permlane16_swap_b32 v29, v31
    v_permlane16_swap_b32 v32, v34
    v_permlane16_swap_b32 v33, v35
    v_permlane16_swap_b32 v36, v38
    v_permlane16_swap_b32 v37, v39
    v_permlane16_swap_b32 v40, v42
    v_permlane16_swap_b32 v41, v43
    v_permlane16_swap_b32 v44, v46
    v_permlane16_swap_b32 v45, v47
    v_permlane16_swap_b32 v48, v50
    v_permlane16_swap_b32 v49, v51
    v_permlane16_swap_b32 v52, v54
    v_permlane16_swap_b32 v53, v55
    v_permlane16_swap_b32 v56, v58
    v_permlane16_swap_b32 v57, v59
    v_permlane16_swap_b32 v60, v62
    v_permlane16_swap_b32 v61, v63
    v_permlane16_swap_b32 v64, v66
    v_permlane16_swap_b32 v65, v67
    v_permlane16_swap_b32 v68, v70
    v_permlane16_swap_b32 v69, v71
    v_permlane16_swap_b32 v72, v74
    v_permlane16_swap_b32 v73, v75
    s_nop 1
    v_accvgpr_write_b32 a128, v12
    v_accvgpr_write_b32 a129, v14
    v_accvgpr_write_b32 a130, v13
    v_accvgpr_write_b32 a131, v15
    v_accvgpr_write_b32 a132, v16
    v_accvgpr_write_b32 a133, v18
    v_accvgpr_write_b32 a134, v17
    v_accvgpr_write_b32 a135, v19
    v_accvgpr_write_b32 a136, v20
    v_accvgpr_write_b32 a137, v22
    v_accvgpr_write_b32 a138, v21
    v_accvgpr_write_b32 a139, v23
    v_accvgpr_write_b32 a140, v24
    v_accvgpr_write_b32 a141, v26
    v_accvgpr_write_b32 a142, v25
    v_accvgpr_write_b32 a143, v27
    v_accvgpr_write_b32 a144, v28
    v_accvgpr_write_b32 a145, v30
    v_accvgpr_write_b32 a146, v29
    v_accvgpr_write_b32 a147, v31
    v_accvgpr_write_b32 a148, v32
    v_accvgpr_write_b32 a149, v34
    v_accvgpr_write_b32 a150, v33
    v_accvgpr_write_b32 a151, v35
    v_accvgpr_write_b32 a152, v36
    v_accvgpr_write_b32 a153, v38
    v_accvgpr_write_b32 a154, v37
    v_accvgpr_write_b32 a155, v39
    v_accvgpr_write_b32 a156, v40
    v_accvgpr_write_b32 a157, v42
    v_accvgpr_write_b32 a158, v41
    v_accvgpr_write_b32 a159, v43
    v_accvgpr_write_b32 a160, v44
    v_accvgpr_write_b32 a161, v46
    v_accvgpr_write_b32 a162, v45
    v_accvgpr_write_b32 a163, v47
    v_accvgpr_write_b32 a164, v48
    v_accvgpr_write_b32 a165, v50
    v_accvgpr_write_b32 a166, v49
    v_accvgpr_write_b32 a167, v51
    v_accvgpr_write_b32 a168, v52
    v_accvgpr_write_b32 a169, v54
    v_accvgpr_write_b32 a170, v53
    v_accvgpr_write_b32 a171, v55
    v_accvgpr_write_b32 a172, v56
    v_accvgpr_write_b32 a173, v58
    v_accvgpr_write_b32 a174, v57
    v_accvgpr_write_b32 a175, v59
    v_accvgpr_write_b32 a176, v60
    v_accvgpr_write_b32 a177, v62
    v_accvgpr_write_b32 a178, v61
    v_accvgpr_write_b32 a179, v63
    v_accvgpr_write_b32 a180, v64
    v_accvgpr_write_b32 a181, v66
    v_accvgpr_write_b32 a182, v65
    v_accvgpr_write_b32 a183, v67
    v_accvgpr_write_b32 a184, v68
    v_accvgpr_write_b32 a185, v70
    v_accvgpr_write_b32 a186, v69
    v_accvgpr_write_b32 a187, v71
    v_accvgpr_write_b32 a188, v72
    v_accvgpr_write_b32 a189, v74
    v_accvgpr_write_b32 a190, v73
    v_accvgpr_write_b32 a191, v75
    s_waitcnt lgkmcnt(0)
    s_add_u32 s23, s22, 7899136
    buffer_load_dwordx4 v[12:15], v2, s[4:7], s23 offen
    s_add_u32 s23, s22, 7900160
    buffer_load_dwordx4 v[16:19], v2, s[4:7], s23 offen
    s_add_u32 s23, s22, 7919616
    buffer_load_dwordx4 v[20:23], v2, s[4:7], s23 offen
    s_add_u32 s23, s22, 7920640
    buffer_load_dwordx4 v[24:27], v2, s[4:7], s23 offen
    s_add_u32 s23, s22, 16384
    buffer_load_dwordx4 v[28:31], v2, s[4:7], s23 offen
    s_add_u32 s23, s22, 17408
    buffer_load_dwordx4 v[32:35], v2, s[4:7], s23 offen
    s_add_u32 s23, s22, 36864
    buffer_load_dwordx4 v[36:39], v2, s[4:7], s23 offen
    s_add_u32 s23, s22, 37888
    buffer_load_dwordx4 v[40:43], v2, s[4:7], s23 offen
    s_add_u32 s23, s22, 57344
    buffer_load_dwordx4 v[44:47], v2, s[4:7], s23 offen
    s_add_u32 s23, s22, 58368
    buffer_load_dwordx4 v[48:51], v2, s[4:7], s23 offen
    s_add_u32 s23, s22, 7880704
    buffer_load_dwordx4 v[52:55], v2, s[4:7], s23 offen
    s_add_u32 s23, s22, 7881728
    buffer_load_dwordx4 v[56:59], v2, s[4:7], s23 offen
    s_add_u32 s23, s22, 7901184
    buffer_load_dwordx4 v[60:63], v2, s[4:7], s23 offen
    s_add_u32 s23, s22, 7902208
    buffer_load_dwordx4 v[64:67], v2, s[4:7], s23 offen
    s_add_u32 s23, s22, 7921664
    buffer_load_dwordx4 v[68:71], v2, s[4:7], s23 offen
    s_add_u32 s23, s22, 7922688
    buffer_load_dwordx4 v[72:75], v2, s[4:7], s23 offen
    s_waitcnt vmcnt(0)
    v_permlane16_swap_b32 v12, v14
    v_permlane16_swap_b32 v13, v15
    v_permlane16_swap_b32 v16, v18
    v_permlane16_swap_b32 v17, v19
    v_permlane16_swap_b32 v20, v22
    v_permlane16_swap_b32 v21, v23
    v_permlane16_swap_b32 v24, v26
    v_permlane16_swap_b32 v25, v27
    v_permlane16_swap_b32 v28, v30
    v_permlane16_swap_b32 v29, v31
    v_permlane16_swap_b32 v32, v34
    v_permlane16_swap_b32 v33, v35
    v_permlane16_swap_b32 v36, v38
    v_permlane16_swap_b32 v37, v39
    v_permlane16_swap_b32 v40, v42
    v_permlane16_swap_b32 v41, v43
    v_permlane16_swap_b32 v44, v46
    v_permlane16_swap_b32 v45, v47
    v_permlane16_swap_b32 v48, v50
    v_permlane16_swap_b32 v49, v51
    v_permlane16_swap_b32 v52, v54
    v_permlane16_swap_b32 v53, v55
    v_permlane16_swap_b32 v56, v58
    v_permlane16_swap_b32 v57, v59
    v_permlane16_swap_b32 v60, v62
    v_permlane16_swap_b32 v61, v63
    v_permlane16_swap_b32 v64, v66
    v_permlane16_swap_b32 v65, v67
    v_permlane16_swap_b32 v68, v70
    v_permlane16_swap_b32 v69, v71
    v_permlane16_swap_b32 v72, v74
    v_permlane16_swap_b32 v73, v75
    s_nop 1
    v_accvgpr_write_b32 a192, v12
    v_accvgpr_write_b32 a193, v14
    v_accvgpr_write_b32 a194, v13
    v_accvgpr_write_b32 a195, v15
    v_accvgpr_write_b32 a196, v16
    v_accvgpr_write_b32 a197, v18
    v_accvgpr_write_b32 a198, v17
    v_accvgpr_write_b32 a199, v19
    v_accvgpr_write_b32 a200, v20
    v_accvgpr_write_b32 a201, v22
    v_accvgpr_write_b32 a202, v21
    v_accvgpr_write_b32 a203, v23
    v_accvgpr_write_b32 a204, v24
    v_accvgpr_write_b32 a205, v26
    v_accvgpr_write_b32 a206, v25
    v_accvgpr_write_b32 a207, v27
    v_accvgpr_write_b32 a208, v28
    v_accvgpr_write_b32 a209, v30
    v_accvgpr_write_b32 a210, v29
    v_accvgpr_write_b32 a211, v31
    v_accvgpr_write_b32 a212, v32
    v_accvgpr_write_b32 a213, v34
    v_accvgpr_write_b32 a214, v33
    v_accvgpr_write_b32 a215, v35
    v_accvgpr_write_b32 a216, v36
    v_accvgpr_write_b32 a217, v38
    v_accvgpr_write_b32 a218, v37
    v_accvgpr_write_b32 a219, v39
    v_accvgpr_write_b32 a220, v40
    v_accvgpr_write_b32 a221, v42
    v_accvgpr_write_b32 a222, v41
    v_accvgpr_write_b32 a223, v43
    v_accvgpr_write_b32 a224, v44
    v_accvgpr_write_b32 a225, v46
    v_accvgpr_write_b32 a226, v45
    v_accvgpr_write_b32 a227, v47
    v_accvgpr_write_b32 a228, v48
    v_accvgpr_write_b32 a229, v50
    v_accvgpr_write_b32 a230, v49
    v_accvgpr_write_b32 a231, v51
    v_accvgpr_write_b32 a232, v52
    v_accvgpr_write_b32 a233, v54
    v_accvgpr_write_b32 a234, v53
    v_accvgpr_write_b32 a235, v55
    v_accvgpr_write_b32 a236, v56
    v_accvgpr_write_b32 a237, v58
    v_accvgpr_write_b32 a238, v57
    v_accvgpr_write_b32 a239, v59
    v_accvgpr_write_b32 a240, v60
    v_accvgpr_write_b32 a241, v62
    v_accvgpr_write_b32 a242, v61
    v_accvgpr_write_b32 a243, v63
    v_accvgpr_write_b32 a244, v64
    v_accvgpr_write_b32 a245, v66
    v_accvgpr_write_b32 a246, v65
    v_accvgpr_write_b32 a247, v67
    v_accvgpr_write_b32 a248, v68
    v_accvgpr_write_b32 a249, v70
    v_accvgpr_write_b32 a250, v69
    v_accvgpr_write_b32 a251, v71
    v_accvgpr_write_b32 a252, v72
    v_accvgpr_write_b32 a253, v74
    v_accvgpr_write_b32 a254, v73
    v_accvgpr_write_b32 a255, v75
    s_waitcnt lgkmcnt(0)
    s_add_u32 s23, s22, 18432
    buffer_load_dwordx4 v[12:15], v2, s[4:7], s23 offen
    s_add_u32 s23, s22, 19456
    buffer_load_dwordx4 v[16:19], v2, s[4:7], s23 offen
    s_add_u32 s23, s22, 38912
    buffer_load_dwordx4 v[20:23], v2, s[4:7], s23 offen
    s_add_u32 s23, s22, 39936
    buffer_load_dwordx4 v[24:27], v2, s[4:7], s23 offen
    s_add_u32 s23, s22, 59392
    buffer_load_dwordx4 v[28:31], v2, s[4:7], s23 offen
    s_add_u32 s23, s22, 60416
    buffer_load_dwordx4 v[32:35], v2, s[4:7], s23 offen
    s_add_u32 s23, s22, 7882752
    buffer_load_dwordx4 v[36:39], v2, s[4:7], s23 offen
    s_add_u32 s23, s22, 7883776
    buffer_load_dwordx4 v[40:43], v2, s[4:7], s23 offen
    s_add_u32 s23, s22, 7903232
    buffer_load_dwordx4 v[44:47], v2, s[4:7], s23 offen
    s_add_u32 s23, s22, 7904256
    buffer_load_dwordx4 v[48:51], v2, s[4:7], s23 offen
    s_add_u32 s23, s22, 7923712
    buffer_load_dwordx4 v[52:55], v2, s[4:7], s23 offen
    s_add_u32 s23, s22, 7924736
    buffer_load_dwordx4 v[56:59], v2, s[4:7], s23 offen
    s_waitcnt vmcnt(0)
    v_permlane16_swap_b32 v12, v14
    v_permlane16_swap_b32 v13, v15
    v_permlane16_swap_b32 v16, v18
    v_permlane16_swap_b32 v17, v19
    v_permlane16_swap_b32 v20, v22
    v_permlane16_swap_b32 v21, v23
    v_permlane16_swap_b32 v24, v26
    v_permlane16_swap_b32 v25, v27
    v_permlane16_swap_b32 v28, v30
    v_permlane16_swap_b32 v29, v31
    v_permlane16_swap_b32 v32, v34
    v_permlane16_swap_b32 v33, v35
    v_permlane16_swap_b32 v36, v38
    v_permlane16_swap_b32 v37, v39
    v_permlane16_swap_b32 v40, v42
    v_permlane16_swap_b32 v41, v43
    v_permlane16_swap_b32 v44, v46
    v_permlane16_swap_b32 v45, v47
    v_permlane16_swap_b32 v48, v50
    v_permlane16_swap_b32 v49, v51
    v_permlane16_swap_b32 v52, v54
    v_permlane16_swap_b32 v53, v55
    v_permlane16_swap_b32 v56, v58
    v_permlane16_swap_b32 v57, v59
    s_nop 1
    v_swap_b32 v13, v14
    s_nop 0
    ds_write_b128 v0, v[12:15] offset:34816
    v_swap_b32 v17, v18
    s_nop 0
    ds_write_b128 v0, v[16:19] offset:35840
    v_swap_b32 v21, v22
    s_nop 0
    ds_write_b128 v0, v[20:23] offset:36864
    v_swap_b32 v25, v26
    s_nop 0
    ds_write_b128 v0, v[24:27] offset:37888
    v_swap_b32 v29, v30
    s_nop 0
    ds_write_b128 v0, v[28:31] offset:38912
    v_swap_b32 v33, v34
    s_nop 0
    ds_write_b128 v0, v[32:35] offset:39936
    v_swap_b32 v37, v38
    s_nop 0
    ds_write_b128 v0, v[36:39] offset:40960
    v_swap_b32 v41, v42
    s_nop 0
    ds_write_b128 v0, v[40:43] offset:41984
    v_swap_b32 v45, v46
    s_nop 0
    ds_write_b128 v0, v[44:47] offset:43008
    v_swap_b32 v49, v50
    s_nop 0
    ds_write_b128 v0, v[48:51] offset:44032
    v_swap_b32 v53, v54
    s_nop 0
    ds_write_b128 v0, v[52:55] offset:45056
    v_swap_b32 v57, v58
    s_nop 0
    ds_write_b128 v0, v[56:59] offset:46080
    s_waitcnt lgkmcnt(0)
    v_mov_b32 v20, 0
    v_mov_b32 v21, 0
    v_mov_b32 v22, 0
    v_mov_b32 v23, 0
    v_and_b32 v5, 15, v1
    v_lshrrev_b32 v6, 4, v1
    v_and_b32 v7, 8, v1
    v_cmp_eq_u32 vcc, 0, v7
    v_mov_b32 v3, 0xeeeeeeee
    v_mov_b32 v7, 0x44444444
    v_cndmask_b32 v3, v3, v7, vcc
    v_lshrrev_b32 v7, 2, v5
    v_lshlrev_b32 v7, 4, v7
    v_and_b32 v8, 3, v5
    v_lshlrev_b32 v8, 1, v8
    v_add_u32 v7, v7, v8
    v_and_b32 v8, 1, v6
    v_lshlrev_b32 v8, 8, v8
    v_add_u32 v7, v7, v8
    v_lshrrev_b32 v8, 1, v6
    v_lshlrev_b32 v8, 6, v8
    v_add_u32 v7, v7, v8
    v_lshlrev_b32 v8, 6, v5
    v_lshlrev_b32 v9, 4, v6
    v_add_u32 v8, v8, v9
    v_mov_b32 v11, v8
    v_lshlrev_b32 v8, 7, v6
    v_lshlrev_b32 v9, 4, v5
    v_add_u32 v8, v8, v9
    v_add_u32 v8, 128, v8
    v_lshlrev_b32 v10, 3, v6
    v_add_u32 v9, v9, v10
    v_cmp_gt_u32 vcc, 2, v6
    s_mov_b64 s[48:49], vcc
    s_mov_b32 s66, 0x00ff00ff
    s_mov_b32 s67, 0x00ff00ff
    s_mov_b32 s46, 0x00ff00ff
    s_mov_b32 s47, 0
    s_add_u32 s50, s51, 0
    s_lshr_b32 s52, s50, 1
    s_lshl_b32 s52, s52, 10
    s_and_b32 s50, s50, 1
    s_lshl_b32 s50, s50, 3
    s_add_u32 s53, s50, s52
    s_add_u32 s50, s51, 1
    s_lshr_b32 s52, s50, 1
    s_lshl_b32 s52, s52, 10
    s_and_b32 s50, s50, 1
    s_lshl_b32 s50, s50, 3
    s_add_u32 s54, s50, s52
    s_add_u32 s50, s51, 2
    s_lshr_b32 s52, s50, 1
    s_lshl_b32 s52, s52, 10
    s_and_b32 s50, s50, 1
    s_lshl_b32 s50, s50, 3
    s_add_u32 s55, s50, s52
    v_add_u32 v5, s53, v7
    v_add_u32 v6, s54, v7
    v_add_u32 v7, s55, v7
    s_mul_i32 s24, s20, 3072
    v_add_u32 v10, s24, v2
    s_mov_b32 s58, 1033096506
    s_mov_b32 s56, 1069066811
    s_cmp_ge_u32 s20, 2
    s_cselect_b32 s57, 190464, 0
    s_mul_i32 s24, s20, 3072
    s_add_u32 s57, s57, s24
    v_lshlrev_b32 v1, 3, v1
    s_lshr_b32 s45, s40, 2
    s_lshl_b32 s45, s45, 9
    s_add_u32 s68, s45, 2019328
    buffer_load_dwordx2 v[20:21], v1, s[4:7], s68 offen sc1
    s_waitcnt vmcnt(0)
    s_mov_b32 s92, 0xf0000000
    s_mov_b32 s93, -1
    s_mov_b32 s42, 0
L_s1i_fl:
    v_and_b32 v20, v20, v21
    v_cmp_ne_u32 vcc, 1, v20
    s_and_b64 vcc, vcc, s[92:93]
    s_cbranch_vccz L_s1i_flok
    s_add_u32 s42, s42, 1
    s_cmp_lt_u32 s42, s44
    s_cbranch_scc0 L_s1i_flto
    buffer_load_dwordx2 v[20:21], v1, s[4:7], s68 offen sc1
    s_waitcnt vmcnt(0)
    s_branch L_s1i_fl
L_s1i_flto:
    s_mov_b32 s44, 0
L_s1i_flok:
    s_mul_i32 s45, s40, 393216
    s_mul_i32 s50, s2, 6144
    s_add_u32 s45, s45, s50
    s_add_u32 s45, s45, 65228800
    s_add_u32 s45, s45, s57
    buffer_load_dwordx4 v[64:67], v2, s[4:7], s45 offen offset:0
    buffer_load_dwordx4 v[68:71], v2, s[4:7], s45 offen offset:1024
    buffer_load_dwordx4 v[72:75], v2, s[4:7], s45 offen offset:2048
    s_mov_b32 s59, 0
L_s1_loop:
    v_mov_b32 v40, 0
    v_mov_b32 v41, 0
    v_mov_b32 v42, 0
    v_mov_b32 v43, 0
    v_mov_b32 v44, 0
    v_mov_b32 v45, 0
    v_mov_b32 v46, 0
    v_mov_b32 v47, 0
    v_mov_b32 v48, 0
    v_mov_b32 v49, 0
    v_mov_b32 v50, 0
    v_mov_b32 v51, 0
    v_mov_b32 v52, 0
    v_mov_b32 v53, 0
    v_mov_b32 v54, 0
    v_mov_b32 v55, 0
    v_mov_b32 v56, 0
    v_mov_b32 v57, 0
    v_mov_b32 v58, 0
    v_mov_b32 v59, 0
    v_mov_b32 v60, 0
    v_mov_b32 v61, 0
    v_mov_b32 v62, 0
    v_mov_b32 v63, 0
    v_mov_b32 v20, 0
    v_mov_b32 v21, 0
    v_mov_b32 v22, 0
    v_mov_b32 v23, 0
    s_add_u32 s50, s40, 1
    s_min_u32 s52, s50, 63
    s_cmp_lt_u32 s52, 12
    s_cselect_b32 s92, 0xf0000000, -1
    s_lshr_b32 s45, s52, 2
    s_lshl_b32 s45, s45, 9
    s_add_u32 s68, s45, 2019328
    buffer_load_dwordx2 v[76:77], v1, s[4:7], s68 offen sc1
    s_mul_i32 s41, s40, 10240
    s_add_u32 s41, s41, 8192
    s_mov_b32 s42, 0
L_s1_poll:
    buffer_load_dwordx4 v[12:15], v4, s[4:7], s41 offen sc1
    buffer_load_dwordx4 v[16:19], v4, s[4:7], s41 offen offset:1024 sc1
    s_mov_b64 exec, s[60:61]
    buffer_load_dwordx4 v[20:23], v4, s[4:7], s41 offen offset:2048 sc1
    s_mov_b64 exec, -1
L_s1_chk:
    s_waitcnt vmcnt(0)
    s_cmp_eq_u32 s59, 0
    s_cbranch_scc1 L_kfl_a
    v_mov_b32 v24, 1
    v_mov_b32 v25, 0
    s_mov_b64 exec, 1
    buffer_store_dword v24, v25, s[4:7], s59 offen sc1
    s_mov_b64 exec, -1
    s_mov_b32 s59, 0
L_kfl_a:
    v_max3_u32 v24, v12, v13, v14
    v_max3_u32 v25, v15, v16, v17
    v_max3_u32 v24, v24, v18, v19
    v_max3_u32 v25, v25, v20, v21
    v_max3_u32 v24, v24, v22, v23
    v_max_u32 v24, v24, v25
    v_cmp_eq_u32 vcc, -1, v24
    s_cbranch_vccz L_s1_ok
    s_add_u32 s42, s42, 1
    s_cmp_lt_u32 s42, s44
    s_cbranch_scc1 L_s1_poll
    s_mov_b32 s44, 0
L_s1_ok:
    ds_write_b128 v4, v[12:15] offset:0
    ds_write_b128 v4, v[16:19] offset:1024
    s_mov_b64 exec, s[60:61]
    ds_write_b128 v4, v[20:23] offset:2048
    s_mov_b64 exec, -1
    ds_write_b128 v10, v[64:67] offset:22528
    ds_write_b128 v10, v[68:71] offset:23552
    ds_write_b128 v10, v[72:75] offset:24576
    v_and_b32 v76, v76, v77
    v_cmp_ne_u32 vcc, 1, v76
    s_and_b64 s[70:71], vcc, s[92:93]
    s_waitcnt lgkmcnt(0)
    s_barrier
    ds_read_b128 v[24:27], v2 offset:0
    ds_read_b128 v[28:31], v2 offset:1024
    ds_read_b128 v[12:15], v2 offset:9216
    ds_read_b128 v[64:67], v0 offset:34816
    ds_read_b128 v[68:71], v0 offset:35840
    ds_read_b128 v[32:35], v2 offset:2048
    ds_read_b128 v[72:75], v0 offset:36864
    ds_read_b128 v[76:79], v0 offset:37888
    ds_read_b128 v[36:39], v2 offset:3072
    s_waitcnt lgkmcnt(8)
    v_smfmac_f32_16x16x64_bf16 v[40:43], v[24:27], v[80:87], v3
    v_smfmac_f32_16x16x64_bf16 v[44:47], v[24:27], v[88:95], v3
    v_smfmac_f32_16x16x64_bf16 v[48:51], v[24:27], v[96:103], v3
    v_smfmac_f32_16x16x64_bf16 v[52:55], v[24:27], v[104:111], v3
    v_smfmac_f32_16x16x64_bf16 v[56:59], v[24:27], v[112:119], v3
    v_smfmac_f32_16x16x64_bf16 v[60:63], v[24:27], v[120:127], v3
    s_waitcnt lgkmcnt(6)
    s_waitcnt lgkmcnt(4)
    v_smfmac_f32_16x16x64_bf16 v[40:43], v[12:15], v[64:71], v3
    ds_read_b128 v[64:67], v0 offset:38912
    ds_read_b128 v[68:71], v0 offset:39936
    ds_read_b128 v[24:27], v2 offset:4096
    v_smfmac_f32_16x16x64_bf16 v[40:43], v[28:31], v[128:135], v3
    v_smfmac_f32_16x16x64_bf16 v[44:47], v[28:31], v[136:143], v3
    v_smfmac_f32_16x16x64_bf16 v[48:51], v[28:31], v[144:151], v3
    v_smfmac_f32_16x16x64_bf16 v[52:55], v[28:31], v[152:159], v3
    v_smfmac_f32_16x16x64_bf16 v[56:59], v[28:31], v[160:167], v3
    v_smfmac_f32_16x16x64_bf16 v[60:63], v[28:31], v[168:175], v3
    s_waitcnt lgkmcnt(4)
    v_smfmac_f32_16x16x64_bf16 v[44:47], v[12:15], v[72:79], v3
    ds_read_b128 v[72:75], v0 offset:40960
    ds_read_b128 v[76:79], v0 offset:41984
    ds_read_b128 v[28:31], v2 offset:5120
    v_smfmac_f32_16x16x64_bf16 v[40:43], v[32:35], v[176:183], v3
    v_smfmac_f32_16x16x64_bf16 v[44:47], v[32:35], v[184:191], v3
    v_smfmac_f32_16x16x64_bf16 v[48:51], v[32:35], v[192:199], v3
    v_smfmac_f32_16x16x64_bf16 v[52:55], v[32:35], v[200:207], v3
    v_smfmac_f32_16x16x64_bf16 v[56:59], v[32:35], v[208:215], v3
    v_smfmac_f32_16x16x64_bf16 v[60:63], v[32:35], v[216:223], v3
    s_waitcnt lgkmcnt(4)
    v_smfmac_f32_16x16x64_bf16 v[48:51], v[12:15], v[64:71], v3
    ds_read_b128 v[64:67], v0 offset:43008
    ds_read_b128 v[68:71], v0 offset:44032
    ds_read_b128 v[32:35], v2 offset:6144
    v_smfmac_f32_16x16x64_bf16 v[40:43], v[36:39], v[224:231], v3
    v_smfmac_f32_16x16x64_bf16 v[44:47], v[36:39], v[232:239], v3
    v_smfmac_f32_16x16x64_bf16 v[48:51], v[36:39], v[240:247], v3
    v_smfmac_f32_16x16x64_bf16 v[52:55], v[36:39], v[248:255], v3
    v_smfmac_f32_16x16x64_bf16 v[56:59], v[36:39], a[0:7], v3
    v_smfmac_f32_16x16x64_bf16 v[60:63], v[36:39], a[8:15], v3
    s_waitcnt lgkmcnt(4)
    v_smfmac_f32_16x16x64_bf16 v[52:55], v[12:15], v[72:79], v3
    ds_read_b128 v[72:75], v0 offset:45056
    ds_read_b128 v[76:79], v0 offset:46080
    ds_read_b128 v[36:39], v2 offset:7168
    v_smfmac_f32_16x16x64_bf16 v[40:43], v[24:27], a[16:23], v3
    v_smfmac_f32_16x16x64_bf16 v[44:47], v[24:27], a[24:31], v3
    v_smfmac_f32_16x16x64_bf16 v[48:51], v[24:27], a[32:39], v3
    v_smfmac_f32_16x16x64_bf16 v[52:55], v[24:27], a[40:47], v3
    v_smfmac_f32_16x16x64_bf16 v[56:59], v[24:27], a[48:55], v3
    v_smfmac_f32_16x16x64_bf16 v[60:63], v[24:27], a[56:63], v3
    s_waitcnt lgkmcnt(4)
    v_smfmac_f32_16x16x64_bf16 v[56:59], v[12:15], v[64:71], v3
    ds_read_b128 v[24:27], v2 offset:8192
    v_smfmac_f32_16x16x64_bf16 v[40:43], v[28:31], a[64:71], v3
    v_smfmac_f32_16x16x64_bf16 v[44:47], v[28:31], a[72:79], v3
    v_smfmac_f32_16x16x64_bf16 v[48:51], v[28:31], a[80:87], v3
    v_smfmac_f32_16x16x64_bf16 v[52:55], v[28:31], a[88:95], v3
    v_smfmac_f32_16x16x64_bf16 v[56:59], v[28:31], a[96:103], v3
    v_smfmac_f32_16x16x64_bf16 v[60:63], v[28:31], a[104:111], v3
    s_waitcnt lgkmcnt(2)
    v_smfmac_f32_16x16x64_bf16 v[60:63], v[12:15], v[72:79], v3
    v_smfmac_f32_16x16x64_bf16 v[40:43], v[32:35], a[112:119], v3
    v_smfmac_f32_16x16x64_bf16 v[44:47], v[32:35], a[120:127], v3
    v_smfmac_f32_16x16x64_bf16 v[48:51], v[32:35], a[128:135], v3
    v_smfmac_f32_16x16x64_bf16 v[52:55], v[32:35], a[136:143], v3
    v_smfmac_f32_16x16x64_bf16 v[56:59], v[32:35], a[144:151], v3
    v_smfmac_f32_16x16x64_bf16 v[60:63], v[32:35], a[152:159], v3
    s_waitcnt lgkmcnt(1)
    v_smfmac_f32_16x16x64_bf16 v[40:43], v[36:39], a[160:167], v3
    v_smfmac_f32_16x16x64_bf16 v[44:47], v[36:39], a[168:175], v3
    v_smfmac_f32_16x16x64_bf16 v[48:51], v[36:39], a[176:183], v3
    v_smfmac_f32_16x16x64_bf16 v[52:55], v[36:39], a[184:191], v3
    v_smfmac_f32_16x16x64_bf16 v[56:59], v[36:39], a[192:199], v3
    v_smfmac_f32_16x16x64_bf16 v[60:63], v[36:39], a[200:207], v3
    s_waitcnt lgkmcnt(0)
    v_smfmac_f32_16x16x64_bf16 v[40:43], v[24:27], a[208:215], v3
    v_smfmac_f32_16x16x64_bf16 v[44:47], v[24:27], a[216:223], v3
    v_smfmac_f32_16x16x64_bf16 v[48:51], v[24:27], a[224:231], v3
    v_smfmac_f32_16x16x64_bf16 v[52:55], v[24:27], a[232:239], v3
    v_smfmac_f32_16x16x64_bf16 v[56:59], v[24:27], a[240:247], v3
    v_smfmac_f32_16x16x64_bf16 v[60:63], v[24:27], a[248:255], v3
    s_nop 7
    s_nop 3
    v_permlane32_swap_b32 v40, v41
    v_permlane32_swap_b32 v42, v43
    v_permlane32_swap_b32 v44, v45
    v_permlane32_swap_b32 v46, v47
    v_permlane32_swap_b32 v48, v49
    v_permlane32_swap_b32 v50, v51
    v_permlane32_swap_b32 v52, v53
    v_permlane32_swap_b32 v54, v55
    v_permlane32_swap_b32 v56, v57
    v_permlane32_swap_b32 v58, v59
    v_permlane32_swap_b32 v60, v61
    v_permlane32_swap_b32 v62, v63
    s_nop 0
    v_add_f32 v40, v40, v41
    v_add_f32 v42, v42, v43
    v_cvt_pk_bf16_f32 v40, v40, v42
    ds_write_b16 v5, v40 offset:10240
    ds_write_b16_d16_hi v5, v40 offset:10368
    v_add_f32 v44, v44, v45
    v_add_f32 v46, v46, v47
    v_cvt_pk_bf16_f32 v44, v44, v46
    ds_write_b16 v6, v44 offset:10240
    ds_write_b16_d16_hi v6, v44 offset:10368
    v_add_f32 v48, v48, v49
    v_add_f32 v50, v50, v51
    v_cvt_pk_bf16_f32 v48, v48, v50
    ds_write_b16 v7, v48 offset:10240
    ds_write_b16_d16_hi v7, v48 offset:10368
    v_add_f32 v52, v52, v53
    v_add_f32 v54, v54, v55
    v_cvt_pk_bf16_f32 v52, v52, v54
    ds_write_b16 v5, v52 offset:16384
    ds_write_b16_d16_hi v5, v52 offset:16512
    v_add_f32 v56, v56, v57
    v_add_f32 v58, v58, v59
    v_cvt_pk_bf16_f32 v56, v56, v58
    ds_write_b16 v6, v56 offset:16384
    ds_write_b16_d16_hi v6, v56 offset:16512
    v_add_f32 v60, v60, v61
    v_add_f32 v62, v62, v63
    v_cvt_pk_bf16_f32 v60, v60, v62
    ds_write_b16 v7, v60 offset:16384
    ds_write_b16_d16_hi v7, v60 offset:16512
    s_mul_i32 s45, s40, 20480
    s_mul_i32 s50, s2, 640
    s_add_u32 s45, s45, s50
    s_add_u32 s45, s45, 675840
    s_waitcnt lgkmcnt(0)
    s_barrier
    s_cmp_lg_u32 s20, 0
    s_cbranch_scc1 L_s1_nopub
    ds_read_b128 v[24:27], v11 offset:10240
    ds_read_b128 v[28:31], v11 offset:16384
    ds_read_b128 v[32:35], v2 offset:22528
    ds_read_b128 v[36:39], v2 offset:28672
    ds_read_b128 v[40:43], v11 offset:11264
    ds_read_b128 v[44:47], v11 offset:17408
    ds_read_b128 v[48:51], v2 offset:23552
    ds_read_b128 v[52:55], v2 offset:29696
    ds_read_b128 v[56:59], v11 offset:12288
    ds_read_b128 v[60:63], v11 offset:18432
    ds_read_b128 v[64:67], v2 offset:24576
    ds_read_b128 v[68:71], v2 offset:30720
    s_waitcnt lgkmcnt(10)
    v_mfma_f32_16x16x32_bf16 v[12:15], v[28:31], v[24:27], 0
    s_waitcnt lgkmcnt(9)
    v_mfma_f32_16x16x32_bf16 v[16:19], v[32:35], v[24:27], 0
    s_waitcnt lgkmcnt(8)
    v_mfma_f32_16x16x32_bf16 v[20:23], v[36:39], v[24:27], 0
    ds_read_b128 v[24:27], v11 offset:13312
    ds_read_b128 v[28:31], v11 offset:19456
    ds_read_b128 v[32:35], v2 offset:25600
    ds_read_b128 v[36:39], v2 offset:31744
    s_waitcnt lgkmcnt(10)
    v_mfma_f32_16x16x32_bf16 v[12:15], v[44:47], v[40:43], v[12:15]
    s_waitcnt lgkmcnt(9)
    v_mfma_f32_16x16x32_bf16 v[16:19], v[48:51], v[40:43], v[16:19]
    s_waitcnt lgkmcnt(8)
    v_mfma_f32_16x16x32_bf16 v[20:23], v[52:55], v[40:43], v[20:23]
    ds_read_b128 v[40:43], v11 offset:14336
    ds_read_b128 v[44:47], v11 offset:20480
    ds_read_b128 v[48:51], v2 offset:26624
    ds_read_b128 v[52:55], v2 offset:32768
    s_waitcnt lgkmcnt(10)
    v_mfma_f32_16x16x32_bf16 v[12:15], v[60:63], v[56:59], v[12:15]
    s_waitcnt lgkmcnt(9)
    v_mfma_f32_16x16x32_bf16 v[16:19], v[64:67], v[56:59], v[16:19]
    s_waitcnt lgkmcnt(8)
    v_mfma_f32_16x16x32_bf16 v[20:23], v[68:71], v[56:59], v[20:23]
    ds_read_b128 v[56:59], v11 offset:15360
    ds_read_b128 v[60:63], v11 offset:21504
    ds_read_b128 v[64:67], v2 offset:27648
    ds_read_b128 v[68:71], v2 offset:33792
    s_waitcnt lgkmcnt(10)
    v_mfma_f32_16x16x32_bf16 v[12:15], v[28:31], v[24:27], v[12:15]
    s_waitcnt lgkmcnt(9)
    v_mfma_f32_16x16x32_bf16 v[16:19], v[32:35], v[24:27], v[16:19]
    s_waitcnt lgkmcnt(8)
    v_mfma_f32_16x16x32_bf16 v[20:23], v[36:39], v[24:27], v[20:23]
    s_waitcnt lgkmcnt(6)
    v_mfma_f32_16x16x32_bf16 v[12:15], v[44:47], v[40:43], v[12:15]
    s_waitcnt lgkmcnt(5)
    v_mfma_f32_16x16x32_bf16 v[16:19], v[48:51], v[40:43], v[16:19]
    s_waitcnt lgkmcnt(4)
    v_mfma_f32_16x16x32_bf16 v[20:23], v[52:55], v[40:43], v[20:23]
    s_waitcnt lgkmcnt(2)
    v_mfma_f32_16x16x32_bf16 v[12:15], v[60:63], v[56:59], v[12:15]
    s_waitcnt lgkmcnt(1)
    v_mfma_f32_16x16x32_bf16 v[16:19], v[64:67], v[56:59], v[16:19]
    s_waitcnt lgkmcnt(0)
    v_mfma_f32_16x16x32_bf16 v[20:23], v[68:71], v[56:59], v[20:23]
    s_nop 7
    v_mov_b32 v36, s58
    v_mov_b32 v37, s58
    v_mov_b32 v38, s56
    v_mov_b32 v39, s56
    v_mov_b32 v25, 0xff800000
    v_max3_f32 v26, v12, v13, v14
    v_max3_f32 v27, v16, v17, v18
    v_max_f32 v26, v26, v15
    v_max3_f32 v27, v27, v19, v20
    v_cndmask_b32 v26, v25, v26, s[48:49]
    v_max3_f32 v27, v27, v21, v22
    v_max3_f32 v26, v26, v27, v23
    v_cvt_pk_bf16_f32 v28, v12, v13
    v_cvt_pk_bf16_f32 v29, v14, v15
    v_cvt_pk_bf16_f32 v30, v16, v17
    v_cvt_pk_bf16_f32 v31, v18, v19
    v_cvt_pk_bf16_f32 v32, v20, v21
    v_cvt_pk_bf16_f32 v33, v22, v23
    v_mov_b32 v27, v26
    v_lshlrev_b32 v12, 16, v28
    v_and_b32 v13, 0xffff0000, v28
    v_lshlrev_b32 v14, 16, v29
    v_and_b32 v15, 0xffff0000, v29
    v_lshlrev_b32 v16, 16, v30
    v_and_b32 v17, 0xffff0000, v30
    v_lshlrev_b32 v18, 16, v31
    v_and_b32 v19, 0xffff0000, v31
    v_lshlrev_b32 v20, 16, v32
    v_and_b32 v21, 0xffff0000, v32
    v_lshlrev_b32 v22, 16, v33
    v_and_b32 v23, 0xffff0000, v33
    v_permlane16_swap_b32 v26, v27
    v_pk_mul_f32 v[12:13], v[12:13], v[36:37]
    v_pk_mul_f32 v[14:15], v[14:15], v[36:37]
    v_pk_mul_f32 v[16:17], v[16:17], v[36:37]
    v_pk_mul_f32 v[18:19], v[18:19], v[36:37]
    v_pk_mul_f32 v[20:21], v[20:21], v[36:37]
    v_pk_mul_f32 v[22:23], v[22:23], v[36:37]
    v_max_f32 v26, v26, v27
    v_cvt_pk_bf16_f32 v28, v12, v13
    v_cvt_pk_bf16_f32 v29, v14, v15
    v_cvt_pk_bf16_f32 v30, v16, v17
    v_cvt_pk_bf16_f32 v31, v18, v19
    v_cvt_pk_bf16_f32 v32, v20, v21
    v_cvt_pk_bf16_f32 v33, v22, v23
    v_mov_b32 v27, v26
    v_lshlrev_b32 v12, 16, v28
    v_and_b32 v13, 0xffff0000, v28
    v_lshlrev_b32 v14, 16, v29
    v_and_b32 v15, 0xffff0000, v29
    v_lshlrev_b32 v16, 16, v30
    v_and_b32 v17, 0xffff0000, v30
    v_permlane32_swap_b32 v26, v27
    v_lshlrev_b32 v18, 16, v31
    v_and_b32 v19, 0xffff0000, v31
    v_lshlrev_b32 v20, 16, v32
    v_and_b32 v21, 0xffff0000, v32
    v_lshlrev_b32 v22, 16, v33
    v_and_b32 v23, 0xffff0000, v33
    v_max_f32 v26, v26, v27
    v_cvt_pk_bf16_f32 v27, v26, v26
    v_lshlrev_b32 v26, 16, v27
    v_mul_f32 v26, s58, v26
    v_cvt_pk_bf16_f32 v27, v26, v26
    v_lshlrev_b32 v26, 16, v27
    v_mul_f32 v26, s56, v26
    v_xor_b32 v26, 0x80000000, v26
    v_mov_b32 v27, v26
    v_pk_fma_f32 v[12:13], v[12:13], v[38:39], v[26:27]
    v_pk_fma_f32 v[14:15], v[14:15], v[38:39], v[26:27]
    v_pk_fma_f32 v[16:17], v[16:17], v[38:39], v[26:27]
    v_pk_fma_f32 v[18:19], v[18:19], v[38:39], v[26:27]
    v_pk_fma_f32 v[20:21], v[20:21], v[38:39], v[26:27]
    v_pk_fma_f32 v[22:23], v[22:23], v[38:39], v[26:27]
    v_exp_f32 v12, v12
    v_exp_f32 v13, v13
    v_exp_f32 v14, v14
    v_exp_f32 v15, v15
    v_exp_f32 v16, v16
    v_exp_f32 v17, v17
    v_exp_f32 v18, v18
    v_exp_f32 v19, v19
    v_exp_f32 v20, v20
    v_exp_f32 v21, v21
    v_exp_f32 v22, v22
    v_exp_f32 v23, v23
    s_nop 0
    v_cndmask_b32 v12, 0, v12, s[48:49]
    v_cndmask_b32 v13, 0, v13, s[48:49]
    v_cndmask_b32 v14, 0, v14, s[48:49]
    v_cndmask_b32 v15, 0, v15, s[48:49]
    v_pk_add_f32 v[26:27], v[16:17], v[18:19]
    v_pk_add_f32 v[34:35], v[20:21], v[22:23]
    v_pk_add_f32 v[26:27], v[26:27], v[12:13]
    v_pk_add_f32 v[34:35], v[34:35], v[14:15]
    v_pk_add_f32 v[26:27], v[26:27], v[34:35]
    v_add_f32 v26, v26, v27
    v_mov_b32 v27, v26
    s_nop 1
    v_permlane16_swap_b32 v26, v27
    s_nop 1
    v_add_f32 v26, v26, v27
    v_mov_b32 v27, v26
    s_nop 1
    v_permlane32_swap_b32 v26, v27
    s_nop 1
    v_add_f32 v26, v26, v27
    v_rcp_f32 v26, v26
    s_nop 0
    v_mov_b32 v27, v26
    v_pk_mul_f32 v[12:13], v[12:13], v[26:27]
    v_pk_mul_f32 v[14:15], v[14:15], v[26:27]
    v_pk_mul_f32 v[16:17], v[16:17], v[26:27]
    v_pk_mul_f32 v[18:19], v[18:19], v[26:27]
    v_pk_mul_f32 v[20:21], v[20:21], v[26:27]
    v_pk_mul_f32 v[22:23], v[22:23], v[26:27]
    v_cvt_pk_bf16_f32 v28, v16, v17
    v_cvt_pk_bf16_f32 v29, v18, v19
    v_cvt_pk_bf16_f32 v30, v20, v21
    v_cvt_pk_bf16_f32 v31, v22, v23
    v_cvt_pk_bf16_f32 v32, v12, v13
    v_cvt_pk_bf16_f32 v33, v14, v15
    s_mov_b64 exec, s[66:67]
    buffer_store_dwordx4 v[28:31], v8, s[4:7], s45 offen sc1
    s_mov_b64 exec, s[46:47]
    buffer_store_dwordx2 v[32:33], v9, s[4:7], s45 offen sc1
    s_mov_b64 exec, -1
    s_branch L_s1_pubd
L_s1_nopub:
    s_sub_u32 s50, s20, 1
    s_lshl_b32 s50, s50, 11
    v_add_u32 v24, s50, v11
    ds_read_b128 v[28:31], v24 offset:16384
    ds_read_b128 v[32:35], v24 offset:17408
    v_add_u32 v24, s50, v2
    s_lshl_b32 s45, s40, 5
    s_add_u32 s45, s45, s2
    s_mul_i32 s45, s45, 6144
    s_add_u32 s45, s45, 200495104
    s_waitcnt lgkmcnt(0)
    buffer_store_dwordx4 v[28:31], v24, s[4:7], s45 offen sc1
    buffer_store_dwordx4 v[32:35], v24, s[4:7], s45 offen offset:1024 sc1
    s_lshl_b32 s59, s40, 9
    s_lshl_b32 s50, s2, 4
    s_add_u32 s59, s59, s50
    s_lshl_b32 s50, s20, 2
    s_add_u32 s59, s59, s50
    s_add_u32 s59, s59, 250859520
L_s1_pubd:
    s_cmp_eq_u64 s[70:71], 0
    s_cbranch_scc1 L_s1_flgood
    buffer_load_dwordx2 v[20:21], v1, s[4:7], s68 offen sc1
    s_waitcnt vmcnt(0)
    s_mov_b32 s42, 0
L_s1l_fl:
    v_and_b32 v20, v20, v21
    v_cmp_ne_u32 vcc, 1, v20
    s_and_b64 vcc, vcc, s[92:93]
    s_cbranch_vccz L_s1l_flok
    s_add_u32 s42, s42, 1
    s_cmp_lt_u32 s42, s44
    s_cbranch_scc0 L_s1l_flto
    buffer_load_dwordx2 v[20:21], v1, s[4:7], s68 offen sc1
    s_waitcnt vmcnt(0)
    s_branch L_s1l_fl
L_s1l_flto:
    s_mov_b32 s44, 0
L_s1l_flok:
L_s1_flgood:
    s_add_u32 s50, s40, 1
    s_min_u32 s52, s50, 63
    s_mul_i32 s45, s52, 393216
    s_mul_i32 s50, s2, 6144
    s_add_u32 s45, s45, s50
    s_add_u32 s45, s45, 65228800
    s_add_u32 s45, s45, s57
    buffer_load_dwordx4 v[64:67], v2, s[4:7], s45 offen offset:0
    buffer_load_dwordx4 v[68:71], v2, s[4:7], s45 offen offset:1024
    buffer_load_dwordx4 v[72:75], v2, s[4:7], s45 offen offset:2048
    s_add_u32 s40, s40, 1
    s_cmp_lt_u32 s40, 64
    s_cbranch_scc1 L_s1_loop
    s_waitcnt vmcnt(0)
    s_cmp_eq_u32 s59, 0
    s_cbranch_scc1 L_kfl_b
    v_mov_b32 v24, 1
    v_mov_b32 v25, 0
    s_mov_b64 exec, 1
    buffer_store_dword v24, v25, s[4:7], s59 offen sc1
    s_mov_b64 exec, -1
    s_mov_b32 s59, 0
L_kfl_b:
    s_endpgm
L_ch_s2:
    v_mov_b32 v20, 0
    v_mov_b32 v21, 0
    v_mov_b32 v22, 0
    v_mov_b32 v23, 0
    s_sub_u32 s21, s2, 32
    s_lshr_b32 s22, s21, 1
    s_and_b32 s23, s21, 1
    v_and_b32 v5, 15, v1
    v_lshrrev_b32 v6, 4, v1
    v_and_b32 v7, 7, v1
    v_lshrrev_b32 v8, 3, v5
    s_lshl_b32 s24, s23, 3
    v_lshlrev_b32 v9, 4, v6
    v_add_u32 v9, v9, v7
    v_add_u32 v9, s24, v9
    v_lshlrev_b32 v9, 4, v9
    v_mul_u32_u24 v10, 40960, v8
    v_add_u32 v9, v9, v10
    s_lshl_b32 s24, s20, 3
    s_mul_i32 s24, s24, 40
    s_add_u32 s24, s24, s22
    s_lshl_b32 s24, s24, 10
    s_add_u32 s24, s24, 174280704
    v_min_u32 v22, 39, v1
    v_lshlrev_b32 v22, 2, v22
    s_mul_i32 s68, s20, 160
    s_add_u32 s68, s68, 2028032
    s_mov_b32 s42, 0
L_s2w_fl:
    buffer_load_dword v20, v22, s[4:7], s68 offen sc1
    s_waitcnt vmcnt(0)
    v_cmp_ne_u32 vcc, 1, v20
    s_cbranch_vccz L_s2w_ok
    s_add_u32 s42, s42, 1
    s_cmp_lt_u32 s42, s44
    s_cbranch_scc1 L_s2w_fl
    s_mov_b32 s44, 0
L_s2w_ok:
    s_add_u32 s25, s24, 0
    buffer_load_dwordx4 v[192:195], v9, s[4:7], s25 offen
    s_add_u32 s25, s24, 81920
    buffer_load_dwordx4 v[196:199], v9, s[4:7], s25 offen
    s_add_u32 s25, s24, 163840
    buffer_load_dwordx4 v[200:203], v9, s[4:7], s25 offen
    s_add_u32 s25, s24, 245760
    buffer_load_dwordx4 v[204:207], v9, s[4:7], s25 offen
    s_add_u32 s25, s24, 1310720
    buffer_load_dwordx4 v[208:211], v9, s[4:7], s25 offen
    s_add_u32 s25, s24, 1392640
    buffer_load_dwordx4 v[212:215], v9, s[4:7], s25 offen
    s_add_u32 s25, s24, 1474560
    buffer_load_dwordx4 v[216:219], v9, s[4:7], s25 offen
    s_add_u32 s25, s24, 1556480
    buffer_load_dwordx4 v[220:223], v9, s[4:7], s25 offen
    s_add_u32 s25, s24, 2621440
    buffer_load_dwordx4 v[224:227], v9, s[4:7], s25 offen
    s_add_u32 s25, s24, 2703360
    buffer_load_dwordx4 v[228:231], v9, s[4:7], s25 offen
    s_add_u32 s25, s24, 2785280
    buffer_load_dwordx4 v[232:235], v9, s[4:7], s25 offen
    s_add_u32 s25, s24, 2867200
    buffer_load_dwordx4 v[236:239], v9, s[4:7], s25 offen
    s_add_u32 s25, s24, 3932160
    buffer_load_dwordx4 v[240:243], v9, s[4:7], s25 offen
    s_add_u32 s25, s24, 4014080
    buffer_load_dwordx4 v[244:247], v9, s[4:7], s25 offen
    s_add_u32 s25, s24, 4096000
    buffer_load_dwordx4 v[248:251], v9, s[4:7], s25 offen
    s_add_u32 s25, s24, 4177920
    buffer_load_dwordx4 v[252:255], v9, s[4:7], s25 offen
    s_add_u32 s25, s24, 5242880
    buffer_load_dwordx4 a[0:3], v9, s[4:7], s25 offen
    s_add_u32 s25, s24, 5324800
    buffer_load_dwordx4 a[4:7], v9, s[4:7], s25 offen
    s_add_u32 s25, s24, 5406720
    buffer_load_dwordx4 a[8:11], v9, s[4:7], s25 offen
    s_add_u32 s25, s24, 5488640
    buffer_load_dwordx4 a[12:15], v9, s[4:7], s25 offen
    s_add_u32 s25, s24, 6553600
    buffer_load_dwordx4 a[16:19], v9, s[4:7], s25 offen
    s_add_u32 s25, s24, 6635520
    buffer_load_dwordx4 a[20:23], v9, s[4:7], s25 offen
    s_add_u32 s25, s24, 6717440
    buffer_load_dwordx4 a[24:27], v9, s[4:7], s25 offen
    s_add_u32 s25, s24, 6799360
    buffer_load_dwordx4 a[28:31], v9, s[4:7], s25 offen
    s_add_u32 s25, s24, 7864320
    buffer_load_dwordx4 a[32:35], v9, s[4:7], s25 offen
    s_add_u32 s25, s24, 7946240
    buffer_load_dwordx4 a[36:39], v9, s[4:7], s25 offen
    s_add_u32 s25, s24, 8028160
    buffer_load_dwordx4 a[40:43], v9, s[4:7], s25 offen
    s_add_u32 s25, s24, 8110080
    buffer_load_dwordx4 a[44:47], v9, s[4:7], s25 offen
    s_add_u32 s25, s24, 9175040
    buffer_load_dwordx4 a[48:51], v9, s[4:7], s25 offen
    s_add_u32 s25, s24, 9256960
    buffer_load_dwordx4 a[52:55], v9, s[4:7], s25 offen
    s_add_u32 s25, s24, 9338880
    buffer_load_dwordx4 a[56:59], v9, s[4:7], s25 offen
    s_add_u32 s25, s24, 9420800
    buffer_load_dwordx4 a[60:63], v9, s[4:7], s25 offen
    s_add_u32 s25, s24, 10485760
    buffer_load_dwordx4 a[64:67], v9, s[4:7], s25 offen
    s_add_u32 s25, s24, 10567680
    buffer_load_dwordx4 a[68:71], v9, s[4:7], s25 offen
    s_add_u32 s25, s24, 10649600
    buffer_load_dwordx4 a[72:75], v9, s[4:7], s25 offen
    s_add_u32 s25, s24, 10731520
    buffer_load_dwordx4 a[76:79], v9, s[4:7], s25 offen
    s_add_u32 s25, s24, 11796480
    buffer_load_dwordx4 a[80:83], v9, s[4:7], s25 offen
    s_add_u32 s25, s24, 11878400
    buffer_load_dwordx4 a[84:87], v9, s[4:7], s25 offen
    s_add_u32 s25, s24, 11960320
    buffer_load_dwordx4 a[88:91], v9, s[4:7], s25 offen
    s_add_u32 s25, s24, 12042240
    buffer_load_dwordx4 a[92:95], v9, s[4:7], s25 offen
    s_add_u32 s25, s24, 13107200
    buffer_load_dwordx4 a[96:99], v9, s[4:7], s25 offen
    s_add_u32 s25, s24, 13189120
    buffer_load_dwordx4 a[100:103], v9, s[4:7], s25 offen
    s_add_u32 s25, s24, 13271040
    buffer_load_dwordx4 a[104:107], v9, s[4:7], s25 offen
    s_add_u32 s25, s24, 13352960
    buffer_load_dwordx4 a[108:111], v9, s[4:7], s25 offen
    s_add_u32 s25, s24, 14417920
    buffer_load_dwordx4 a[112:115], v9, s[4:7], s25 offen
    s_add_u32 s25, s24, 14499840
    buffer_load_dwordx4 a[116:119], v9, s[4:7], s25 offen
    s_add_u32 s25, s24, 14581760
    buffer_load_dwordx4 a[120:123], v9, s[4:7], s25 offen
    s_add_u32 s25, s24, 14663680
    buffer_load_dwordx4 a[124:127], v9, s[4:7], s25 offen
    s_add_u32 s25, s24, 15728640
    buffer_load_dwordx4 a[128:131], v9, s[4:7], s25 offen
    s_add_u32 s25, s24, 15810560
    buffer_load_dwordx4 a[132:135], v9, s[4:7], s25 offen
    s_add_u32 s25, s24, 15892480
    buffer_load_dwordx4 a[136:139], v9, s[4:7], s25 offen
    s_add_u32 s25, s24, 15974400
    buffer_load_dwordx4 a[140:143], v9, s[4:7], s25 offen
    s_add_u32 s25, s24, 17039360
    buffer_load_dwordx4 a[144:147], v9, s[4:7], s25 offen
    s_add_u32 s25, s24, 17121280
    buffer_load_dwordx4 a[148:151], v9, s[4:7], s25 offen
    s_add_u32 s25, s24, 17203200
    buffer_load_dwordx4 a[152:155], v9, s[4:7], s25 offen
    s_add_u32 s25, s24, 17285120
    buffer_load_dwordx4 a[156:159], v9, s[4:7], s25 offen
    s_add_u32 s25, s24, 18350080
    buffer_load_dwordx4 a[160:163], v9, s[4:7], s25 offen
    s_add_u32 s25, s24, 18432000
    buffer_load_dwordx4 a[164:167], v9, s[4:7], s25 offen
    s_add_u32 s25, s24, 18513920
    buffer_load_dwordx4 a[168:171], v9, s[4:7], s25 offen
    s_add_u32 s25, s24, 18595840
    buffer_load_dwordx4 a[172:175], v9, s[4:7], s25 offen
    s_add_u32 s25, s24, 19660800
    buffer_load_dwordx4 a[176:179], v9, s[4:7], s25 offen
    s_add_u32 s25, s24, 19742720
    buffer_load_dwordx4 a[180:183], v9, s[4:7], s25 offen
    s_add_u32 s25, s24, 19824640
    buffer_load_dwordx4 a[184:187], v9, s[4:7], s25 offen
    s_add_u32 s25, s24, 19906560
    buffer_load_dwordx4 a[188:191], v9, s[4:7], s25 offen
    s_add_u32 s25, s24, 20971520
    buffer_load_dwordx4 a[192:195], v9, s[4:7], s25 offen
    s_add_u32 s25, s24, 21053440
    buffer_load_dwordx4 a[196:199], v9, s[4:7], s25 offen
    s_add_u32 s25, s24, 21135360
    buffer_load_dwordx4 a[200:203], v9, s[4:7], s25 offen
    s_add_u32 s25, s24, 21217280
    buffer_load_dwordx4 a[204:207], v9, s[4:7], s25 offen
    s_add_u32 s25, s24, 22282240
    buffer_load_dwordx4 a[208:211], v9, s[4:7], s25 offen
    s_add_u32 s25, s24, 22364160
    buffer_load_dwordx4 a[212:215], v9, s[4:7], s25 offen
    s_add_u32 s25, s24, 22446080
    buffer_load_dwordx4 a[216:219], v9, s[4:7], s25 offen
    s_add_u32 s25, s24, 22528000
    buffer_load_dwordx4 a[220:223], v9, s[4:7], s25 offen
    s_add_u32 s25, s24, 23592960
    buffer_load_dwordx4 a[224:227], v9, s[4:7], s25 offen
    s_add_u32 s25, s24, 23674880
    buffer_load_dwordx4 a[228:231], v9, s[4:7], s25 offen
    s_add_u32 s25, s24, 23756800
    buffer_load_dwordx4 a[232:235], v9, s[4:7], s25 offen
    s_add_u32 s25, s24, 23838720
    buffer_load_dwordx4 a[236:239], v9, s[4:7], s25 offen
    s_add_u32 s25, s24, 24903680
    buffer_load_dwordx4 a[240:243], v9, s[4:7], s25 offen
    s_add_u32 s25, s24, 24985600
    buffer_load_dwordx4 a[244:247], v9, s[4:7], s25 offen
    s_add_u32 s25, s24, 25067520
    buffer_load_dwordx4 a[248:251], v9, s[4:7], s25 offen
    s_add_u32 s25, s24, 25149440
    buffer_load_dwordx4 a[252:255], v9, s[4:7], s25 offen
    v_lshrrev_b32 v9, 1, v6
    v_lshlrev_b32 v9, 7, v9
    v_lshlrev_b32 v10, 4, v7
    v_add_u32 v9, v9, v10
    v_and_b32 v10, 1, v6
    v_lshlrev_b32 v10, 3, v10
    v_add_u32 v9, v9, v10
    v_add_u32 v148, 2048, v9
    v_add_u32 v149, 4096, v9
    v_add_u32 v150, 6144, v9
    v_add_u32 v151, 8192, v9
    v_lshlrev_b32 v10, 8, v8
    s_lshl_b32 s24, s23, 3
    v_add_u32 v11, s24, v7
    v_lshlrev_b32 v11, 4, v11
    v_add_u32 v10, v10, v11
    v_lshlrev_b32 v11, 3, v6
    v_add_u32 v10, v10, v11
    s_lshl_b32 s24, s20, 11
    s_add_u32 s24, s24, 16384
    v_add_u32 v11, s24, v10
    v_add_u32 v152, s24, v2
    v_lshlrev_b32 v153, 4, v7
    v_lshlrev_b32 v154, 7, v6
    v_add_u32 v154, v154, v153
    v_mul_u32_u24 v155, 640, v6
    v_add_u32 v155, v155, v153
    v_mul_u32_u24 v153, 640, v8
    v_add_u32 v154, v154, v153
    v_mul_u32_u24 v153, 2560, v8
    v_add_u32 v155, v155, v153
    s_mov_b32 s66, 0x00ff00ff
    s_mov_b32 s67, 0x00ff00ff
    v_mov_b32 v24, 0
    v_mov_b32 v25, 0
    v_mov_b32 v26, 0
    v_mov_b32 v27, 0
    v_mov_b32 v28, 0
    v_mov_b32 v29, 0
    v_mov_b32 v30, 0
    v_mov_b32 v31, 0
    v_mov_b32 v32, 0
    v_mov_b32 v33, 0
    v_mov_b32 v34, 0
    v_mov_b32 v35, 0
    v_mov_b32 v36, 0
    v_mov_b32 v37, 0
    v_mov_b32 v38, 0
    v_mov_b32 v39, 0
    v_mov_b32 v40, 0
    v_mov_b32 v41, 0
    v_mov_b32 v42, 0
    v_mov_b32 v43, 0
    v_mov_b32 v44, 0
    v_mov_b32 v45, 0
    v_mov_b32 v46, 0
    v_mov_b32 v47, 0
    v_mov_b32 v48, 0
    v_mov_b32 v49, 0
    v_mov_b32 v50, 0
    v_mov_b32 v51, 0
    v_mov_b32 v52, 0
    v_mov_b32 v53, 0
    v_mov_b32 v54, 0
    v_mov_b32 v55, 0
    v_mov_b32 v56, 0
    v_mov_b32 v57, 0
    v_mov_b32 v58, 0
    v_mov_b32 v59, 0
    v_mov_b32 v60, 0
    v_mov_b32 v61, 0
    v_mov_b32 v62, 0
    v_mov_b32 v63, 0
    v_mov_b32 v164, 0
    v_mov_b32 v165, 0
    v_mov_b32 v166, 0
    v_mov_b32 v167, 0
    v_mov_b32 v168, 0
    v_mov_b32 v169, 0
    v_mov_b32 v170, 0
    v_mov_b32 v171, 0
    v_mov_b32 v172, 0
    v_mov_b32 v173, 0
    v_mov_b32 v174, 0
    v_mov_b32 v175, 0
    v_mov_b32 v176, 0
    v_mov_b32 v177, 0
    v_mov_b32 v178, 0
    v_mov_b32 v179, 0
    v_mov_b32 v180, 0
    v_mov_b32 v181, 0
    v_mov_b32 v182, 0
    v_mov_b32 v183, 0
    v_mov_b32 v184, 0
    v_mov_b32 v185, 0
    v_mov_b32 v186, 0
    v_mov_b32 v187, 0
    v_mov_b32 v188, 0
    v_mov_b32 v189, 0
    v_mov_b32 v190, 0
    v_mov_b32 v191, 0
    s_lshl_b32 s24, s20, 10
    v_add_u32 v156, s24, v2
    v_and_b32 v157, 1, v8
    s_lshl_b32 s24, s23, 1
    v_add_u32 v158, s24, v157
    v_lshlrev_b32 v158, 4, v158
    v_add_u32 v158, v158, v7
    v_lshlrev_b32 v158, 4, v158
    s_lshr_b32 s24, s22, 1
    s_lshl_b32 s24, s24, 9
    s_and_b32 s25, s22, 1
    s_lshl_b32 s25, s25, 1
    s_add_u32 s25, s25, s23
    s_lshl_b32 s25, s25, 7
    s_add_u32 s24, s24, s25
    v_lshlrev_b32 v159, 4, v7
    v_lshlrev_b32 v157, 3, v157
    v_add_u32 v159, v159, v157
    v_add_u32 v159, s24, v159
    v_mov_b32 v140, 0
    v_mov_b32 v141, 0
    v_mov_b32 v142, 0
    v_mov_b32 v143, 0
    ds_write_b128 v152, v[140:143]
    ds_write_b128 v152, v[140:143] offset:1024
    v_lshlrev_b32 v160, 10, v8
    v_lshlrev_b32 v161, 8, v6
    v_add_u32 v160, v160, v161
    s_lshl_b32 s24, s23, 3
    v_add_u32 v161, s24, v7
    v_lshlrev_b32 v161, 4, v161
    v_add_u32 v160, v160, v161
    s_lshl_b32 s24, s20, 13
    s_add_u32 s24, s24, 32768
    v_add_u32 v160, s24, v160
    v_add_u32 v161, s24, v2
    v_lshrrev_b32 v162, 1, v6
    v_lshlrev_b32 v162, 8, v162
    v_lshlrev_b32 v163, 4, v5
    v_add_u32 v162, v162, v163
    v_and_b32 v163, 1, v6
    v_lshlrev_b32 v163, 3, v163
    v_add_u32 v162, v162, v163
    s_mul_i32 s24, s20, 10240
    s_add_u32 s24, s24, 65536
    v_add_u32 v163, s24, v2
    v_add_u32 v162, 65536, v162
    v_lshlrev_b32 v1, 3, v1
    s_mul_i32 s45, s40, 40960
    s_mul_i32 s50, s20, 10240
    s_add_u32 s45, s45, s50
    s_add_u32 s45, s45, 2052096
    buffer_load_dwordx4 v[164:167], v2, s[4:7], s45 offen offset:0
    buffer_load_dwordx4 v[168:171], v2, s[4:7], s45 offen offset:1024
    buffer_load_dwordx4 v[172:175], v2, s[4:7], s45 offen offset:2048
    buffer_load_dwordx4 v[176:179], v2, s[4:7], s45 offen offset:3072
    s_add_u32 s45, s45, 4096
    buffer_load_dwordx4 v[180:183], v2, s[4:7], s45 offen offset:0
    buffer_load_dwordx4 v[184:187], v2, s[4:7], s45 offen offset:1024
    buffer_load_dwordx4 v[188:191], v2, s[4:7], s45 offen offset:2048
    buffer_load_dwordx4 v[128:131], v2, s[4:7], s45 offen offset:3072
    s_add_u32 s45, s45, 4096
    buffer_load_dwordx4 v[132:135], v2, s[4:7], s45 offen offset:0
    buffer_load_dwordx4 v[136:139], v2, s[4:7], s45 offen offset:1024
    s_waitcnt vmcnt(0) lgkmcnt(0)
    ds_write_b128 v163, v[164:167] offset:0
    ds_write_b128 v163, v[168:171] offset:1024
    ds_write_b128 v163, v[172:175] offset:2048
    ds_write_b128 v163, v[176:179] offset:3072
    ds_write_b128 v163, v[180:183] offset:4096
    ds_write_b128 v163, v[184:187] offset:5120
    ds_write_b128 v163, v[188:191] offset:6144
    ds_write_b128 v163, v[128:131] offset:7168
    ds_write_b128 v163, v[132:135] offset:8192
    ds_write_b128 v163, v[136:139] offset:9216
    s_waitcnt lgkmcnt(0)
    s_barrier
    ds_read_b64 v[96:97], v162 offset:0
    ds_read_b64 v[98:99], v162 offset:512
    ds_read_b64 v[100:101], v162 offset:1024
    ds_read_b64 v[102:103], v162 offset:1536
    ds_read_b64 v[104:105], v162 offset:2048
    ds_read_b64 v[106:107], v162 offset:2560
    ds_read_b64 v[108:109], v162 offset:3072
    ds_read_b64 v[110:111], v162 offset:3584
    s_waitcnt lgkmcnt(6)
    v_mfma_f32_16x16x32_bf16 v[112:115], v[96:99], v[192:195], 0
    v_mfma_f32_16x16x32_bf16 v[116:119], v[96:99], v[196:199], 0
    v_mfma_f32_16x16x32_bf16 v[120:123], v[96:99], v[200:203], 0
    v_mfma_f32_16x16x32_bf16 v[124:127], v[96:99], v[204:207], 0
    ds_read_b64 v[96:97], v162 offset:4096
    ds_read_b64 v[98:99], v162 offset:4608
    s_waitcnt lgkmcnt(6)
    v_mfma_f32_16x16x32_bf16 v[112:115], v[100:103], v[208:211], v[112:115]
    v_mfma_f32_16x16x32_bf16 v[116:119], v[100:103], v[212:215], v[116:119]
    v_mfma_f32_16x16x32_bf16 v[120:123], v[100:103], v[216:219], v[120:123]
    v_mfma_f32_16x16x32_bf16 v[124:127], v[100:103], v[220:223], v[124:127]
    ds_read_b64 v[100:101], v162 offset:5120
    ds_read_b64 v[102:103], v162 offset:5632
    s_waitcnt lgkmcnt(6)
    v_mfma_f32_16x16x32_bf16 v[112:115], v[104:107], v[224:227], v[112:115]
    v_mfma_f32_16x16x32_bf16 v[116:119], v[104:107], v[228:231], v[116:119]
    v_mfma_f32_16x16x32_bf16 v[120:123], v[104:107], v[232:235], v[120:123]
    v_mfma_f32_16x16x32_bf16 v[124:127], v[104:107], v[236:239], v[124:127]
    ds_read_b64 v[104:105], v162 offset:6144
    ds_read_b64 v[106:107], v162 offset:6656
    s_waitcnt lgkmcnt(6)
    v_mfma_f32_16x16x32_bf16 v[112:115], v[108:111], v[240:243], v[112:115]
    v_mfma_f32_16x16x32_bf16 v[116:119], v[108:111], v[244:247], v[116:119]
    v_mfma_f32_16x16x32_bf16 v[120:123], v[108:111], v[248:251], v[120:123]
    v_mfma_f32_16x16x32_bf16 v[124:127], v[108:111], v[252:255], v[124:127]
    ds_read_b64 v[108:109], v162 offset:7168
    ds_read_b64 v[110:111], v162 offset:7680
    s_waitcnt lgkmcnt(6)
    v_mfma_f32_16x16x32_bf16 v[112:115], v[96:99], a[0:3], v[112:115]
    v_mfma_f32_16x16x32_bf16 v[116:119], v[96:99], a[4:7], v[116:119]
    v_mfma_f32_16x16x32_bf16 v[120:123], v[96:99], a[8:11], v[120:123]
    v_mfma_f32_16x16x32_bf16 v[124:127], v[96:99], a[12:15], v[124:127]
    ds_read_b64 v[96:97], v162 offset:8192
    ds_read_b64 v[98:99], v162 offset:8704
    s_waitcnt lgkmcnt(6)
    v_mfma_f32_16x16x32_bf16 v[112:115], v[100:103], a[16:19], v[112:115]
    v_mfma_f32_16x16x32_bf16 v[116:119], v[100:103], a[20:23], v[116:119]
    v_mfma_f32_16x16x32_bf16 v[120:123], v[100:103], a[24:27], v[120:123]
    v_mfma_f32_16x16x32_bf16 v[124:127], v[100:103], a[28:31], v[124:127]
    ds_read_b64 v[100:101], v162 offset:9216
    ds_read_b64 v[102:103], v162 offset:9728
    s_waitcnt lgkmcnt(6)
    v_mfma_f32_16x16x32_bf16 v[112:115], v[104:107], a[32:35], v[112:115]
    v_mfma_f32_16x16x32_bf16 v[116:119], v[104:107], a[36:39], v[116:119]
    v_mfma_f32_16x16x32_bf16 v[120:123], v[104:107], a[40:43], v[120:123]
    v_mfma_f32_16x16x32_bf16 v[124:127], v[104:107], a[44:47], v[124:127]
    ds_read_b64 v[104:105], v162 offset:10240
    ds_read_b64 v[106:107], v162 offset:10752
    s_waitcnt lgkmcnt(6)
    v_mfma_f32_16x16x32_bf16 v[112:115], v[108:111], a[48:51], v[112:115]
    v_mfma_f32_16x16x32_bf16 v[116:119], v[108:111], a[52:55], v[116:119]
    v_mfma_f32_16x16x32_bf16 v[120:123], v[108:111], a[56:59], v[120:123]
    v_mfma_f32_16x16x32_bf16 v[124:127], v[108:111], a[60:63], v[124:127]
    ds_read_b64 v[108:109], v162 offset:11264
    ds_read_b64 v[110:111], v162 offset:11776
    s_waitcnt lgkmcnt(6)
    v_mfma_f32_16x16x32_bf16 v[112:115], v[96:99], a[64:67], v[112:115]
    v_mfma_f32_16x16x32_bf16 v[116:119], v[96:99], a[68:71], v[116:119]
    v_mfma_f32_16x16x32_bf16 v[120:123], v[96:99], a[72:75], v[120:123]
    v_mfma_f32_16x16x32_bf16 v[124:127], v[96:99], a[76:79], v[124:127]
    ds_read_b64 v[96:97], v162 offset:12288
    ds_read_b64 v[98:99], v162 offset:12800
    s_waitcnt lgkmcnt(6)
    v_mfma_f32_16x16x32_bf16 v[112:115], v[100:103], a[80:83], v[112:115]
    v_mfma_f32_16x16x32_bf16 v[116:119], v[100:103], a[84:87], v[116:119]
    v_mfma_f32_16x16x32_bf16 v[120:123], v[100:103], a[88:91], v[120:123]
    v_mfma_f32_16x16x32_bf16 v[124:127], v[100:103], a[92:95], v[124:127]
    ds_read_b64 v[100:101], v162 offset:13312
    ds_read_b64 v[102:103], v162 offset:13824
    s_waitcnt lgkmcnt(6)
    v_mfma_f32_16x16x32_bf16 v[112:115], v[104:107], a[96:99], v[112:115]
    v_mfma_f32_16x16x32_bf16 v[116:119], v[104:107], a[100:103], v[116:119]
    v_mfma_f32_16x16x32_bf16 v[120:123], v[104:107], a[104:107], v[120:123]
    v_mfma_f32_16x16x32_bf16 v[124:127], v[104:107], a[108:111], v[124:127]
    ds_read_b64 v[104:105], v162 offset:14336
    ds_read_b64 v[106:107], v162 offset:14848
    s_waitcnt lgkmcnt(6)
    v_mfma_f32_16x16x32_bf16 v[112:115], v[108:111], a[112:115], v[112:115]
    v_mfma_f32_16x16x32_bf16 v[116:119], v[108:111], a[116:119], v[116:119]
    v_mfma_f32_16x16x32_bf16 v[120:123], v[108:111], a[120:123], v[120:123]
    v_mfma_f32_16x16x32_bf16 v[124:127], v[108:111], a[124:127], v[124:127]
    ds_read_b64 v[108:109], v162 offset:15360
    ds_read_b64 v[110:111], v162 offset:15872
    s_waitcnt lgkmcnt(6)
    v_mfma_f32_16x16x32_bf16 v[112:115], v[96:99], a[128:131], v[112:115]
    v_mfma_f32_16x16x32_bf16 v[116:119], v[96:99], a[132:135], v[116:119]
    v_mfma_f32_16x16x32_bf16 v[120:123], v[96:99], a[136:139], v[120:123]
    v_mfma_f32_16x16x32_bf16 v[124:127], v[96:99], a[140:143], v[124:127]
    ds_read_b64 v[96:97], v162 offset:16384
    ds_read_b64 v[98:99], v162 offset:16896
    s_waitcnt lgkmcnt(6)
    v_mfma_f32_16x16x32_bf16 v[112:115], v[100:103], a[144:147], v[112:115]
    v_mfma_f32_16x16x32_bf16 v[116:119], v[100:103], a[148:151], v[116:119]
    v_mfma_f32_16x16x32_bf16 v[120:123], v[100:103], a[152:155], v[120:123]
    v_mfma_f32_16x16x32_bf16 v[124:127], v[100:103], a[156:159], v[124:127]
    ds_read_b64 v[100:101], v162 offset:17408
    ds_read_b64 v[102:103], v162 offset:17920
    s_waitcnt lgkmcnt(6)
    v_mfma_f32_16x16x32_bf16 v[112:115], v[104:107], a[160:163], v[112:115]
    v_mfma_f32_16x16x32_bf16 v[116:119], v[104:107], a[164:167], v[116:119]
    v_mfma_f32_16x16x32_bf16 v[120:123], v[104:107], a[168:171], v[120:123]
    v_mfma_f32_16x16x32_bf16 v[124:127], v[104:107], a[172:175], v[124:127]
    ds_read_b64 v[104:105], v162 offset:18432
    ds_read_b64 v[106:107], v162 offset:18944
    s_waitcnt lgkmcnt(6)
    v_mfma_f32_16x16x32_bf16 v[112:115], v[108:111], a[176:179], v[112:115]
    v_mfma_f32_16x16x32_bf16 v[116:119], v[108:111], a[180:183], v[116:119]
    v_mfma_f32_16x16x32_bf16 v[120:123], v[108:111], a[184:187], v[120:123]
    v_mfma_f32_16x16x32_bf16 v[124:127], v[108:111], a[188:191], v[124:127]
    ds_read_b64 v[108:109], v162 offset:19456
    ds_read_b64 v[110:111], v162 offset:19968
    s_waitcnt lgkmcnt(6)
    v_mfma_f32_16x16x32_bf16 v[112:115], v[96:99], a[192:195], v[112:115]
    v_mfma_f32_16x16x32_bf16 v[116:119], v[96:99], a[196:199], v[116:119]
    v_mfma_f32_16x16x32_bf16 v[120:123], v[96:99], a[200:203], v[120:123]
    v_mfma_f32_16x16x32_bf16 v[124:127], v[96:99], a[204:207], v[124:127]
    ds_read_b64 v[96:97], v162 offset:20480
    ds_read_b64 v[98:99], v162 offset:20992
    s_waitcnt lgkmcnt(6)
    v_mfma_f32_16x16x32_bf16 v[112:115], v[100:103], a[208:211], v[112:115]
    v_mfma_f32_16x16x32_bf16 v[116:119], v[100:103], a[212:215], v[116:119]
    v_mfma_f32_16x16x32_bf16 v[120:123], v[100:103], a[216:219], v[120:123]
    v_mfma_f32_16x16x32_bf16 v[124:127], v[100:103], a[220:223], v[124:127]
    ds_read_b64 v[100:101], v162 offset:21504
    ds_read_b64 v[102:103], v162 offset:22016
    s_waitcnt lgkmcnt(6)
    v_mfma_f32_16x16x32_bf16 v[112:115], v[104:107], a[224:227], v[112:115]
    v_mfma_f32_16x16x32_bf16 v[116:119], v[104:107], a[228:231], v[116:119]
    v_mfma_f32_16x16x32_bf16 v[120:123], v[104:107], a[232:235], v[120:123]
    v_mfma_f32_16x16x32_bf16 v[124:127], v[104:107], a[236:239], v[124:127]
    ds_read_b64 v[104:105], v162 offset:22528
    ds_read_b64 v[106:107], v162 offset:23040
    s_waitcnt lgkmcnt(6)
    v_mfma_f32_16x16x32_bf16 v[112:115], v[108:111], a[240:243], v[112:115]
    v_mfma_f32_16x16x32_bf16 v[116:119], v[108:111], a[244:247], v[116:119]
    v_mfma_f32_16x16x32_bf16 v[120:123], v[108:111], a[248:251], v[120:123]
    v_mfma_f32_16x16x32_bf16 v[124:127], v[108:111], a[252:255], v[124:127]
    s_nop 7
    s_nop 7
    v_cvt_pk_bf16_f32 v140, v112, v113
    v_cvt_pk_bf16_f32 v141, v114, v115
    v_cvt_pk_bf16_f32 v142, v116, v117
    v_cvt_pk_bf16_f32 v143, v118, v119
    v_cvt_pk_bf16_f32 v144, v120, v121
    v_cvt_pk_bf16_f32 v145, v122, v123
    v_cvt_pk_bf16_f32 v146, v124, v125
    v_cvt_pk_bf16_f32 v147, v126, v127
    ds_write_b64 v160, v[140:141] offset:0
    ds_write_b64 v160, v[142:143] offset:2048
    ds_write_b64 v160, v[144:145] offset:4096
    ds_write_b64 v160, v[146:147] offset:6144
    s_nop 1
    ds_read_b64 v[108:109], v162 offset:23552
    ds_read_b64 v[110:111], v162 offset:24064
    s_waitcnt lgkmcnt(10)
    v_mfma_f32_16x16x32_bf16 v[112:115], v[96:99], v[192:195], 0
    v_mfma_f32_16x16x32_bf16 v[116:119], v[96:99], v[196:199], 0
    v_mfma_f32_16x16x32_bf16 v[120:123], v[96:99], v[200:203], 0
    v_mfma_f32_16x16x32_bf16 v[124:127], v[96:99], v[204:207], 0
    ds_read_b64 v[96:97], v162 offset:24576
    ds_read_b64 v[98:99], v162 offset:25088
    s_waitcnt lgkmcnt(10)
    v_mfma_f32_16x16x32_bf16 v[112:115], v[100:103], v[208:211], v[112:115]
    v_mfma_f32_16x16x32_bf16 v[116:119], v[100:103], v[212:215], v[116:119]
    v_mfma_f32_16x16x32_bf16 v[120:123], v[100:103], v[216:219], v[120:123]
    v_mfma_f32_16x16x32_bf16 v[124:127], v[100:103], v[220:223], v[124:127]
    ds_read_b64 v[100:101], v162 offset:25600
    ds_read_b64 v[102:103], v162 offset:26112
    s_waitcnt lgkmcnt(10)
    v_mfma_f32_16x16x32_bf16 v[112:115], v[104:107], v[224:227], v[112:115]
    v_mfma_f32_16x16x32_bf16 v[116:119], v[104:107], v[228:231], v[116:119]
    v_mfma_f32_16x16x32_bf16 v[120:123], v[104:107], v[232:235], v[120:123]
    v_mfma_f32_16x16x32_bf16 v[124:127], v[104:107], v[236:239], v[124:127]
    ds_read_b64 v[104:105], v162 offset:26624
    ds_read_b64 v[106:107], v162 offset:27136
    s_waitcnt lgkmcnt(6)
    v_mfma_f32_16x16x32_bf16 v[112:115], v[108:111], v[240:243], v[112:115]
    v_mfma_f32_16x16x32_bf16 v[116:119], v[108:111], v[244:247], v[116:119]
    v_mfma_f32_16x16x32_bf16 v[120:123], v[108:111], v[248:251], v[120:123]
    v_mfma_f32_16x16x32_bf16 v[124:127], v[108:111], v[252:255], v[124:127]
    ds_read_b64 v[108:109], v162 offset:27648
    ds_read_b64 v[110:111], v162 offset:28160
    s_waitcnt lgkmcnt(6)
    v_mfma_f32_16x16x32_bf16 v[112:115], v[96:99], a[0:3], v[112:115]
    v_mfma_f32_16x16x32_bf16 v[116:119], v[96:99], a[4:7], v[116:119]
    v_mfma_f32_16x16x32_bf16 v[120:123], v[96:99], a[8:11], v[120:123]
    v_mfma_f32_16x16x32_bf16 v[124:127], v[96:99], a[12:15], v[124:127]
    ds_read_b64 v[96:97], v162 offset:28672
    ds_read_b64 v[98:99], v162 offset:29184
    s_waitcnt lgkmcnt(6)
    v_mfma_f32_16x16x32_bf16 v[112:115], v[100:103], a[16:19], v[112:115]
    v_mfma_f32_16x16x32_bf16 v[116:119], v[100:103], a[20:23], v[116:119]
    v_mfma_f32_16x16x32_bf16 v[120:123], v[100:103], a[24:27], v[120:123]
    v_mfma_f32_16x16x32_bf16 v[124:127], v[100:103], a[28:31], v[124:127]
    ds_read_b64 v[100:101], v162 offset:29696
    ds_read_b64 v[102:103], v162 offset:30208
    s_waitcnt lgkmcnt(6)
    v_mfma_f32_16x16x32_bf16 v[112:115], v[104:107], a[32:35], v[112:115]
    v_mfma_f32_16x16x32_bf16 v[116:119], v[104:107], a[36:39], v[116:119]
    v_mfma_f32_16x16x32_bf16 v[120:123], v[104:107], a[40:43], v[120:123]
    v_mfma_f32_16x16x32_bf16 v[124:127], v[104:107], a[44:47], v[124:127]
    ds_read_b64 v[104:105], v162 offset:30720
    ds_read_b64 v[106:107], v162 offset:31232
    s_waitcnt lgkmcnt(6)
    v_mfma_f32_16x16x32_bf16 v[112:115], v[108:111], a[48:51], v[112:115]
    v_mfma_f32_16x16x32_bf16 v[116:119], v[108:111], a[52:55], v[116:119]
    v_mfma_f32_16x16x32_bf16 v[120:123], v[108:111], a[56:59], v[120:123]
    v_mfma_f32_16x16x32_bf16 v[124:127], v[108:111], a[60:63], v[124:127]
    ds_read_b64 v[108:109], v162 offset:31744
    ds_read_b64 v[110:111], v162 offset:32256
    s_waitcnt lgkmcnt(6)
    v_mfma_f32_16x16x32_bf16 v[112:115], v[96:99], a[64:67], v[112:115]
    v_mfma_f32_16x16x32_bf16 v[116:119], v[96:99], a[68:71], v[116:119]
    v_mfma_f32_16x16x32_bf16 v[120:123], v[96:99], a[72:75], v[120:123]
    v_mfma_f32_16x16x32_bf16 v[124:127], v[96:99], a[76:79], v[124:127]
    ds_read_b64 v[96:97], v162 offset:32768
    ds_read_b64 v[98:99], v162 offset:33280
    s_waitcnt lgkmcnt(6)
    v_mfma_f32_16x16x32_bf16 v[112:115], v[100:103], a[80:83], v[112:115]
    v_mfma_f32_16x16x32_bf16 v[116:119], v[100:103], a[84:87], v[116:119]
    v_mfma_f32_16x16x32_bf16 v[120:123], v[100:103], a[88:91], v[120:123]
    v_mfma_f32_16x16x32_bf16 v[124:127], v[100:103], a[92:95], v[124:127]
    ds_read_b64 v[100:101], v162 offset:33792
    ds_read_b64 v[102:103], v162 offset:34304
    s_waitcnt lgkmcnt(6)
    v_mfma_f32_16x16x32_bf16 v[112:115], v[104:107], a[96:99], v[112:115]
    v_mfma_f32_16x16x32_bf16 v[116:119], v[104:107], a[100:103], v[116:119]
    v_mfma_f32_16x16x32_bf16 v[120:123], v[104:107], a[104:107], v[120:123]
    v_mfma_f32_16x16x32_bf16 v[124:127], v[104:107], a[108:111], v[124:127]
    ds_read_b64 v[104:105], v162 offset:34816
    ds_read_b64 v[106:107], v162 offset:35328
    s_waitcnt lgkmcnt(6)
    v_mfma_f32_16x16x32_bf16 v[112:115], v[108:111], a[112:115], v[112:115]
    v_mfma_f32_16x16x32_bf16 v[116:119], v[108:111], a[116:119], v[116:119]
    v_mfma_f32_16x16x32_bf16 v[120:123], v[108:111], a[120:123], v[120:123]
    v_mfma_f32_16x16x32_bf16 v[124:127], v[108:111], a[124:127], v[124:127]
    ds_read_b64 v[108:109], v162 offset:35840
    ds_read_b64 v[110:111], v162 offset:36352
    s_waitcnt lgkmcnt(6)
    v_mfma_f32_16x16x32_bf16 v[112:115], v[96:99], a[128:131], v[112:115]
    v_mfma_f32_16x16x32_bf16 v[116:119], v[96:99], a[132:135], v[116:119]
    v_mfma_f32_16x16x32_bf16 v[120:123], v[96:99], a[136:139], v[120:123]
    v_mfma_f32_16x16x32_bf16 v[124:127], v[96:99], a[140:143], v[124:127]
    ds_read_b64 v[96:97], v162 offset:36864
    ds_read_b64 v[98:99], v162 offset:37376
    s_waitcnt lgkmcnt(6)
    v_mfma_f32_16x16x32_bf16 v[112:115], v[100:103], a[144:147], v[112:115]
    v_mfma_f32_16x16x32_bf16 v[116:119], v[100:103], a[148:151], v[116:119]
    v_mfma_f32_16x16x32_bf16 v[120:123], v[100:103], a[152:155], v[120:123]
    v_mfma_f32_16x16x32_bf16 v[124:127], v[100:103], a[156:159], v[124:127]
    ds_read_b64 v[100:101], v162 offset:37888
    ds_read_b64 v[102:103], v162 offset:38400
    s_waitcnt lgkmcnt(6)
    v_mfma_f32_16x16x32_bf16 v[112:115], v[104:107], a[160:163], v[112:115]
    v_mfma_f32_16x16x32_bf16 v[116:119], v[104:107], a[164:167], v[116:119]
    v_mfma_f32_16x16x32_bf16 v[120:123], v[104:107], a[168:171], v[120:123]
    v_mfma_f32_16x16x32_bf16 v[124:127], v[104:107], a[172:175], v[124:127]
    ds_read_b64 v[104:105], v162 offset:38912
    ds_read_b64 v[106:107], v162 offset:39424
    s_waitcnt lgkmcnt(6)
    v_mfma_f32_16x16x32_bf16 v[112:115], v[108:111], a[176:179], v[112:115]
    v_mfma_f32_16x16x32_bf16 v[116:119], v[108:111], a[180:183], v[116:119]
    v_mfma_f32_16x16x32_bf16 v[120:123], v[108:111], a[184:187], v[120:123]
    v_mfma_f32_16x16x32_bf16 v[124:127], v[108:111], a[188:191], v[124:127]
    ds_read_b64 v[108:109], v162 offset:39936
    ds_read_b64 v[110:111], v162 offset:40448
    s_waitcnt lgkmcnt(6)
    v_mfma_f32_16x16x32_bf16 v[112:115], v[96:99], a[192:195], v[112:115]
    v_mfma_f32_16x16x32_bf16 v[116:119], v[96:99], a[196:199], v[116:119]
    v_mfma_f32_16x16x32_bf16 v[120:123], v[96:99], a[200:203], v[120:123]
    v_mfma_f32_16x16x32_bf16 v[124:127], v[96:99], a[204:207], v[124:127]
    s_waitcnt lgkmcnt(4)
    v_mfma_f32_16x16x32_bf16 v[112:115], v[100:103], a[208:211], v[112:115]
    v_mfma_f32_16x16x32_bf16 v[116:119], v[100:103], a[212:215], v[116:119]
    v_mfma_f32_16x16x32_bf16 v[120:123], v[100:103], a[216:219], v[120:123]
    v_mfma_f32_16x16x32_bf16 v[124:127], v[100:103], a[220:223], v[124:127]
    s_waitcnt lgkmcnt(2)
    v_mfma_f32_16x16x32_bf16 v[112:115], v[104:107], a[224:227], v[112:115]
    v_mfma_f32_16x16x32_bf16 v[116:119], v[104:107], a[228:231], v[116:119]
    v_mfma_f32_16x16x32_bf16 v[120:123], v[104:107], a[232:235], v[120:123]
    v_mfma_f32_16x16x32_bf16 v[124:127], v[104:107], a[236:239], v[124:127]
    s_waitcnt lgkmcnt(0)
    v_mfma_f32_16x16x32_bf16 v[112:115], v[108:111], a[240:243], v[112:115]
    v_mfma_f32_16x16x32_bf16 v[116:119], v[108:111], a[244:247], v[116:119]
    v_mfma_f32_16x16x32_bf16 v[120:123], v[108:111], a[248:251], v[120:123]
    v_mfma_f32_16x16x32_bf16 v[124:127], v[108:111], a[252:255], v[124:127]
    s_nop 7
    s_nop 7
    v_cvt_pk_bf16_f32 v140, v112, v113
    v_cvt_pk_bf16_f32 v141, v114, v115
    v_cvt_pk_bf16_f32 v142, v116, v117
    v_cvt_pk_bf16_f32 v143, v118, v119
    v_cvt_pk_bf16_f32 v144, v120, v121
    v_cvt_pk_bf16_f32 v145, v122, v123
    v_cvt_pk_bf16_f32 v146, v124, v125
    v_cvt_pk_bf16_f32 v147, v126, v127
    ds_write_b64 v160, v[140:141] offset:8
    ds_write_b64 v160, v[142:143] offset:2056
    ds_write_b64 v160, v[144:145] offset:4104
    ds_write_b64 v160, v[146:147] offset:6152
    s_nop 1
    s_waitcnt lgkmcnt(0)
    ds_read_b128 v[64:67], v161 offset:0
    ds_read_b128 v[68:71], v161 offset:1024
    ds_read_b128 v[72:75], v161 offset:2048
    ds_read_b128 v[76:79], v161 offset:3072
    ds_read_b128 v[80:83], v161 offset:4096
    ds_read_b128 v[84:87], v161 offset:5120
    ds_read_b128 v[88:91], v161 offset:6144
    ds_read_b128 v[92:95], v161 offset:7168
    s_waitcnt vmcnt(0) lgkmcnt(0)
L_s2_loop:
    s_cmp_ge_u32 s40, 3
    s_cbranch_scc1 L_s2_nost
    s_add_u32 s51, s40, 1
    s_mul_i32 s45, s51, 40960
    s_mul_i32 s50, s20, 10240
    s_add_u32 s45, s45, s50
    s_add_u32 s45, s45, 2052096
    buffer_load_dwordx4 v[164:167], v2, s[4:7], s45 offen offset:0
    buffer_load_dwordx4 v[168:171], v2, s[4:7], s45 offen offset:1024
    buffer_load_dwordx4 v[172:175], v2, s[4:7], s45 offen offset:2048
    buffer_load_dwordx4 v[176:179], v2, s[4:7], s45 offen offset:3072
    s_add_u32 s45, s45, 4096
    buffer_load_dwordx4 v[180:183], v2, s[4:7], s45 offen offset:0
    buffer_load_dwordx4 v[184:187], v2, s[4:7], s45 offen offset:1024
    buffer_load_dwordx4 v[188:191], v2, s[4:7], s45 offen offset:2048
    buffer_load_dwordx4 v[128:131], v2, s[4:7], s45 offen offset:3072
    s_add_u32 s45, s45, 4096
    buffer_load_dwordx4 v[132:135], v2, s[4:7], s45 offen offset:0
    buffer_load_dwordx4 v[136:139], v2, s[4:7], s45 offen offset:1024
L_s2_nost:
    s_mul_i32 s41, s40, 10240
    s_add_u32 s41, s41, 8192
    s_mov_b32 s42, 0
L_s2_poll:
    buffer_load_dwordx4 v[12:15], v4, s[4:7], s41 offen sc1
    buffer_load_dwordx4 v[16:19], v4, s[4:7], s41 offen offset:1024 sc1
    s_mov_b64 exec, s[60:61]
    buffer_load_dwordx4 v[20:23], v4, s[4:7], s41 offen offset:2048 sc1
    s_mov_b64 exec, -1
L_s2_chk:
    s_waitcnt vmcnt(0)
    v_max3_u32 v24, v12, v13, v14
    v_max3_u32 v25, v15, v16, v17
    v_max3_u32 v24, v24, v18, v19
    v_max3_u32 v25, v25, v20, v21
    v_max3_u32 v24, v24, v22, v23
    v_max_u32 v24, v24, v25
    v_cmp_eq_u32 vcc, -1, v24
    s_cbranch_vccz L_s2_ok
    s_add_u32 s42, s42, 1
    s_cmp_lt_u32 s42, s44
    s_cbranch_scc1 L_s2_poll
    s_mov_b32 s44, 0
L_s2_ok:
    ds_write_b128 v4, v[12:15] offset:0
    ds_write_b128 v4, v[16:19] offset:1024
    s_mov_b64 exec, s[60:61]
    ds_write_b128 v4, v[20:23] offset:2048
    s_mov_b64 exec, -1
    s_cmp_ge_u32 s40, 3
    s_cbranch_scc1 L_s2_nosw
    ds_write_b128 v163, v[164:167] offset:0
    ds_write_b128 v163, v[168:171] offset:1024
    ds_write_b128 v163, v[172:175] offset:2048
    ds_write_b128 v163, v[176:179] offset:3072
    ds_write_b128 v163, v[180:183] offset:4096
    ds_write_b128 v163, v[184:187] offset:5120
    ds_write_b128 v163, v[188:191] offset:6144
    ds_write_b128 v163, v[128:131] offset:7168
    ds_write_b128 v163, v[132:135] offset:8192
    ds_write_b128 v163, v[136:139] offset:9216
L_s2_nosw:
    s_waitcnt lgkmcnt(0)
    s_barrier
    s_add_u32 s50, s40, 1
    s_min_u32 s52, s50, 63
    s_lshr_b32 s45, s52, 2
    s_lshl_b32 s45, s45, 9
    s_add_u32 s68, s45, 2019328
    buffer_load_dwordx2 v[20:21], v1, s[4:7], s68 offen sc1
    ds_read2_b64 v[96:99], v9 offset0:0 offset1:32
    ds_read2_b64 v[100:103], v9 offset0:64 offset1:96
    ds_read2_b64 v[104:107], v9 offset0:128 offset1:160
    ds_read2_b64 v[108:111], v9 offset0:192 offset1:224
    s_waitcnt lgkmcnt(3)
    v_mfma_f32_16x16x32_bf16 v[112:115], v[96:99], v[192:195], 0
    v_mfma_f32_16x16x32_bf16 v[116:119], v[96:99], v[196:199], 0
    v_mfma_f32_16x16x32_bf16 v[120:123], v[96:99], v[200:203], 0
    v_mfma_f32_16x16x32_bf16 v[124:127], v[96:99], v[204:207], 0
    ds_read2_b64 v[96:99], v148 offset0:0 offset1:32
    s_waitcnt lgkmcnt(3)
    v_mfma_f32_16x16x32_bf16 v[112:115], v[100:103], v[208:211], v[112:115]
    v_mfma_f32_16x16x32_bf16 v[116:119], v[100:103], v[212:215], v[116:119]
    v_mfma_f32_16x16x32_bf16 v[120:123], v[100:103], v[216:219], v[120:123]
    v_mfma_f32_16x16x32_bf16 v[124:127], v[100:103], v[220:223], v[124:127]
    ds_read2_b64 v[100:103], v148 offset0:64 offset1:96
    s_waitcnt lgkmcnt(3)
    v_mfma_f32_16x16x32_bf16 v[112:115], v[104:107], v[224:227], v[112:115]
    v_mfma_f32_16x16x32_bf16 v[116:119], v[104:107], v[228:231], v[116:119]
    v_mfma_f32_16x16x32_bf16 v[120:123], v[104:107], v[232:235], v[120:123]
    v_mfma_f32_16x16x32_bf16 v[124:127], v[104:107], v[236:239], v[124:127]
    ds_read2_b64 v[104:107], v148 offset0:128 offset1:160
    s_waitcnt lgkmcnt(3)
    v_mfma_f32_16x16x32_bf16 v[112:115], v[108:111], v[240:243], v[112:115]
    v_mfma_f32_16x16x32_bf16 v[116:119], v[108:111], v[244:247], v[116:119]
    v_mfma_f32_16x16x32_bf16 v[120:123], v[108:111], v[248:251], v[120:123]
    v_mfma_f32_16x16x32_bf16 v[124:127], v[108:111], v[252:255], v[124:127]
    ds_read2_b64 v[108:111], v148 offset0:192 offset1:224
    s_waitcnt lgkmcnt(3)
    v_mfma_f32_16x16x32_bf16 v[112:115], v[96:99], a[0:3], v[112:115]
    v_mfma_f32_16x16x32_bf16 v[116:119], v[96:99], a[4:7], v[116:119]
    v_mfma_f32_16x16x32_bf16 v[120:123], v[96:99], a[8:11], v[120:123]
    v_mfma_f32_16x16x32_bf16 v[124:127], v[96:99], a[12:15], v[124:127]
    ds_read2_b64 v[96:99], v149 offset0:0 offset1:32
    s_waitcnt lgkmcnt(3)
    v_mfma_f32_16x16x32_bf16 v[112:115], v[100:103], a[16:19], v[112:115]
    v_mfma_f32_16x16x32_bf16 v[116:119], v[100:103], a[20:23], v[116:119]
    v_mfma_f32_16x16x32_bf16 v[120:123], v[100:103], a[24:27], v[120:123]
    v_mfma_f32_16x16x32_bf16 v[124:127], v[100:103], a[28:31], v[124:127]
    ds_read2_b64 v[100:103], v149 offset0:64 offset1:96
    s_waitcnt lgkmcnt(3)
    v_mfma_f32_16x16x32_bf16 v[112:115], v[104:107], a[32:35], v[112:115]
    v_mfma_f32_16x16x32_bf16 v[116:119], v[104:107], a[36:39], v[116:119]
    v_mfma_f32_16x16x32_bf16 v[120:123], v[104:107], a[40:43], v[120:123]
    v_mfma_f32_16x16x32_bf16 v[124:127], v[104:107], a[44:47], v[124:127]
    ds_read2_b64 v[104:107], v149 offset0:128 offset1:160
    s_waitcnt lgkmcnt(3)
    v_mfma_f32_16x16x32_bf16 v[112:115], v[108:111], a[48:51], v[112:115]
    v_mfma_f32_16x16x32_bf16 v[116:119], v[108:111], a[52:55], v[116:119]
    v_mfma_f32_16x16x32_bf16 v[120:123], v[108:111], a[56:59], v[120:123]
    v_mfma_f32_16x16x32_bf16 v[124:127], v[108:111], a[60:63], v[124:127]
    ds_read2_b64 v[108:111], v149 offset0:192 offset1:224
    s_waitcnt lgkmcnt(3)
    v_mfma_f32_16x16x32_bf16 v[112:115], v[96:99], a[64:67], v[112:115]
    v_mfma_f32_16x16x32_bf16 v[116:119], v[96:99], a[68:71], v[116:119]
    v_mfma_f32_16x16x32_bf16 v[120:123], v[96:99], a[72:75], v[120:123]
    v_mfma_f32_16x16x32_bf16 v[124:127], v[96:99], a[76:79], v[124:127]
    ds_read2_b64 v[96:99], v150 offset0:0 offset1:32
    s_waitcnt lgkmcnt(3)
    v_mfma_f32_16x16x32_bf16 v[112:115], v[100:103], a[80:83], v[112:115]
    v_mfma_f32_16x16x32_bf16 v[116:119], v[100:103], a[84:87], v[116:119]
    v_mfma_f32_16x16x32_bf16 v[120:123], v[100:103], a[88:91], v[120:123]
    v_mfma_f32_16x16x32_bf16 v[124:127], v[100:103], a[92:95], v[124:127]
    ds_read2_b64 v[100:103], v150 offset0:64 offset1:96
    s_waitcnt lgkmcnt(3)
    v_mfma_f32_16x16x32_bf16 v[112:115], v[104:107], a[96:99], v[112:115]
    v_mfma_f32_16x16x32_bf16 v[116:119], v[104:107], a[100:103], v[116:119]
    v_mfma_f32_16x16x32_bf16 v[120:123], v[104:107], a[104:107], v[120:123]
    v_mfma_f32_16x16x32_bf16 v[124:127], v[104:107], a[108:111], v[124:127]
    ds_read2_b64 v[104:107], v150 offset0:128 offset1:160
    s_waitcnt lgkmcnt(3)
    v_mfma_f32_16x16x32_bf16 v[112:115], v[108:111], a[112:115], v[112:115]
    v_mfma_f32_16x16x32_bf16 v[116:119], v[108:111], a[116:119], v[116:119]
    v_mfma_f32_16x16x32_bf16 v[120:123], v[108:111], a[120:123], v[120:123]
    v_mfma_f32_16x16x32_bf16 v[124:127], v[108:111], a[124:127], v[124:127]
    ds_read2_b64 v[108:111], v150 offset0:192 offset1:224
    s_waitcnt lgkmcnt(3)
    v_mfma_f32_16x16x32_bf16 v[112:115], v[96:99], a[128:131], v[112:115]
    v_mfma_f32_16x16x32_bf16 v[116:119], v[96:99], a[132:135], v[116:119]
    v_mfma_f32_16x16x32_bf16 v[120:123], v[96:99], a[136:139], v[120:123]
    v_mfma_f32_16x16x32_bf16 v[124:127], v[96:99], a[140:143], v[124:127]
    ds_read2_b64 v[96:99], v151 offset0:0 offset1:32
    s_waitcnt lgkmcnt(3)
    v_mfma_f32_16x16x32_bf16 v[112:115], v[100:103], a[144:147], v[112:115]
    v_mfma_f32_16x16x32_bf16 v[116:119], v[100:103], a[148:151], v[116:119]
    v_mfma_f32_16x16x32_bf16 v[120:123], v[100:103], a[152:155], v[120:123]
    v_mfma_f32_16x16x32_bf16 v[124:127], v[100:103], a[156:159], v[124:127]
    ds_read2_b64 v[100:103], v151 offset0:64 offset1:96
    s_waitcnt lgkmcnt(3)
    v_mfma_f32_16x16x32_bf16 v[112:115], v[104:107], a[160:163], v[112:115]
    v_mfma_f32_16x16x32_bf16 v[116:119], v[104:107], a[164:167], v[116:119]
    v_mfma_f32_16x16x32_bf16 v[120:123], v[104:107], a[168:171], v[120:123]
    v_mfma_f32_16x16x32_bf16 v[124:127], v[104:107], a[172:175], v[124:127]
    ds_read2_b64 v[104:107], v151 offset0:128 offset1:160
    s_waitcnt lgkmcnt(3)
    v_mfma_f32_16x16x32_bf16 v[112:115], v[108:111], a[176:179], v[112:115]
    v_mfma_f32_16x16x32_bf16 v[116:119], v[108:111], a[180:183], v[116:119]
    v_mfma_f32_16x16x32_bf16 v[120:123], v[108:111], a[184:187], v[120:123]
    v_mfma_f32_16x16x32_bf16 v[124:127], v[108:111], a[188:191], v[124:127]
    ds_read2_b64 v[108:111], v151 offset0:192 offset1:224
    s_waitcnt lgkmcnt(3)
    v_mfma_f32_16x16x32_bf16 v[112:115], v[96:99], a[192:195], v[112:115]
    v_mfma_f32_16x16x32_bf16 v[116:119], v[96:99], a[196:199], v[116:119]
    v_mfma_f32_16x16x32_bf16 v[120:123], v[96:99], a[200:203], v[120:123]
    v_mfma_f32_16x16x32_bf16 v[124:127], v[96:99], a[204:207], v[124:127]
    s_waitcnt lgkmcnt(2)
    v_mfma_f32_16x16x32_bf16 v[112:115], v[100:103], a[208:211], v[112:115]
    v_mfma_f32_16x16x32_bf16 v[116:119], v[100:103], a[212:215], v[116:119]
    v_mfma_f32_16x16x32_bf16 v[120:123], v[100:103], a[216:219], v[120:123]
    v_mfma_f32_16x16x32_bf16 v[124:127], v[100:103], a[220:223], v[124:127]
    s_waitcnt lgkmcnt(1)
    v_mfma_f32_16x16x32_bf16 v[112:115], v[104:107], a[224:227], v[112:115]
    v_mfma_f32_16x16x32_bf16 v[116:119], v[104:107], a[228:231], v[116:119]
    v_mfma_f32_16x16x32_bf16 v[120:123], v[104:107], a[232:235], v[120:123]
    v_mfma_f32_16x16x32_bf16 v[124:127], v[104:107], a[236:239], v[124:127]
    s_waitcnt lgkmcnt(0)
    v_mfma_f32_16x16x32_bf16 v[112:115], v[108:111], a[240:243], v[112:115]
    v_mfma_f32_16x16x32_bf16 v[116:119], v[108:111], a[244:247], v[116:119]
    v_mfma_f32_16x16x32_bf16 v[120:123], v[108:111], a[248:251], v[120:123]
    v_mfma_f32_16x16x32_bf16 v[124:127], v[108:111], a[252:255], v[124:127]
    s_nop 7
    s_nop 3
    s_lshl_b32 s45, s40, 3
    s_lshl_b32 s50, s20, 1
    s_add_u32 s45, s45, s50
    s_mul_i32 s45, s45, 40
    s_add_u32 s45, s45, s22
    s_lshl_b32 s45, s45, 10
    s_add_u32 s45, s45, 213078016
    s_add_u32 s50, s45, 40960
    v_cvt_pk_bf16_f32 v140, v112, v113
    v_cvt_pk_bf16_f32 v141, v114, v115
    v_cvt_pk_bf16_f32 v142, v116, v117
    v_cvt_pk_bf16_f32 v143, v118, v119
    v_cvt_pk_bf16_f32 v144, v120, v121
    v_cvt_pk_bf16_f32 v145, v122, v123
    v_cvt_pk_bf16_f32 v146, v124, v125
    v_cvt_pk_bf16_f32 v147, v126, v127
    s_mov_b64 exec, s[60:61]
    ds_write_b64 v11, v[140:141] offset:0
    buffer_store_dwordx2 v[140:141], v10, s[4:7], s45 offen offset:0 sc1
    ds_write_b64 v11, v[142:143] offset:512
    buffer_store_dwordx2 v[142:143], v10, s[4:7], s45 offen offset:512 sc1
    ds_write_b64 v11, v[144:145] offset:1024
    buffer_store_dwordx2 v[144:145], v10, s[4:7], s50 offen offset:0 sc1
    ds_write_b64 v11, v[146:147] offset:1536
    buffer_store_dwordx2 v[146:147], v10, s[4:7], s50 offen offset:512 sc1
    s_mov_b64 exec, -1
    ds_read_b128 v[132:135], v152
    ds_read_b128 v[136:139], v152 offset:1024
    s_cmp_ge_u32 s40, 3
    s_cbranch_scc1 L_s2_notok
    ds_read_b64 v[96:97], v162 offset:0
    ds_read_b64 v[98:99], v162 offset:512
    ds_read_b64 v[100:101], v162 offset:1024
    ds_read_b64 v[102:103], v162 offset:1536
    ds_read_b64 v[104:105], v162 offset:2048
    ds_read_b64 v[106:107], v162 offset:2560
    ds_read_b64 v[108:109], v162 offset:3072
    ds_read_b64 v[110:111], v162 offset:3584
    s_waitcnt lgkmcnt(6)
    v_mfma_f32_16x16x32_bf16 v[112:115], v[96:99], v[192:195], 0
    v_mfma_f32_16x16x32_bf16 v[116:119], v[96:99], v[196:199], 0
    v_mfma_f32_16x16x32_bf16 v[120:123], v[96:99], v[200:203], 0
    v_mfma_f32_16x16x32_bf16 v[124:127], v[96:99], v[204:207], 0
    ds_read_b64 v[96:97], v162 offset:4096
    ds_read_b64 v[98:99], v162 offset:4608
    s_waitcnt lgkmcnt(6)
    v_mfma_f32_16x16x32_bf16 v[112:115], v[100:103], v[208:211], v[112:115]
    v_mfma_f32_16x16x32_bf16 v[116:119], v[100:103], v[212:215], v[116:119]
    v_mfma_f32_16x16x32_bf16 v[120:123], v[100:103], v[216:219], v[120:123]
    v_mfma_f32_16x16x32_bf16 v[124:127], v[100:103], v[220:223], v[124:127]
    ds_read_b64 v[100:101], v162 offset:5120
    ds_read_b64 v[102:103], v162 offset:5632
    s_waitcnt lgkmcnt(6)
    v_mfma_f32_16x16x32_bf16 v[112:115], v[104:107], v[224:227], v[112:115]
    v_mfma_f32_16x16x32_bf16 v[116:119], v[104:107], v[228:231], v[116:119]
    v_mfma_f32_16x16x32_bf16 v[120:123], v[104:107], v[232:235], v[120:123]
    v_mfma_f32_16x16x32_bf16 v[124:127], v[104:107], v[236:239], v[124:127]
    ds_read_b64 v[104:105], v162 offset:6144
    ds_read_b64 v[106:107], v162 offset:6656
    s_waitcnt lgkmcnt(6)
    v_mfma_f32_16x16x32_bf16 v[112:115], v[108:111], v[240:243], v[112:115]
    v_mfma_f32_16x16x32_bf16 v[116:119], v[108:111], v[244:247], v[116:119]
    v_mfma_f32_16x16x32_bf16 v[120:123], v[108:111], v[248:251], v[120:123]
    v_mfma_f32_16x16x32_bf16 v[124:127], v[108:111], v[252:255], v[124:127]
    ds_read_b64 v[108:109], v162 offset:7168
    ds_read_b64 v[110:111], v162 offset:7680
    s_waitcnt lgkmcnt(6)
    v_mfma_f32_16x16x32_bf16 v[112:115], v[96:99], a[0:3], v[112:115]
    v_mfma_f32_16x16x32_bf16 v[116:119], v[96:99], a[4:7], v[116:119]
    v_mfma_f32_16x16x32_bf16 v[120:123], v[96:99], a[8:11], v[120:123]
    v_mfma_f32_16x16x32_bf16 v[124:127], v[96:99], a[12:15], v[124:127]
    ds_read_b64 v[96:97], v162 offset:8192
    ds_read_b64 v[98:99], v162 offset:8704
    s_waitcnt lgkmcnt(6)
    v_mfma_f32_16x16x32_bf16 v[112:115], v[100:103], a[16:19], v[112:115]
    v_mfma_f32_16x16x32_bf16 v[116:119], v[100:103], a[20:23], v[116:119]
    v_mfma_f32_16x16x32_bf16 v[120:123], v[100:103], a[24:27], v[120:123]
    v_mfma_f32_16x16x32_bf16 v[124:127], v[100:103], a[28:31], v[124:127]
    ds_read_b64 v[100:101], v162 offset:9216
    ds_read_b64 v[102:103], v162 offset:9728
    s_waitcnt lgkmcnt(6)
    v_mfma_f32_16x16x32_bf16 v[112:115], v[104:107], a[32:35], v[112:115]
    v_mfma_f32_16x16x32_bf16 v[116:119], v[104:107], a[36:39], v[116:119]
    v_mfma_f32_16x16x32_bf16 v[120:123], v[104:107], a[40:43], v[120:123]
    v_mfma_f32_16x16x32_bf16 v[124:127], v[104:107], a[44:47], v[124:127]
    ds_read_b64 v[104:105], v162 offset:10240
    ds_read_b64 v[106:107], v162 offset:10752
    s_waitcnt lgkmcnt(6)
    v_mfma_f32_16x16x32_bf16 v[112:115], v[108:111], a[48:51], v[112:115]
    v_mfma_f32_16x16x32_bf16 v[116:119], v[108:111], a[52:55], v[116:119]
    v_mfma_f32_16x16x32_bf16 v[120:123], v[108:111], a[56:59], v[120:123]
    v_mfma_f32_16x16x32_bf16 v[124:127], v[108:111], a[60:63], v[124:127]
    ds_read_b64 v[108:109], v162 offset:11264
    ds_read_b64 v[110:111], v162 offset:11776
    s_waitcnt lgkmcnt(6)
    v_mfma_f32_16x16x32_bf16 v[112:115], v[96:99], a[64:67], v[112:115]
    v_mfma_f32_16x16x32_bf16 v[116:119], v[96:99], a[68:71], v[116:119]
    v_mfma_f32_16x16x32_bf16 v[120:123], v[96:99], a[72:75], v[120:123]
    v_mfma_f32_16x16x32_bf16 v[124:127], v[96:99], a[76:79], v[124:127]
    ds_read_b64 v[96:97], v162 offset:12288
    ds_read_b64 v[98:99], v162 offset:12800
    s_waitcnt lgkmcnt(6)
    v_mfma_f32_16x16x32_bf16 v[112:115], v[100:103], a[80:83], v[112:115]
    v_mfma_f32_16x16x32_bf16 v[116:119], v[100:103], a[84:87], v[116:119]
    v_mfma_f32_16x16x32_bf16 v[120:123], v[100:103], a[88:91], v[120:123]
    v_mfma_f32_16x16x32_bf16 v[124:127], v[100:103], a[92:95], v[124:127]
    ds_read_b64 v[100:101], v162 offset:13312
    ds_read_b64 v[102:103], v162 offset:13824
    s_waitcnt lgkmcnt(6)
    v_mfma_f32_16x16x32_bf16 v[112:115], v[104:107], a[96:99], v[112:115]
    v_mfma_f32_16x16x32_bf16 v[116:119], v[104:107], a[100:103], v[116:119]
    v_mfma_f32_16x16x32_bf16 v[120:123], v[104:107], a[104:107], v[120:123]
    v_mfma_f32_16x16x32_bf16 v[124:127], v[104:107], a[108:111], v[124:127]
    ds_read_b64 v[104:105], v162 offset:14336
    ds_read_b64 v[106:107], v162 offset:14848
    s_waitcnt lgkmcnt(6)
    v_mfma_f32_16x16x32_bf16 v[112:115], v[108:111], a[112:115], v[112:115]
    v_mfma_f32_16x16x32_bf16 v[116:119], v[108:111], a[116:119], v[116:119]
    v_mfma_f32_16x16x32_bf16 v[120:123], v[108:111], a[120:123], v[120:123]
    v_mfma_f32_16x16x32_bf16 v[124:127], v[108:111], a[124:127], v[124:127]
    ds_read_b64 v[108:109], v162 offset:15360
    ds_read_b64 v[110:111], v162 offset:15872
    s_waitcnt lgkmcnt(6)
    v_mfma_f32_16x16x32_bf16 v[112:115], v[96:99], a[128:131], v[112:115]
    v_mfma_f32_16x16x32_bf16 v[116:119], v[96:99], a[132:135], v[116:119]
    v_mfma_f32_16x16x32_bf16 v[120:123], v[96:99], a[136:139], v[120:123]
    v_mfma_f32_16x16x32_bf16 v[124:127], v[96:99], a[140:143], v[124:127]
    ds_read_b64 v[96:97], v162 offset:16384
    ds_read_b64 v[98:99], v162 offset:16896
    s_waitcnt lgkmcnt(6)
    v_mfma_f32_16x16x32_bf16 v[112:115], v[100:103], a[144:147], v[112:115]
    v_mfma_f32_16x16x32_bf16 v[116:119], v[100:103], a[148:151], v[116:119]
    v_mfma_f32_16x16x32_bf16 v[120:123], v[100:103], a[152:155], v[120:123]
    v_mfma_f32_16x16x32_bf16 v[124:127], v[100:103], a[156:159], v[124:127]
    ds_read_b64 v[100:101], v162 offset:17408
    ds_read_b64 v[102:103], v162 offset:17920
    s_waitcnt lgkmcnt(6)
    v_mfma_f32_16x16x32_bf16 v[112:115], v[104:107], a[160:163], v[112:115]
    v_mfma_f32_16x16x32_bf16 v[116:119], v[104:107], a[164:167], v[116:119]
    v_mfma_f32_16x16x32_bf16 v[120:123], v[104:107], a[168:171], v[120:123]
    v_mfma_f32_16x16x32_bf16 v[124:127], v[104:107], a[172:175], v[124:127]
    ds_read_b64 v[104:105], v162 offset:18432
    ds_read_b64 v[106:107], v162 offset:18944
    s_waitcnt lgkmcnt(6)
    v_mfma_f32_16x16x32_bf16 v[112:115], v[108:111], a[176:179], v[112:115]
    v_mfma_f32_16x16x32_bf16 v[116:119], v[108:111], a[180:183], v[116:119]
    v_mfma_f32_16x16x32_bf16 v[120:123], v[108:111], a[184:187], v[120:123]
    v_mfma_f32_16x16x32_bf16 v[124:127], v[108:111], a[188:191], v[124:127]
    ds_read_b64 v[108:109], v162 offset:19456
    ds_read_b64 v[110:111], v162 offset:19968
    s_waitcnt lgkmcnt(6)
    v_mfma_f32_16x16x32_bf16 v[112:115], v[96:99], a[192:195], v[112:115]
    v_mfma_f32_16x16x32_bf16 v[116:119], v[96:99], a[196:199], v[116:119]
    v_mfma_f32_16x16x32_bf16 v[120:123], v[96:99], a[200:203], v[120:123]
    v_mfma_f32_16x16x32_bf16 v[124:127], v[96:99], a[204:207], v[124:127]
    ds_read_b64 v[96:97], v162 offset:20480
    ds_read_b64 v[98:99], v162 offset:20992
    s_waitcnt lgkmcnt(6)
    v_mfma_f32_16x16x32_bf16 v[112:115], v[100:103], a[208:211], v[112:115]
    v_mfma_f32_16x16x32_bf16 v[116:119], v[100:103], a[212:215], v[116:119]
    v_mfma_f32_16x16x32_bf16 v[120:123], v[100:103], a[216:219], v[120:123]
    v_mfma_f32_16x16x32_bf16 v[124:127], v[100:103], a[220:223], v[124:127]
    ds_read_b64 v[100:101], v162 offset:21504
    ds_read_b64 v[102:103], v162 offset:22016
    s_waitcnt lgkmcnt(6)
    v_mfma_f32_16x16x32_bf16 v[112:115], v[104:107], a[224:227], v[112:115]
    v_mfma_f32_16x16x32_bf16 v[116:119], v[104:107], a[228:231], v[116:119]
    v_mfma_f32_16x16x32_bf16 v[120:123], v[104:107], a[232:235], v[120:123]
    v_mfma_f32_16x16x32_bf16 v[124:127], v[104:107], a[236:239], v[124:127]
    ds_read_b64 v[104:105], v162 offset:22528
    ds_read_b64 v[106:107], v162 offset:23040
    s_waitcnt lgkmcnt(6)
    v_mfma_f32_16x16x32_bf16 v[112:115], v[108:111], a[240:243], v[112:115]
    v_mfma_f32_16x16x32_bf16 v[116:119], v[108:111], a[244:247], v[116:119]
    v_mfma_f32_16x16x32_bf16 v[120:123], v[108:111], a[248:251], v[120:123]
    v_mfma_f32_16x16x32_bf16 v[124:127], v[108:111], a[252:255], v[124:127]
    s_nop 7
    s_nop 7
    v_cvt_pk_bf16_f32 v140, v112, v113
    v_cvt_pk_bf16_f32 v141, v114, v115
    v_cvt_pk_bf16_f32 v142, v116, v117
    v_cvt_pk_bf16_f32 v143, v118, v119
    v_cvt_pk_bf16_f32 v144, v120, v121
    v_cvt_pk_bf16_f32 v145, v122, v123
    v_cvt_pk_bf16_f32 v146, v124, v125
    v_cvt_pk_bf16_f32 v147, v126, v127
    ds_write_b64 v160, v[140:141] offset:0
    ds_write_b64 v160, v[142:143] offset:2048
    ds_write_b64 v160, v[144:145] offset:4096
    ds_write_b64 v160, v[146:147] offset:6144
    s_nop 1
    ds_read_b64 v[108:109], v162 offset:23552
    ds_read_b64 v[110:111], v162 offset:24064
    s_waitcnt lgkmcnt(10)
    v_mfma_f32_16x16x32_bf16 v[112:115], v[96:99], v[192:195], 0
    v_mfma_f32_16x16x32_bf16 v[116:119], v[96:99], v[196:199], 0
    v_mfma_f32_16x16x32_bf16 v[120:123], v[96:99], v[200:203], 0
    v_mfma_f32_16x16x32_bf16 v[124:127], v[96:99], v[204:207], 0
    ds_read_b64 v[96:97], v162 offset:24576
    ds_read_b64 v[98:99], v162 offset:25088
    s_waitcnt lgkmcnt(10)
    v_mfma_f32_16x16x32_bf16 v[112:115], v[100:103], v[208:211], v[112:115]
    v_mfma_f32_16x16x32_bf16 v[116:119], v[100:103], v[212:215], v[116:119]
    v_mfma_f32_16x16x32_bf16 v[120:123], v[100:103], v[216:219], v[120:123]
    v_mfma_f32_16x16x32_bf16 v[124:127], v[100:103], v[220:223], v[124:127]
    ds_read_b64 v[100:101], v162 offset:25600
    ds_read_b64 v[102:103], v162 offset:26112
    s_waitcnt lgkmcnt(10)
    v_mfma_f32_16x16x32_bf16 v[112:115], v[104:107], v[224:227], v[112:115]
    v_mfma_f32_16x16x32_bf16 v[116:119], v[104:107], v[228:231], v[116:119]
    v_mfma_f32_16x16x32_bf16 v[120:123], v[104:107], v[232:235], v[120:123]
    v_mfma_f32_16x16x32_bf16 v[124:127], v[104:107], v[236:239], v[124:127]
    ds_read_b64 v[104:105], v162 offset:26624
    ds_read_b64 v[106:107], v162 offset:27136
    s_waitcnt lgkmcnt(6)
    v_mfma_f32_16x16x32_bf16 v[112:115], v[108:111], v[240:243], v[112:115]
    v_mfma_f32_16x16x32_bf16 v[116:119], v[108:111], v[244:247], v[116:119]
    v_mfma_f32_16x16x32_bf16 v[120:123], v[108:111], v[248:251], v[120:123]
    v_mfma_f32_16x16x32_bf16 v[124:127], v[108:111], v[252:255], v[124:127]
    ds_read_b64 v[108:109], v162 offset:27648
    ds_read_b64 v[110:111], v162 offset:28160
    s_waitcnt lgkmcnt(6)
    v_mfma_f32_16x16x32_bf16 v[112:115], v[96:99], a[0:3], v[112:115]
    v_mfma_f32_16x16x32_bf16 v[116:119], v[96:99], a[4:7], v[116:119]
    v_mfma_f32_16x16x32_bf16 v[120:123], v[96:99], a[8:11], v[120:123]
    v_mfma_f32_16x16x32_bf16 v[124:127], v[96:99], a[12:15], v[124:127]
    ds_read_b64 v[96:97], v162 offset:28672
    ds_read_b64 v[98:99], v162 offset:29184
    s_waitcnt lgkmcnt(6)
    v_mfma_f32_16x16x32_bf16 v[112:115], v[100:103], a[16:19], v[112:115]
    v_mfma_f32_16x16x32_bf16 v[116:119], v[100:103], a[20:23], v[116:119]
    v_mfma_f32_16x16x32_bf16 v[120:123], v[100:103], a[24:27], v[120:123]
    v_mfma_f32_16x16x32_bf16 v[124:127], v[100:103], a[28:31], v[124:127]
    ds_read_b64 v[100:101], v162 offset:29696
    ds_read_b64 v[102:103], v162 offset:30208
    s_waitcnt lgkmcnt(6)
    v_mfma_f32_16x16x32_bf16 v[112:115], v[104:107], a[32:35], v[112:115]
    v_mfma_f32_16x16x32_bf16 v[116:119], v[104:107], a[36:39], v[116:119]
    v_mfma_f32_16x16x32_bf16 v[120:123], v[104:107], a[40:43], v[120:123]
    v_mfma_f32_16x16x32_bf16 v[124:127], v[104:107], a[44:47], v[124:127]
    ds_read_b64 v[104:105], v162 offset:30720
    ds_read_b64 v[106:107], v162 offset:31232
    s_waitcnt lgkmcnt(6)
    v_mfma_f32_16x16x32_bf16 v[112:115], v[108:111], a[48:51], v[112:115]
    v_mfma_f32_16x16x32_bf16 v[116:119], v[108:111], a[52:55], v[116:119]
    v_mfma_f32_16x16x32_bf16 v[120:123], v[108:111], a[56:59], v[120:123]
    v_mfma_f32_16x16x32_bf16 v[124:127], v[108:111], a[60:63], v[124:127]
    ds_read_b64 v[108:109], v162 offset:31744
    ds_read_b64 v[110:111], v162 offset:32256
    s_waitcnt lgkmcnt(6)
    v_mfma_f32_16x16x32_bf16 v[112:115], v[96:99], a[64:67], v[112:115]
    v_mfma_f32_16x16x32_bf16 v[116:119], v[96:99], a[68:71], v[116:119]
    v_mfma_f32_16x16x32_bf16 v[120:123], v[96:99], a[72:75], v[120:123]
    v_mfma_f32_16x16x32_bf16 v[124:127], v[96:99], a[76:79], v[124:127]
    ds_read_b64 v[96:97], v162 offset:32768
    ds_read_b64 v[98:99], v162 offset:33280
    s_waitcnt lgkmcnt(6)
    v_mfma_f32_16x16x32_bf16 v[112:115], v[100:103], a[80:83], v[112:115]
    v_mfma_f32_16x16x32_bf16 v[116:119], v[100:103], a[84:87], v[116:119]
    v_mfma_f32_16x16x32_bf16 v[120:123], v[100:103], a[88:91], v[120:123]
    v_mfma_f32_16x16x32_bf16 v[124:127], v[100:103], a[92:95], v[124:127]
    ds_read_b64 v[100:101], v162 offset:33792
    ds_read_b64 v[102:103], v162 offset:34304
    s_waitcnt lgkmcnt(6)
    v_mfma_f32_16x16x32_bf16 v[112:115], v[104:107], a[96:99], v[112:115]
    v_mfma_f32_16x16x32_bf16 v[116:119], v[104:107], a[100:103], v[116:119]
    v_mfma_f32_16x16x32_bf16 v[120:123], v[104:107], a[104:107], v[120:123]
    v_mfma_f32_16x16x32_bf16 v[124:127], v[104:107], a[108:111], v[124:127]
    ds_read_b64 v[104:105], v162 offset:34816
    ds_read_b64 v[106:107], v162 offset:35328
    s_waitcnt lgkmcnt(6)
    v_mfma_f32_16x16x32_bf16 v[112:115], v[108:111], a[112:115], v[112:115]
    v_mfma_f32_16x16x32_bf16 v[116:119], v[108:111], a[116:119], v[116:119]
    v_mfma_f32_16x16x32_bf16 v[120:123], v[108:111], a[120:123], v[120:123]
    v_mfma_f32_16x16x32_bf16 v[124:127], v[108:111], a[124:127], v[124:127]
    ds_read_b64 v[108:109], v162 offset:35840
    ds_read_b64 v[110:111], v162 offset:36352
    s_waitcnt lgkmcnt(6)
    v_mfma_f32_16x16x32_bf16 v[112:115], v[96:99], a[128:131], v[112:115]
    v_mfma_f32_16x16x32_bf16 v[116:119], v[96:99], a[132:135], v[116:119]
    v_mfma_f32_16x16x32_bf16 v[120:123], v[96:99], a[136:139], v[120:123]
    v_mfma_f32_16x16x32_bf16 v[124:127], v[96:99], a[140:143], v[124:127]
    ds_read_b64 v[96:97], v162 offset:36864
    ds_read_b64 v[98:99], v162 offset:37376
    s_waitcnt lgkmcnt(6)
    v_mfma_f32_16x16x32_bf16 v[112:115], v[100:103], a[144:147], v[112:115]
    v_mfma_f32_16x16x32_bf16 v[116:119], v[100:103], a[148:151], v[116:119]
    v_mfma_f32_16x16x32_bf16 v[120:123], v[100:103], a[152:155], v[120:123]
    v_mfma_f32_16x16x32_bf16 v[124:127], v[100:103], a[156:159], v[124:127]
    ds_read_b64 v[100:101], v162 offset:37888
    ds_read_b64 v[102:103], v162 offset:38400
    s_waitcnt lgkmcnt(6)
    v_mfma_f32_16x16x32_bf16 v[112:115], v[104:107], a[160:163], v[112:115]
    v_mfma_f32_16x16x32_bf16 v[116:119], v[104:107], a[164:167], v[116:119]
    v_mfma_f32_16x16x32_bf16 v[120:123], v[104:107], a[168:171], v[120:123]
    v_mfma_f32_16x16x32_bf16 v[124:127], v[104:107], a[172:175], v[124:127]
    ds_read_b64 v[104:105], v162 offset:38912
    ds_read_b64 v[106:107], v162 offset:39424
    s_waitcnt lgkmcnt(6)
    v_mfma_f32_16x16x32_bf16 v[112:115], v[108:111], a[176:179], v[112:115]
    v_mfma_f32_16x16x32_bf16 v[116:119], v[108:111], a[180:183], v[116:119]
    v_mfma_f32_16x16x32_bf16 v[120:123], v[108:111], a[184:187], v[120:123]
    v_mfma_f32_16x16x32_bf16 v[124:127], v[108:111], a[188:191], v[124:127]
    ds_read_b64 v[108:109], v162 offset:39936
    ds_read_b64 v[110:111], v162 offset:40448
    s_waitcnt lgkmcnt(6)
    v_mfma_f32_16x16x32_bf16 v[112:115], v[96:99], a[192:195], v[112:115]
    v_mfma_f32_16x16x32_bf16 v[116:119], v[96:99], a[196:199], v[116:119]
    v_mfma_f32_16x16x32_bf16 v[120:123], v[96:99], a[200:203], v[120:123]
    v_mfma_f32_16x16x32_bf16 v[124:127], v[96:99], a[204:207], v[124:127]
    s_waitcnt lgkmcnt(4)
    v_mfma_f32_16x16x32_bf16 v[112:115], v[100:103], a[208:211], v[112:115]
    v_mfma_f32_16x16x32_bf16 v[116:119], v[100:103], a[212:215], v[116:119]
    v_mfma_f32_16x16x32_bf16 v[120:123], v[100:103], a[216:219], v[120:123]
    v_mfma_f32_16x16x32_bf16 v[124:127], v[100:103], a[220:223], v[124:127]
    s_waitcnt lgkmcnt(2)
    v_mfma_f32_16x16x32_bf16 v[112:115], v[104:107], a[224:227], v[112:115]
    v_mfma_f32_16x16x32_bf16 v[116:119], v[104:107], a[228:231], v[116:119]
    v_mfma_f32_16x16x32_bf16 v[120:123], v[104:107], a[232:235], v[120:123]
    v_mfma_f32_16x16x32_bf16 v[124:127], v[104:107], a[236:239], v[124:127]
    s_waitcnt lgkmcnt(0)
    v_mfma_f32_16x16x32_bf16 v[112:115], v[108:111], a[240:243], v[112:115]
    v_mfma_f32_16x16x32_bf16 v[116:119], v[108:111], a[244:247], v[116:119]
    v_mfma_f32_16x16x32_bf16 v[120:123], v[108:111], a[248:251], v[120:123]
    v_mfma_f32_16x16x32_bf16 v[124:127], v[108:111], a[252:255], v[124:127]
    s_nop 7
    s_nop 7
    v_cvt_pk_bf16_f32 v140, v112, v113
    v_cvt_pk_bf16_f32 v141, v114, v115
    v_cvt_pk_bf16_f32 v142, v116, v117
    v_cvt_pk_bf16_f32 v143, v118, v119
    v_cvt_pk_bf16_f32 v144, v120, v121
    v_cvt_pk_bf16_f32 v145, v122, v123
    v_cvt_pk_bf16_f32 v146, v124, v125
    v_cvt_pk_bf16_f32 v147, v126, v127
    ds_write_b64 v160, v[140:141] offset:8
    ds_write_b64 v160, v[142:143] offset:2056
    ds_write_b64 v160, v[144:145] offset:4104
    ds_write_b64 v160, v[146:147] offset:6152
    s_nop 1
L_s2_notok:
    s_mul_i32 s45, s40, 20480
    s_add_u32 s45, s45, 675840
    s_mul_i32 s50, s20, 5120
    s_add_u32 s45, s45, s50
    s_add_u32 s50, s45, 2560
    s_mov_b32 s43, 18
    L_dl_pd0:
    s_nop 15
    s_sub_u32 s43, s43, 1
    s_cmp_lg_u32 s43, 0
    s_cbranch_scc1 L_dl_pd0
    s_mov_b32 s42, 0
L_s2_ppoll:
    buffer_load_dwordx4 v[24:27], v154, s[4:7], s45 offen offset:128 sc1
    buffer_load_dwordx4 v[28:31], v154, s[4:7], s45 offen offset:1408 sc1
    buffer_load_dwordx4 v[32:35], v154, s[4:7], s50 offen offset:128 sc1
    buffer_load_dwordx4 v[36:39], v154, s[4:7], s50 offen offset:1408 sc1
    buffer_load_dwordx4 v[56:59], v155, s[4:7], s45 offen sc1
    s_waitcnt vmcnt(0)
    v_max3_u32 v12, v24, v25, v26
    v_max3_u32 v13, v27, v28, v29
    v_max3_u32 v12, v12, v30, v31
    v_max3_u32 v13, v13, v32, v33
    v_max3_u32 v12, v12, v34, v35
    v_max3_u32 v13, v13, v36, v37
    v_max3_u32 v12, v12, v38, v39
    v_max3_u32 v13, v13, v56, v57
    v_max3_u32 v12, v12, v58, v59
    v_max_u32 v12, v12, v13
    v_cmp_eq_u32 vcc, -1, v12
    s_cbranch_vccz L_s2_pok
    s_add_u32 s42, s42, 1
    s_cmp_lt_u32 s42, s44
    s_cbranch_scc1 L_s2_ppoll
    s_mov_b32 s44, 0
L_s2_pok:
    s_waitcnt lgkmcnt(0)
    v_mfma_f32_16x16x32_bf16 v[128:131], v[64:67], v[24:27], 0
    v_mfma_f32_16x16x32_bf16 v[112:115], v[68:71], v[24:27], 0
    v_mfma_f32_16x16x32_bf16 v[128:131], v[72:75], v[28:31], v[128:131]
    v_mfma_f32_16x16x32_bf16 v[112:115], v[76:79], v[28:31], v[112:115]
    v_mfma_f32_16x16x32_bf16 v[128:131], v[80:83], v[32:35], v[128:131]
    v_mfma_f32_16x16x32_bf16 v[112:115], v[84:87], v[32:35], v[112:115]
    v_mfma_f32_16x16x32_bf16 v[128:131], v[88:91], v[36:39], v[128:131]
    v_mfma_f32_16x16x32_bf16 v[112:115], v[92:95], v[36:39], v[112:115]
    v_mfma_f32_16x16x32_bf16 v[128:131], v[132:135], v[56:59], v[128:131]
    v_mfma_f32_16x16x32_bf16 v[112:115], v[136:139], v[56:59], v[112:115]
    s_nop 7
    s_nop 3
    v_add_f32_dpp v128, v112, v128 row_ror:8 row_mask:0xf bank_mask:0xf
    v_add_f32_dpp v129, v113, v129 row_ror:8 row_mask:0xf bank_mask:0xf
    v_add_f32_dpp v130, v114, v130 row_ror:8 row_mask:0xf bank_mask:0xf
    v_add_f32_dpp v131, v115, v131 row_ror:8 row_mask:0xf bank_mask:0xf
    ds_write_b128 v156, v[128:131] offset:10240
    s_waitcnt lgkmcnt(0)
    s_barrier
    s_cmp_lg_u32 s20, 0
    s_cbranch_scc1 L_s2_next
    ds_read_b128 v[112:115], v158 offset:10240
    ds_read_b128 v[116:119], v158 offset:11264
    ds_read_b128 v[120:123], v158 offset:12288
    ds_read_b128 v[124:127], v158 offset:13312
    s_waitcnt lgkmcnt(2)
    v_add_f32 v112, v112, v116
    v_add_f32 v113, v113, v117
    v_add_f32 v114, v114, v118
    v_add_f32 v115, v115, v119
    s_waitcnt lgkmcnt(0)
    v_add_f32 v120, v120, v124
    v_add_f32 v121, v121, v125
    v_add_f32 v122, v122, v126
    v_add_f32 v123, v123, v127
    v_add_f32 v112, v112, v120
    v_add_f32 v113, v113, v121
    v_add_f32 v114, v114, v122
    v_add_f32 v115, v115, v123
    v_cvt_pk_bf16_f32 v112, v112, v113
    v_cvt_pk_bf16_f32 v113, v114, v115
    v_min_u32 v112, 0xfffffffe, v112
    v_min_u32 v113, 0xfffffffe, v113
    s_add_u32 s45, s40, 1
    s_mul_i32 s45, s45, 10240
    s_add_u32 s45, s45, 8192
    s_mov_b64 exec, s[62:63]
    buffer_store_dwordx2 v[112:113], v159, s[4:7], s45 offen sc1
    s_mov_b64 exec, -1
L_s2_next:
    s_cmp_ge_u32 s40, 3
    s_cbranch_scc1 L_s2_vtn
    s_waitcnt lgkmcnt(0)
    ds_read_b128 v[64:67], v161 offset:0
    ds_read_b128 v[68:71], v161 offset:1024
    ds_read_b128 v[72:75], v161 offset:2048
    ds_read_b128 v[76:79], v161 offset:3072
    ds_read_b128 v[80:83], v161 offset:4096
    ds_read_b128 v[84:87], v161 offset:5120
    ds_read_b128 v[88:91], v161 offset:6144
    ds_read_b128 v[92:95], v161 offset:7168
    s_branch L_s2_vtd
L_s2_vtn:
    s_cmp_lt_u32 s40, 11
    s_cselect_b32 s92, 0xffff, -1
    s_cselect_b32 s93, 0, -1
    s_mov_b32 s42, 0
L_s2l_fl:
    v_and_b32 v20, v20, v21
    v_cmp_ne_u32 vcc, 1, v20
    s_and_b64 vcc, vcc, s[92:93]
    s_cbranch_vccz L_s2l_flok
    s_add_u32 s42, s42, 1
    s_cmp_lt_u32 s42, s44
    s_cbranch_scc0 L_s2l_flto
    buffer_load_dwordx2 v[20:21], v1, s[4:7], s68 offen sc1
    s_waitcnt vmcnt(0)
    s_branch L_s2l_fl
L_s2l_flto:
    s_mov_b32 s44, 0
L_s2l_flok:
    s_add_u32 s50, s40, 1
    s_min_u32 s52, s50, 63
    s_lshl_b32 s45, s52, 5
    s_lshl_b32 s50, s20, 3
    s_add_u32 s45, s45, s50
    s_mul_i32 s45, s45, 40
    s_add_u32 s45, s45, s22
    s_lshl_b32 s45, s45, 10
    s_add_u32 s45, s45, 90394624
    buffer_load_dwordx4 v[64:67], v2, s[4:7], s45 offen
    s_add_u32 s45, s45, 40960
    buffer_load_dwordx4 v[68:71], v2, s[4:7], s45 offen
    s_add_u32 s45, s45, 40960
    buffer_load_dwordx4 v[72:75], v2, s[4:7], s45 offen
    s_add_u32 s45, s45, 40960
    buffer_load_dwordx4 v[76:79], v2, s[4:7], s45 offen
    s_add_u32 s45, s45, 40960
    buffer_load_dwordx4 v[80:83], v2, s[4:7], s45 offen
    s_add_u32 s45, s45, 40960
    buffer_load_dwordx4 v[84:87], v2, s[4:7], s45 offen
    s_add_u32 s45, s45, 40960
    buffer_load_dwordx4 v[88:91], v2, s[4:7], s45 offen
    s_add_u32 s45, s45, 40960
    buffer_load_dwordx4 v[92:95], v2, s[4:7], s45 offen
L_s2_vtd:
    s_add_u32 s40, s40, 1
    s_cmp_lt_u32 s40, 64
    s_cbranch_scc1 L_s2_loop
    s_endpgm
L_ch_w:
    s_load_dwordx2 s[80:81], s[0:1], 72
    s_load_dwordx2 s[84:85], s[0:1], 88
    s_load_dwordx2 s[88:89], s[0:1], 112
    s_waitcnt lgkmcnt(0)
    s_and_b32 s81, s81, 0xffff
    s_mov_b32 s82, 3072
    s_mov_b32 s83, 0x00020000
    s_and_b32 s85, s85, 0xffff
    s_mov_b32 s86, 1280
    s_mov_b32 s87, 0x00020000
    s_and_b32 s89, s89, 0xffff
    s_mov_b32 s90, 2621440
    s_mov_b32 s91, 0x00020000
    s_sub_u32 s22, s2, 112
    s_and_b32 s73, s22, 1
    s_lshr_b32 s22, s22, 1
    s_mov_b32 s75, 0
    s_mov_b32 s23, 0
    s_cmp_ge_u32 s22, 8
    s_cselect_b32 s75, 1, s75
    s_cselect_b32 s23, 8, s23
    s_cmp_ge_u32 s22, 18
    s_cselect_b32 s75, 4, s75
    s_cselect_b32 s23, 18, s23
    s_cmp_ge_u32 s22, 20
    s_cselect_b32 s75, 2, s75
    s_cselect_b32 s23, 20, s23
    s_cmp_ge_u32 s22, 44
    s_cselect_b32 s75, 3, s75
    s_cselect_b32 s23, 44, s23
    s_cmp_ge_u32 s22, 64
    s_cselect_b32 s75, 5, s75
    s_cselect_b32 s23, 64, s23
    s_sub_u32 s74, s22, s23
    s_cmp_eq_u32 s75, 5
    s_cselect_b32 s73, 64, s73
    s_mov_b32 s76, 1
    s_mov_b32 s79, 0
    s_mov_b32 s69, 0
    s_getreg_b32 s66, hwreg(HW_REG_XCC_ID, 0, 4)
    s_and_b32 s66, s66, 7
    s_mov_b32 s67, 0
    s_mov_b32 s69, 0
    s_sub_u32 s22, s2, 192
    s_cmp_lt_u32 s22, 48
    s_cbranch_scc0 L_w_next
    s_mov_b32 s21, 0
    s_lshr_b32 s71, s22, 1
    s_and_b32 s23, s22, 1
    s_mul_i32 s23, s23, 24
    s_add_u32 s71, s71, s23
    s_add_u32 s71, s71, 56
    s_mov_b32 s72, s71
    s_and_b32 s23, s20, 1
    s_lshr_b32 s24, s20, 1
    s_lshl_b32 s25, s22, 3
    s_add_u32 s25, s25, 384
    s_lshl_b32 s26, s24, 2
    s_add_u32 s25, s25, s26
    s_lshl_b32 s26, s21, 3
    s_lshl_b32 s27, s23, 2
    s_add_u32 s26, s26, s27
    s_mul_i32 s27, s25, 20480
    s_add_u32 s27, s27, 4673536
    v_add_u32 v4, s27, v2
    s_add_u32 s27, s27, 20480
    v_add_u32 v5, s27, v2
    s_add_u32 s27, s27, 20480
    v_add_u32 v6, s27, v2
    s_add_u32 s27, s27, 20480
    v_add_u32 v7, s27, v2
    s_mul_i32 s27, s26, 20480
    s_add_u32 s27, s27, 2052096
    v_add_u32 v12, s27, v2
    s_add_u32 s27, s27, 20480
    v_add_u32 v13, s27, v2
    s_add_u32 s27, s27, 20480
    v_add_u32 v14, s27, v2
    s_add_u32 s27, s27, 20480
    v_add_u32 v15, s27, v2
    s_mov_b32 s28, 0
    buffer_load_dwordx4 a[0:3], v4, s[4:7], s28 offen
    buffer_load_dwordx4 a[4:7], v5, s[4:7], s28 offen
    buffer_load_dwordx4 a[8:11], v6, s[4:7], s28 offen
    buffer_load_dwordx4 a[12:15], v7, s[4:7], s28 offen
    buffer_load_dwordx4 a[16:19], v12, s[4:7], s28 offen
    buffer_load_dwordx4 a[20:23], v13, s[4:7], s28 offen
    buffer_load_dwordx4 a[24:27], v14, s[4:7], s28 offen
    buffer_load_dwordx4 a[28:31], v15, s[4:7], s28 offen
    s_mov_b32 s28, 1024
    buffer_load_dwordx4 a[32:35], v4, s[4:7], s28 offen
    buffer_load_dwordx4 a[36:39], v5, s[4:7], s28 offen
    buffer_load_dwordx4 a[40:43], v6, s[4:7], s28 offen
    buffer_load_dwordx4 a[44:47], v7, s[4:7], s28 offen
    buffer_load_dwordx4 a[48:51], v12, s[4:7], s28 offen
    buffer_load_dwordx4 a[52:55], v13, s[4:7], s28 offen
    buffer_load_dwordx4 a[56:59], v14, s[4:7], s28 offen
    buffer_load_dwordx4 a[60:63], v15, s[4:7], s28 offen
    s_mov_b32 s28, 2048
    buffer_load_dwordx4 a[64:67], v4, s[4:7], s28 offen
    buffer_load_dwordx4 a[68:71], v5, s[4:7], s28 offen
    buffer_load_dwordx4 a[72:75], v6, s[4:7], s28 offen
    buffer_load_dwordx4 a[76:79], v7, s[4:7], s28 offen
    buffer_load_dwordx4 a[80:83], v12, s[4:7], s28 offen
    buffer_load_dwordx4 a[84:87], v13, s[4:7], s28 offen
    buffer_load_dwordx4 a[88:91], v14, s[4:7], s28 offen
    buffer_load_dwordx4 a[92:95], v15, s[4:7], s28 offen
    s_mov_b32 s28, 3072
    buffer_load_dwordx4 a[96:99], v4, s[4:7], s28 offen
    buffer_load_dwordx4 a[100:103], v5, s[4:7], s28 offen
    buffer_load_dwordx4 a[104:107], v6, s[4:7], s28 offen
    buffer_load_dwordx4 a[108:111], v7, s[4:7], s28 offen
    buffer_load_dwordx4 a[112:115], v12, s[4:7], s28 offen
    buffer_load_dwordx4 a[116:119], v13, s[4:7], s28 offen
    buffer_load_dwordx4 a[120:123], v14, s[4:7], s28 offen
    buffer_load_dwordx4 a[124:127], v15, s[4:7], s28 offen
    s_mov_b32 s28, 4096
    buffer_load_dwordx4 a[128:131], v4, s[4:7], s28 offen
    buffer_load_dwordx4 a[132:135], v5, s[4:7], s28 offen
    buffer_load_dwordx4 a[136:139], v6, s[4:7], s28 offen
    buffer_load_dwordx4 a[140:143], v7, s[4:7], s28 offen
    buffer_load_dwordx4 a[144:147], v12, s[4:7], s28 offen
    buffer_load_dwordx4 a[148:151], v13, s[4:7], s28 offen
    buffer_load_dwordx4 a[152:155], v14, s[4:7], s28 offen
    buffer_load_dwordx4 a[156:159], v15, s[4:7], s28 offen
    s_mov_b32 s28, 5120
    buffer_load_dwordx4 a[160:163], v4, s[4:7], s28 offen
    buffer_load_dwordx4 a[164:167], v5, s[4:7], s28 offen
    buffer_load_dwordx4 a[168:171], v6, s[4:7], s28 offen
    buffer_load_dwordx4 a[172:175], v7, s[4:7], s28 offen
    buffer_load_dwordx4 a[176:179], v12, s[4:7], s28 offen
    buffer_load_dwordx4 a[180:183], v13, s[4:7], s28 offen
    buffer_load_dwordx4 a[184:187], v14, s[4:7], s28 offen
    buffer_load_dwordx4 a[188:191], v15, s[4:7], s28 offen
    s_mov_b32 s28, 6144
    buffer_load_dwordx4 a[192:195], v4, s[4:7], s28 offen
    buffer_load_dwordx4 a[196:199], v5, s[4:7], s28 offen
    buffer_load_dwordx4 a[200:203], v6, s[4:7], s28 offen
    buffer_load_dwordx4 a[204:207], v7, s[4:7], s28 offen
    buffer_load_dwordx4 a[208:211], v12, s[4:7], s28 offen
    buffer_load_dwordx4 a[212:215], v13, s[4:7], s28 offen
    buffer_load_dwordx4 a[216:219], v14, s[4:7], s28 offen
    buffer_load_dwordx4 a[220:223], v15, s[4:7], s28 offen
    s_mov_b32 s28, 7168
    buffer_load_dwordx4 a[224:227], v4, s[4:7], s28 offen
    buffer_load_dwordx4 a[228:231], v5, s[4:7], s28 offen
    buffer_load_dwordx4 a[232:235], v6, s[4:7], s28 offen
    buffer_load_dwordx4 a[236:239], v7, s[4:7], s28 offen
    buffer_load_dwordx4 a[240:243], v12, s[4:7], s28 offen
    buffer_load_dwordx4 a[244:247], v13, s[4:7], s28 offen
    buffer_load_dwordx4 a[248:251], v14, s[4:7], s28 offen
    buffer_load_dwordx4 a[252:255], v15, s[4:7], s28 offen
    s_waitcnt vmcnt(56)
    v_mfma_f32_16x16x32_bf16 v[16:19], a[0:3], a[16:19], 0
    v_mfma_f32_16x16x32_bf16 v[20:23], a[0:3], a[20:23], 0
    v_mfma_f32_16x16x32_bf16 v[24:27], a[0:3], a[24:27], 0
    v_mfma_f32_16x16x32_bf16 v[28:31], a[0:3], a[28:31], 0
    v_mfma_f32_16x16x32_bf16 v[32:35], a[4:7], a[16:19], 0
    v_mfma_f32_16x16x32_bf16 v[36:39], a[4:7], a[20:23], 0
    v_mfma_f32_16x16x32_bf16 v[40:43], a[4:7], a[24:27], 0
    v_mfma_f32_16x16x32_bf16 v[44:47], a[4:7], a[28:31], 0
    v_mfma_f32_16x16x32_bf16 v[48:51], a[8:11], a[16:19], 0
    v_mfma_f32_16x16x32_bf16 v[52:55], a[8:11], a[20:23], 0
    v_mfma_f32_16x16x32_bf16 v[56:59], a[8:11], a[24:27], 0
    v_mfma_f32_16x16x32_bf16 v[60:63], a[8:11], a[28:31], 0
    v_mfma_f32_16x16x32_bf16 v[64:67], a[12:15], a[16:19], 0
    v_mfma_f32_16x16x32_bf16 v[68:71], a[12:15], a[20:23], 0
    v_mfma_f32_16x16x32_bf16 v[72:75], a[12:15], a[24:27], 0
    v_mfma_f32_16x16x32_bf16 v[76:79], a[12:15], a[28:31], 0
    s_mov_b32 s28, 8192
    buffer_load_dwordx4 a[0:3], v4, s[4:7], s28 offen
    buffer_load_dwordx4 a[4:7], v5, s[4:7], s28 offen
    buffer_load_dwordx4 a[8:11], v6, s[4:7], s28 offen
    buffer_load_dwordx4 a[12:15], v7, s[4:7], s28 offen
    buffer_load_dwordx4 a[16:19], v12, s[4:7], s28 offen
    buffer_load_dwordx4 a[20:23], v13, s[4:7], s28 offen
    buffer_load_dwordx4 a[24:27], v14, s[4:7], s28 offen
    buffer_load_dwordx4 a[28:31], v15, s[4:7], s28 offen
    s_waitcnt vmcnt(56)
    v_mfma_f32_16x16x32_bf16 v[16:19], a[32:35], a[48:51], v[16:19]
    v_mfma_f32_16x16x32_bf16 v[20:23], a[32:35], a[52:55], v[20:23]
    v_mfma_f32_16x16x32_bf16 v[24:27], a[32:35], a[56:59], v[24:27]
    v_mfma_f32_16x16x32_bf16 v[28:31], a[32:35], a[60:63], v[28:31]
    v_mfma_f32_16x16x32_bf16 v[32:35], a[36:39], a[48:51], v[32:35]
    v_mfma_f32_16x16x32_bf16 v[36:39], a[36:39], a[52:55], v[36:39]
    v_mfma_f32_16x16x32_bf16 v[40:43], a[36:39], a[56:59], v[40:43]
    v_mfma_f32_16x16x32_bf16 v[44:47], a[36:39], a[60:63], v[44:47]
    v_mfma_f32_16x16x32_bf16 v[48:51], a[40:43], a[48:51], v[48:51]
    v_mfma_f32_16x16x32_bf16 v[52:55], a[40:43], a[52:55], v[52:55]
    v_mfma_f32_16x16x32_bf16 v[56:59], a[40:43], a[56:59], v[56:59]
    v_mfma_f32_16x16x32_bf16 v[60:63], a[40:43], a[60:63], v[60:63]
    v_mfma_f32_16x16x32_bf16 v[64:67], a[44:47], a[48:51], v[64:67]
    v_mfma_f32_16x16x32_bf16 v[68:71], a[44:47], a[52:55], v[68:71]
    v_mfma_f32_16x16x32_bf16 v[72:75], a[44:47], a[56:59], v[72:75]
    v_mfma_f32_16x16x32_bf16 v[76:79], a[44:47], a[60:63], v[76:79]
    s_mov_b32 s28, 9216
    buffer_load_dwordx4 a[32:35], v4, s[4:7], s28 offen
    buffer_load_dwordx4 a[36:39], v5, s[4:7], s28 offen
    buffer_load_dwordx4 a[40:43], v6, s[4:7], s28 offen
    buffer_load_dwordx4 a[44:47], v7, s[4:7], s28 offen
    buffer_load_dwordx4 a[48:51], v12, s[4:7], s28 offen
    buffer_load_dwordx4 a[52:55], v13, s[4:7], s28 offen
    buffer_load_dwordx4 a[56:59], v14, s[4:7], s28 offen
    buffer_load_dwordx4 a[60:63], v15, s[4:7], s28 offen
    s_waitcnt vmcnt(56)
    v_mfma_f32_16x16x32_bf16 v[16:19], a[64:67], a[80:83], v[16:19]
    v_mfma_f32_16x16x32_bf16 v[20:23], a[64:67], a[84:87], v[20:23]
    v_mfma_f32_16x16x32_bf16 v[24:27], a[64:67], a[88:91], v[24:27]
    v_mfma_f32_16x16x32_bf16 v[28:31], a[64:67], a[92:95], v[28:31]
    v_mfma_f32_16x16x32_bf16 v[32:35], a[68:71], a[80:83], v[32:35]
    v_mfma_f32_16x16x32_bf16 v[36:39], a[68:71], a[84:87], v[36:39]
    v_mfma_f32_16x16x32_bf16 v[40:43], a[68:71], a[88:91], v[40:43]
    v_mfma_f32_16x16x32_bf16 v[44:47], a[68:71], a[92:95], v[44:47]
    v_mfma_f32_16x16x32_bf16 v[48:51], a[72:75], a[80:83], v[48:51]
    v_mfma_f32_16x16x32_bf16 v[52:55], a[72:75], a[84:87], v[52:55]
    v_mfma_f32_16x16x32_bf16 v[56:59], a[72:75], a[88:91], v[56:59]
    v_mfma_f32_16x16x32_bf16 v[60:63], a[72:75], a[92:95], v[60:63]
    v_mfma_f32_16x16x32_bf16 v[64:67], a[76:79], a[80:83], v[64:67]
    v_mfma_f32_16x16x32_bf16 v[68:71], a[76:79], a[84:87], v[68:71]
    v_mfma_f32_16x16x32_bf16 v[72:75], a[76:79], a[88:91], v[72:75]
    v_mfma_f32_16x16x32_bf16 v[76:79], a[76:79], a[92:95], v[76:79]
    s_mov_b32 s28, 10240
    buffer_load_dwordx4 a[64:67], v4, s[4:7], s28 offen
    buffer_load_dwordx4 a[68:71], v5, s[4:7], s28 offen
    buffer_load_dwordx4 a[72:75], v6, s[4:7], s28 offen
    buffer_load_dwordx4 a[76:79], v7, s[4:7], s28 offen
    buffer_load_dwordx4 a[80:83], v12, s[4:7], s28 offen
    buffer_load_dwordx4 a[84:87], v13, s[4:7], s28 offen
    buffer_load_dwordx4 a[88:91], v14, s[4:7], s28 offen
    buffer_load_dwordx4 a[92:95], v15, s[4:7], s28 offen
    s_waitcnt vmcnt(56)
    v_mfma_f32_16x16x32_bf16 v[16:19], a[96:99], a[112:115], v[16:19]
    v_mfma_f32_16x16x32_bf16 v[20:23], a[96:99], a[116:119], v[20:23]
    v_mfma_f32_16x16x32_bf16 v[24:27], a[96:99], a[120:123], v[24:27]
    v_mfma_f32_16x16x32_bf16 v[28:31], a[96:99], a[124:127], v[28:31]
    v_mfma_f32_16x16x32_bf16 v[32:35], a[100:103], a[112:115], v[32:35]
    v_mfma_f32_16x16x32_bf16 v[36:39], a[100:103], a[116:119], v[36:39]
    v_mfma_f32_16x16x32_bf16 v[40:43], a[100:103], a[120:123], v[40:43]
    v_mfma_f32_16x16x32_bf16 v[44:47], a[100:103], a[124:127], v[44:47]
    v_mfma_f32_16x16x32_bf16 v[48:51], a[104:107], a[112:115], v[48:51]
    v_mfma_f32_16x16x32_bf16 v[52:55], a[104:107], a[116:119], v[52:55]
    v_mfma_f32_16x16x32_bf16 v[56:59], a[104:107], a[120:123], v[56:59]
    v_mfma_f32_16x16x32_bf16 v[60:63], a[104:107], a[124:127], v[60:63]
    v_mfma_f32_16x16x32_bf16 v[64:67], a[108:111], a[112:115], v[64:67]
    v_mfma_f32_16x16x32_bf16 v[68:71], a[108:111], a[116:119], v[68:71]
    v_mfma_f32_16x16x32_bf16 v[72:75], a[108:111], a[120:123], v[72:75]
    v_mfma_f32_16x16x32_bf16 v[76:79], a[108:111], a[124:127], v[76:79]
    s_mov_b32 s28, 11264
    buffer_load_dwordx4 a[96:99], v4, s[4:7], s28 offen
    buffer_load_dwordx4 a[100:103], v5, s[4:7], s28 offen
    buffer_load_dwordx4 a[104:107], v6, s[4:7], s28 offen
    buffer_load_dwordx4 a[108:111], v7, s[4:7], s28 offen
    buffer_load_dwordx4 a[112:115], v12, s[4:7], s28 offen
    buffer_load_dwordx4 a[116:119], v13, s[4:7], s28 offen
    buffer_load_dwordx4 a[120:123], v14, s[4:7], s28 offen
    buffer_load_dwordx4 a[124:127], v15, s[4:7], s28 offen
    s_waitcnt vmcnt(56)
    v_mfma_f32_16x16x32_bf16 v[16:19], a[128:131], a[144:147], v[16:19]
    v_mfma_f32_16x16x32_bf16 v[20:23], a[128:131], a[148:151], v[20:23]
    v_mfma_f32_16x16x32_bf16 v[24:27], a[128:131], a[152:155], v[24:27]
    v_mfma_f32_16x16x32_bf16 v[28:31], a[128:131], a[156:159], v[28:31]
    v_mfma_f32_16x16x32_bf16 v[32:35], a[132:135], a[144:147], v[32:35]
    v_mfma_f32_16x16x32_bf16 v[36:39], a[132:135], a[148:151], v[36:39]
    v_mfma_f32_16x16x32_bf16 v[40:43], a[132:135], a[152:155], v[40:43]
    v_mfma_f32_16x16x32_bf16 v[44:47], a[132:135], a[156:159], v[44:47]
    v_mfma_f32_16x16x32_bf16 v[48:51], a[136:139], a[144:147], v[48:51]
    v_mfma_f32_16x16x32_bf16 v[52:55], a[136:139], a[148:151], v[52:55]
    v_mfma_f32_16x16x32_bf16 v[56:59], a[136:139], a[152:155], v[56:59]
    v_mfma_f32_16x16x32_bf16 v[60:63], a[136:139], a[156:159], v[60:63]
    v_mfma_f32_16x16x32_bf16 v[64:67], a[140:143], a[144:147], v[64:67]
    v_mfma_f32_16x16x32_bf16 v[68:71], a[140:143], a[148:151], v[68:71]
    v_mfma_f32_16x16x32_bf16 v[72:75], a[140:143], a[152:155], v[72:75]
    v_mfma_f32_16x16x32_bf16 v[76:79], a[140:143], a[156:159], v[76:79]
    s_mov_b32 s28, 12288
    buffer_load_dwordx4 a[128:131], v4, s[4:7], s28 offen
    buffer_load_dwordx4 a[132:135], v5, s[4:7], s28 offen
    buffer_load_dwordx4 a[136:139], v6, s[4:7], s28 offen
    buffer_load_dwordx4 a[140:143], v7, s[4:7], s28 offen
    buffer_load_dwordx4 a[144:147], v12, s[4:7], s28 offen
    buffer_load_dwordx4 a[148:151], v13, s[4:7], s28 offen
    buffer_load_dwordx4 a[152:155], v14, s[4:7], s28 offen
    buffer_load_dwordx4 a[156:159], v15, s[4:7], s28 offen
    s_waitcnt vmcnt(56)
    v_mfma_f32_16x16x32_bf16 v[16:19], a[160:163], a[176:179], v[16:19]
    v_mfma_f32_16x16x32_bf16 v[20:23], a[160:163], a[180:183], v[20:23]
    v_mfma_f32_16x16x32_bf16 v[24:27], a[160:163], a[184:187], v[24:27]
    v_mfma_f32_16x16x32_bf16 v[28:31], a[160:163], a[188:191], v[28:31]
    v_mfma_f32_16x16x32_bf16 v[32:35], a[164:167], a[176:179], v[32:35]
    v_mfma_f32_16x16x32_bf16 v[36:39], a[164:167], a[180:183], v[36:39]
    v_mfma_f32_16x16x32_bf16 v[40:43], a[164:167], a[184:187], v[40:43]
    v_mfma_f32_16x16x32_bf16 v[44:47], a[164:167], a[188:191], v[44:47]
    v_mfma_f32_16x16x32_bf16 v[48:51], a[168:171], a[176:179], v[48:51]
    v_mfma_f32_16x16x32_bf16 v[52:55], a[168:171], a[180:183], v[52:55]
    v_mfma_f32_16x16x32_bf16 v[56:59], a[168:171], a[184:187], v[56:59]
    v_mfma_f32_16x16x32_bf16 v[60:63], a[168:171], a[188:191], v[60:63]
    v_mfma_f32_16x16x32_bf16 v[64:67], a[172:175], a[176:179], v[64:67]
    v_mfma_f32_16x16x32_bf16 v[68:71], a[172:175], a[180:183], v[68:71]
    v_mfma_f32_16x16x32_bf16 v[72:75], a[172:175], a[184:187], v[72:75]
    v_mfma_f32_16x16x32_bf16 v[76:79], a[172:175], a[188:191], v[76:79]
    s_mov_b32 s28, 13312
    buffer_load_dwordx4 a[160:163], v4, s[4:7], s28 offen
    buffer_load_dwordx4 a[164:167], v5, s[4:7], s28 offen
    buffer_load_dwordx4 a[168:171], v6, s[4:7], s28 offen
    buffer_load_dwordx4 a[172:175], v7, s[4:7], s28 offen
    buffer_load_dwordx4 a[176:179], v12, s[4:7], s28 offen
    buffer_load_dwordx4 a[180:183], v13, s[4:7], s28 offen
    buffer_load_dwordx4 a[184:187], v14, s[4:7], s28 offen
    buffer_load_dwordx4 a[188:191], v15, s[4:7], s28 offen
    s_waitcnt vmcnt(56)
    v_mfma_f32_16x16x32_bf16 v[16:19], a[192:195], a[208:211], v[16:19]
    v_mfma_f32_16x16x32_bf16 v[20:23], a[192:195], a[212:215], v[20:23]
    v_mfma_f32_16x16x32_bf16 v[24:27], a[192:195], a[216:219], v[24:27]
    v_mfma_f32_16x16x32_bf16 v[28:31], a[192:195], a[220:223], v[28:31]
    v_mfma_f32_16x16x32_bf16 v[32:35], a[196:199], a[208:211], v[32:35]
    v_mfma_f32_16x16x32_bf16 v[36:39], a[196:199], a[212:215], v[36:39]
    v_mfma_f32_16x16x32_bf16 v[40:43], a[196:199], a[216:219], v[40:43]
    v_mfma_f32_16x16x32_bf16 v[44:47], a[196:199], a[220:223], v[44:47]
    v_mfma_f32_16x16x32_bf16 v[48:51], a[200:203], a[208:211], v[48:51]
    v_mfma_f32_16x16x32_bf16 v[52:55], a[200:203], a[212:215], v[52:55]
    v_mfma_f32_16x16x32_bf16 v[56:59], a[200:203], a[216:219], v[56:59]
    v_mfma_f32_16x16x32_bf16 v[60:63], a[200:203], a[220:223], v[60:63]
    v_mfma_f32_16x16x32_bf16 v[64:67], a[204:207], a[208:211], v[64:67]
    v_mfma_f32_16x16x32_bf16 v[68:71], a[204:207], a[212:215], v[68:71]
    v_mfma_f32_16x16x32_bf16 v[72:75], a[204:207], a[216:219], v[72:75]
    v_mfma_f32_16x16x32_bf16 v[76:79], a[204:207], a[220:223], v[76:79]
    s_mov_b32 s28, 14336
    buffer_load_dwordx4 a[192:195], v4, s[4:7], s28 offen
    buffer_load_dwordx4 a[196:199], v5, s[4:7], s28 offen
    buffer_load_dwordx4 a[200:203], v6, s[4:7], s28 offen
    buffer_load_dwordx4 a[204:207], v7, s[4:7], s28 offen
    buffer_load_dwordx4 a[208:211], v12, s[4:7], s28 offen
    buffer_load_dwordx4 a[212:215], v13, s[4:7], s28 offen
    buffer_load_dwordx4 a[216:219], v14, s[4:7], s28 offen
    buffer_load_dwordx4 a[220:223], v15, s[4:7], s28 offen
    s_waitcnt vmcnt(56)
    v_mfma_f32_16x16x32_bf16 v[16:19], a[224:227], a[240:243], v[16:19]
    v_mfma_f32_16x16x32_bf16 v[20:23], a[224:227], a[244:247], v[20:23]
    v_mfma_f32_16x16x32_bf16 v[24:27], a[224:227], a[248:251], v[24:27]
    v_mfma_f32_16x16x32_bf16 v[28:31], a[224:227], a[252:255], v[28:31]
    v_mfma_f32_16x16x32_bf16 v[32:35], a[228:231], a[240:243], v[32:35]
    v_mfma_f32_16x16x32_bf16 v[36:39], a[228:231], a[244:247], v[36:39]
    v_mfma_f32_16x16x32_bf16 v[40:43], a[228:231], a[248:251], v[40:43]
    v_mfma_f32_16x16x32_bf16 v[44:47], a[228:231], a[252:255], v[44:47]
    v_mfma_f32_16x16x32_bf16 v[48:51], a[232:235], a[240:243], v[48:51]
    v_mfma_f32_16x16x32_bf16 v[52:55], a[232:235], a[244:247], v[52:55]
    v_mfma_f32_16x16x32_bf16 v[56:59], a[232:235], a[248:251], v[56:59]
    v_mfma_f32_16x16x32_bf16 v[60:63], a[232:235], a[252:255], v[60:63]
    v_mfma_f32_16x16x32_bf16 v[64:67], a[236:239], a[240:243], v[64:67]
    v_mfma_f32_16x16x32_bf16 v[68:71], a[236:239], a[244:247], v[68:71]
    v_mfma_f32_16x16x32_bf16 v[72:75], a[236:239], a[248:251], v[72:75]
    v_mfma_f32_16x16x32_bf16 v[76:79], a[236:239], a[252:255], v[76:79]
    s_mov_b32 s28, 15360
    buffer_load_dwordx4 a[224:227], v4, s[4:7], s28 offen
    buffer_load_dwordx4 a[228:231], v5, s[4:7], s28 offen
    buffer_load_dwordx4 a[232:235], v6, s[4:7], s28 offen
    buffer_load_dwordx4 a[236:239], v7, s[4:7], s28 offen
    buffer_load_dwordx4 a[240:243], v12, s[4:7], s28 offen
    buffer_load_dwordx4 a[244:247], v13, s[4:7], s28 offen
    buffer_load_dwordx4 a[248:251], v14, s[4:7], s28 offen
    buffer_load_dwordx4 a[252:255], v15, s[4:7], s28 offen
    s_waitcnt vmcnt(56)
    v_mfma_f32_16x16x32_bf16 v[16:19], a[0:3], a[16:19], v[16:19]
    v_mfma_f32_16x16x32_bf16 v[20:23], a[0:3], a[20:23], v[20:23]
    v_mfma_f32_16x16x32_bf16 v[24:27], a[0:3], a[24:27], v[24:27]
    v_mfma_f32_16x16x32_bf16 v[28:31], a[0:3], a[28:31], v[28:31]
    v_mfma_f32_16x16x32_bf16 v[32:35], a[4:7], a[16:19], v[32:35]
    v_mfma_f32_16x16x32_bf16 v[36:39], a[4:7], a[20:23], v[36:39]
    v_mfma_f32_16x16x32_bf16 v[40:43], a[4:7], a[24:27], v[40:43]
    v_mfma_f32_16x16x32_bf16 v[44:47], a[4:7], a[28:31], v[44:47]
    v_mfma_f32_16x16x32_bf16 v[48:51], a[8:11], a[16:19], v[48:51]
    v_mfma_f32_16x16x32_bf16 v[52:55], a[8:11], a[20:23], v[52:55]
    v_mfma_f32_16x16x32_bf16 v[56:59], a[8:11], a[24:27], v[56:59]
    v_mfma_f32_16x16x32_bf16 v[60:63], a[8:11], a[28:31], v[60:63]
    v_mfma_f32_16x16x32_bf16 v[64:67], a[12:15], a[16:19], v[64:67]
    v_mfma_f32_16x16x32_bf16 v[68:71], a[12:15], a[20:23], v[68:71]
    v_mfma_f32_16x16x32_bf16 v[72:75], a[12:15], a[24:27], v[72:75]
    v_mfma_f32_16x16x32_bf16 v[76:79], a[12:15], a[28:31], v[76:79]
    s_mov_b32 s28, 16384
    buffer_load_dwordx4 a[0:3], v4, s[4:7], s28 offen
    buffer_load_dwordx4 a[4:7], v5, s[4:7], s28 offen
    buffer_load_dwordx4 a[8:11], v6, s[4:7], s28 offen
    buffer_load_dwordx4 a[12:15], v7, s[4:7], s28 offen
    buffer_load_dwordx4 a[16:19], v12, s[4:7], s28 offen
    buffer_load_dwordx4 a[20:23], v13, s[4:7], s28 offen
    buffer_load_dwordx4 a[24:27], v14, s[4:7], s28 offen
    buffer_load_dwordx4 a[28:31], v15, s[4:7], s28 offen
    s_waitcnt vmcnt(56)
    v_mfma_f32_16x16x32_bf16 v[16:19], a[32:35], a[48:51], v[16:19]
    v_mfma_f32_16x16x32_bf16 v[20:23], a[32:35], a[52:55], v[20:23]
    v_mfma_f32_16x16x32_bf16 v[24:27], a[32:35], a[56:59], v[24:27]
    v_mfma_f32_16x16x32_bf16 v[28:31], a[32:35], a[60:63], v[28:31]
    v_mfma_f32_16x16x32_bf16 v[32:35], a[36:39], a[48:51], v[32:35]
    v_mfma_f32_16x16x32_bf16 v[36:39], a[36:39], a[52:55], v[36:39]
    v_mfma_f32_16x16x32_bf16 v[40:43], a[36:39], a[56:59], v[40:43]
    v_mfma_f32_16x16x32_bf16 v[44:47], a[36:39], a[60:63], v[44:47]
    v_mfma_f32_16x16x32_bf16 v[48:51], a[40:43], a[48:51], v[48:51]
    v_mfma_f32_16x16x32_bf16 v[52:55], a[40:43], a[52:55], v[52:55]
    v_mfma_f32_16x16x32_bf16 v[56:59], a[40:43], a[56:59], v[56:59]
    v_mfma_f32_16x16x32_bf16 v[60:63], a[40:43], a[60:63], v[60:63]
    v_mfma_f32_16x16x32_bf16 v[64:67], a[44:47], a[48:51], v[64:67]
    v_mfma_f32_16x16x32_bf16 v[68:71], a[44:47], a[52:55], v[68:71]
    v_mfma_f32_16x16x32_bf16 v[72:75], a[44:47], a[56:59], v[72:75]
    v_mfma_f32_16x16x32_bf16 v[76:79], a[44:47], a[60:63], v[76:79]
    s_mov_b32 s28, 17408
    buffer_load_dwordx4 a[32:35], v4, s[4:7], s28 offen
    buffer_load_dwordx4 a[36:39], v5, s[4:7], s28 offen
    buffer_load_dwordx4 a[40:43], v6, s[4:7], s28 offen
    buffer_load_dwordx4 a[44:47], v7, s[4:7], s28 offen
    buffer_load_dwordx4 a[48:51], v12, s[4:7], s28 offen
    buffer_load_dwordx4 a[52:55], v13, s[4:7], s28 offen
    buffer_load_dwordx4 a[56:59], v14, s[4:7], s28 offen
    buffer_load_dwordx4 a[60:63], v15, s[4:7], s28 offen
    s_waitcnt vmcnt(56)
    v_mfma_f32_16x16x32_bf16 v[16:19], a[64:67], a[80:83], v[16:19]
    v_mfma_f32_16x16x32_bf16 v[20:23], a[64:67], a[84:87], v[20:23]
    v_mfma_f32_16x16x32_bf16 v[24:27], a[64:67], a[88:91], v[24:27]
    v_mfma_f32_16x16x32_bf16 v[28:31], a[64:67], a[92:95], v[28:31]
    v_mfma_f32_16x16x32_bf16 v[32:35], a[68:71], a[80:83], v[32:35]
    v_mfma_f32_16x16x32_bf16 v[36:39], a[68:71], a[84:87], v[36:39]
    v_mfma_f32_16x16x32_bf16 v[40:43], a[68:71], a[88:91], v[40:43]
    v_mfma_f32_16x16x32_bf16 v[44:47], a[68:71], a[92:95], v[44:47]
    v_mfma_f32_16x16x32_bf16 v[48:51], a[72:75], a[80:83], v[48:51]
    v_mfma_f32_16x16x32_bf16 v[52:55], a[72:75], a[84:87], v[52:55]
    v_mfma_f32_16x16x32_bf16 v[56:59], a[72:75], a[88:91], v[56:59]
    v_mfma_f32_16x16x32_bf16 v[60:63], a[72:75], a[92:95], v[60:63]
    v_mfma_f32_16x16x32_bf16 v[64:67], a[76:79], a[80:83], v[64:67]
    v_mfma_f32_16x16x32_bf16 v[68:71], a[76:79], a[84:87], v[68:71]
    v_mfma_f32_16x16x32_bf16 v[72:75], a[76:79], a[88:91], v[72:75]
    v_mfma_f32_16x16x32_bf16 v[76:79], a[76:79], a[92:95], v[76:79]
    s_mov_b32 s28, 18432
    buffer_load_dwordx4 a[64:67], v4, s[4:7], s28 offen
    buffer_load_dwordx4 a[68:71], v5, s[4:7], s28 offen
    buffer_load_dwordx4 a[72:75], v6, s[4:7], s28 offen
    buffer_load_dwordx4 a[76:79], v7, s[4:7], s28 offen
    buffer_load_dwordx4 a[80:83], v12, s[4:7], s28 offen
    buffer_load_dwordx4 a[84:87], v13, s[4:7], s28 offen
    buffer_load_dwordx4 a[88:91], v14, s[4:7], s28 offen
    buffer_load_dwordx4 a[92:95], v15, s[4:7], s28 offen
    s_waitcnt vmcnt(56)
    v_mfma_f32_16x16x32_bf16 v[16:19], a[96:99], a[112:115], v[16:19]
    v_mfma_f32_16x16x32_bf16 v[20:23], a[96:99], a[116:119], v[20:23]
    v_mfma_f32_16x16x32_bf16 v[24:27], a[96:99], a[120:123], v[24:27]
    v_mfma_f32_16x16x32_bf16 v[28:31], a[96:99], a[124:127], v[28:31]
    v_mfma_f32_16x16x32_bf16 v[32:35], a[100:103], a[112:115], v[32:35]
    v_mfma_f32_16x16x32_bf16 v[36:39], a[100:103], a[116:119], v[36:39]
    v_mfma_f32_16x16x32_bf16 v[40:43], a[100:103], a[120:123], v[40:43]
    v_mfma_f32_16x16x32_bf16 v[44:47], a[100:103], a[124:127], v[44:47]
    v_mfma_f32_16x16x32_bf16 v[48:51], a[104:107], a[112:115], v[48:51]
    v_mfma_f32_16x16x32_bf16 v[52:55], a[104:107], a[116:119], v[52:55]
    v_mfma_f32_16x16x32_bf16 v[56:59], a[104:107], a[120:123], v[56:59]
    v_mfma_f32_16x16x32_bf16 v[60:63], a[104:107], a[124:127], v[60:63]
    v_mfma_f32_16x16x32_bf16 v[64:67], a[108:111], a[112:115], v[64:67]
    v_mfma_f32_16x16x32_bf16 v[68:71], a[108:111], a[116:119], v[68:71]
    v_mfma_f32_16x16x32_bf16 v[72:75], a[108:111], a[120:123], v[72:75]
    v_mfma_f32_16x16x32_bf16 v[76:79], a[108:111], a[124:127], v[76:79]
    s_mov_b32 s28, 19456
    buffer_load_dwordx4 a[96:99], v4, s[4:7], s28 offen
    buffer_load_dwordx4 a[100:103], v5, s[4:7], s28 offen
    buffer_load_dwordx4 a[104:107], v6, s[4:7], s28 offen
    buffer_load_dwordx4 a[108:111], v7, s[4:7], s28 offen
    buffer_load_dwordx4 a[112:115], v12, s[4:7], s28 offen
    buffer_load_dwordx4 a[116:119], v13, s[4:7], s28 offen
    buffer_load_dwordx4 a[120:123], v14, s[4:7], s28 offen
    buffer_load_dwordx4 a[124:127], v15, s[4:7], s28 offen
    s_waitcnt vmcnt(56)
    v_mfma_f32_16x16x32_bf16 v[16:19], a[128:131], a[144:147], v[16:19]
    v_mfma_f32_16x16x32_bf16 v[20:23], a[128:131], a[148:151], v[20:23]
    v_mfma_f32_16x16x32_bf16 v[24:27], a[128:131], a[152:155], v[24:27]
    v_mfma_f32_16x16x32_bf16 v[28:31], a[128:131], a[156:159], v[28:31]
    v_mfma_f32_16x16x32_bf16 v[32:35], a[132:135], a[144:147], v[32:35]
    v_mfma_f32_16x16x32_bf16 v[36:39], a[132:135], a[148:151], v[36:39]
    v_mfma_f32_16x16x32_bf16 v[40:43], a[132:135], a[152:155], v[40:43]
    v_mfma_f32_16x16x32_bf16 v[44:47], a[132:135], a[156:159], v[44:47]
    v_mfma_f32_16x16x32_bf16 v[48:51], a[136:139], a[144:147], v[48:51]
    v_mfma_f32_16x16x32_bf16 v[52:55], a[136:139], a[148:151], v[52:55]
    v_mfma_f32_16x16x32_bf16 v[56:59], a[136:139], a[152:155], v[56:59]
    v_mfma_f32_16x16x32_bf16 v[60:63], a[136:139], a[156:159], v[60:63]
    v_mfma_f32_16x16x32_bf16 v[64:67], a[140:143], a[144:147], v[64:67]
    v_mfma_f32_16x16x32_bf16 v[68:71], a[140:143], a[148:151], v[68:71]
    v_mfma_f32_16x16x32_bf16 v[72:75], a[140:143], a[152:155], v[72:75]
    v_mfma_f32_16x16x32_bf16 v[76:79], a[140:143], a[156:159], v[76:79]
    s_waitcnt vmcnt(48)
    v_mfma_f32_16x16x32_bf16 v[16:19], a[160:163], a[176:179], v[16:19]
    v_mfma_f32_16x16x32_bf16 v[20:23], a[160:163], a[180:183], v[20:23]
    v_mfma_f32_16x16x32_bf16 v[24:27], a[160:163], a[184:187], v[24:27]
    v_mfma_f32_16x16x32_bf16 v[28:31], a[160:163], a[188:191], v[28:31]
    v_mfma_f32_16x16x32_bf16 v[32:35], a[164:167], a[176:179], v[32:35]
    v_mfma_f32_16x16x32_bf16 v[36:39], a[164:167], a[180:183], v[36:39]
    v_mfma_f32_16x16x32_bf16 v[40:43], a[164:167], a[184:187], v[40:43]
    v_mfma_f32_16x16x32_bf16 v[44:47], a[164:167], a[188:191], v[44:47]
    v_mfma_f32_16x16x32_bf16 v[48:51], a[168:171], a[176:179], v[48:51]
    v_mfma_f32_16x16x32_bf16 v[52:55], a[168:171], a[180:183], v[52:55]
    v_mfma_f32_16x16x32_bf16 v[56:59], a[168:171], a[184:187], v[56:59]
    v_mfma_f32_16x16x32_bf16 v[60:63], a[168:171], a[188:191], v[60:63]
    v_mfma_f32_16x16x32_bf16 v[64:67], a[172:175], a[176:179], v[64:67]
    v_mfma_f32_16x16x32_bf16 v[68:71], a[172:175], a[180:183], v[68:71]
    v_mfma_f32_16x16x32_bf16 v[72:75], a[172:175], a[184:187], v[72:75]
    v_mfma_f32_16x16x32_bf16 v[76:79], a[172:175], a[188:191], v[76:79]
    s_waitcnt vmcnt(40)
    v_mfma_f32_16x16x32_bf16 v[16:19], a[192:195], a[208:211], v[16:19]
    v_mfma_f32_16x16x32_bf16 v[20:23], a[192:195], a[212:215], v[20:23]
    v_mfma_f32_16x16x32_bf16 v[24:27], a[192:195], a[216:219], v[24:27]
    v_mfma_f32_16x16x32_bf16 v[28:31], a[192:195], a[220:223], v[28:31]
    v_mfma_f32_16x16x32_bf16 v[32:35], a[196:199], a[208:211], v[32:35]
    v_mfma_f32_16x16x32_bf16 v[36:39], a[196:199], a[212:215], v[36:39]
    v_mfma_f32_16x16x32_bf16 v[40:43], a[196:199], a[216:219], v[40:43]
    v_mfma_f32_16x16x32_bf16 v[44:47], a[196:199], a[220:223], v[44:47]
    v_mfma_f32_16x16x32_bf16 v[48:51], a[200:203], a[208:211], v[48:51]
    v_mfma_f32_16x16x32_bf16 v[52:55], a[200:203], a[212:215], v[52:55]
    v_mfma_f32_16x16x32_bf16 v[56:59], a[200:203], a[216:219], v[56:59]
    v_mfma_f32_16x16x32_bf16 v[60:63], a[200:203], a[220:223], v[60:63]
    v_mfma_f32_16x16x32_bf16 v[64:67], a[204:207], a[208:211], v[64:67]
    v_mfma_f32_16x16x32_bf16 v[68:71], a[204:207], a[212:215], v[68:71]
    v_mfma_f32_16x16x32_bf16 v[72:75], a[204:207], a[216:219], v[72:75]
    v_mfma_f32_16x16x32_bf16 v[76:79], a[204:207], a[220:223], v[76:79]
    s_waitcnt vmcnt(32)
    v_mfma_f32_16x16x32_bf16 v[16:19], a[224:227], a[240:243], v[16:19]
    v_mfma_f32_16x16x32_bf16 v[20:23], a[224:227], a[244:247], v[20:23]
    v_mfma_f32_16x16x32_bf16 v[24:27], a[224:227], a[248:251], v[24:27]
    v_mfma_f32_16x16x32_bf16 v[28:31], a[224:227], a[252:255], v[28:31]
    v_mfma_f32_16x16x32_bf16 v[32:35], a[228:231], a[240:243], v[32:35]
    v_mfma_f32_16x16x32_bf16 v[36:39], a[228:231], a[244:247], v[36:39]
    v_mfma_f32_16x16x32_bf16 v[40:43], a[228:231], a[248:251], v[40:43]
    v_mfma_f32_16x16x32_bf16 v[44:47], a[228:231], a[252:255], v[44:47]
    v_mfma_f32_16x16x32_bf16 v[48:51], a[232:235], a[240:243], v[48:51]
    v_mfma_f32_16x16x32_bf16 v[52:55], a[232:235], a[244:247], v[52:55]
    v_mfma_f32_16x16x32_bf16 v[56:59], a[232:235], a[248:251], v[56:59]
    v_mfma_f32_16x16x32_bf16 v[60:63], a[232:235], a[252:255], v[60:63]
    v_mfma_f32_16x16x32_bf16 v[64:67], a[236:239], a[240:243], v[64:67]
    v_mfma_f32_16x16x32_bf16 v[68:71], a[236:239], a[244:247], v[68:71]
    v_mfma_f32_16x16x32_bf16 v[72:75], a[236:239], a[248:251], v[72:75]
    v_mfma_f32_16x16x32_bf16 v[76:79], a[236:239], a[252:255], v[76:79]
    s_waitcnt vmcnt(24)
    v_mfma_f32_16x16x32_bf16 v[16:19], a[0:3], a[16:19], v[16:19]
    v_mfma_f32_16x16x32_bf16 v[20:23], a[0:3], a[20:23], v[20:23]
    v_mfma_f32_16x16x32_bf16 v[24:27], a[0:3], a[24:27], v[24:27]
    v_mfma_f32_16x16x32_bf16 v[28:31], a[0:3], a[28:31], v[28:31]
    v_mfma_f32_16x16x32_bf16 v[32:35], a[4:7], a[16:19], v[32:35]
    v_mfma_f32_16x16x32_bf16 v[36:39], a[4:7], a[20:23], v[36:39]
    v_mfma_f32_16x16x32_bf16 v[40:43], a[4:7], a[24:27], v[40:43]
    v_mfma_f32_16x16x32_bf16 v[44:47], a[4:7], a[28:31], v[44:47]
    v_mfma_f32_16x16x32_bf16 v[48:51], a[8:11], a[16:19], v[48:51]
    v_mfma_f32_16x16x32_bf16 v[52:55], a[8:11], a[20:23], v[52:55]
    v_mfma_f32_16x16x32_bf16 v[56:59], a[8:11], a[24:27], v[56:59]
    v_mfma_f32_16x16x32_bf16 v[60:63], a[8:11], a[28:31], v[60:63]
    v_mfma_f32_16x16x32_bf16 v[64:67], a[12:15], a[16:19], v[64:67]
    v_mfma_f32_16x16x32_bf16 v[68:71], a[12:15], a[20:23], v[68:71]
    v_mfma_f32_16x16x32_bf16 v[72:75], a[12:15], a[24:27], v[72:75]
    v_mfma_f32_16x16x32_bf16 v[76:79], a[12:15], a[28:31], v[76:79]
    s_waitcnt vmcnt(16)
    v_mfma_f32_16x16x32_bf16 v[16:19], a[32:35], a[48:51], v[16:19]
    v_mfma_f32_16x16x32_bf16 v[20:23], a[32:35], a[52:55], v[20:23]
    v_mfma_f32_16x16x32_bf16 v[24:27], a[32:35], a[56:59], v[24:27]
    v_mfma_f32_16x16x32_bf16 v[28:31], a[32:35], a[60:63], v[28:31]
    v_mfma_f32_16x16x32_bf16 v[32:35], a[36:39], a[48:51], v[32:35]
    v_mfma_f32_16x16x32_bf16 v[36:39], a[36:39], a[52:55], v[36:39]
    v_mfma_f32_16x16x32_bf16 v[40:43], a[36:39], a[56:59], v[40:43]
    v_mfma_f32_16x16x32_bf16 v[44:47], a[36:39], a[60:63], v[44:47]
    v_mfma_f32_16x16x32_bf16 v[48:51], a[40:43], a[48:51], v[48:51]
    v_mfma_f32_16x16x32_bf16 v[52:55], a[40:43], a[52:55], v[52:55]
    v_mfma_f32_16x16x32_bf16 v[56:59], a[40:43], a[56:59], v[56:59]
    v_mfma_f32_16x16x32_bf16 v[60:63], a[40:43], a[60:63], v[60:63]
    v_mfma_f32_16x16x32_bf16 v[64:67], a[44:47], a[48:51], v[64:67]
    v_mfma_f32_16x16x32_bf16 v[68:71], a[44:47], a[52:55], v[68:71]
    v_mfma_f32_16x16x32_bf16 v[72:75], a[44:47], a[56:59], v[72:75]
    v_mfma_f32_16x16x32_bf16 v[76:79], a[44:47], a[60:63], v[76:79]
    s_waitcnt vmcnt(8)
    v_mfma_f32_16x16x32_bf16 v[16:19], a[64:67], a[80:83], v[16:19]
    v_mfma_f32_16x16x32_bf16 v[20:23], a[64:67], a[84:87], v[20:23]
    v_mfma_f32_16x16x32_bf16 v[24:27], a[64:67], a[88:91], v[24:27]
    v_mfma_f32_16x16x32_bf16 v[28:31], a[64:67], a[92:95], v[28:31]
    v_mfma_f32_16x16x32_bf16 v[32:35], a[68:71], a[80:83], v[32:35]
    v_mfma_f32_16x16x32_bf16 v[36:39], a[68:71], a[84:87], v[36:39]
    v_mfma_f32_16x16x32_bf16 v[40:43], a[68:71], a[88:91], v[40:43]
    v_mfma_f32_16x16x32_bf16 v[44:47], a[68:71], a[92:95], v[44:47]
    v_mfma_f32_16x16x32_bf16 v[48:51], a[72:75], a[80:83], v[48:51]
    v_mfma_f32_16x16x32_bf16 v[52:55], a[72:75], a[84:87], v[52:55]
    v_mfma_f32_16x16x32_bf16 v[56:59], a[72:75], a[88:91], v[56:59]
    v_mfma_f32_16x16x32_bf16 v[60:63], a[72:75], a[92:95], v[60:63]
    v_mfma_f32_16x16x32_bf16 v[64:67], a[76:79], a[80:83], v[64:67]
    v_mfma_f32_16x16x32_bf16 v[68:71], a[76:79], a[84:87], v[68:71]
    v_mfma_f32_16x16x32_bf16 v[72:75], a[76:79], a[88:91], v[72:75]
    v_mfma_f32_16x16x32_bf16 v[76:79], a[76:79], a[92:95], v[76:79]
    s_waitcnt vmcnt(0)
    v_mfma_f32_16x16x32_bf16 v[16:19], a[96:99], a[112:115], v[16:19]
    v_mfma_f32_16x16x32_bf16 v[20:23], a[96:99], a[116:119], v[20:23]
    v_mfma_f32_16x16x32_bf16 v[24:27], a[96:99], a[120:123], v[24:27]
    v_mfma_f32_16x16x32_bf16 v[28:31], a[96:99], a[124:127], v[28:31]
    v_mfma_f32_16x16x32_bf16 v[32:35], a[100:103], a[112:115], v[32:35]
    v_mfma_f32_16x16x32_bf16 v[36:39], a[100:103], a[116:119], v[36:39]
    v_mfma_f32_16x16x32_bf16 v[40:43], a[100:103], a[120:123], v[40:43]
    v_mfma_f32_16x16x32_bf16 v[44:47], a[100:103], a[124:127], v[44:47]
    v_mfma_f32_16x16x32_bf16 v[48:51], a[104:107], a[112:115], v[48:51]
    v_mfma_f32_16x16x32_bf16 v[52:55], a[104:107], a[116:119], v[52:55]
    v_mfma_f32_16x16x32_bf16 v[56:59], a[104:107], a[120:123], v[56:59]
    v_mfma_f32_16x16x32_bf16 v[60:63], a[104:107], a[124:127], v[60:63]
    v_mfma_f32_16x16x32_bf16 v[64:67], a[108:111], a[112:115], v[64:67]
    v_mfma_f32_16x16x32_bf16 v[68:71], a[108:111], a[116:119], v[68:71]
    v_mfma_f32_16x16x32_bf16 v[72:75], a[108:111], a[120:123], v[72:75]
    v_mfma_f32_16x16x32_bf16 v[76:79], a[108:111], a[124:127], v[76:79]
    s_nop 7
    s_nop 7
    s_cmp_ge_u32 s25, 384
    s_cselect_b32 s30, 384, 0
    s_cselect_b32 s32, 25165824, 0
    s_sub_u32 s30, s25, s30
    s_lshr_b32 s30, s30, 1
    s_add_u32 s32, s32, 40062976
    s_mul_i32 s31, s26, 192
    s_add_u32 s31, s31, s30
    s_lshl_b32 s31, s31, 10
    s_add_u32 s32, s32, s31
    v_cvt_pk_bf16_f32 v144, v16, v17
    v_cvt_pk_bf16_f32 v145, v18, v19
    v_cvt_pk_bf16_f32 v146, v32, v33
    v_cvt_pk_bf16_f32 v147, v34, v35
    s_add_u32 s31, s32, 0
    buffer_store_dwordx4 v[144:147], v2, s[4:7], s31 offen sc1
    v_cvt_pk_bf16_f32 v148, v48, v49
    v_cvt_pk_bf16_f32 v149, v50, v51
    v_cvt_pk_bf16_f32 v150, v64, v65
    v_cvt_pk_bf16_f32 v151, v66, v67
    s_add_u32 s31, s32, 1024
    buffer_store_dwordx4 v[148:151], v2, s[4:7], s31 offen sc1
    v_cvt_pk_bf16_f32 v152, v20, v21
    v_cvt_pk_bf16_f32 v153, v22, v23
    v_cvt_pk_bf16_f32 v154, v36, v37
    v_cvt_pk_bf16_f32 v155, v38, v39
    s_add_u32 s31, s32, 196608
    buffer_store_dwordx4 v[152:155], v2, s[4:7], s31 offen sc1
    v_cvt_pk_bf16_f32 v156, v52, v53
    v_cvt_pk_bf16_f32 v157, v54, v55
    v_cvt_pk_bf16_f32 v158, v68, v69
    v_cvt_pk_bf16_f32 v159, v70, v71
    s_add_u32 s31, s32, 197632
    buffer_store_dwordx4 v[156:159], v2, s[4:7], s31 offen sc1
    v_cvt_pk_bf16_f32 v160, v24, v25
    v_cvt_pk_bf16_f32 v161, v26, v27
    v_cvt_pk_bf16_f32 v162, v40, v41
    v_cvt_pk_bf16_f32 v163, v42, v43
    s_add_u32 s31, s32, 393216
    buffer_store_dwordx4 v[160:163], v2, s[4:7], s31 offen sc1
    v_cvt_pk_bf16_f32 v164, v56, v57
    v_cvt_pk_bf16_f32 v165, v58, v59
    v_cvt_pk_bf16_f32 v166, v72, v73
    v_cvt_pk_bf16_f32 v167, v74, v75
    s_add_u32 s31, s32, 394240
    buffer_store_dwordx4 v[164:167], v2, s[4:7], s31 offen sc1
    v_cvt_pk_bf16_f32 v168, v28, v29
    v_cvt_pk_bf16_f32 v169, v30, v31
    v_cvt_pk_bf16_f32 v170, v44, v45
    v_cvt_pk_bf16_f32 v171, v46, v47
    s_add_u32 s31, s32, 589824
    buffer_store_dwordx4 v[168:171], v2, s[4:7], s31 offen sc1
    v_cvt_pk_bf16_f32 v172, v60, v61
    v_cvt_pk_bf16_f32 v173, v62, v63
    v_cvt_pk_bf16_f32 v174, v76, v77
    v_cvt_pk_bf16_f32 v175, v78, v79
    s_add_u32 s31, s32, 590848
    buffer_store_dwordx4 v[172:175], v2, s[4:7], s31 offen sc1
    s_branch L_w_fin
L_w_next:
    s_cmp_lg_u32 s20, 0
    s_cbranch_scc1 L_w_nq
    v_mov_b32 v4, 1
    v_mov_b32 v5, 0
    s_lshl_b32 s22, s66, 7
    s_add_u32 s22, s22, 250844160
    s_mov_b64 exec, 1
    buffer_atomic_add v4, v5, s[4:7], s22 offen sc0
    s_waitcnt vmcnt(0)
    v_mov_b32 v5, 49216
    ds_write_b32 v5, v4
    s_mov_b64 exec, -1
    s_waitcnt lgkmcnt(0)
L_w_nq:
    s_barrier
    v_mov_b32 v5, 49216
    ds_read_b32 v4, v5
    s_waitcnt lgkmcnt(0)
    v_readfirstlane_b32 s70, v4
    s_barrier
    s_cmp_lt_u32 s70, 157
    s_cbranch_scc1 L_w_got
    s_add_u32 s66, s66, 1
    s_and_b32 s66, s66, 7
    s_add_u32 s67, s67, 1
    s_cmp_lt_u32 s67, 8
    s_cbranch_scc1 L_w_next
    s_branch L_w_end
L_w_got:
    s_mul_i32 s24, s66, 3
    s_lshl_b32 s23, s66, 2
    s_cmp_lt_u32 s70, 14
    s_cbranch_scc0 L_w_q1
    s_cmp_ge_u32 s70, 7
    s_cselect_b32 s21, 2, 1
    s_cselect_b32 s22, 7, 0
    s_sub_u32 s22, s70, s22
    s_branch L_w_C
L_w_q1:
    s_cmp_lt_u32 s70, 21
    s_cbranch_scc0 L_w_q2
    s_mov_b32 s21, 0
    s_sub_u32 s22, s70, 14
    s_cmp_lt_u32 s22, 4
    s_cbranch_scc1 L_w_C
    s_sub_u32 s22, s22, 4
    s_branch L_w_Q
L_w_q2:
    s_cmp_lt_u32 s70, 151
    s_cbranch_scc0 L_w_q3
    s_sub_u32 s70, s70, 21
    s_mul_hi_u32 s21, s70, 429496730
    s_mul_i32 s22, s21, 10
    s_sub_u32 s22, s70, s22
    s_add_u32 s21, s21, 3
    s_cmp_lt_u32 s22, 7
    s_cbranch_scc1 L_w_C
    s_sub_u32 s21, s21, 2
    s_sub_u32 s22, s22, 7
    s_branch L_w_Q
L_w_q3:
    s_sub_u32 s22, s70, 151
    s_cmp_ge_u32 s22, 3
    s_cselect_b32 s21, 15, 14
    s_cselect_b32 s70, 3, 0
    s_sub_u32 s22, s22, s70
L_w_Q:
    s_add_u32 s71, s24, s22
    s_add_u32 s71, s71, 32
    s_branch L_w_T
L_w_C:
    s_add_u32 s23, s23, s22
    s_add_u32 s24, s24, s22
    s_add_u32 s24, s24, 52
    s_cmp_lt_u32 s22, 4
    s_cselect_b32 s71, s23, s24
L_w_T:
    s_mul_i32 s72, s21, 80
    s_add_u32 s72, s72, s71
L_w_task:
    s_mul_hi_u32 s21, s72, 53687092
    s_mul_i32 s22, s21, 80
    s_sub_u32 s71, s72, s22
    s_cmp_lt_u32 s71, 32
    s_cbranch_scc1 L_w_vo
    s_sub_u32 s22, s71, 32
    s_and_b32 s23, s20, 1
    s_lshr_b32 s24, s20, 1
    s_lshl_b32 s25, s22, 4
    s_lshl_b32 s26, s24, 3
    s_add_u32 s25, s25, s26
    s_lshl_b32 s26, s21, 3
    s_lshl_b32 s27, s23, 2
    s_add_u32 s26, s26, s27
    s_mul_i32 s27, s25, 20480
    s_add_u32 s27, s27, 4673536
    v_add_u32 v4, s27, v2
    s_add_u32 s27, s27, 20480
    v_add_u32 v5, s27, v2
    s_add_u32 s27, s27, 20480
    v_add_u32 v6, s27, v2
    s_add_u32 s27, s27, 20480
    v_add_u32 v7, s27, v2
    s_add_u32 s27, s27, 20480
    v_add_u32 v8, s27, v2
    s_add_u32 s27, s27, 20480
    v_add_u32 v9, s27, v2
    s_add_u32 s27, s27, 20480
    v_add_u32 v10, s27, v2
    s_add_u32 s27, s27, 20480
    v_add_u32 v11, s27, v2
    s_mul_i32 s27, s26, 20480
    s_add_u32 s27, s27, 2052096
    v_add_u32 v12, s27, v2
    s_add_u32 s27, s27, 20480
    v_add_u32 v13, s27, v2
    s_add_u32 s27, s27, 20480
    v_add_u32 v14, s27, v2
    s_add_u32 s27, s27, 20480
    v_add_u32 v15, s27, v2
    s_mov_b32 s28, 0
    buffer_load_dwordx4 a[0:3], v4, s[4:7], s28 offen
    buffer_load_dwordx4 a[4:7], v5, s[4:7], s28 offen
    buffer_load_dwordx4 a[8:11], v6, s[4:7], s28 offen
    buffer_load_dwordx4 a[12:15], v7, s[4:7], s28 offen
    buffer_load_dwordx4 a[16:19], v8, s[4:7], s28 offen
    buffer_load_dwordx4 a[20:23], v9, s[4:7], s28 offen
    buffer_load_dwordx4 a[24:27], v10, s[4:7], s28 offen
    buffer_load_dwordx4 a[28:31], v11, s[4:7], s28 offen
    buffer_load_dwordx4 a[32:35], v12, s[4:7], s28 offen
    buffer_load_dwordx4 a[36:39], v13, s[4:7], s28 offen
    buffer_load_dwordx4 a[40:43], v14, s[4:7], s28 offen
    buffer_load_dwordx4 a[44:47], v15, s[4:7], s28 offen
    s_mov_b32 s28, 1024
    buffer_load_dwordx4 a[48:51], v4, s[4:7], s28 offen
    buffer_load_dwordx4 a[52:55], v5, s[4:7], s28 offen
    buffer_load_dwordx4 a[56:59], v6, s[4:7], s28 offen
    buffer_load_dwordx4 a[60:63], v7, s[4:7], s28 offen
    buffer_load_dwordx4 a[64:67], v8, s[4:7], s28 offen
    buffer_load_dwordx4 a[68:71], v9, s[4:7], s28 offen
    buffer_load_dwordx4 a[72:75], v10, s[4:7], s28 offen
    buffer_load_dwordx4 a[76:79], v11, s[4:7], s28 offen
    buffer_load_dwordx4 a[80:83], v12, s[4:7], s28 offen
    buffer_load_dwordx4 a[84:87], v13, s[4:7], s28 offen
    buffer_load_dwordx4 a[88:91], v14, s[4:7], s28 offen
    buffer_load_dwordx4 a[92:95], v15, s[4:7], s28 offen
    s_mov_b32 s28, 2048
    buffer_load_dwordx4 a[96:99], v4, s[4:7], s28 offen
    buffer_load_dwordx4 a[100:103], v5, s[4:7], s28 offen
    buffer_load_dwordx4 a[104:107], v6, s[4:7], s28 offen
    buffer_load_dwordx4 a[108:111], v7, s[4:7], s28 offen
    buffer_load_dwordx4 a[112:115], v8, s[4:7], s28 offen
    buffer_load_dwordx4 a[116:119], v9, s[4:7], s28 offen
    buffer_load_dwordx4 a[120:123], v10, s[4:7], s28 offen
    buffer_load_dwordx4 a[124:127], v11, s[4:7], s28 offen
    buffer_load_dwordx4 a[128:131], v12, s[4:7], s28 offen
    buffer_load_dwordx4 a[132:135], v13, s[4:7], s28 offen
    buffer_load_dwordx4 a[136:139], v14, s[4:7], s28 offen
    buffer_load_dwordx4 a[140:143], v15, s[4:7], s28 offen
    s_mov_b32 s28, 3072
    buffer_load_dwordx4 a[144:147], v4, s[4:7], s28 offen
    buffer_load_dwordx4 a[148:151], v5, s[4:7], s28 offen
    buffer_load_dwordx4 a[152:155], v6, s[4:7], s28 offen
    buffer_load_dwordx4 a[156:159], v7, s[4:7], s28 offen
    buffer_load_dwordx4 a[160:163], v8, s[4:7], s28 offen
    buffer_load_dwordx4 a[164:167], v9, s[4:7], s28 offen
    buffer_load_dwordx4 a[168:171], v10, s[4:7], s28 offen
    buffer_load_dwordx4 a[172:175], v11, s[4:7], s28 offen
    buffer_load_dwordx4 a[176:179], v12, s[4:7], s28 offen
    buffer_load_dwordx4 a[180:183], v13, s[4:7], s28 offen
    buffer_load_dwordx4 a[184:187], v14, s[4:7], s28 offen
    buffer_load_dwordx4 a[188:191], v15, s[4:7], s28 offen
    s_mov_b32 s28, 4096
    buffer_load_dwordx4 a[192:195], v4, s[4:7], s28 offen
    buffer_load_dwordx4 a[196:199], v5, s[4:7], s28 offen
    buffer_load_dwordx4 a[200:203], v6, s[4:7], s28 offen
    buffer_load_dwordx4 a[204:207], v7, s[4:7], s28 offen
    buffer_load_dwordx4 a[208:211], v8, s[4:7], s28 offen
    buffer_load_dwordx4 a[212:215], v9, s[4:7], s28 offen
    buffer_load_dwordx4 a[216:219], v10, s[4:7], s28 offen
    buffer_load_dwordx4 a[220:223], v11, s[4:7], s28 offen
    buffer_load_dwordx4 a[224:227], v12, s[4:7], s28 offen
    buffer_load_dwordx4 a[228:231], v13, s[4:7], s28 offen
    buffer_load_dwordx4 a[232:235], v14, s[4:7], s28 offen
    buffer_load_dwordx4 a[236:239], v15, s[4:7], s28 offen
    s_waitcnt vmcnt(48)
    v_mfma_f32_16x16x32_bf16 v[16:19], a[0:3], a[32:35], 0
    v_mfma_f32_16x16x32_bf16 v[20:23], a[0:3], a[36:39], 0
    v_mfma_f32_16x16x32_bf16 v[24:27], a[0:3], a[40:43], 0
    v_mfma_f32_16x16x32_bf16 v[28:31], a[0:3], a[44:47], 0
    v_mfma_f32_16x16x32_bf16 v[32:35], a[4:7], a[32:35], 0
    v_mfma_f32_16x16x32_bf16 v[36:39], a[4:7], a[36:39], 0
    v_mfma_f32_16x16x32_bf16 v[40:43], a[4:7], a[40:43], 0
    v_mfma_f32_16x16x32_bf16 v[44:47], a[4:7], a[44:47], 0
    v_mfma_f32_16x16x32_bf16 v[48:51], a[8:11], a[32:35], 0
    v_mfma_f32_16x16x32_bf16 v[52:55], a[8:11], a[36:39], 0
    v_mfma_f32_16x16x32_bf16 v[56:59], a[8:11], a[40:43], 0
    v_mfma_f32_16x16x32_bf16 v[60:63], a[8:11], a[44:47], 0
    v_mfma_f32_16x16x32_bf16 v[64:67], a[12:15], a[32:35], 0
    v_mfma_f32_16x16x32_bf16 v[68:71], a[12:15], a[36:39], 0
    v_mfma_f32_16x16x32_bf16 v[72:75], a[12:15], a[40:43], 0
    v_mfma_f32_16x16x32_bf16 v[76:79], a[12:15], a[44:47], 0
    v_mfma_f32_16x16x32_bf16 v[80:83], a[16:19], a[32:35], 0
    v_mfma_f32_16x16x32_bf16 v[84:87], a[16:19], a[36:39], 0
    v_mfma_f32_16x16x32_bf16 v[88:91], a[16:19], a[40:43], 0
    v_mfma_f32_16x16x32_bf16 v[92:95], a[16:19], a[44:47], 0
    v_mfma_f32_16x16x32_bf16 v[96:99], a[20:23], a[32:35], 0
    v_mfma_f32_16x16x32_bf16 v[100:103], a[20:23], a[36:39], 0
    v_mfma_f32_16x16x32_bf16 v[104:107], a[20:23], a[40:43], 0
    v_mfma_f32_16x16x32_bf16 v[108:111], a[20:23], a[44:47], 0
    v_mfma_f32_16x16x32_bf16 v[112:115], a[24:27], a[32:35], 0
    v_mfma_f32_16x16x32_bf16 v[116:119], a[24:27], a[36:39], 0
    v_mfma_f32_16x16x32_bf16 v[120:123], a[24:27], a[40:43], 0
    v_mfma_f32_16x16x32_bf16 v[124:127], a[24:27], a[44:47], 0
    v_mfma_f32_16x16x32_bf16 v[128:131], a[28:31], a[32:35], 0
    v_mfma_f32_16x16x32_bf16 v[132:135], a[28:31], a[36:39], 0
    v_mfma_f32_16x16x32_bf16 v[136:139], a[28:31], a[40:43], 0
    v_mfma_f32_16x16x32_bf16 v[140:143], a[28:31], a[44:47], 0
    s_mov_b32 s28, 5120
    buffer_load_dwordx4 a[0:3], v4, s[4:7], s28 offen
    buffer_load_dwordx4 a[4:7], v5, s[4:7], s28 offen
    buffer_load_dwordx4 a[8:11], v6, s[4:7], s28 offen
    buffer_load_dwordx4 a[12:15], v7, s[4:7], s28 offen
    buffer_load_dwordx4 a[16:19], v8, s[4:7], s28 offen
    buffer_load_dwordx4 a[20:23], v9, s[4:7], s28 offen
    buffer_load_dwordx4 a[24:27], v10, s[4:7], s28 offen
    buffer_load_dwordx4 a[28:31], v11, s[4:7], s28 offen
    buffer_load_dwordx4 a[32:35], v12, s[4:7], s28 offen
    buffer_load_dwordx4 a[36:39], v13, s[4:7], s28 offen
    buffer_load_dwordx4 a[40:43], v14, s[4:7], s28 offen
    buffer_load_dwordx4 a[44:47], v15, s[4:7], s28 offen
    s_waitcnt vmcnt(48)
    v_mfma_f32_16x16x32_bf16 v[16:19], a[48:51], a[80:83], v[16:19]
    v_mfma_f32_16x16x32_bf16 v[20:23], a[48:51], a[84:87], v[20:23]
    v_mfma_f32_16x16x32_bf16 v[24:27], a[48:51], a[88:91], v[24:27]
    v_mfma_f32_16x16x32_bf16 v[28:31], a[48:51], a[92:95], v[28:31]
    v_mfma_f32_16x16x32_bf16 v[32:35], a[52:55], a[80:83], v[32:35]
    v_mfma_f32_16x16x32_bf16 v[36:39], a[52:55], a[84:87], v[36:39]
    v_mfma_f32_16x16x32_bf16 v[40:43], a[52:55], a[88:91], v[40:43]
    v_mfma_f32_16x16x32_bf16 v[44:47], a[52:55], a[92:95], v[44:47]
    v_mfma_f32_16x16x32_bf16 v[48:51], a[56:59], a[80:83], v[48:51]
    v_mfma_f32_16x16x32_bf16 v[52:55], a[56:59], a[84:87], v[52:55]
    v_mfma_f32_16x16x32_bf16 v[56:59], a[56:59], a[88:91], v[56:59]
    v_mfma_f32_16x16x32_bf16 v[60:63], a[56:59], a[92:95], v[60:63]
    v_mfma_f32_16x16x32_bf16 v[64:67], a[60:63], a[80:83], v[64:67]
    v_mfma_f32_16x16x32_bf16 v[68:71], a[60:63], a[84:87], v[68:71]
    v_mfma_f32_16x16x32_bf16 v[72:75], a[60:63], a[88:91], v[72:75]
    v_mfma_f32_16x16x32_bf16 v[76:79], a[60:63], a[92:95], v[76:79]
    v_mfma_f32_16x16x32_bf16 v[80:83], a[64:67], a[80:83], v[80:83]
    v_mfma_f32_16x16x32_bf16 v[84:87], a[64:67], a[84:87], v[84:87]
    v_mfma_f32_16x16x32_bf16 v[88:91], a[64:67], a[88:91], v[88:91]
    v_mfma_f32_16x16x32_bf16 v[92:95], a[64:67], a[92:95], v[92:95]
    v_mfma_f32_16x16x32_bf16 v[96:99], a[68:71], a[80:83], v[96:99]
    v_mfma_f32_16x16x32_bf16 v[100:103], a[68:71], a[84:87], v[100:103]
    v_mfma_f32_16x16x32_bf16 v[104:107], a[68:71], a[88:91], v[104:107]
    v_mfma_f32_16x16x32_bf16 v[108:111], a[68:71], a[92:95], v[108:111]
    v_mfma_f32_16x16x32_bf16 v[112:115], a[72:75], a[80:83], v[112:115]
    v_mfma_f32_16x16x32_bf16 v[116:119], a[72:75], a[84:87], v[116:119]
    v_mfma_f32_16x16x32_bf16 v[120:123], a[72:75], a[88:91], v[120:123]
    v_mfma_f32_16x16x32_bf16 v[124:127], a[72:75], a[92:95], v[124:127]
    v_mfma_f32_16x16x32_bf16 v[128:131], a[76:79], a[80:83], v[128:131]
    v_mfma_f32_16x16x32_bf16 v[132:135], a[76:79], a[84:87], v[132:135]
    v_mfma_f32_16x16x32_bf16 v[136:139], a[76:79], a[88:91], v[136:139]
    v_mfma_f32_16x16x32_bf16 v[140:143], a[76:79], a[92:95], v[140:143]
    s_mov_b32 s28, 6144
    buffer_load_dwordx4 a[48:51], v4, s[4:7], s28 offen
    buffer_load_dwordx4 a[52:55], v5, s[4:7], s28 offen
    buffer_load_dwordx4 a[56:59], v6, s[4:7], s28 offen
    buffer_load_dwordx4 a[60:63], v7, s[4:7], s28 offen
    buffer_load_dwordx4 a[64:67], v8, s[4:7], s28 offen
    buffer_load_dwordx4 a[68:71], v9, s[4:7], s28 offen
    buffer_load_dwordx4 a[72:75], v10, s[4:7], s28 offen
    buffer_load_dwordx4 a[76:79], v11, s[4:7], s28 offen
    buffer_load_dwordx4 a[80:83], v12, s[4:7], s28 offen
    buffer_load_dwordx4 a[84:87], v13, s[4:7], s28 offen
    buffer_load_dwordx4 a[88:91], v14, s[4:7], s28 offen
    buffer_load_dwordx4 a[92:95], v15, s[4:7], s28 offen
    s_waitcnt vmcnt(48)
    v_mfma_f32_16x16x32_bf16 v[16:19], a[96:99], a[128:131], v[16:19]
    v_mfma_f32_16x16x32_bf16 v[20:23], a[96:99], a[132:135], v[20:23]
    v_mfma_f32_16x16x32_bf16 v[24:27], a[96:99], a[136:139], v[24:27]
    v_mfma_f32_16x16x32_bf16 v[28:31], a[96:99], a[140:143], v[28:31]
    v_mfma_f32_16x16x32_bf16 v[32:35], a[100:103], a[128:131], v[32:35]
    v_mfma_f32_16x16x32_bf16 v[36:39], a[100:103], a[132:135], v[36:39]
    v_mfma_f32_16x16x32_bf16 v[40:43], a[100:103], a[136:139], v[40:43]
    v_mfma_f32_16x16x32_bf16 v[44:47], a[100:103], a[140:143], v[44:47]
    v_mfma_f32_16x16x32_bf16 v[48:51], a[104:107], a[128:131], v[48:51]
    v_mfma_f32_16x16x32_bf16 v[52:55], a[104:107], a[132:135], v[52:55]
    v_mfma_f32_16x16x32_bf16 v[56:59], a[104:107], a[136:139], v[56:59]
    v_mfma_f32_16x16x32_bf16 v[60:63], a[104:107], a[140:143], v[60:63]
    v_mfma_f32_16x16x32_bf16 v[64:67], a[108:111], a[128:131], v[64:67]
    v_mfma_f32_16x16x32_bf16 v[68:71], a[108:111], a[132:135], v[68:71]
    v_mfma_f32_16x16x32_bf16 v[72:75], a[108:111], a[136:139], v[72:75]
    v_mfma_f32_16x16x32_bf16 v[76:79], a[108:111], a[140:143], v[76:79]
    v_mfma_f32_16x16x32_bf16 v[80:83], a[112:115], a[128:131], v[80:83]
    v_mfma_f32_16x16x32_bf16 v[84:87], a[112:115], a[132:135], v[84:87]
    v_mfma_f32_16x16x32_bf16 v[88:91], a[112:115], a[136:139], v[88:91]
    v_mfma_f32_16x16x32_bf16 v[92:95], a[112:115], a[140:143], v[92:95]
    v_mfma_f32_16x16x32_bf16 v[96:99], a[116:119], a[128:131], v[96:99]
    v_mfma_f32_16x16x32_bf16 v[100:103], a[116:119], a[132:135], v[100:103]
    v_mfma_f32_16x16x32_bf16 v[104:107], a[116:119], a[136:139], v[104:107]
    v_mfma_f32_16x16x32_bf16 v[108:111], a[116:119], a[140:143], v[108:111]
    v_mfma_f32_16x16x32_bf16 v[112:115], a[120:123], a[128:131], v[112:115]
    v_mfma_f32_16x16x32_bf16 v[116:119], a[120:123], a[132:135], v[116:119]
    v_mfma_f32_16x16x32_bf16 v[120:123], a[120:123], a[136:139], v[120:123]
    v_mfma_f32_16x16x32_bf16 v[124:127], a[120:123], a[140:143], v[124:127]
    v_mfma_f32_16x16x32_bf16 v[128:131], a[124:127], a[128:131], v[128:131]
    v_mfma_f32_16x16x32_bf16 v[132:135], a[124:127], a[132:135], v[132:135]
    v_mfma_f32_16x16x32_bf16 v[136:139], a[124:127], a[136:139], v[136:139]
    v_mfma_f32_16x16x32_bf16 v[140:143], a[124:127], a[140:143], v[140:143]
    s_mov_b32 s28, 7168
    buffer_load_dwordx4 a[96:99], v4, s[4:7], s28 offen
    buffer_load_dwordx4 a[100:103], v5, s[4:7], s28 offen
    buffer_load_dwordx4 a[104:107], v6, s[4:7], s28 offen
    buffer_load_dwordx4 a[108:111], v7, s[4:7], s28 offen
    buffer_load_dwordx4 a[112:115], v8, s[4:7], s28 offen
    buffer_load_dwordx4 a[116:119], v9, s[4:7], s28 offen
    buffer_load_dwordx4 a[120:123], v10, s[4:7], s28 offen
    buffer_load_dwordx4 a[124:127], v11, s[4:7], s28 offen
    buffer_load_dwordx4 a[128:131], v12, s[4:7], s28 offen
    buffer_load_dwordx4 a[132:135], v13, s[4:7], s28 offen
    buffer_load_dwordx4 a[136:139], v14, s[4:7], s28 offen
    buffer_load_dwordx4 a[140:143], v15, s[4:7], s28 offen
    s_waitcnt vmcnt(48)
    v_mfma_f32_16x16x32_bf16 v[16:19], a[144:147], a[176:179], v[16:19]
    v_mfma_f32_16x16x32_bf16 v[20:23], a[144:147], a[180:183], v[20:23]
    v_mfma_f32_16x16x32_bf16 v[24:27], a[144:147], a[184:187], v[24:27]
    v_mfma_f32_16x16x32_bf16 v[28:31], a[144:147], a[188:191], v[28:31]
    v_mfma_f32_16x16x32_bf16 v[32:35], a[148:151], a[176:179], v[32:35]
    v_mfma_f32_16x16x32_bf16 v[36:39], a[148:151], a[180:183], v[36:39]
    v_mfma_f32_16x16x32_bf16 v[40:43], a[148:151], a[184:187], v[40:43]
    v_mfma_f32_16x16x32_bf16 v[44:47], a[148:151], a[188:191], v[44:47]
    v_mfma_f32_16x16x32_bf16 v[48:51], a[152:155], a[176:179], v[48:51]
    v_mfma_f32_16x16x32_bf16 v[52:55], a[152:155], a[180:183], v[52:55]
    v_mfma_f32_16x16x32_bf16 v[56:59], a[152:155], a[184:187], v[56:59]
    v_mfma_f32_16x16x32_bf16 v[60:63], a[152:155], a[188:191], v[60:63]
    v_mfma_f32_16x16x32_bf16 v[64:67], a[156:159], a[176:179], v[64:67]
    v_mfma_f32_16x16x32_bf16 v[68:71], a[156:159], a[180:183], v[68:71]
    v_mfma_f32_16x16x32_bf16 v[72:75], a[156:159], a[184:187], v[72:75]
    v_mfma_f32_16x16x32_bf16 v[76:79], a[156:159], a[188:191], v[76:79]
    v_mfma_f32_16x16x32_bf16 v[80:83], a[160:163], a[176:179], v[80:83]
    v_mfma_f32_16x16x32_bf16 v[84:87], a[160:163], a[180:183], v[84:87]
    v_mfma_f32_16x16x32_bf16 v[88:91], a[160:163], a[184:187], v[88:91]
    v_mfma_f32_16x16x32_bf16 v[92:95], a[160:163], a[188:191], v[92:95]
    v_mfma_f32_16x16x32_bf16 v[96:99], a[164:167], a[176:179], v[96:99]
    v_mfma_f32_16x16x32_bf16 v[100:103], a[164:167], a[180:183], v[100:103]
    v_mfma_f32_16x16x32_bf16 v[104:107], a[164:167], a[184:187], v[104:107]
    v_mfma_f32_16x16x32_bf16 v[108:111], a[164:167], a[188:191], v[108:111]
    v_mfma_f32_16x16x32_bf16 v[112:115], a[168:171], a[176:179], v[112:115]
    v_mfma_f32_16x16x32_bf16 v[116:119], a[168:171], a[180:183], v[116:119]
    v_mfma_f32_16x16x32_bf16 v[120:123], a[168:171], a[184:187], v[120:123]
    v_mfma_f32_16x16x32_bf16 v[124:127], a[168:171], a[188:191], v[124:127]
    v_mfma_f32_16x16x32_bf16 v[128:131], a[172:175], a[176:179], v[128:131]
    v_mfma_f32_16x16x32_bf16 v[132:135], a[172:175], a[180:183], v[132:135]
    v_mfma_f32_16x16x32_bf16 v[136:139], a[172:175], a[184:187], v[136:139]
    v_mfma_f32_16x16x32_bf16 v[140:143], a[172:175], a[188:191], v[140:143]
    s_mov_b32 s28, 8192
    buffer_load_dwordx4 a[144:147], v4, s[4:7], s28 offen
    buffer_load_dwordx4 a[148:151], v5, s[4:7], s28 offen
    buffer_load_dwordx4 a[152:155], v6, s[4:7], s28 offen
    buffer_load_dwordx4 a[156:159], v7, s[4:7], s28 offen
    buffer_load_dwordx4 a[160:163], v8, s[4:7], s28 offen
    buffer_load_dwordx4 a[164:167], v9, s[4:7], s28 offen
    buffer_load_dwordx4 a[168:171], v10, s[4:7], s28 offen
    buffer_load_dwordx4 a[172:175], v11, s[4:7], s28 offen
    buffer_load_dwordx4 a[176:179], v12, s[4:7], s28 offen
    buffer_load_dwordx4 a[180:183], v13, s[4:7], s28 offen
    buffer_load_dwordx4 a[184:187], v14, s[4:7], s28 offen
    buffer_load_dwordx4 a[188:191], v15, s[4:7], s28 offen
    s_waitcnt vmcnt(48)
    v_mfma_f32_16x16x32_bf16 v[16:19], a[192:195], a[224:227], v[16:19]
    v_mfma_f32_16x16x32_bf16 v[20:23], a[192:195], a[228:231], v[20:23]
    v_mfma_f32_16x16x32_bf16 v[24:27], a[192:195], a[232:235], v[24:27]
    v_mfma_f32_16x16x32_bf16 v[28:31], a[192:195], a[236:239], v[28:31]
    v_mfma_f32_16x16x32_bf16 v[32:35], a[196:199], a[224:227], v[32:35]
    v_mfma_f32_16x16x32_bf16 v[36:39], a[196:199], a[228:231], v[36:39]
    v_mfma_f32_16x16x32_bf16 v[40:43], a[196:199], a[232:235], v[40:43]
    v_mfma_f32_16x16x32_bf16 v[44:47], a[196:199], a[236:239], v[44:47]
    v_mfma_f32_16x16x32_bf16 v[48:51], a[200:203], a[224:227], v[48:51]
    v_mfma_f32_16x16x32_bf16 v[52:55], a[200:203], a[228:231], v[52:55]
    v_mfma_f32_16x16x32_bf16 v[56:59], a[200:203], a[232:235], v[56:59]
    v_mfma_f32_16x16x32_bf16 v[60:63], a[200:203], a[236:239], v[60:63]
    v_mfma_f32_16x16x32_bf16 v[64:67], a[204:207], a[224:227], v[64:67]
    v_mfma_f32_16x16x32_bf16 v[68:71], a[204:207], a[228:231], v[68:71]
    v_mfma_f32_16x16x32_bf16 v[72:75], a[204:207], a[232:235], v[72:75]
    v_mfma_f32_16x16x32_bf16 v[76:79], a[204:207], a[236:239], v[76:79]
    v_mfma_f32_16x16x32_bf16 v[80:83], a[208:211], a[224:227], v[80:83]
    v_mfma_f32_16x16x32_bf16 v[84:87], a[208:211], a[228:231], v[84:87]
    v_mfma_f32_16x16x32_bf16 v[88:91], a[208:211], a[232:235], v[88:91]
    v_mfma_f32_16x16x32_bf16 v[92:95], a[208:211], a[236:239], v[92:95]
    v_mfma_f32_16x16x32_bf16 v[96:99], a[212:215], a[224:227], v[96:99]
    v_mfma_f32_16x16x32_bf16 v[100:103], a[212:215], a[228:231], v[100:103]
    v_mfma_f32_16x16x32_bf16 v[104:107], a[212:215], a[232:235], v[104:107]
    v_mfma_f32_16x16x32_bf16 v[108:111], a[212:215], a[236:239], v[108:111]
    v_mfma_f32_16x16x32_bf16 v[112:115], a[216:219], a[224:227], v[112:115]
    v_mfma_f32_16x16x32_bf16 v[116:119], a[216:219], a[228:231], v[116:119]
    v_mfma_f32_16x16x32_bf16 v[120:123], a[216:219], a[232:235], v[120:123]
    v_mfma_f32_16x16x32_bf16 v[124:127], a[216:219], a[236:239], v[124:127]
    v_mfma_f32_16x16x32_bf16 v[128:131], a[220:223], a[224:227], v[128:131]
    v_mfma_f32_16x16x32_bf16 v[132:135], a[220:223], a[228:231], v[132:135]
    v_mfma_f32_16x16x32_bf16 v[136:139], a[220:223], a[232:235], v[136:139]
    v_mfma_f32_16x16x32_bf16 v[140:143], a[220:223], a[236:239], v[140:143]
    s_mov_b32 s28, 9216
    buffer_load_dwordx4 a[192:195], v4, s[4:7], s28 offen
    buffer_load_dwordx4 a[196:199], v5, s[4:7], s28 offen
    buffer_load_dwordx4 a[200:203], v6, s[4:7], s28 offen
    buffer_load_dwordx4 a[204:207], v7, s[4:7], s28 offen
    buffer_load_dwordx4 a[208:211], v8, s[4:7], s28 offen
    buffer_load_dwordx4 a[212:215], v9, s[4:7], s28 offen
    buffer_load_dwordx4 a[216:219], v10, s[4:7], s28 offen
    buffer_load_dwordx4 a[220:223], v11, s[4:7], s28 offen
    buffer_load_dwordx4 a[224:227], v12, s[4:7], s28 offen
    buffer_load_dwordx4 a[228:231], v13, s[4:7], s28 offen
    buffer_load_dwordx4 a[232:235], v14, s[4:7], s28 offen
    buffer_load_dwordx4 a[236:239], v15, s[4:7], s28 offen
    s_waitcnt vmcnt(48)
    v_mfma_f32_16x16x32_bf16 v[16:19], a[0:3], a[32:35], v[16:19]
    v_mfma_f32_16x16x32_bf16 v[20:23], a[0:3], a[36:39], v[20:23]
    v_mfma_f32_16x16x32_bf16 v[24:27], a[0:3], a[40:43], v[24:27]
    v_mfma_f32_16x16x32_bf16 v[28:31], a[0:3], a[44:47], v[28:31]
    v_mfma_f32_16x16x32_bf16 v[32:35], a[4:7], a[32:35], v[32:35]
    v_mfma_f32_16x16x32_bf16 v[36:39], a[4:7], a[36:39], v[36:39]
    v_mfma_f32_16x16x32_bf16 v[40:43], a[4:7], a[40:43], v[40:43]
    v_mfma_f32_16x16x32_bf16 v[44:47], a[4:7], a[44:47], v[44:47]
    v_mfma_f32_16x16x32_bf16 v[48:51], a[8:11], a[32:35], v[48:51]
    v_mfma_f32_16x16x32_bf16 v[52:55], a[8:11], a[36:39], v[52:55]
    v_mfma_f32_16x16x32_bf16 v[56:59], a[8:11], a[40:43], v[56:59]
    v_mfma_f32_16x16x32_bf16 v[60:63], a[8:11], a[44:47], v[60:63]
    v_mfma_f32_16x16x32_bf16 v[64:67], a[12:15], a[32:35], v[64:67]
    v_mfma_f32_16x16x32_bf16 v[68:71], a[12:15], a[36:39], v[68:71]
    v_mfma_f32_16x16x32_bf16 v[72:75], a[12:15], a[40:43], v[72:75]
    v_mfma_f32_16x16x32_bf16 v[76:79], a[12:15], a[44:47], v[76:79]
    v_mfma_f32_16x16x32_bf16 v[80:83], a[16:19], a[32:35], v[80:83]
    v_mfma_f32_16x16x32_bf16 v[84:87], a[16:19], a[36:39], v[84:87]
    v_mfma_f32_16x16x32_bf16 v[88:91], a[16:19], a[40:43], v[88:91]
    v_mfma_f32_16x16x32_bf16 v[92:95], a[16:19], a[44:47], v[92:95]
    v_mfma_f32_16x16x32_bf16 v[96:99], a[20:23], a[32:35], v[96:99]
    v_mfma_f32_16x16x32_bf16 v[100:103], a[20:23], a[36:39], v[100:103]
    v_mfma_f32_16x16x32_bf16 v[104:107], a[20:23], a[40:43], v[104:107]
    v_mfma_f32_16x16x32_bf16 v[108:111], a[20:23], a[44:47], v[108:111]
    v_mfma_f32_16x16x32_bf16 v[112:115], a[24:27], a[32:35], v[112:115]
    v_mfma_f32_16x16x32_bf16 v[116:119], a[24:27], a[36:39], v[116:119]
    v_mfma_f32_16x16x32_bf16 v[120:123], a[24:27], a[40:43], v[120:123]
    v_mfma_f32_16x16x32_bf16 v[124:127], a[24:27], a[44:47], v[124:127]
    v_mfma_f32_16x16x32_bf16 v[128:131], a[28:31], a[32:35], v[128:131]
    v_mfma_f32_16x16x32_bf16 v[132:135], a[28:31], a[36:39], v[132:135]
    v_mfma_f32_16x16x32_bf16 v[136:139], a[28:31], a[40:43], v[136:139]
    v_mfma_f32_16x16x32_bf16 v[140:143], a[28:31], a[44:47], v[140:143]
    s_mov_b32 s28, 10240
    buffer_load_dwordx4 a[0:3], v4, s[4:7], s28 offen
    buffer_load_dwordx4 a[4:7], v5, s[4:7], s28 offen
    buffer_load_dwordx4 a[8:11], v6, s[4:7], s28 offen
    buffer_load_dwordx4 a[12:15], v7, s[4:7], s28 offen
    buffer_load_dwordx4 a[16:19], v8, s[4:7], s28 offen
    buffer_load_dwordx4 a[20:23], v9, s[4:7], s28 offen
    buffer_load_dwordx4 a[24:27], v10, s[4:7], s28 offen
    buffer_load_dwordx4 a[28:31], v11, s[4:7], s28 offen
    buffer_load_dwordx4 a[32:35], v12, s[4:7], s28 offen
    buffer_load_dwordx4 a[36:39], v13, s[4:7], s28 offen
    buffer_load_dwordx4 a[40:43], v14, s[4:7], s28 offen
    buffer_load_dwordx4 a[44:47], v15, s[4:7], s28 offen
    s_waitcnt vmcnt(48)
    v_mfma_f32_16x16x32_bf16 v[16:19], a[48:51], a[80:83], v[16:19]
    v_mfma_f32_16x16x32_bf16 v[20:23], a[48:51], a[84:87], v[20:23]
    v_mfma_f32_16x16x32_bf16 v[24:27], a[48:51], a[88:91], v[24:27]
    v_mfma_f32_16x16x32_bf16 v[28:31], a[48:51], a[92:95], v[28:31]
    v_mfma_f32_16x16x32_bf16 v[32:35], a[52:55], a[80:83], v[32:35]
    v_mfma_f32_16x16x32_bf16 v[36:39], a[52:55], a[84:87], v[36:39]
    v_mfma_f32_16x16x32_bf16 v[40:43], a[52:55], a[88:91], v[40:43]
    v_mfma_f32_16x16x32_bf16 v[44:47], a[52:55], a[92:95], v[44:47]
    v_mfma_f32_16x16x32_bf16 v[48:51], a[56:59], a[80:83], v[48:51]
    v_mfma_f32_16x16x32_bf16 v[52:55], a[56:59], a[84:87], v[52:55]
    v_mfma_f32_16x16x32_bf16 v[56:59], a[56:59], a[88:91], v[56:59]
    v_mfma_f32_16x16x32_bf16 v[60:63], a[56:59], a[92:95], v[60:63]
    v_mfma_f32_16x16x32_bf16 v[64:67], a[60:63], a[80:83], v[64:67]
    v_mfma_f32_16x16x32_bf16 v[68:71], a[60:63], a[84:87], v[68:71]
    v_mfma_f32_16x16x32_bf16 v[72:75], a[60:63], a[88:91], v[72:75]
    v_mfma_f32_16x16x32_bf16 v[76:79], a[60:63], a[92:95], v[76:79]
    v_mfma_f32_16x16x32_bf16 v[80:83], a[64:67], a[80:83], v[80:83]
    v_mfma_f32_16x16x32_bf16 v[84:87], a[64:67], a[84:87], v[84:87]
    v_mfma_f32_16x16x32_bf16 v[88:91], a[64:67], a[88:91], v[88:91]
    v_mfma_f32_16x16x32_bf16 v[92:95], a[64:67], a[92:95], v[92:95]
    v_mfma_f32_16x16x32_bf16 v[96:99], a[68:71], a[80:83], v[96:99]
    v_mfma_f32_16x16x32_bf16 v[100:103], a[68:71], a[84:87], v[100:103]
    v_mfma_f32_16x16x32_bf16 v[104:107], a[68:71], a[88:91], v[104:107]
    v_mfma_f32_16x16x32_bf16 v[108:111], a[68:71], a[92:95], v[108:111]
    v_mfma_f32_16x16x32_bf16 v[112:115], a[72:75], a[80:83], v[112:115]
    v_mfma_f32_16x16x32_bf16 v[116:119], a[72:75], a[84:87], v[116:119]
    v_mfma_f32_16x16x32_bf16 v[120:123], a[72:75], a[88:91], v[120:123]
    v_mfma_f32_16x16x32_bf16 v[124:127], a[72:75], a[92:95], v[124:127]
    v_mfma_f32_16x16x32_bf16 v[128:131], a[76:79], a[80:83], v[128:131]
    v_mfma_f32_16x16x32_bf16 v[132:135], a[76:79], a[84:87], v[132:135]
    v_mfma_f32_16x16x32_bf16 v[136:139], a[76:79], a[88:91], v[136:139]
    v_mfma_f32_16x16x32_bf16 v[140:143], a[76:79], a[92:95], v[140:143]
    s_mov_b32 s28, 11264
    buffer_load_dwordx4 a[48:51], v4, s[4:7], s28 offen
    buffer_load_dwordx4 a[52:55], v5, s[4:7], s28 offen
    buffer_load_dwordx4 a[56:59], v6, s[4:7], s28 offen
    buffer_load_dwordx4 a[60:63], v7, s[4:7], s28 offen
    buffer_load_dwordx4 a[64:67], v8, s[4:7], s28 offen
    buffer_load_dwordx4 a[68:71], v9, s[4:7], s28 offen
    buffer_load_dwordx4 a[72:75], v10, s[4:7], s28 offen
    buffer_load_dwordx4 a[76:79], v11, s[4:7], s28 offen
    buffer_load_dwordx4 a[80:83], v12, s[4:7], s28 offen
    buffer_load_dwordx4 a[84:87], v13, s[4:7], s28 offen
    buffer_load_dwordx4 a[88:91], v14, s[4:7], s28 offen
    buffer_load_dwordx4 a[92:95], v15, s[4:7], s28 offen
    s_waitcnt vmcnt(48)
    v_mfma_f32_16x16x32_bf16 v[16:19], a[96:99], a[128:131], v[16:19]
    v_mfma_f32_16x16x32_bf16 v[20:23], a[96:99], a[132:135], v[20:23]
    v_mfma_f32_16x16x32_bf16 v[24:27], a[96:99], a[136:139], v[24:27]
    v_mfma_f32_16x16x32_bf16 v[28:31], a[96:99], a[140:143], v[28:31]
    v_mfma_f32_16x16x32_bf16 v[32:35], a[100:103], a[128:131], v[32:35]
    v_mfma_f32_16x16x32_bf16 v[36:39], a[100:103], a[132:135], v[36:39]
    v_mfma_f32_16x16x32_bf16 v[40:43], a[100:103], a[136:139], v[40:43]
    v_mfma_f32_16x16x32_bf16 v[44:47], a[100:103], a[140:143], v[44:47]
    v_mfma_f32_16x16x32_bf16 v[48:51], a[104:107], a[128:131], v[48:51]
    v_mfma_f32_16x16x32_bf16 v[52:55], a[104:107], a[132:135], v[52:55]
    v_mfma_f32_16x16x32_bf16 v[56:59], a[104:107], a[136:139], v[56:59]
    v_mfma_f32_16x16x32_bf16 v[60:63], a[104:107], a[140:143], v[60:63]
    v_mfma_f32_16x16x32_bf16 v[64:67], a[108:111], a[128:131], v[64:67]
    v_mfma_f32_16x16x32_bf16 v[68:71], a[108:111], a[132:135], v[68:71]
    v_mfma_f32_16x16x32_bf16 v[72:75], a[108:111], a[136:139], v[72:75]
    v_mfma_f32_16x16x32_bf16 v[76:79], a[108:111], a[140:143], v[76:79]
    v_mfma_f32_16x16x32_bf16 v[80:83], a[112:115], a[128:131], v[80:83]
    v_mfma_f32_16x16x32_bf16 v[84:87], a[112:115], a[132:135], v[84:87]
    v_mfma_f32_16x16x32_bf16 v[88:91], a[112:115], a[136:139], v[88:91]
    v_mfma_f32_16x16x32_bf16 v[92:95], a[112:115], a[140:143], v[92:95]
    v_mfma_f32_16x16x32_bf16 v[96:99], a[116:119], a[128:131], v[96:99]
    v_mfma_f32_16x16x32_bf16 v[100:103], a[116:119], a[132:135], v[100:103]
    v_mfma_f32_16x16x32_bf16 v[104:107], a[116:119], a[136:139], v[104:107]
    v_mfma_f32_16x16x32_bf16 v[108:111], a[116:119], a[140:143], v[108:111]
    v_mfma_f32_16x16x32_bf16 v[112:115], a[120:123], a[128:131], v[112:115]
    v_mfma_f32_16x16x32_bf16 v[116:119], a[120:123], a[132:135], v[116:119]
    v_mfma_f32_16x16x32_bf16 v[120:123], a[120:123], a[136:139], v[120:123]
    v_mfma_f32_16x16x32_bf16 v[124:127], a[120:123], a[140:143], v[124:127]
    v_mfma_f32_16x16x32_bf16 v[128:131], a[124:127], a[128:131], v[128:131]
    v_mfma_f32_16x16x32_bf16 v[132:135], a[124:127], a[132:135], v[132:135]
    v_mfma_f32_16x16x32_bf16 v[136:139], a[124:127], a[136:139], v[136:139]
    v_mfma_f32_16x16x32_bf16 v[140:143], a[124:127], a[140:143], v[140:143]
    s_mov_b32 s28, 12288
    buffer_load_dwordx4 a[96:99], v4, s[4:7], s28 offen
    buffer_load_dwordx4 a[100:103], v5, s[4:7], s28 offen
    buffer_load_dwordx4 a[104:107], v6, s[4:7], s28 offen
    buffer_load_dwordx4 a[108:111], v7, s[4:7], s28 offen
    buffer_load_dwordx4 a[112:115], v8, s[4:7], s28 offen
    buffer_load_dwordx4 a[116:119], v9, s[4:7], s28 offen
    buffer_load_dwordx4 a[120:123], v10, s[4:7], s28 offen
    buffer_load_dwordx4 a[124:127], v11, s[4:7], s28 offen
    buffer_load_dwordx4 a[128:131], v12, s[4:7], s28 offen
    buffer_load_dwordx4 a[132:135], v13, s[4:7], s28 offen
    buffer_load_dwordx4 a[136:139], v14, s[4:7], s28 offen
    buffer_load_dwordx4 a[140:143], v15, s[4:7], s28 offen
    s_waitcnt vmcnt(48)
    v_mfma_f32_16x16x32_bf16 v[16:19], a[144:147], a[176:179], v[16:19]
    v_mfma_f32_16x16x32_bf16 v[20:23], a[144:147], a[180:183], v[20:23]
    v_mfma_f32_16x16x32_bf16 v[24:27], a[144:147], a[184:187], v[24:27]
    v_mfma_f32_16x16x32_bf16 v[28:31], a[144:147], a[188:191], v[28:31]
    v_mfma_f32_16x16x32_bf16 v[32:35], a[148:151], a[176:179], v[32:35]
    v_mfma_f32_16x16x32_bf16 v[36:39], a[148:151], a[180:183], v[36:39]
    v_mfma_f32_16x16x32_bf16 v[40:43], a[148:151], a[184:187], v[40:43]
    v_mfma_f32_16x16x32_bf16 v[44:47], a[148:151], a[188:191], v[44:47]
    v_mfma_f32_16x16x32_bf16 v[48:51], a[152:155], a[176:179], v[48:51]
    v_mfma_f32_16x16x32_bf16 v[52:55], a[152:155], a[180:183], v[52:55]
    v_mfma_f32_16x16x32_bf16 v[56:59], a[152:155], a[184:187], v[56:59]
    v_mfma_f32_16x16x32_bf16 v[60:63], a[152:155], a[188:191], v[60:63]
    v_mfma_f32_16x16x32_bf16 v[64:67], a[156:159], a[176:179], v[64:67]
    v_mfma_f32_16x16x32_bf16 v[68:71], a[156:159], a[180:183], v[68:71]
    v_mfma_f32_16x16x32_bf16 v[72:75], a[156:159], a[184:187], v[72:75]
    v_mfma_f32_16x16x32_bf16 v[76:79], a[156:159], a[188:191], v[76:79]
    v_mfma_f32_16x16x32_bf16 v[80:83], a[160:163], a[176:179], v[80:83]
    v_mfma_f32_16x16x32_bf16 v[84:87], a[160:163], a[180:183], v[84:87]
    v_mfma_f32_16x16x32_bf16 v[88:91], a[160:163], a[184:187], v[88:91]
    v_mfma_f32_16x16x32_bf16 v[92:95], a[160:163], a[188:191], v[92:95]
    v_mfma_f32_16x16x32_bf16 v[96:99], a[164:167], a[176:179], v[96:99]
    v_mfma_f32_16x16x32_bf16 v[100:103], a[164:167], a[180:183], v[100:103]
    v_mfma_f32_16x16x32_bf16 v[104:107], a[164:167], a[184:187], v[104:107]
    v_mfma_f32_16x16x32_bf16 v[108:111], a[164:167], a[188:191], v[108:111]
    v_mfma_f32_16x16x32_bf16 v[112:115], a[168:171], a[176:179], v[112:115]
    v_mfma_f32_16x16x32_bf16 v[116:119], a[168:171], a[180:183], v[116:119]
    v_mfma_f32_16x16x32_bf16 v[120:123], a[168:171], a[184:187], v[120:123]
    v_mfma_f32_16x16x32_bf16 v[124:127], a[168:171], a[188:191], v[124:127]
    v_mfma_f32_16x16x32_bf16 v[128:131], a[172:175], a[176:179], v[128:131]
    v_mfma_f32_16x16x32_bf16 v[132:135], a[172:175], a[180:183], v[132:135]
    v_mfma_f32_16x16x32_bf16 v[136:139], a[172:175], a[184:187], v[136:139]
    v_mfma_f32_16x16x32_bf16 v[140:143], a[172:175], a[188:191], v[140:143]
    s_mov_b32 s28, 13312
    buffer_load_dwordx4 a[144:147], v4, s[4:7], s28 offen
    buffer_load_dwordx4 a[148:151], v5, s[4:7], s28 offen
    buffer_load_dwordx4 a[152:155], v6, s[4:7], s28 offen
    buffer_load_dwordx4 a[156:159], v7, s[4:7], s28 offen
    buffer_load_dwordx4 a[160:163], v8, s[4:7], s28 offen
    buffer_load_dwordx4 a[164:167], v9, s[4:7], s28 offen
    buffer_load_dwordx4 a[168:171], v10, s[4:7], s28 offen
    buffer_load_dwordx4 a[172:175], v11, s[4:7], s28 offen
    buffer_load_dwordx4 a[176:179], v12, s[4:7], s28 offen
    buffer_load_dwordx4 a[180:183], v13, s[4:7], s28 offen
    buffer_load_dwordx4 a[184:187], v14, s[4:7], s28 offen
    buffer_load_dwordx4 a[188:191], v15, s[4:7], s28 offen
    s_waitcnt vmcnt(48)
    v_mfma_f32_16x16x32_bf16 v[16:19], a[192:195], a[224:227], v[16:19]
    v_mfma_f32_16x16x32_bf16 v[20:23], a[192:195], a[228:231], v[20:23]
    v_mfma_f32_16x16x32_bf16 v[24:27], a[192:195], a[232:235], v[24:27]
    v_mfma_f32_16x16x32_bf16 v[28:31], a[192:195], a[236:239], v[28:31]
    v_mfma_f32_16x16x32_bf16 v[32:35], a[196:199], a[224:227], v[32:35]
    v_mfma_f32_16x16x32_bf16 v[36:39], a[196:199], a[228:231], v[36:39]
    v_mfma_f32_16x16x32_bf16 v[40:43], a[196:199], a[232:235], v[40:43]
    v_mfma_f32_16x16x32_bf16 v[44:47], a[196:199], a[236:239], v[44:47]
    v_mfma_f32_16x16x32_bf16 v[48:51], a[200:203], a[224:227], v[48:51]
    v_mfma_f32_16x16x32_bf16 v[52:55], a[200:203], a[228:231], v[52:55]
    v_mfma_f32_16x16x32_bf16 v[56:59], a[200:203], a[232:235], v[56:59]
    v_mfma_f32_16x16x32_bf16 v[60:63], a[200:203], a[236:239], v[60:63]
    v_mfma_f32_16x16x32_bf16 v[64:67], a[204:207], a[224:227], v[64:67]
    v_mfma_f32_16x16x32_bf16 v[68:71], a[204:207], a[228:231], v[68:71]
    v_mfma_f32_16x16x32_bf16 v[72:75], a[204:207], a[232:235], v[72:75]
    v_mfma_f32_16x16x32_bf16 v[76:79], a[204:207], a[236:239], v[76:79]
    v_mfma_f32_16x16x32_bf16 v[80:83], a[208:211], a[224:227], v[80:83]
    v_mfma_f32_16x16x32_bf16 v[84:87], a[208:211], a[228:231], v[84:87]
    v_mfma_f32_16x16x32_bf16 v[88:91], a[208:211], a[232:235], v[88:91]
    v_mfma_f32_16x16x32_bf16 v[92:95], a[208:211], a[236:239], v[92:95]
    v_mfma_f32_16x16x32_bf16 v[96:99], a[212:215], a[224:227], v[96:99]
    v_mfma_f32_16x16x32_bf16 v[100:103], a[212:215], a[228:231], v[100:103]
    v_mfma_f32_16x16x32_bf16 v[104:107], a[212:215], a[232:235], v[104:107]
    v_mfma_f32_16x16x32_bf16 v[108:111], a[212:215], a[236:239], v[108:111]
    v_mfma_f32_16x16x32_bf16 v[112:115], a[216:219], a[224:227], v[112:115]
    v_mfma_f32_16x16x32_bf16 v[116:119], a[216:219], a[228:231], v[116:119]
    v_mfma_f32_16x16x32_bf16 v[120:123], a[216:219], a[232:235], v[120:123]
    v_mfma_f32_16x16x32_bf16 v[124:127], a[216:219], a[236:239], v[124:127]
    v_mfma_f32_16x16x32_bf16 v[128:131], a[220:223], a[224:227], v[128:131]
    v_mfma_f32_16x16x32_bf16 v[132:135], a[220:223], a[228:231], v[132:135]
    v_mfma_f32_16x16x32_bf16 v[136:139], a[220:223], a[232:235], v[136:139]
    v_mfma_f32_16x16x32_bf16 v[140:143], a[220:223], a[236:239], v[140:143]
    s_mov_b32 s28, 14336
    buffer_load_dwordx4 a[192:195], v4, s[4:7], s28 offen
    buffer_load_dwordx4 a[196:199], v5, s[4:7], s28 offen
    buffer_load_dwordx4 a[200:203], v6, s[4:7], s28 offen
    buffer_load_dwordx4 a[204:207], v7, s[4:7], s28 offen
    buffer_load_dwordx4 a[208:211], v8, s[4:7], s28 offen
    buffer_load_dwordx4 a[212:215], v9, s[4:7], s28 offen
    buffer_load_dwordx4 a[216:219], v10, s[4:7], s28 offen
    buffer_load_dwordx4 a[220:223], v11, s[4:7], s28 offen
    buffer_load_dwordx4 a[224:227], v12, s[4:7], s28 offen
    buffer_load_dwordx4 a[228:231], v13, s[4:7], s28 offen
    buffer_load_dwordx4 a[232:235], v14, s[4:7], s28 offen
    buffer_load_dwordx4 a[236:239], v15, s[4:7], s28 offen
    s_waitcnt vmcnt(48)
    v_mfma_f32_16x16x32_bf16 v[16:19], a[0:3], a[32:35], v[16:19]
    v_mfma_f32_16x16x32_bf16 v[20:23], a[0:3], a[36:39], v[20:23]
    v_mfma_f32_16x16x32_bf16 v[24:27], a[0:3], a[40:43], v[24:27]
    v_mfma_f32_16x16x32_bf16 v[28:31], a[0:3], a[44:47], v[28:31]
    v_mfma_f32_16x16x32_bf16 v[32:35], a[4:7], a[32:35], v[32:35]
    v_mfma_f32_16x16x32_bf16 v[36:39], a[4:7], a[36:39], v[36:39]
    v_mfma_f32_16x16x32_bf16 v[40:43], a[4:7], a[40:43], v[40:43]
    v_mfma_f32_16x16x32_bf16 v[44:47], a[4:7], a[44:47], v[44:47]
    v_mfma_f32_16x16x32_bf16 v[48:51], a[8:11], a[32:35], v[48:51]
    v_mfma_f32_16x16x32_bf16 v[52:55], a[8:11], a[36:39], v[52:55]
    v_mfma_f32_16x16x32_bf16 v[56:59], a[8:11], a[40:43], v[56:59]
    v_mfma_f32_16x16x32_bf16 v[60:63], a[8:11], a[44:47], v[60:63]
    v_mfma_f32_16x16x32_bf16 v[64:67], a[12:15], a[32:35], v[64:67]
    v_mfma_f32_16x16x32_bf16 v[68:71], a[12:15], a[36:39], v[68:71]
    v_mfma_f32_16x16x32_bf16 v[72:75], a[12:15], a[40:43], v[72:75]
    v_mfma_f32_16x16x32_bf16 v[76:79], a[12:15], a[44:47], v[76:79]
    v_mfma_f32_16x16x32_bf16 v[80:83], a[16:19], a[32:35], v[80:83]
    v_mfma_f32_16x16x32_bf16 v[84:87], a[16:19], a[36:39], v[84:87]
    v_mfma_f32_16x16x32_bf16 v[88:91], a[16:19], a[40:43], v[88:91]
    v_mfma_f32_16x16x32_bf16 v[92:95], a[16:19], a[44:47], v[92:95]
    v_mfma_f32_16x16x32_bf16 v[96:99], a[20:23], a[32:35], v[96:99]
    v_mfma_f32_16x16x32_bf16 v[100:103], a[20:23], a[36:39], v[100:103]
    v_mfma_f32_16x16x32_bf16 v[104:107], a[20:23], a[40:43], v[104:107]
    v_mfma_f32_16x16x32_bf16 v[108:111], a[20:23], a[44:47], v[108:111]
    v_mfma_f32_16x16x32_bf16 v[112:115], a[24:27], a[32:35], v[112:115]
    v_mfma_f32_16x16x32_bf16 v[116:119], a[24:27], a[36:39], v[116:119]
    v_mfma_f32_16x16x32_bf16 v[120:123], a[24:27], a[40:43], v[120:123]
    v_mfma_f32_16x16x32_bf16 v[124:127], a[24:27], a[44:47], v[124:127]
    v_mfma_f32_16x16x32_bf16 v[128:131], a[28:31], a[32:35], v[128:131]
    v_mfma_f32_16x16x32_bf16 v[132:135], a[28:31], a[36:39], v[132:135]
    v_mfma_f32_16x16x32_bf16 v[136:139], a[28:31], a[40:43], v[136:139]
    v_mfma_f32_16x16x32_bf16 v[140:143], a[28:31], a[44:47], v[140:143]
    s_mov_b32 s28, 15360
    buffer_load_dwordx4 a[0:3], v4, s[4:7], s28 offen
    buffer_load_dwordx4 a[4:7], v5, s[4:7], s28 offen
    buffer_load_dwordx4 a[8:11], v6, s[4:7], s28 offen
    buffer_load_dwordx4 a[12:15], v7, s[4:7], s28 offen
    buffer_load_dwordx4 a[16:19], v8, s[4:7], s28 offen
    buffer_load_dwordx4 a[20:23], v9, s[4:7], s28 offen
    buffer_load_dwordx4 a[24:27], v10, s[4:7], s28 offen
    buffer_load_dwordx4 a[28:31], v11, s[4:7], s28 offen
    buffer_load_dwordx4 a[32:35], v12, s[4:7], s28 offen
    buffer_load_dwordx4 a[36:39], v13, s[4:7], s28 offen
    buffer_load_dwordx4 a[40:43], v14, s[4:7], s28 offen
    buffer_load_dwordx4 a[44:47], v15, s[4:7], s28 offen
    s_waitcnt vmcnt(48)
    v_mfma_f32_16x16x32_bf16 v[16:19], a[48:51], a[80:83], v[16:19]
    v_mfma_f32_16x16x32_bf16 v[20:23], a[48:51], a[84:87], v[20:23]
    v_mfma_f32_16x16x32_bf16 v[24:27], a[48:51], a[88:91], v[24:27]
    v_mfma_f32_16x16x32_bf16 v[28:31], a[48:51], a[92:95], v[28:31]
    v_mfma_f32_16x16x32_bf16 v[32:35], a[52:55], a[80:83], v[32:35]
    v_mfma_f32_16x16x32_bf16 v[36:39], a[52:55], a[84:87], v[36:39]
    v_mfma_f32_16x16x32_bf16 v[40:43], a[52:55], a[88:91], v[40:43]
    v_mfma_f32_16x16x32_bf16 v[44:47], a[52:55], a[92:95], v[44:47]
    v_mfma_f32_16x16x32_bf16 v[48:51], a[56:59], a[80:83], v[48:51]
    v_mfma_f32_16x16x32_bf16 v[52:55], a[56:59], a[84:87], v[52:55]
    v_mfma_f32_16x16x32_bf16 v[56:59], a[56:59], a[88:91], v[56:59]
    v_mfma_f32_16x16x32_bf16 v[60:63], a[56:59], a[92:95], v[60:63]
    v_mfma_f32_16x16x32_bf16 v[64:67], a[60:63], a[80:83], v[64:67]
    v_mfma_f32_16x16x32_bf16 v[68:71], a[60:63], a[84:87], v[68:71]
    v_mfma_f32_16x16x32_bf16 v[72:75], a[60:63], a[88:91], v[72:75]
    v_mfma_f32_16x16x32_bf16 v[76:79], a[60:63], a[92:95], v[76:79]
    v_mfma_f32_16x16x32_bf16 v[80:83], a[64:67], a[80:83], v[80:83]
    v_mfma_f32_16x16x32_bf16 v[84:87], a[64:67], a[84:87], v[84:87]
    v_mfma_f32_16x16x32_bf16 v[88:91], a[64:67], a[88:91], v[88:91]
    v_mfma_f32_16x16x32_bf16 v[92:95], a[64:67], a[92:95], v[92:95]
    v_mfma_f32_16x16x32_bf16 v[96:99], a[68:71], a[80:83], v[96:99]
    v_mfma_f32_16x16x32_bf16 v[100:103], a[68:71], a[84:87], v[100:103]
    v_mfma_f32_16x16x32_bf16 v[104:107], a[68:71], a[88:91], v[104:107]
    v_mfma_f32_16x16x32_bf16 v[108:111], a[68:71], a[92:95], v[108:111]
    v_mfma_f32_16x16x32_bf16 v[112:115], a[72:75], a[80:83], v[112:115]
    v_mfma_f32_16x16x32_bf16 v[116:119], a[72:75], a[84:87], v[116:119]
    v_mfma_f32_16x16x32_bf16 v[120:123], a[72:75], a[88:91], v[120:123]
    v_mfma_f32_16x16x32_bf16 v[124:127], a[72:75], a[92:95], v[124:127]
    v_mfma_f32_16x16x32_bf16 v[128:131], a[76:79], a[80:83], v[128:131]
    v_mfma_f32_16x16x32_bf16 v[132:135], a[76:79], a[84:87], v[132:135]
    v_mfma_f32_16x16x32_bf16 v[136:139], a[76:79], a[88:91], v[136:139]
    v_mfma_f32_16x16x32_bf16 v[140:143], a[76:79], a[92:95], v[140:143]
    s_mov_b32 s28, 16384
    buffer_load_dwordx4 a[48:51], v4, s[4:7], s28 offen
    buffer_load_dwordx4 a[52:55], v5, s[4:7], s28 offen
    buffer_load_dwordx4 a[56:59], v6, s[4:7], s28 offen
    buffer_load_dwordx4 a[60:63], v7, s[4:7], s28 offen
    buffer_load_dwordx4 a[64:67], v8, s[4:7], s28 offen
    buffer_load_dwordx4 a[68:71], v9, s[4:7], s28 offen
    buffer_load_dwordx4 a[72:75], v10, s[4:7], s28 offen
    buffer_load_dwordx4 a[76:79], v11, s[4:7], s28 offen
    buffer_load_dwordx4 a[80:83], v12, s[4:7], s28 offen
    buffer_load_dwordx4 a[84:87], v13, s[4:7], s28 offen
    buffer_load_dwordx4 a[88:91], v14, s[4:7], s28 offen
    buffer_load_dwordx4 a[92:95], v15, s[4:7], s28 offen
    s_waitcnt vmcnt(48)
    v_mfma_f32_16x16x32_bf16 v[16:19], a[96:99], a[128:131], v[16:19]
    v_mfma_f32_16x16x32_bf16 v[20:23], a[96:99], a[132:135], v[20:23]
    v_mfma_f32_16x16x32_bf16 v[24:27], a[96:99], a[136:139], v[24:27]
    v_mfma_f32_16x16x32_bf16 v[28:31], a[96:99], a[140:143], v[28:31]
    v_mfma_f32_16x16x32_bf16 v[32:35], a[100:103], a[128:131], v[32:35]
    v_mfma_f32_16x16x32_bf16 v[36:39], a[100:103], a[132:135], v[36:39]
    v_mfma_f32_16x16x32_bf16 v[40:43], a[100:103], a[136:139], v[40:43]
    v_mfma_f32_16x16x32_bf16 v[44:47], a[100:103], a[140:143], v[44:47]
    v_mfma_f32_16x16x32_bf16 v[48:51], a[104:107], a[128:131], v[48:51]
    v_mfma_f32_16x16x32_bf16 v[52:55], a[104:107], a[132:135], v[52:55]
    v_mfma_f32_16x16x32_bf16 v[56:59], a[104:107], a[136:139], v[56:59]
    v_mfma_f32_16x16x32_bf16 v[60:63], a[104:107], a[140:143], v[60:63]
    v_mfma_f32_16x16x32_bf16 v[64:67], a[108:111], a[128:131], v[64:67]
    v_mfma_f32_16x16x32_bf16 v[68:71], a[108:111], a[132:135], v[68:71]
    v_mfma_f32_16x16x32_bf16 v[72:75], a[108:111], a[136:139], v[72:75]
    v_mfma_f32_16x16x32_bf16 v[76:79], a[108:111], a[140:143], v[76:79]
    v_mfma_f32_16x16x32_bf16 v[80:83], a[112:115], a[128:131], v[80:83]
    v_mfma_f32_16x16x32_bf16 v[84:87], a[112:115], a[132:135], v[84:87]
    v_mfma_f32_16x16x32_bf16 v[88:91], a[112:115], a[136:139], v[88:91]
    v_mfma_f32_16x16x32_bf16 v[92:95], a[112:115], a[140:143], v[92:95]
    v_mfma_f32_16x16x32_bf16 v[96:99], a[116:119], a[128:131], v[96:99]
    v_mfma_f32_16x16x32_bf16 v[100:103], a[116:119], a[132:135], v[100:103]
    v_mfma_f32_16x16x32_bf16 v[104:107], a[116:119], a[136:139], v[104:107]
    v_mfma_f32_16x16x32_bf16 v[108:111], a[116:119], a[140:143], v[108:111]
    v_mfma_f32_16x16x32_bf16 v[112:115], a[120:123], a[128:131], v[112:115]
    v_mfma_f32_16x16x32_bf16 v[116:119], a[120:123], a[132:135], v[116:119]
    v_mfma_f32_16x16x32_bf16 v[120:123], a[120:123], a[136:139], v[120:123]
    v_mfma_f32_16x16x32_bf16 v[124:127], a[120:123], a[140:143], v[124:127]
    v_mfma_f32_16x16x32_bf16 v[128:131], a[124:127], a[128:131], v[128:131]
    v_mfma_f32_16x16x32_bf16 v[132:135], a[124:127], a[132:135], v[132:135]
    v_mfma_f32_16x16x32_bf16 v[136:139], a[124:127], a[136:139], v[136:139]
    v_mfma_f32_16x16x32_bf16 v[140:143], a[124:127], a[140:143], v[140:143]
    s_mov_b32 s28, 17408
    buffer_load_dwordx4 a[96:99], v4, s[4:7], s28 offen
    buffer_load_dwordx4 a[100:103], v5, s[4:7], s28 offen
    buffer_load_dwordx4 a[104:107], v6, s[4:7], s28 offen
    buffer_load_dwordx4 a[108:111], v7, s[4:7], s28 offen
    buffer_load_dwordx4 a[112:115], v8, s[4:7], s28 offen
    buffer_load_dwordx4 a[116:119], v9, s[4:7], s28 offen
    buffer_load_dwordx4 a[120:123], v10, s[4:7], s28 offen
    buffer_load_dwordx4 a[124:127], v11, s[4:7], s28 offen
    buffer_load_dwordx4 a[128:131], v12, s[4:7], s28 offen
    buffer_load_dwordx4 a[132:135], v13, s[4:7], s28 offen
    buffer_load_dwordx4 a[136:139], v14, s[4:7], s28 offen
    buffer_load_dwordx4 a[140:143], v15, s[4:7], s28 offen
    s_waitcnt vmcnt(48)
    v_mfma_f32_16x16x32_bf16 v[16:19], a[144:147], a[176:179], v[16:19]
    v_mfma_f32_16x16x32_bf16 v[20:23], a[144:147], a[180:183], v[20:23]
    v_mfma_f32_16x16x32_bf16 v[24:27], a[144:147], a[184:187], v[24:27]
    v_mfma_f32_16x16x32_bf16 v[28:31], a[144:147], a[188:191], v[28:31]
    v_mfma_f32_16x16x32_bf16 v[32:35], a[148:151], a[176:179], v[32:35]
    v_mfma_f32_16x16x32_bf16 v[36:39], a[148:151], a[180:183], v[36:39]
    v_mfma_f32_16x16x32_bf16 v[40:43], a[148:151], a[184:187], v[40:43]
    v_mfma_f32_16x16x32_bf16 v[44:47], a[148:151], a[188:191], v[44:47]
    v_mfma_f32_16x16x32_bf16 v[48:51], a[152:155], a[176:179], v[48:51]
    v_mfma_f32_16x16x32_bf16 v[52:55], a[152:155], a[180:183], v[52:55]
    v_mfma_f32_16x16x32_bf16 v[56:59], a[152:155], a[184:187], v[56:59]
    v_mfma_f32_16x16x32_bf16 v[60:63], a[152:155], a[188:191], v[60:63]
    v_mfma_f32_16x16x32_bf16 v[64:67], a[156:159], a[176:179], v[64:67]
    v_mfma_f32_16x16x32_bf16 v[68:71], a[156:159], a[180:183], v[68:71]
    v_mfma_f32_16x16x32_bf16 v[72:75], a[156:159], a[184:187], v[72:75]
    v_mfma_f32_16x16x32_bf16 v[76:79], a[156:159], a[188:191], v[76:79]
    v_mfma_f32_16x16x32_bf16 v[80:83], a[160:163], a[176:179], v[80:83]
    v_mfma_f32_16x16x32_bf16 v[84:87], a[160:163], a[180:183], v[84:87]
    v_mfma_f32_16x16x32_bf16 v[88:91], a[160:163], a[184:187], v[88:91]
    v_mfma_f32_16x16x32_bf16 v[92:95], a[160:163], a[188:191], v[92:95]
    v_mfma_f32_16x16x32_bf16 v[96:99], a[164:167], a[176:179], v[96:99]
    v_mfma_f32_16x16x32_bf16 v[100:103], a[164:167], a[180:183], v[100:103]
    v_mfma_f32_16x16x32_bf16 v[104:107], a[164:167], a[184:187], v[104:107]
    v_mfma_f32_16x16x32_bf16 v[108:111], a[164:167], a[188:191], v[108:111]
    v_mfma_f32_16x16x32_bf16 v[112:115], a[168:171], a[176:179], v[112:115]
    v_mfma_f32_16x16x32_bf16 v[116:119], a[168:171], a[180:183], v[116:119]
    v_mfma_f32_16x16x32_bf16 v[120:123], a[168:171], a[184:187], v[120:123]
    v_mfma_f32_16x16x32_bf16 v[124:127], a[168:171], a[188:191], v[124:127]
    v_mfma_f32_16x16x32_bf16 v[128:131], a[172:175], a[176:179], v[128:131]
    v_mfma_f32_16x16x32_bf16 v[132:135], a[172:175], a[180:183], v[132:135]
    v_mfma_f32_16x16x32_bf16 v[136:139], a[172:175], a[184:187], v[136:139]
    v_mfma_f32_16x16x32_bf16 v[140:143], a[172:175], a[188:191], v[140:143]
    s_mov_b32 s28, 18432
    buffer_load_dwordx4 a[144:147], v4, s[4:7], s28 offen
    buffer_load_dwordx4 a[148:151], v5, s[4:7], s28 offen
    buffer_load_dwordx4 a[152:155], v6, s[4:7], s28 offen
    buffer_load_dwordx4 a[156:159], v7, s[4:7], s28 offen
    buffer_load_dwordx4 a[160:163], v8, s[4:7], s28 offen
    buffer_load_dwordx4 a[164:167], v9, s[4:7], s28 offen
    buffer_load_dwordx4 a[168:171], v10, s[4:7], s28 offen
    buffer_load_dwordx4 a[172:175], v11, s[4:7], s28 offen
    buffer_load_dwordx4 a[176:179], v12, s[4:7], s28 offen
    buffer_load_dwordx4 a[180:183], v13, s[4:7], s28 offen
    buffer_load_dwordx4 a[184:187], v14, s[4:7], s28 offen
    buffer_load_dwordx4 a[188:191], v15, s[4:7], s28 offen
    s_waitcnt vmcnt(48)
    v_mfma_f32_16x16x32_bf16 v[16:19], a[192:195], a[224:227], v[16:19]
    v_mfma_f32_16x16x32_bf16 v[20:23], a[192:195], a[228:231], v[20:23]
    v_mfma_f32_16x16x32_bf16 v[24:27], a[192:195], a[232:235], v[24:27]
    v_mfma_f32_16x16x32_bf16 v[28:31], a[192:195], a[236:239], v[28:31]
    v_mfma_f32_16x16x32_bf16 v[32:35], a[196:199], a[224:227], v[32:35]
    v_mfma_f32_16x16x32_bf16 v[36:39], a[196:199], a[228:231], v[36:39]
    v_mfma_f32_16x16x32_bf16 v[40:43], a[196:199], a[232:235], v[40:43]
    v_mfma_f32_16x16x32_bf16 v[44:47], a[196:199], a[236:239], v[44:47]
    v_mfma_f32_16x16x32_bf16 v[48:51], a[200:203], a[224:227], v[48:51]
    v_mfma_f32_16x16x32_bf16 v[52:55], a[200:203], a[228:231], v[52:55]
    v_mfma_f32_16x16x32_bf16 v[56:59], a[200:203], a[232:235], v[56:59]
    v_mfma_f32_16x16x32_bf16 v[60:63], a[200:203], a[236:239], v[60:63]
    v_mfma_f32_16x16x32_bf16 v[64:67], a[204:207], a[224:227], v[64:67]
    v_mfma_f32_16x16x32_bf16 v[68:71], a[204:207], a[228:231], v[68:71]
    v_mfma_f32_16x16x32_bf16 v[72:75], a[204:207], a[232:235], v[72:75]
    v_mfma_f32_16x16x32_bf16 v[76:79], a[204:207], a[236:239], v[76:79]
    v_mfma_f32_16x16x32_bf16 v[80:83], a[208:211], a[224:227], v[80:83]
    v_mfma_f32_16x16x32_bf16 v[84:87], a[208:211], a[228:231], v[84:87]
    v_mfma_f32_16x16x32_bf16 v[88:91], a[208:211], a[232:235], v[88:91]
    v_mfma_f32_16x16x32_bf16 v[92:95], a[208:211], a[236:239], v[92:95]
    v_mfma_f32_16x16x32_bf16 v[96:99], a[212:215], a[224:227], v[96:99]
    v_mfma_f32_16x16x32_bf16 v[100:103], a[212:215], a[228:231], v[100:103]
    v_mfma_f32_16x16x32_bf16 v[104:107], a[212:215], a[232:235], v[104:107]
    v_mfma_f32_16x16x32_bf16 v[108:111], a[212:215], a[236:239], v[108:111]
    v_mfma_f32_16x16x32_bf16 v[112:115], a[216:219], a[224:227], v[112:115]
    v_mfma_f32_16x16x32_bf16 v[116:119], a[216:219], a[228:231], v[116:119]
    v_mfma_f32_16x16x32_bf16 v[120:123], a[216:219], a[232:235], v[120:123]
    v_mfma_f32_16x16x32_bf16 v[124:127], a[216:219], a[236:239], v[124:127]
    v_mfma_f32_16x16x32_bf16 v[128:131], a[220:223], a[224:227], v[128:131]
    v_mfma_f32_16x16x32_bf16 v[132:135], a[220:223], a[228:231], v[132:135]
    v_mfma_f32_16x16x32_bf16 v[136:139], a[220:223], a[232:235], v[136:139]
    v_mfma_f32_16x16x32_bf16 v[140:143], a[220:223], a[236:239], v[140:143]
    s_mov_b32 s28, 19456
    buffer_load_dwordx4 a[192:195], v4, s[4:7], s28 offen
    buffer_load_dwordx4 a[196:199], v5, s[4:7], s28 offen
    buffer_load_dwordx4 a[200:203], v6, s[4:7], s28 offen
    buffer_load_dwordx4 a[204:207], v7, s[4:7], s28 offen
    buffer_load_dwordx4 a[208:211], v8, s[4:7], s28 offen
    buffer_load_dwordx4 a[212:215], v9, s[4:7], s28 offen
    buffer_load_dwordx4 a[216:219], v10, s[4:7], s28 offen
    buffer_load_dwordx4 a[220:223], v11, s[4:7], s28 offen
    buffer_load_dwordx4 a[224:227], v12, s[4:7], s28 offen
    buffer_load_dwordx4 a[228:231], v13, s[4:7], s28 offen
    buffer_load_dwordx4 a[232:235], v14, s[4:7], s28 offen
    buffer_load_dwordx4 a[236:239], v15, s[4:7], s28 offen
    s_waitcnt vmcnt(48)
    v_mfma_f32_16x16x32_bf16 v[16:19], a[0:3], a[32:35], v[16:19]
    v_mfma_f32_16x16x32_bf16 v[20:23], a[0:3], a[36:39], v[20:23]
    v_mfma_f32_16x16x32_bf16 v[24:27], a[0:3], a[40:43], v[24:27]
    v_mfma_f32_16x16x32_bf16 v[28:31], a[0:3], a[44:47], v[28:31]
    v_mfma_f32_16x16x32_bf16 v[32:35], a[4:7], a[32:35], v[32:35]
    v_mfma_f32_16x16x32_bf16 v[36:39], a[4:7], a[36:39], v[36:39]
    v_mfma_f32_16x16x32_bf16 v[40:43], a[4:7], a[40:43], v[40:43]
    v_mfma_f32_16x16x32_bf16 v[44:47], a[4:7], a[44:47], v[44:47]
    v_mfma_f32_16x16x32_bf16 v[48:51], a[8:11], a[32:35], v[48:51]
    v_mfma_f32_16x16x32_bf16 v[52:55], a[8:11], a[36:39], v[52:55]
    v_mfma_f32_16x16x32_bf16 v[56:59], a[8:11], a[40:43], v[56:59]
    v_mfma_f32_16x16x32_bf16 v[60:63], a[8:11], a[44:47], v[60:63]
    v_mfma_f32_16x16x32_bf16 v[64:67], a[12:15], a[32:35], v[64:67]
    v_mfma_f32_16x16x32_bf16 v[68:71], a[12:15], a[36:39], v[68:71]
    v_mfma_f32_16x16x32_bf16 v[72:75], a[12:15], a[40:43], v[72:75]
    v_mfma_f32_16x16x32_bf16 v[76:79], a[12:15], a[44:47], v[76:79]
    v_mfma_f32_16x16x32_bf16 v[80:83], a[16:19], a[32:35], v[80:83]
    v_mfma_f32_16x16x32_bf16 v[84:87], a[16:19], a[36:39], v[84:87]
    v_mfma_f32_16x16x32_bf16 v[88:91], a[16:19], a[40:43], v[88:91]
    v_mfma_f32_16x16x32_bf16 v[92:95], a[16:19], a[44:47], v[92:95]
    v_mfma_f32_16x16x32_bf16 v[96:99], a[20:23], a[32:35], v[96:99]
    v_mfma_f32_16x16x32_bf16 v[100:103], a[20:23], a[36:39], v[100:103]
    v_mfma_f32_16x16x32_bf16 v[104:107], a[20:23], a[40:43], v[104:107]
    v_mfma_f32_16x16x32_bf16 v[108:111], a[20:23], a[44:47], v[108:111]
    v_mfma_f32_16x16x32_bf16 v[112:115], a[24:27], a[32:35], v[112:115]
    v_mfma_f32_16x16x32_bf16 v[116:119], a[24:27], a[36:39], v[116:119]
    v_mfma_f32_16x16x32_bf16 v[120:123], a[24:27], a[40:43], v[120:123]
    v_mfma_f32_16x16x32_bf16 v[124:127], a[24:27], a[44:47], v[124:127]
    v_mfma_f32_16x16x32_bf16 v[128:131], a[28:31], a[32:35], v[128:131]
    v_mfma_f32_16x16x32_bf16 v[132:135], a[28:31], a[36:39], v[132:135]
    v_mfma_f32_16x16x32_bf16 v[136:139], a[28:31], a[40:43], v[136:139]
    v_mfma_f32_16x16x32_bf16 v[140:143], a[28:31], a[44:47], v[140:143]
    s_waitcnt vmcnt(36)
    v_mfma_f32_16x16x32_bf16 v[16:19], a[48:51], a[80:83], v[16:19]
    v_mfma_f32_16x16x32_bf16 v[20:23], a[48:51], a[84:87], v[20:23]
    v_mfma_f32_16x16x32_bf16 v[24:27], a[48:51], a[88:91], v[24:27]
    v_mfma_f32_16x16x32_bf16 v[28:31], a[48:51], a[92:95], v[28:31]
    v_mfma_f32_16x16x32_bf16 v[32:35], a[52:55], a[80:83], v[32:35]
    v_mfma_f32_16x16x32_bf16 v[36:39], a[52:55], a[84:87], v[36:39]
    v_mfma_f32_16x16x32_bf16 v[40:43], a[52:55], a[88:91], v[40:43]
    v_mfma_f32_16x16x32_bf16 v[44:47], a[52:55], a[92:95], v[44:47]
    v_mfma_f32_16x16x32_bf16 v[48:51], a[56:59], a[80:83], v[48:51]
    v_mfma_f32_16x16x32_bf16 v[52:55], a[56:59], a[84:87], v[52:55]
    v_mfma_f32_16x16x32_bf16 v[56:59], a[56:59], a[88:91], v[56:59]
    v_mfma_f32_16x16x32_bf16 v[60:63], a[56:59], a[92:95], v[60:63]
    v_mfma_f32_16x16x32_bf16 v[64:67], a[60:63], a[80:83], v[64:67]
    v_mfma_f32_16x16x32_bf16 v[68:71], a[60:63], a[84:87], v[68:71]
    v_mfma_f32_16x16x32_bf16 v[72:75], a[60:63], a[88:91], v[72:75]
    v_mfma_f32_16x16x32_bf16 v[76:79], a[60:63], a[92:95], v[76:79]
    v_mfma_f32_16x16x32_bf16 v[80:83], a[64:67], a[80:83], v[80:83]
    v_mfma_f32_16x16x32_bf16 v[84:87], a[64:67], a[84:87], v[84:87]
    v_mfma_f32_16x16x32_bf16 v[88:91], a[64:67], a[88:91], v[88:91]
    v_mfma_f32_16x16x32_bf16 v[92:95], a[64:67], a[92:95], v[92:95]
    v_mfma_f32_16x16x32_bf16 v[96:99], a[68:71], a[80:83], v[96:99]
    v_mfma_f32_16x16x32_bf16 v[100:103], a[68:71], a[84:87], v[100:103]
    v_mfma_f32_16x16x32_bf16 v[104:107], a[68:71], a[88:91], v[104:107]
    v_mfma_f32_16x16x32_bf16 v[108:111], a[68:71], a[92:95], v[108:111]
    v_mfma_f32_16x16x32_bf16 v[112:115], a[72:75], a[80:83], v[112:115]
    v_mfma_f32_16x16x32_bf16 v[116:119], a[72:75], a[84:87], v[116:119]
    v_mfma_f32_16x16x32_bf16 v[120:123], a[72:75], a[88:91], v[120:123]
    v_mfma_f32_16x16x32_bf16 v[124:127], a[72:75], a[92:95], v[124:127]
    v_mfma_f32_16x16x32_bf16 v[128:131], a[76:79], a[80:83], v[128:131]
    v_mfma_f32_16x16x32_bf16 v[132:135], a[76:79], a[84:87], v[132:135]
    v_mfma_f32_16x16x32_bf16 v[136:139], a[76:79], a[88:91], v[136:139]
    v_mfma_f32_16x16x32_bf16 v[140:143], a[76:79], a[92:95], v[140:143]
    s_waitcnt vmcnt(24)
    v_mfma_f32_16x16x32_bf16 v[16:19], a[96:99], a[128:131], v[16:19]
    v_mfma_f32_16x16x32_bf16 v[20:23], a[96:99], a[132:135], v[20:23]
    v_mfma_f32_16x16x32_bf16 v[24:27], a[96:99], a[136:139], v[24:27]
    v_mfma_f32_16x16x32_bf16 v[28:31], a[96:99], a[140:143], v[28:31]
    v_mfma_f32_16x16x32_bf16 v[32:35], a[100:103], a[128:131], v[32:35]
    v_mfma_f32_16x16x32_bf16 v[36:39], a[100:103], a[132:135], v[36:39]
    v_mfma_f32_16x16x32_bf16 v[40:43], a[100:103], a[136:139], v[40:43]
    v_mfma_f32_16x16x32_bf16 v[44:47], a[100:103], a[140:143], v[44:47]
    v_mfma_f32_16x16x32_bf16 v[48:51], a[104:107], a[128:131], v[48:51]
    v_mfma_f32_16x16x32_bf16 v[52:55], a[104:107], a[132:135], v[52:55]
    v_mfma_f32_16x16x32_bf16 v[56:59], a[104:107], a[136:139], v[56:59]
    v_mfma_f32_16x16x32_bf16 v[60:63], a[104:107], a[140:143], v[60:63]
    v_mfma_f32_16x16x32_bf16 v[64:67], a[108:111], a[128:131], v[64:67]
    v_mfma_f32_16x16x32_bf16 v[68:71], a[108:111], a[132:135], v[68:71]
    v_mfma_f32_16x16x32_bf16 v[72:75], a[108:111], a[136:139], v[72:75]
    v_mfma_f32_16x16x32_bf16 v[76:79], a[108:111], a[140:143], v[76:79]
    v_mfma_f32_16x16x32_bf16 v[80:83], a[112:115], a[128:131], v[80:83]
    v_mfma_f32_16x16x32_bf16 v[84:87], a[112:115], a[132:135], v[84:87]
    v_mfma_f32_16x16x32_bf16 v[88:91], a[112:115], a[136:139], v[88:91]
    v_mfma_f32_16x16x32_bf16 v[92:95], a[112:115], a[140:143], v[92:95]
    v_mfma_f32_16x16x32_bf16 v[96:99], a[116:119], a[128:131], v[96:99]
    v_mfma_f32_16x16x32_bf16 v[100:103], a[116:119], a[132:135], v[100:103]
    v_mfma_f32_16x16x32_bf16 v[104:107], a[116:119], a[136:139], v[104:107]
    v_mfma_f32_16x16x32_bf16 v[108:111], a[116:119], a[140:143], v[108:111]
    v_mfma_f32_16x16x32_bf16 v[112:115], a[120:123], a[128:131], v[112:115]
    v_mfma_f32_16x16x32_bf16 v[116:119], a[120:123], a[132:135], v[116:119]
    v_mfma_f32_16x16x32_bf16 v[120:123], a[120:123], a[136:139], v[120:123]
    v_mfma_f32_16x16x32_bf16 v[124:127], a[120:123], a[140:143], v[124:127]
    v_mfma_f32_16x16x32_bf16 v[128:131], a[124:127], a[128:131], v[128:131]
    v_mfma_f32_16x16x32_bf16 v[132:135], a[124:127], a[132:135], v[132:135]
    v_mfma_f32_16x16x32_bf16 v[136:139], a[124:127], a[136:139], v[136:139]
    v_mfma_f32_16x16x32_bf16 v[140:143], a[124:127], a[140:143], v[140:143]
    s_waitcnt vmcnt(12)
    v_mfma_f32_16x16x32_bf16 v[16:19], a[144:147], a[176:179], v[16:19]
    v_mfma_f32_16x16x32_bf16 v[20:23], a[144:147], a[180:183], v[20:23]
    v_mfma_f32_16x16x32_bf16 v[24:27], a[144:147], a[184:187], v[24:27]
    v_mfma_f32_16x16x32_bf16 v[28:31], a[144:147], a[188:191], v[28:31]
    v_mfma_f32_16x16x32_bf16 v[32:35], a[148:151], a[176:179], v[32:35]
    v_mfma_f32_16x16x32_bf16 v[36:39], a[148:151], a[180:183], v[36:39]
    v_mfma_f32_16x16x32_bf16 v[40:43], a[148:151], a[184:187], v[40:43]
    v_mfma_f32_16x16x32_bf16 v[44:47], a[148:151], a[188:191], v[44:47]
    v_mfma_f32_16x16x32_bf16 v[48:51], a[152:155], a[176:179], v[48:51]
    v_mfma_f32_16x16x32_bf16 v[52:55], a[152:155], a[180:183], v[52:55]
    v_mfma_f32_16x16x32_bf16 v[56:59], a[152:155], a[184:187], v[56:59]
    v_mfma_f32_16x16x32_bf16 v[60:63], a[152:155], a[188:191], v[60:63]
    v_mfma_f32_16x16x32_bf16 v[64:67], a[156:159], a[176:179], v[64:67]
    v_mfma_f32_16x16x32_bf16 v[68:71], a[156:159], a[180:183], v[68:71]
    v_mfma_f32_16x16x32_bf16 v[72:75], a[156:159], a[184:187], v[72:75]
    v_mfma_f32_16x16x32_bf16 v[76:79], a[156:159], a[188:191], v[76:79]
    v_mfma_f32_16x16x32_bf16 v[80:83], a[160:163], a[176:179], v[80:83]
    v_mfma_f32_16x16x32_bf16 v[84:87], a[160:163], a[180:183], v[84:87]
    v_mfma_f32_16x16x32_bf16 v[88:91], a[160:163], a[184:187], v[88:91]
    v_mfma_f32_16x16x32_bf16 v[92:95], a[160:163], a[188:191], v[92:95]
    v_mfma_f32_16x16x32_bf16 v[96:99], a[164:167], a[176:179], v[96:99]
    v_mfma_f32_16x16x32_bf16 v[100:103], a[164:167], a[180:183], v[100:103]
    v_mfma_f32_16x16x32_bf16 v[104:107], a[164:167], a[184:187], v[104:107]
    v_mfma_f32_16x16x32_bf16 v[108:111], a[164:167], a[188:191], v[108:111]
    v_mfma_f32_16x16x32_bf16 v[112:115], a[168:171], a[176:179], v[112:115]
    v_mfma_f32_16x16x32_bf16 v[116:119], a[168:171], a[180:183], v[116:119]
    v_mfma_f32_16x16x32_bf16 v[120:123], a[168:171], a[184:187], v[120:123]
    v_mfma_f32_16x16x32_bf16 v[124:127], a[168:171], a[188:191], v[124:127]
    v_mfma_f32_16x16x32_bf16 v[128:131], a[172:175], a[176:179], v[128:131]
    v_mfma_f32_16x16x32_bf16 v[132:135], a[172:175], a[180:183], v[132:135]
    v_mfma_f32_16x16x32_bf16 v[136:139], a[172:175], a[184:187], v[136:139]
    v_mfma_f32_16x16x32_bf16 v[140:143], a[172:175], a[188:191], v[140:143]
    s_waitcnt vmcnt(0)
    v_mfma_f32_16x16x32_bf16 v[16:19], a[192:195], a[224:227], v[16:19]
    v_mfma_f32_16x16x32_bf16 v[20:23], a[192:195], a[228:231], v[20:23]
    v_mfma_f32_16x16x32_bf16 v[24:27], a[192:195], a[232:235], v[24:27]
    v_mfma_f32_16x16x32_bf16 v[28:31], a[192:195], a[236:239], v[28:31]
    v_mfma_f32_16x16x32_bf16 v[32:35], a[196:199], a[224:227], v[32:35]
    v_mfma_f32_16x16x32_bf16 v[36:39], a[196:199], a[228:231], v[36:39]
    v_mfma_f32_16x16x32_bf16 v[40:43], a[196:199], a[232:235], v[40:43]
    v_mfma_f32_16x16x32_bf16 v[44:47], a[196:199], a[236:239], v[44:47]
    v_mfma_f32_16x16x32_bf16 v[48:51], a[200:203], a[224:227], v[48:51]
    v_mfma_f32_16x16x32_bf16 v[52:55], a[200:203], a[228:231], v[52:55]
    v_mfma_f32_16x16x32_bf16 v[56:59], a[200:203], a[232:235], v[56:59]
    v_mfma_f32_16x16x32_bf16 v[60:63], a[200:203], a[236:239], v[60:63]
    v_mfma_f32_16x16x32_bf16 v[64:67], a[204:207], a[224:227], v[64:67]
    v_mfma_f32_16x16x32_bf16 v[68:71], a[204:207], a[228:231], v[68:71]
    v_mfma_f32_16x16x32_bf16 v[72:75], a[204:207], a[232:235], v[72:75]
    v_mfma_f32_16x16x32_bf16 v[76:79], a[204:207], a[236:239], v[76:79]
    v_mfma_f32_16x16x32_bf16 v[80:83], a[208:211], a[224:227], v[80:83]
    v_mfma_f32_16x16x32_bf16 v[84:87], a[208:211], a[228:231], v[84:87]
    v_mfma_f32_16x16x32_bf16 v[88:91], a[208:211], a[232:235], v[88:91]
    v_mfma_f32_16x16x32_bf16 v[92:95], a[208:211], a[236:239], v[92:95]
    v_mfma_f32_16x16x32_bf16 v[96:99], a[212:215], a[224:227], v[96:99]
    v_mfma_f32_16x16x32_bf16 v[100:103], a[212:215], a[228:231], v[100:103]
    v_mfma_f32_16x16x32_bf16 v[104:107], a[212:215], a[232:235], v[104:107]
    v_mfma_f32_16x16x32_bf16 v[108:111], a[212:215], a[236:239], v[108:111]
    v_mfma_f32_16x16x32_bf16 v[112:115], a[216:219], a[224:227], v[112:115]
    v_mfma_f32_16x16x32_bf16 v[116:119], a[216:219], a[228:231], v[116:119]
    v_mfma_f32_16x16x32_bf16 v[120:123], a[216:219], a[232:235], v[120:123]
    v_mfma_f32_16x16x32_bf16 v[124:127], a[216:219], a[236:239], v[124:127]
    v_mfma_f32_16x16x32_bf16 v[128:131], a[220:223], a[224:227], v[128:131]
    v_mfma_f32_16x16x32_bf16 v[132:135], a[220:223], a[228:231], v[132:135]
    v_mfma_f32_16x16x32_bf16 v[136:139], a[220:223], a[232:235], v[136:139]
    v_mfma_f32_16x16x32_bf16 v[140:143], a[220:223], a[236:239], v[140:143]
    s_nop 7
    s_nop 7
    s_cmp_ge_u32 s25, 384
    s_cselect_b32 s30, 384, 0
    s_cselect_b32 s32, 25165824, 0
    s_sub_u32 s30, s25, s30
    s_lshr_b32 s30, s30, 1
    s_add_u32 s32, s32, 40062976
    s_mul_i32 s31, s26, 192
    s_add_u32 s31, s31, s30
    s_lshl_b32 s31, s31, 10
    s_add_u32 s32, s32, s31
    v_cvt_pk_bf16_f32 v144, v16, v17
    v_cvt_pk_bf16_f32 v145, v18, v19
    v_cvt_pk_bf16_f32 v146, v32, v33
    v_cvt_pk_bf16_f32 v147, v34, v35
    s_add_u32 s31, s32, 0
    buffer_store_dwordx4 v[144:147], v2, s[4:7], s31 offen sc1
    v_cvt_pk_bf16_f32 v148, v48, v49
    v_cvt_pk_bf16_f32 v149, v50, v51
    v_cvt_pk_bf16_f32 v150, v64, v65
    v_cvt_pk_bf16_f32 v151, v66, v67
    s_add_u32 s31, s32, 1024
    buffer_store_dwordx4 v[148:151], v2, s[4:7], s31 offen sc1
    v_cvt_pk_bf16_f32 v152, v80, v81
    v_cvt_pk_bf16_f32 v153, v82, v83
    v_cvt_pk_bf16_f32 v154, v96, v97
    v_cvt_pk_bf16_f32 v155, v98, v99
    s_add_u32 s31, s32, 2048
    buffer_store_dwordx4 v[152:155], v2, s[4:7], s31 offen sc1
    v_cvt_pk_bf16_f32 v156, v112, v113
    v_cvt_pk_bf16_f32 v157, v114, v115
    v_cvt_pk_bf16_f32 v158, v128, v129
    v_cvt_pk_bf16_f32 v159, v130, v131
    s_add_u32 s31, s32, 3072
    buffer_store_dwordx4 v[156:159], v2, s[4:7], s31 offen sc1
    v_cvt_pk_bf16_f32 v160, v20, v21
    v_cvt_pk_bf16_f32 v161, v22, v23
    v_cvt_pk_bf16_f32 v162, v36, v37
    v_cvt_pk_bf16_f32 v163, v38, v39
    s_add_u32 s31, s32, 196608
    buffer_store_dwordx4 v[160:163], v2, s[4:7], s31 offen sc1
    v_cvt_pk_bf16_f32 v164, v52, v53
    v_cvt_pk_bf16_f32 v165, v54, v55
    v_cvt_pk_bf16_f32 v166, v68, v69
    v_cvt_pk_bf16_f32 v167, v70, v71
    s_add_u32 s31, s32, 197632
    buffer_store_dwordx4 v[164:167], v2, s[4:7], s31 offen sc1
    v_cvt_pk_bf16_f32 v168, v84, v85
    v_cvt_pk_bf16_f32 v169, v86, v87
    v_cvt_pk_bf16_f32 v170, v100, v101
    v_cvt_pk_bf16_f32 v171, v102, v103
    s_add_u32 s31, s32, 198656
    buffer_store_dwordx4 v[168:171], v2, s[4:7], s31 offen sc1
    v_cvt_pk_bf16_f32 v172, v116, v117
    v_cvt_pk_bf16_f32 v173, v118, v119
    v_cvt_pk_bf16_f32 v174, v132, v133
    v_cvt_pk_bf16_f32 v175, v134, v135
    s_add_u32 s31, s32, 199680
    buffer_store_dwordx4 v[172:175], v2, s[4:7], s31 offen sc1
    v_cvt_pk_bf16_f32 v176, v24, v25
    v_cvt_pk_bf16_f32 v177, v26, v27
    v_cvt_pk_bf16_f32 v178, v40, v41
    v_cvt_pk_bf16_f32 v179, v42, v43
    s_add_u32 s31, s32, 393216
    buffer_store_dwordx4 v[176:179], v2, s[4:7], s31 offen sc1
    v_cvt_pk_bf16_f32 v180, v56, v57
    v_cvt_pk_bf16_f32 v181, v58, v59
    v_cvt_pk_bf16_f32 v182, v72, v73
    v_cvt_pk_bf16_f32 v183, v74, v75
    s_add_u32 s31, s32, 394240
    buffer_store_dwordx4 v[180:183], v2, s[4:7], s31 offen sc1
    v_cvt_pk_bf16_f32 v184, v88, v89
    v_cvt_pk_bf16_f32 v185, v90, v91
    v_cvt_pk_bf16_f32 v186, v104, v105
    v_cvt_pk_bf16_f32 v187, v106, v107
    s_add_u32 s31, s32, 395264
    buffer_store_dwordx4 v[184:187], v2, s[4:7], s31 offen sc1
    v_cvt_pk_bf16_f32 v188, v120, v121
    v_cvt_pk_bf16_f32 v189, v122, v123
    v_cvt_pk_bf16_f32 v190, v136, v137
    v_cvt_pk_bf16_f32 v191, v138, v139
    s_add_u32 s31, s32, 396288
    buffer_store_dwordx4 v[188:191], v2, s[4:7], s31 offen sc1
    v_cvt_pk_bf16_f32 v192, v28, v29
    v_cvt_pk_bf16_f32 v193, v30, v31
    v_cvt_pk_bf16_f32 v194, v44, v45
    v_cvt_pk_bf16_f32 v195, v46, v47
    s_add_u32 s31, s32, 589824
    buffer_store_dwordx4 v[192:195], v2, s[4:7], s31 offen sc1
    v_cvt_pk_bf16_f32 v196, v60, v61
    v_cvt_pk_bf16_f32 v197, v62, v63
    v_cvt_pk_bf16_f32 v198, v76, v77
    v_cvt_pk_bf16_f32 v199, v78, v79
    s_add_u32 s31, s32, 590848
    buffer_store_dwordx4 v[196:199], v2, s[4:7], s31 offen sc1
    v_cvt_pk_bf16_f32 v200, v92, v93
    v_cvt_pk_bf16_f32 v201, v94, v95
    v_cvt_pk_bf16_f32 v202, v108, v109
    v_cvt_pk_bf16_f32 v203, v110, v111
    s_add_u32 s31, s32, 591872
    buffer_store_dwordx4 v[200:203], v2, s[4:7], s31 offen sc1
    v_cvt_pk_bf16_f32 v204, v124, v125
    v_cvt_pk_bf16_f32 v205, v126, v127
    v_cvt_pk_bf16_f32 v206, v140, v141
    v_cvt_pk_bf16_f32 v207, v142, v143
    s_add_u32 s31, s32, 592896
    buffer_store_dwordx4 v[204:207], v2, s[4:7], s31 offen sc1
    s_branch L_w_fin
L_w_vo:
    s_mov_b32 s22, s71
    s_lshl_b32 s23, s21, 2
    s_and_b32 s24, s20, 1
    s_lshr_b32 s25, s20, 1
    s_mul_i32 s27, s22, 12
    s_mul_i32 s26, s24, 6
    s_add_u32 s27, s27, s26
    s_mul_i32 s27, s27, 20480
    s_add_u32 s27, s27, 20402176
    v_add_u32 v4, s27, v2
    s_add_u32 s27, s27, 20480
    v_add_u32 v5, s27, v2
    s_add_u32 s27, s27, 20480
    v_add_u32 v6, s27, v2
    s_add_u32 s27, s27, 20480
    v_add_u32 v7, s27, v2
    s_add_u32 s27, s27, 20480
    v_add_u32 v8, s27, v2
    s_add_u32 s27, s27, 20480
    v_add_u32 v9, s27, v2
    s_lshl_b32 s27, s23, 1
    s_lshl_b32 s26, s25, 2
    s_add_u32 s27, s27, s26
    s_mul_i32 s27, s27, 20480
    s_add_u32 s27, s27, 2052096
    v_add_u32 v10, s27, v2
    s_add_u32 s27, s27, 20480
    v_add_u32 v11, s27, v2
    s_add_u32 s27, s27, 20480
    v_add_u32 v12, s27, v2
    s_add_u32 s27, s27, 20480
    v_add_u32 v13, s27, v2
    s_mov_b32 s28, 0
    buffer_load_dwordx4 a[0:3], v4, s[4:7], s28 offen
    buffer_load_dwordx4 a[4:7], v5, s[4:7], s28 offen
    buffer_load_dwordx4 a[8:11], v6, s[4:7], s28 offen
    buffer_load_dwordx4 a[12:15], v7, s[4:7], s28 offen
    buffer_load_dwordx4 a[16:19], v8, s[4:7], s28 offen
    buffer_load_dwordx4 a[20:23], v9, s[4:7], s28 offen
    buffer_load_dwordx4 a[24:27], v10, s[4:7], s28 offen
    buffer_load_dwordx4 a[28:31], v11, s[4:7], s28 offen
    buffer_load_dwordx4 a[32:35], v12, s[4:7], s28 offen
    buffer_load_dwordx4 a[36:39], v13, s[4:7], s28 offen
    s_mov_b32 s28, 1024
    buffer_load_dwordx4 a[40:43], v4, s[4:7], s28 offen
    buffer_load_dwordx4 a[44:47], v5, s[4:7], s28 offen
    buffer_load_dwordx4 a[48:51], v6, s[4:7], s28 offen
    buffer_load_dwordx4 a[52:55], v7, s[4:7], s28 offen
    buffer_load_dwordx4 a[56:59], v8, s[4:7], s28 offen
    buffer_load_dwordx4 a[60:63], v9, s[4:7], s28 offen
    buffer_load_dwordx4 a[64:67], v10, s[4:7], s28 offen
    buffer_load_dwordx4 a[68:71], v11, s[4:7], s28 offen
    buffer_load_dwordx4 a[72:75], v12, s[4:7], s28 offen
    buffer_load_dwordx4 a[76:79], v13, s[4:7], s28 offen
    s_mov_b32 s28, 2048
    buffer_load_dwordx4 a[80:83], v4, s[4:7], s28 offen
    buffer_load_dwordx4 a[84:87], v5, s[4:7], s28 offen
    buffer_load_dwordx4 a[88:91], v6, s[4:7], s28 offen
    buffer_load_dwordx4 a[92:95], v7, s[4:7], s28 offen
    buffer_load_dwordx4 a[96:99], v8, s[4:7], s28 offen
    buffer_load_dwordx4 a[100:103], v9, s[4:7], s28 offen
    buffer_load_dwordx4 a[104:107], v10, s[4:7], s28 offen
    buffer_load_dwordx4 a[108:111], v11, s[4:7], s28 offen
    buffer_load_dwordx4 a[112:115], v12, s[4:7], s28 offen
    buffer_load_dwordx4 a[116:119], v13, s[4:7], s28 offen
    s_mov_b32 s28, 3072
    buffer_load_dwordx4 a[120:123], v4, s[4:7], s28 offen
    buffer_load_dwordx4 a[124:127], v5, s[4:7], s28 offen
    buffer_load_dwordx4 a[128:131], v6, s[4:7], s28 offen
    buffer_load_dwordx4 a[132:135], v7, s[4:7], s28 offen
    buffer_load_dwordx4 a[136:139], v8, s[4:7], s28 offen
    buffer_load_dwordx4 a[140:143], v9, s[4:7], s28 offen
    buffer_load_dwordx4 a[144:147], v10, s[4:7], s28 offen
    buffer_load_dwordx4 a[148:151], v11, s[4:7], s28 offen
    buffer_load_dwordx4 a[152:155], v12, s[4:7], s28 offen
    buffer_load_dwordx4 a[156:159], v13, s[4:7], s28 offen
    s_mov_b32 s28, 4096
    buffer_load_dwordx4 a[160:163], v4, s[4:7], s28 offen
    buffer_load_dwordx4 a[164:167], v5, s[4:7], s28 offen
    buffer_load_dwordx4 a[168:171], v6, s[4:7], s28 offen
    buffer_load_dwordx4 a[172:175], v7, s[4:7], s28 offen
    buffer_load_dwordx4 a[176:179], v8, s[4:7], s28 offen
    buffer_load_dwordx4 a[180:183], v9, s[4:7], s28 offen
    buffer_load_dwordx4 a[184:187], v10, s[4:7], s28 offen
    buffer_load_dwordx4 a[188:191], v11, s[4:7], s28 offen
    buffer_load_dwordx4 a[192:195], v12, s[4:7], s28 offen
    buffer_load_dwordx4 a[196:199], v13, s[4:7], s28 offen
    s_mov_b32 s28, 5120
    buffer_load_dwordx4 a[200:203], v4, s[4:7], s28 offen
    buffer_load_dwordx4 a[204:207], v5, s[4:7], s28 offen
    buffer_load_dwordx4 a[208:211], v6, s[4:7], s28 offen
    buffer_load_dwordx4 a[212:215], v7, s[4:7], s28 offen
    buffer_load_dwordx4 a[216:219], v8, s[4:7], s28 offen
    buffer_load_dwordx4 a[220:223], v9, s[4:7], s28 offen
    buffer_load_dwordx4 a[224:227], v10, s[4:7], s28 offen
    buffer_load_dwordx4 a[228:231], v11, s[4:7], s28 offen
    buffer_load_dwordx4 a[232:235], v12, s[4:7], s28 offen
    buffer_load_dwordx4 a[236:239], v13, s[4:7], s28 offen
    s_waitcnt vmcnt(50)
    v_mfma_f32_16x16x32_bf16 v[20:23], a[0:3], a[24:27], 0
    v_mfma_f32_16x16x32_bf16 v[24:27], a[0:3], a[28:31], 0
    v_mfma_f32_16x16x32_bf16 v[28:31], a[0:3], a[32:35], 0
    v_mfma_f32_16x16x32_bf16 v[32:35], a[0:3], a[36:39], 0
    v_mfma_f32_16x16x32_bf16 v[36:39], a[4:7], a[24:27], 0
    v_mfma_f32_16x16x32_bf16 v[40:43], a[4:7], a[28:31], 0
    v_mfma_f32_16x16x32_bf16 v[44:47], a[4:7], a[32:35], 0
    v_mfma_f32_16x16x32_bf16 v[48:51], a[4:7], a[36:39], 0
    v_mfma_f32_16x16x32_bf16 v[52:55], a[8:11], a[24:27], 0
    v_mfma_f32_16x16x32_bf16 v[56:59], a[8:11], a[28:31], 0
    v_mfma_f32_16x16x32_bf16 v[60:63], a[8:11], a[32:35], 0
    v_mfma_f32_16x16x32_bf16 v[64:67], a[8:11], a[36:39], 0
    v_mfma_f32_16x16x32_bf16 v[68:71], a[12:15], a[24:27], 0
    v_mfma_f32_16x16x32_bf16 v[72:75], a[12:15], a[28:31], 0
    v_mfma_f32_16x16x32_bf16 v[76:79], a[12:15], a[32:35], 0
    v_mfma_f32_16x16x32_bf16 v[80:83], a[12:15], a[36:39], 0
    v_mfma_f32_16x16x32_bf16 v[84:87], a[16:19], a[24:27], 0
    v_mfma_f32_16x16x32_bf16 v[88:91], a[16:19], a[28:31], 0
    v_mfma_f32_16x16x32_bf16 v[92:95], a[16:19], a[32:35], 0
    v_mfma_f32_16x16x32_bf16 v[96:99], a[16:19], a[36:39], 0
    v_mfma_f32_16x16x32_bf16 v[100:103], a[20:23], a[24:27], 0
    v_mfma_f32_16x16x32_bf16 v[104:107], a[20:23], a[28:31], 0
    v_mfma_f32_16x16x32_bf16 v[108:111], a[20:23], a[32:35], 0
    v_mfma_f32_16x16x32_bf16 v[112:115], a[20:23], a[36:39], 0
    s_mov_b32 s28, 6144
    buffer_load_dwordx4 a[0:3], v4, s[4:7], s28 offen
    buffer_load_dwordx4 a[4:7], v5, s[4:7], s28 offen
    buffer_load_dwordx4 a[8:11], v6, s[4:7], s28 offen
    buffer_load_dwordx4 a[12:15], v7, s[4:7], s28 offen
    buffer_load_dwordx4 a[16:19], v8, s[4:7], s28 offen
    buffer_load_dwordx4 a[20:23], v9, s[4:7], s28 offen
    buffer_load_dwordx4 a[24:27], v10, s[4:7], s28 offen
    buffer_load_dwordx4 a[28:31], v11, s[4:7], s28 offen
    buffer_load_dwordx4 a[32:35], v12, s[4:7], s28 offen
    buffer_load_dwordx4 a[36:39], v13, s[4:7], s28 offen
    s_waitcnt vmcnt(50)
    v_mfma_f32_16x16x32_bf16 v[20:23], a[40:43], a[64:67], v[20:23]
    v_mfma_f32_16x16x32_bf16 v[24:27], a[40:43], a[68:71], v[24:27]
    v_mfma_f32_16x16x32_bf16 v[28:31], a[40:43], a[72:75], v[28:31]
    v_mfma_f32_16x16x32_bf16 v[32:35], a[40:43], a[76:79], v[32:35]
    v_mfma_f32_16x16x32_bf16 v[36:39], a[44:47], a[64:67], v[36:39]
    v_mfma_f32_16x16x32_bf16 v[40:43], a[44:47], a[68:71], v[40:43]
    v_mfma_f32_16x16x32_bf16 v[44:47], a[44:47], a[72:75], v[44:47]
    v_mfma_f32_16x16x32_bf16 v[48:51], a[44:47], a[76:79], v[48:51]
    v_mfma_f32_16x16x32_bf16 v[52:55], a[48:51], a[64:67], v[52:55]
    v_mfma_f32_16x16x32_bf16 v[56:59], a[48:51], a[68:71], v[56:59]
    v_mfma_f32_16x16x32_bf16 v[60:63], a[48:51], a[72:75], v[60:63]
    v_mfma_f32_16x16x32_bf16 v[64:67], a[48:51], a[76:79], v[64:67]
    v_mfma_f32_16x16x32_bf16 v[68:71], a[52:55], a[64:67], v[68:71]
    v_mfma_f32_16x16x32_bf16 v[72:75], a[52:55], a[68:71], v[72:75]
    v_mfma_f32_16x16x32_bf16 v[76:79], a[52:55], a[72:75], v[76:79]
    v_mfma_f32_16x16x32_bf16 v[80:83], a[52:55], a[76:79], v[80:83]
    v_mfma_f32_16x16x32_bf16 v[84:87], a[56:59], a[64:67], v[84:87]
    v_mfma_f32_16x16x32_bf16 v[88:91], a[56:59], a[68:71], v[88:91]
    v_mfma_f32_16x16x32_bf16 v[92:95], a[56:59], a[72:75], v[92:95]
    v_mfma_f32_16x16x32_bf16 v[96:99], a[56:59], a[76:79], v[96:99]
    v_mfma_f32_16x16x32_bf16 v[100:103], a[60:63], a[64:67], v[100:103]
    v_mfma_f32_16x16x32_bf16 v[104:107], a[60:63], a[68:71], v[104:107]
    v_mfma_f32_16x16x32_bf16 v[108:111], a[60:63], a[72:75], v[108:111]
    v_mfma_f32_16x16x32_bf16 v[112:115], a[60:63], a[76:79], v[112:115]
    s_mov_b32 s28, 7168
    buffer_load_dwordx4 a[40:43], v4, s[4:7], s28 offen
    buffer_load_dwordx4 a[44:47], v5, s[4:7], s28 offen
    buffer_load_dwordx4 a[48:51], v6, s[4:7], s28 offen
    buffer_load_dwordx4 a[52:55], v7, s[4:7], s28 offen
    buffer_load_dwordx4 a[56:59], v8, s[4:7], s28 offen
    buffer_load_dwordx4 a[60:63], v9, s[4:7], s28 offen
    buffer_load_dwordx4 a[64:67], v10, s[4:7], s28 offen
    buffer_load_dwordx4 a[68:71], v11, s[4:7], s28 offen
    buffer_load_dwordx4 a[72:75], v12, s[4:7], s28 offen
    buffer_load_dwordx4 a[76:79], v13, s[4:7], s28 offen
    s_waitcnt vmcnt(50)
    v_mfma_f32_16x16x32_bf16 v[20:23], a[80:83], a[104:107], v[20:23]
    v_mfma_f32_16x16x32_bf16 v[24:27], a[80:83], a[108:111], v[24:27]
    v_mfma_f32_16x16x32_bf16 v[28:31], a[80:83], a[112:115], v[28:31]
    v_mfma_f32_16x16x32_bf16 v[32:35], a[80:83], a[116:119], v[32:35]
    v_mfma_f32_16x16x32_bf16 v[36:39], a[84:87], a[104:107], v[36:39]
    v_mfma_f32_16x16x32_bf16 v[40:43], a[84:87], a[108:111], v[40:43]
    v_mfma_f32_16x16x32_bf16 v[44:47], a[84:87], a[112:115], v[44:47]
    v_mfma_f32_16x16x32_bf16 v[48:51], a[84:87], a[116:119], v[48:51]
    v_mfma_f32_16x16x32_bf16 v[52:55], a[88:91], a[104:107], v[52:55]
    v_mfma_f32_16x16x32_bf16 v[56:59], a[88:91], a[108:111], v[56:59]
    v_mfma_f32_16x16x32_bf16 v[60:63], a[88:91], a[112:115], v[60:63]
    v_mfma_f32_16x16x32_bf16 v[64:67], a[88:91], a[116:119], v[64:67]
    v_mfma_f32_16x16x32_bf16 v[68:71], a[92:95], a[104:107], v[68:71]
    v_mfma_f32_16x16x32_bf16 v[72:75], a[92:95], a[108:111], v[72:75]
    v_mfma_f32_16x16x32_bf16 v[76:79], a[92:95], a[112:115], v[76:79]
    v_mfma_f32_16x16x32_bf16 v[80:83], a[92:95], a[116:119], v[80:83]
    v_mfma_f32_16x16x32_bf16 v[84:87], a[96:99], a[104:107], v[84:87]
    v_mfma_f32_16x16x32_bf16 v[88:91], a[96:99], a[108:111], v[88:91]
    v_mfma_f32_16x16x32_bf16 v[92:95], a[96:99], a[112:115], v[92:95]
    v_mfma_f32_16x16x32_bf16 v[96:99], a[96:99], a[116:119], v[96:99]
    v_mfma_f32_16x16x32_bf16 v[100:103], a[100:103], a[104:107], v[100:103]
    v_mfma_f32_16x16x32_bf16 v[104:107], a[100:103], a[108:111], v[104:107]
    v_mfma_f32_16x16x32_bf16 v[108:111], a[100:103], a[112:115], v[108:111]
    v_mfma_f32_16x16x32_bf16 v[112:115], a[100:103], a[116:119], v[112:115]
    s_mov_b32 s28, 8192
    buffer_load_dwordx4 a[80:83], v4, s[4:7], s28 offen
    buffer_load_dwordx4 a[84:87], v5, s[4:7], s28 offen
    buffer_load_dwordx4 a[88:91], v6, s[4:7], s28 offen
    buffer_load_dwordx4 a[92:95], v7, s[4:7], s28 offen
    buffer_load_dwordx4 a[96:99], v8, s[4:7], s28 offen
    buffer_load_dwordx4 a[100:103], v9, s[4:7], s28 offen
    buffer_load_dwordx4 a[104:107], v10, s[4:7], s28 offen
    buffer_load_dwordx4 a[108:111], v11, s[4:7], s28 offen
    buffer_load_dwordx4 a[112:115], v12, s[4:7], s28 offen
    buffer_load_dwordx4 a[116:119], v13, s[4:7], s28 offen
    s_waitcnt vmcnt(50)
    v_mfma_f32_16x16x32_bf16 v[20:23], a[120:123], a[144:147], v[20:23]
    v_mfma_f32_16x16x32_bf16 v[24:27], a[120:123], a[148:151], v[24:27]
    v_mfma_f32_16x16x32_bf16 v[28:31], a[120:123], a[152:155], v[28:31]
    v_mfma_f32_16x16x32_bf16 v[32:35], a[120:123], a[156:159], v[32:35]
    v_mfma_f32_16x16x32_bf16 v[36:39], a[124:127], a[144:147], v[36:39]
    v_mfma_f32_16x16x32_bf16 v[40:43], a[124:127], a[148:151], v[40:43]
    v_mfma_f32_16x16x32_bf16 v[44:47], a[124:127], a[152:155], v[44:47]
    v_mfma_f32_16x16x32_bf16 v[48:51], a[124:127], a[156:159], v[48:51]
    v_mfma_f32_16x16x32_bf16 v[52:55], a[128:131], a[144:147], v[52:55]
    v_mfma_f32_16x16x32_bf16 v[56:59], a[128:131], a[148:151], v[56:59]
    v_mfma_f32_16x16x32_bf16 v[60:63], a[128:131], a[152:155], v[60:63]
    v_mfma_f32_16x16x32_bf16 v[64:67], a[128:131], a[156:159], v[64:67]
    v_mfma_f32_16x16x32_bf16 v[68:71], a[132:135], a[144:147], v[68:71]
    v_mfma_f32_16x16x32_bf16 v[72:75], a[132:135], a[148:151], v[72:75]
    v_mfma_f32_16x16x32_bf16 v[76:79], a[132:135], a[152:155], v[76:79]
    v_mfma_f32_16x16x32_bf16 v[80:83], a[132:135], a[156:159], v[80:83]
    v_mfma_f32_16x16x32_bf16 v[84:87], a[136:139], a[144:147], v[84:87]
    v_mfma_f32_16x16x32_bf16 v[88:91], a[136:139], a[148:151], v[88:91]
    v_mfma_f32_16x16x32_bf16 v[92:95], a[136:139], a[152:155], v[92:95]
    v_mfma_f32_16x16x32_bf16 v[96:99], a[136:139], a[156:159], v[96:99]
    v_mfma_f32_16x16x32_bf16 v[100:103], a[140:143], a[144:147], v[100:103]
    v_mfma_f32_16x16x32_bf16 v[104:107], a[140:143], a[148:151], v[104:107]
    v_mfma_f32_16x16x32_bf16 v[108:111], a[140:143], a[152:155], v[108:111]
    v_mfma_f32_16x16x32_bf16 v[112:115], a[140:143], a[156:159], v[112:115]
    s_mov_b32 s28, 9216
    buffer_load_dwordx4 a[120:123], v4, s[4:7], s28 offen
    buffer_load_dwordx4 a[124:127], v5, s[4:7], s28 offen
    buffer_load_dwordx4 a[128:131], v6, s[4:7], s28 offen
    buffer_load_dwordx4 a[132:135], v7, s[4:7], s28 offen
    buffer_load_dwordx4 a[136:139], v8, s[4:7], s28 offen
    buffer_load_dwordx4 a[140:143], v9, s[4:7], s28 offen
    buffer_load_dwordx4 a[144:147], v10, s[4:7], s28 offen
    buffer_load_dwordx4 a[148:151], v11, s[4:7], s28 offen
    buffer_load_dwordx4 a[152:155], v12, s[4:7], s28 offen
    buffer_load_dwordx4 a[156:159], v13, s[4:7], s28 offen
    s_waitcnt vmcnt(50)
    v_mfma_f32_16x16x32_bf16 v[20:23], a[160:163], a[184:187], v[20:23]
    v_mfma_f32_16x16x32_bf16 v[24:27], a[160:163], a[188:191], v[24:27]
    v_mfma_f32_16x16x32_bf16 v[28:31], a[160:163], a[192:195], v[28:31]
    v_mfma_f32_16x16x32_bf16 v[32:35], a[160:163], a[196:199], v[32:35]
    v_mfma_f32_16x16x32_bf16 v[36:39], a[164:167], a[184:187], v[36:39]
    v_mfma_f32_16x16x32_bf16 v[40:43], a[164:167], a[188:191], v[40:43]
    v_mfma_f32_16x16x32_bf16 v[44:47], a[164:167], a[192:195], v[44:47]
    v_mfma_f32_16x16x32_bf16 v[48:51], a[164:167], a[196:199], v[48:51]
    v_mfma_f32_16x16x32_bf16 v[52:55], a[168:171], a[184:187], v[52:55]
    v_mfma_f32_16x16x32_bf16 v[56:59], a[168:171], a[188:191], v[56:59]
    v_mfma_f32_16x16x32_bf16 v[60:63], a[168:171], a[192:195], v[60:63]
    v_mfma_f32_16x16x32_bf16 v[64:67], a[168:171], a[196:199], v[64:67]
    v_mfma_f32_16x16x32_bf16 v[68:71], a[172:175], a[184:187], v[68:71]
    v_mfma_f32_16x16x32_bf16 v[72:75], a[172:175], a[188:191], v[72:75]
    v_mfma_f32_16x16x32_bf16 v[76:79], a[172:175], a[192:195], v[76:79]
    v_mfma_f32_16x16x32_bf16 v[80:83], a[172:175], a[196:199], v[80:83]
    v_mfma_f32_16x16x32_bf16 v[84:87], a[176:179], a[184:187], v[84:87]
    v_mfma_f32_16x16x32_bf16 v[88:91], a[176:179], a[188:191], v[88:91]
    v_mfma_f32_16x16x32_bf16 v[92:95], a[176:179], a[192:195], v[92:95]
    v_mfma_f32_16x16x32_bf16 v[96:99], a[176:179], a[196:199], v[96:99]
    v_mfma_f32_16x16x32_bf16 v[100:103], a[180:183], a[184:187], v[100:103]
    v_mfma_f32_16x16x32_bf16 v[104:107], a[180:183], a[188:191], v[104:107]
    v_mfma_f32_16x16x32_bf16 v[108:111], a[180:183], a[192:195], v[108:111]
    v_mfma_f32_16x16x32_bf16 v[112:115], a[180:183], a[196:199], v[112:115]
    s_mov_b32 s28, 10240
    buffer_load_dwordx4 a[160:163], v4, s[4:7], s28 offen
    buffer_load_dwordx4 a[164:167], v5, s[4:7], s28 offen
    buffer_load_dwordx4 a[168:171], v6, s[4:7], s28 offen
    buffer_load_dwordx4 a[172:175], v7, s[4:7], s28 offen
    buffer_load_dwordx4 a[176:179], v8, s[4:7], s28 offen
    buffer_load_dwordx4 a[180:183], v9, s[4:7], s28 offen
    buffer_load_dwordx4 a[184:187], v10, s[4:7], s28 offen
    buffer_load_dwordx4 a[188:191], v11, s[4:7], s28 offen
    buffer_load_dwordx4 a[192:195], v12, s[4:7], s28 offen
    buffer_load_dwordx4 a[196:199], v13, s[4:7], s28 offen
    s_waitcnt vmcnt(50)
    v_mfma_f32_16x16x32_bf16 v[20:23], a[200:203], a[224:227], v[20:23]
    v_mfma_f32_16x16x32_bf16 v[24:27], a[200:203], a[228:231], v[24:27]
    v_mfma_f32_16x16x32_bf16 v[28:31], a[200:203], a[232:235], v[28:31]
    v_mfma_f32_16x16x32_bf16 v[32:35], a[200:203], a[236:239], v[32:35]
    v_mfma_f32_16x16x32_bf16 v[36:39], a[204:207], a[224:227], v[36:39]
    v_mfma_f32_16x16x32_bf16 v[40:43], a[204:207], a[228:231], v[40:43]
    v_mfma_f32_16x16x32_bf16 v[44:47], a[204:207], a[232:235], v[44:47]
    v_mfma_f32_16x16x32_bf16 v[48:51], a[204:207], a[236:239], v[48:51]
    v_mfma_f32_16x16x32_bf16 v[52:55], a[208:211], a[224:227], v[52:55]
    v_mfma_f32_16x16x32_bf16 v[56:59], a[208:211], a[228:231], v[56:59]
    v_mfma_f32_16x16x32_bf16 v[60:63], a[208:211], a[232:235], v[60:63]
    v_mfma_f32_16x16x32_bf16 v[64:67], a[208:211], a[236:239], v[64:67]
    v_mfma_f32_16x16x32_bf16 v[68:71], a[212:215], a[224:227], v[68:71]
    v_mfma_f32_16x16x32_bf16 v[72:75], a[212:215], a[228:231], v[72:75]
    v_mfma_f32_16x16x32_bf16 v[76:79], a[212:215], a[232:235], v[76:79]
    v_mfma_f32_16x16x32_bf16 v[80:83], a[212:215], a[236:239], v[80:83]
    v_mfma_f32_16x16x32_bf16 v[84:87], a[216:219], a[224:227], v[84:87]
    v_mfma_f32_16x16x32_bf16 v[88:91], a[216:219], a[228:231], v[88:91]
    v_mfma_f32_16x16x32_bf16 v[92:95], a[216:219], a[232:235], v[92:95]
    v_mfma_f32_16x16x32_bf16 v[96:99], a[216:219], a[236:239], v[96:99]
    v_mfma_f32_16x16x32_bf16 v[100:103], a[220:223], a[224:227], v[100:103]
    v_mfma_f32_16x16x32_bf16 v[104:107], a[220:223], a[228:231], v[104:107]
    v_mfma_f32_16x16x32_bf16 v[108:111], a[220:223], a[232:235], v[108:111]
    v_mfma_f32_16x16x32_bf16 v[112:115], a[220:223], a[236:239], v[112:115]
    s_mov_b32 s28, 11264
    buffer_load_dwordx4 a[200:203], v4, s[4:7], s28 offen
    buffer_load_dwordx4 a[204:207], v5, s[4:7], s28 offen
    buffer_load_dwordx4 a[208:211], v6, s[4:7], s28 offen
    buffer_load_dwordx4 a[212:215], v7, s[4:7], s28 offen
    buffer_load_dwordx4 a[216:219], v8, s[4:7], s28 offen
    buffer_load_dwordx4 a[220:223], v9, s[4:7], s28 offen
    buffer_load_dwordx4 a[224:227], v10, s[4:7], s28 offen
    buffer_load_dwordx4 a[228:231], v11, s[4:7], s28 offen
    buffer_load_dwordx4 a[232:235], v12, s[4:7], s28 offen
    buffer_load_dwordx4 a[236:239], v13, s[4:7], s28 offen
    s_waitcnt vmcnt(50)
    v_mfma_f32_16x16x32_bf16 v[20:23], a[0:3], a[24:27], v[20:23]
    v_mfma_f32_16x16x32_bf16 v[24:27], a[0:3], a[28:31], v[24:27]
    v_mfma_f32_16x16x32_bf16 v[28:31], a[0:3], a[32:35], v[28:31]
    v_mfma_f32_16x16x32_bf16 v[32:35], a[0:3], a[36:39], v[32:35]
    v_mfma_f32_16x16x32_bf16 v[36:39], a[4:7], a[24:27], v[36:39]
    v_mfma_f32_16x16x32_bf16 v[40:43], a[4:7], a[28:31], v[40:43]
    v_mfma_f32_16x16x32_bf16 v[44:47], a[4:7], a[32:35], v[44:47]
    v_mfma_f32_16x16x32_bf16 v[48:51], a[4:7], a[36:39], v[48:51]
    v_mfma_f32_16x16x32_bf16 v[52:55], a[8:11], a[24:27], v[52:55]
    v_mfma_f32_16x16x32_bf16 v[56:59], a[8:11], a[28:31], v[56:59]
    v_mfma_f32_16x16x32_bf16 v[60:63], a[8:11], a[32:35], v[60:63]
    v_mfma_f32_16x16x32_bf16 v[64:67], a[8:11], a[36:39], v[64:67]
    v_mfma_f32_16x16x32_bf16 v[68:71], a[12:15], a[24:27], v[68:71]
    v_mfma_f32_16x16x32_bf16 v[72:75], a[12:15], a[28:31], v[72:75]
    v_mfma_f32_16x16x32_bf16 v[76:79], a[12:15], a[32:35], v[76:79]
    v_mfma_f32_16x16x32_bf16 v[80:83], a[12:15], a[36:39], v[80:83]
    v_mfma_f32_16x16x32_bf16 v[84:87], a[16:19], a[24:27], v[84:87]
    v_mfma_f32_16x16x32_bf16 v[88:91], a[16:19], a[28:31], v[88:91]
    v_mfma_f32_16x16x32_bf16 v[92:95], a[16:19], a[32:35], v[92:95]
    v_mfma_f32_16x16x32_bf16 v[96:99], a[16:19], a[36:39], v[96:99]
    v_mfma_f32_16x16x32_bf16 v[100:103], a[20:23], a[24:27], v[100:103]
    v_mfma_f32_16x16x32_bf16 v[104:107], a[20:23], a[28:31], v[104:107]
    v_mfma_f32_16x16x32_bf16 v[108:111], a[20:23], a[32:35], v[108:111]
    v_mfma_f32_16x16x32_bf16 v[112:115], a[20:23], a[36:39], v[112:115]
    s_mov_b32 s28, 12288
    buffer_load_dwordx4 a[0:3], v4, s[4:7], s28 offen
    buffer_load_dwordx4 a[4:7], v5, s[4:7], s28 offen
    buffer_load_dwordx4 a[8:11], v6, s[4:7], s28 offen
    buffer_load_dwordx4 a[12:15], v7, s[4:7], s28 offen
    buffer_load_dwordx4 a[16:19], v8, s[4:7], s28 offen
    buffer_load_dwordx4 a[20:23], v9, s[4:7], s28 offen
    buffer_load_dwordx4 a[24:27], v10, s[4:7], s28 offen
    buffer_load_dwordx4 a[28:31], v11, s[4:7], s28 offen
    buffer_load_dwordx4 a[32:35], v12, s[4:7], s28 offen
    buffer_load_dwordx4 a[36:39], v13, s[4:7], s28 offen
    s_waitcnt vmcnt(50)
    v_mfma_f32_16x16x32_bf16 v[20:23], a[40:43], a[64:67], v[20:23]
    v_mfma_f32_16x16x32_bf16 v[24:27], a[40:43], a[68:71], v[24:27]
    v_mfma_f32_16x16x32_bf16 v[28:31], a[40:43], a[72:75], v[28:31]
    v_mfma_f32_16x16x32_bf16 v[32:35], a[40:43], a[76:79], v[32:35]
    v_mfma_f32_16x16x32_bf16 v[36:39], a[44:47], a[64:67], v[36:39]
    v_mfma_f32_16x16x32_bf16 v[40:43], a[44:47], a[68:71], v[40:43]
    v_mfma_f32_16x16x32_bf16 v[44:47], a[44:47], a[72:75], v[44:47]
    v_mfma_f32_16x16x32_bf16 v[48:51], a[44:47], a[76:79], v[48:51]
    v_mfma_f32_16x16x32_bf16 v[52:55], a[48:51], a[64:67], v[52:55]
    v_mfma_f32_16x16x32_bf16 v[56:59], a[48:51], a[68:71], v[56:59]
    v_mfma_f32_16x16x32_bf16 v[60:63], a[48:51], a[72:75], v[60:63]
    v_mfma_f32_16x16x32_bf16 v[64:67], a[48:51], a[76:79], v[64:67]
    v_mfma_f32_16x16x32_bf16 v[68:71], a[52:55], a[64:67], v[68:71]
    v_mfma_f32_16x16x32_bf16 v[72:75], a[52:55], a[68:71], v[72:75]
    v_mfma_f32_16x16x32_bf16 v[76:79], a[52:55], a[72:75], v[76:79]
    v_mfma_f32_16x16x32_bf16 v[80:83], a[52:55], a[76:79], v[80:83]
    v_mfma_f32_16x16x32_bf16 v[84:87], a[56:59], a[64:67], v[84:87]
    v_mfma_f32_16x16x32_bf16 v[88:91], a[56:59], a[68:71], v[88:91]
    v_mfma_f32_16x16x32_bf16 v[92:95], a[56:59], a[72:75], v[92:95]
    v_mfma_f32_16x16x32_bf16 v[96:99], a[56:59], a[76:79], v[96:99]
    v_mfma_f32_16x16x32_bf16 v[100:103], a[60:63], a[64:67], v[100:103]
    v_mfma_f32_16x16x32_bf16 v[104:107], a[60:63], a[68:71], v[104:107]
    v_mfma_f32_16x16x32_bf16 v[108:111], a[60:63], a[72:75], v[108:111]
    v_mfma_f32_16x16x32_bf16 v[112:115], a[60:63], a[76:79], v[112:115]
    s_mov_b32 s28, 13312
    buffer_load_dwordx4 a[40:43], v4, s[4:7], s28 offen
    buffer_load_dwordx4 a[44:47], v5, s[4:7], s28 offen
    buffer_load_dwordx4 a[48:51], v6, s[4:7], s28 offen
    buffer_load_dwordx4 a[52:55], v7, s[4:7], s28 offen
    buffer_load_dwordx4 a[56:59], v8, s[4:7], s28 offen
    buffer_load_dwordx4 a[60:63], v9, s[4:7], s28 offen
    buffer_load_dwordx4 a[64:67], v10, s[4:7], s28 offen
    buffer_load_dwordx4 a[68:71], v11, s[4:7], s28 offen
    buffer_load_dwordx4 a[72:75], v12, s[4:7], s28 offen
    buffer_load_dwordx4 a[76:79], v13, s[4:7], s28 offen
    s_waitcnt vmcnt(50)
    v_mfma_f32_16x16x32_bf16 v[20:23], a[80:83], a[104:107], v[20:23]
    v_mfma_f32_16x16x32_bf16 v[24:27], a[80:83], a[108:111], v[24:27]
    v_mfma_f32_16x16x32_bf16 v[28:31], a[80:83], a[112:115], v[28:31]
    v_mfma_f32_16x16x32_bf16 v[32:35], a[80:83], a[116:119], v[32:35]
    v_mfma_f32_16x16x32_bf16 v[36:39], a[84:87], a[104:107], v[36:39]
    v_mfma_f32_16x16x32_bf16 v[40:43], a[84:87], a[108:111], v[40:43]
    v_mfma_f32_16x16x32_bf16 v[44:47], a[84:87], a[112:115], v[44:47]
    v_mfma_f32_16x16x32_bf16 v[48:51], a[84:87], a[116:119], v[48:51]
    v_mfma_f32_16x16x32_bf16 v[52:55], a[88:91], a[104:107], v[52:55]
    v_mfma_f32_16x16x32_bf16 v[56:59], a[88:91], a[108:111], v[56:59]
    v_mfma_f32_16x16x32_bf16 v[60:63], a[88:91], a[112:115], v[60:63]
    v_mfma_f32_16x16x32_bf16 v[64:67], a[88:91], a[116:119], v[64:67]
    v_mfma_f32_16x16x32_bf16 v[68:71], a[92:95], a[104:107], v[68:71]
    v_mfma_f32_16x16x32_bf16 v[72:75], a[92:95], a[108:111], v[72:75]
    v_mfma_f32_16x16x32_bf16 v[76:79], a[92:95], a[112:115], v[76:79]
    v_mfma_f32_16x16x32_bf16 v[80:83], a[92:95], a[116:119], v[80:83]
    v_mfma_f32_16x16x32_bf16 v[84:87], a[96:99], a[104:107], v[84:87]
    v_mfma_f32_16x16x32_bf16 v[88:91], a[96:99], a[108:111], v[88:91]
    v_mfma_f32_16x16x32_bf16 v[92:95], a[96:99], a[112:115], v[92:95]
    v_mfma_f32_16x16x32_bf16 v[96:99], a[96:99], a[116:119], v[96:99]
    v_mfma_f32_16x16x32_bf16 v[100:103], a[100:103], a[104:107], v[100:103]
    v_mfma_f32_16x16x32_bf16 v[104:107], a[100:103], a[108:111], v[104:107]
    v_mfma_f32_16x16x32_bf16 v[108:111], a[100:103], a[112:115], v[108:111]
    v_mfma_f32_16x16x32_bf16 v[112:115], a[100:103], a[116:119], v[112:115]
    s_mov_b32 s28, 14336
    buffer_load_dwordx4 a[80:83], v4, s[4:7], s28 offen
    buffer_load_dwordx4 a[84:87], v5, s[4:7], s28 offen
    buffer_load_dwordx4 a[88:91], v6, s[4:7], s28 offen
    buffer_load_dwordx4 a[92:95], v7, s[4:7], s28 offen
    buffer_load_dwordx4 a[96:99], v8, s[4:7], s28 offen
    buffer_load_dwordx4 a[100:103], v9, s[4:7], s28 offen
    buffer_load_dwordx4 a[104:107], v10, s[4:7], s28 offen
    buffer_load_dwordx4 a[108:111], v11, s[4:7], s28 offen
    buffer_load_dwordx4 a[112:115], v12, s[4:7], s28 offen
    buffer_load_dwordx4 a[116:119], v13, s[4:7], s28 offen
    s_waitcnt vmcnt(50)
    v_mfma_f32_16x16x32_bf16 v[20:23], a[120:123], a[144:147], v[20:23]
    v_mfma_f32_16x16x32_bf16 v[24:27], a[120:123], a[148:151], v[24:27]
    v_mfma_f32_16x16x32_bf16 v[28:31], a[120:123], a[152:155], v[28:31]
    v_mfma_f32_16x16x32_bf16 v[32:35], a[120:123], a[156:159], v[32:35]
    v_mfma_f32_16x16x32_bf16 v[36:39], a[124:127], a[144:147], v[36:39]
    v_mfma_f32_16x16x32_bf16 v[40:43], a[124:127], a[148:151], v[40:43]
    v_mfma_f32_16x16x32_bf16 v[44:47], a[124:127], a[152:155], v[44:47]
    v_mfma_f32_16x16x32_bf16 v[48:51], a[124:127], a[156:159], v[48:51]
    v_mfma_f32_16x16x32_bf16 v[52:55], a[128:131], a[144:147], v[52:55]
    v_mfma_f32_16x16x32_bf16 v[56:59], a[128:131], a[148:151], v[56:59]
    v_mfma_f32_16x16x32_bf16 v[60:63], a[128:131], a[152:155], v[60:63]
    v_mfma_f32_16x16x32_bf16 v[64:67], a[128:131], a[156:159], v[64:67]
    v_mfma_f32_16x16x32_bf16 v[68:71], a[132:135], a[144:147], v[68:71]
    v_mfma_f32_16x16x32_bf16 v[72:75], a[132:135], a[148:151], v[72:75]
    v_mfma_f32_16x16x32_bf16 v[76:79], a[132:135], a[152:155], v[76:79]
    v_mfma_f32_16x16x32_bf16 v[80:83], a[132:135], a[156:159], v[80:83]
    v_mfma_f32_16x16x32_bf16 v[84:87], a[136:139], a[144:147], v[84:87]
    v_mfma_f32_16x16x32_bf16 v[88:91], a[136:139], a[148:151], v[88:91]
    v_mfma_f32_16x16x32_bf16 v[92:95], a[136:139], a[152:155], v[92:95]
    v_mfma_f32_16x16x32_bf16 v[96:99], a[136:139], a[156:159], v[96:99]
    v_mfma_f32_16x16x32_bf16 v[100:103], a[140:143], a[144:147], v[100:103]
    v_mfma_f32_16x16x32_bf16 v[104:107], a[140:143], a[148:151], v[104:107]
    v_mfma_f32_16x16x32_bf16 v[108:111], a[140:143], a[152:155], v[108:111]
    v_mfma_f32_16x16x32_bf16 v[112:115], a[140:143], a[156:159], v[112:115]
    s_mov_b32 s28, 15360
    buffer_load_dwordx4 a[120:123], v4, s[4:7], s28 offen
    buffer_load_dwordx4 a[124:127], v5, s[4:7], s28 offen
    buffer_load_dwordx4 a[128:131], v6, s[4:7], s28 offen
    buffer_load_dwordx4 a[132:135], v7, s[4:7], s28 offen
    buffer_load_dwordx4 a[136:139], v8, s[4:7], s28 offen
    buffer_load_dwordx4 a[140:143], v9, s[4:7], s28 offen
    buffer_load_dwordx4 a[144:147], v10, s[4:7], s28 offen
    buffer_load_dwordx4 a[148:151], v11, s[4:7], s28 offen
    buffer_load_dwordx4 a[152:155], v12, s[4:7], s28 offen
    buffer_load_dwordx4 a[156:159], v13, s[4:7], s28 offen
    s_waitcnt vmcnt(50)
    v_mfma_f32_16x16x32_bf16 v[20:23], a[160:163], a[184:187], v[20:23]
    v_mfma_f32_16x16x32_bf16 v[24:27], a[160:163], a[188:191], v[24:27]
    v_mfma_f32_16x16x32_bf16 v[28:31], a[160:163], a[192:195], v[28:31]
    v_mfma_f32_16x16x32_bf16 v[32:35], a[160:163], a[196:199], v[32:35]
    v_mfma_f32_16x16x32_bf16 v[36:39], a[164:167], a[184:187], v[36:39]
    v_mfma_f32_16x16x32_bf16 v[40:43], a[164:167], a[188:191], v[40:43]
    v_mfma_f32_16x16x32_bf16 v[44:47], a[164:167], a[192:195], v[44:47]
    v_mfma_f32_16x16x32_bf16 v[48:51], a[164:167], a[196:199], v[48:51]
    v_mfma_f32_16x16x32_bf16 v[52:55], a[168:171], a[184:187], v[52:55]
    v_mfma_f32_16x16x32_bf16 v[56:59], a[168:171], a[188:191], v[56:59]
    v_mfma_f32_16x16x32_bf16 v[60:63], a[168:171], a[192:195], v[60:63]
    v_mfma_f32_16x16x32_bf16 v[64:67], a[168:171], a[196:199], v[64:67]
    v_mfma_f32_16x16x32_bf16 v[68:71], a[172:175], a[184:187], v[68:71]
    v_mfma_f32_16x16x32_bf16 v[72:75], a[172:175], a[188:191], v[72:75]
    v_mfma_f32_16x16x32_bf16 v[76:79], a[172:175], a[192:195], v[76:79]
    v_mfma_f32_16x16x32_bf16 v[80:83], a[172:175], a[196:199], v[80:83]
    v_mfma_f32_16x16x32_bf16 v[84:87], a[176:179], a[184:187], v[84:87]
    v_mfma_f32_16x16x32_bf16 v[88:91], a[176:179], a[188:191], v[88:91]
    v_mfma_f32_16x16x32_bf16 v[92:95], a[176:179], a[192:195], v[92:95]
    v_mfma_f32_16x16x32_bf16 v[96:99], a[176:179], a[196:199], v[96:99]
    v_mfma_f32_16x16x32_bf16 v[100:103], a[180:183], a[184:187], v[100:103]
    v_mfma_f32_16x16x32_bf16 v[104:107], a[180:183], a[188:191], v[104:107]
    v_mfma_f32_16x16x32_bf16 v[108:111], a[180:183], a[192:195], v[108:111]
    v_mfma_f32_16x16x32_bf16 v[112:115], a[180:183], a[196:199], v[112:115]
    s_mov_b32 s28, 16384
    buffer_load_dwordx4 a[160:163], v4, s[4:7], s28 offen
    buffer_load_dwordx4 a[164:167], v5, s[4:7], s28 offen
    buffer_load_dwordx4 a[168:171], v6, s[4:7], s28 offen
    buffer_load_dwordx4 a[172:175], v7, s[4:7], s28 offen
    buffer_load_dwordx4 a[176:179], v8, s[4:7], s28 offen
    buffer_load_dwordx4 a[180:183], v9, s[4:7], s28 offen
    buffer_load_dwordx4 a[184:187], v10, s[4:7], s28 offen
    buffer_load_dwordx4 a[188:191], v11, s[4:7], s28 offen
    buffer_load_dwordx4 a[192:195], v12, s[4:7], s28 offen
    buffer_load_dwordx4 a[196:199], v13, s[4:7], s28 offen
    s_waitcnt vmcnt(50)
    v_mfma_f32_16x16x32_bf16 v[20:23], a[200:203], a[224:227], v[20:23]
    v_mfma_f32_16x16x32_bf16 v[24:27], a[200:203], a[228:231], v[24:27]
    v_mfma_f32_16x16x32_bf16 v[28:31], a[200:203], a[232:235], v[28:31]
    v_mfma_f32_16x16x32_bf16 v[32:35], a[200:203], a[236:239], v[32:35]
    v_mfma_f32_16x16x32_bf16 v[36:39], a[204:207], a[224:227], v[36:39]
    v_mfma_f32_16x16x32_bf16 v[40:43], a[204:207], a[228:231], v[40:43]
    v_mfma_f32_16x16x32_bf16 v[44:47], a[204:207], a[232:235], v[44:47]
    v_mfma_f32_16x16x32_bf16 v[48:51], a[204:207], a[236:239], v[48:51]
    v_mfma_f32_16x16x32_bf16 v[52:55], a[208:211], a[224:227], v[52:55]
    v_mfma_f32_16x16x32_bf16 v[56:59], a[208:211], a[228:231], v[56:59]
    v_mfma_f32_16x16x32_bf16 v[60:63], a[208:211], a[232:235], v[60:63]
    v_mfma_f32_16x16x32_bf16 v[64:67], a[208:211], a[236:239], v[64:67]
    v_mfma_f32_16x16x32_bf16 v[68:71], a[212:215], a[224:227], v[68:71]
    v_mfma_f32_16x16x32_bf16 v[72:75], a[212:215], a[228:231], v[72:75]
    v_mfma_f32_16x16x32_bf16 v[76:79], a[212:215], a[232:235], v[76:79]
    v_mfma_f32_16x16x32_bf16 v[80:83], a[212:215], a[236:239], v[80:83]
    v_mfma_f32_16x16x32_bf16 v[84:87], a[216:219], a[224:227], v[84:87]
    v_mfma_f32_16x16x32_bf16 v[88:91], a[216:219], a[228:231], v[88:91]
    v_mfma_f32_16x16x32_bf16 v[92:95], a[216:219], a[232:235], v[92:95]
    v_mfma_f32_16x16x32_bf16 v[96:99], a[216:219], a[236:239], v[96:99]
    v_mfma_f32_16x16x32_bf16 v[100:103], a[220:223], a[224:227], v[100:103]
    v_mfma_f32_16x16x32_bf16 v[104:107], a[220:223], a[228:231], v[104:107]
    v_mfma_f32_16x16x32_bf16 v[108:111], a[220:223], a[232:235], v[108:111]
    v_mfma_f32_16x16x32_bf16 v[112:115], a[220:223], a[236:239], v[112:115]
    s_mov_b32 s28, 17408
    buffer_load_dwordx4 a[200:203], v4, s[4:7], s28 offen
    buffer_load_dwordx4 a[204:207], v5, s[4:7], s28 offen
    buffer_load_dwordx4 a[208:211], v6, s[4:7], s28 offen
    buffer_load_dwordx4 a[212:215], v7, s[4:7], s28 offen
    buffer_load_dwordx4 a[216:219], v8, s[4:7], s28 offen
    buffer_load_dwordx4 a[220:223], v9, s[4:7], s28 offen
    buffer_load_dwordx4 a[224:227], v10, s[4:7], s28 offen
    buffer_load_dwordx4 a[228:231], v11, s[4:7], s28 offen
    buffer_load_dwordx4 a[232:235], v12, s[4:7], s28 offen
    buffer_load_dwordx4 a[236:239], v13, s[4:7], s28 offen
    s_waitcnt vmcnt(50)
    v_mfma_f32_16x16x32_bf16 v[20:23], a[0:3], a[24:27], v[20:23]
    v_mfma_f32_16x16x32_bf16 v[24:27], a[0:3], a[28:31], v[24:27]
    v_mfma_f32_16x16x32_bf16 v[28:31], a[0:3], a[32:35], v[28:31]
    v_mfma_f32_16x16x32_bf16 v[32:35], a[0:3], a[36:39], v[32:35]
    v_mfma_f32_16x16x32_bf16 v[36:39], a[4:7], a[24:27], v[36:39]
    v_mfma_f32_16x16x32_bf16 v[40:43], a[4:7], a[28:31], v[40:43]
    v_mfma_f32_16x16x32_bf16 v[44:47], a[4:7], a[32:35], v[44:47]
    v_mfma_f32_16x16x32_bf16 v[48:51], a[4:7], a[36:39], v[48:51]
    v_mfma_f32_16x16x32_bf16 v[52:55], a[8:11], a[24:27], v[52:55]
    v_mfma_f32_16x16x32_bf16 v[56:59], a[8:11], a[28:31], v[56:59]
    v_mfma_f32_16x16x32_bf16 v[60:63], a[8:11], a[32:35], v[60:63]
    v_mfma_f32_16x16x32_bf16 v[64:67], a[8:11], a[36:39], v[64:67]
    v_mfma_f32_16x16x32_bf16 v[68:71], a[12:15], a[24:27], v[68:71]
    v_mfma_f32_16x16x32_bf16 v[72:75], a[12:15], a[28:31], v[72:75]
    v_mfma_f32_16x16x32_bf16 v[76:79], a[12:15], a[32:35], v[76:79]
    v_mfma_f32_16x16x32_bf16 v[80:83], a[12:15], a[36:39], v[80:83]
    v_mfma_f32_16x16x32_bf16 v[84:87], a[16:19], a[24:27], v[84:87]
    v_mfma_f32_16x16x32_bf16 v[88:91], a[16:19], a[28:31], v[88:91]
    v_mfma_f32_16x16x32_bf16 v[92:95], a[16:19], a[32:35], v[92:95]
    v_mfma_f32_16x16x32_bf16 v[96:99], a[16:19], a[36:39], v[96:99]
    v_mfma_f32_16x16x32_bf16 v[100:103], a[20:23], a[24:27], v[100:103]
    v_mfma_f32_16x16x32_bf16 v[104:107], a[20:23], a[28:31], v[104:107]
    v_mfma_f32_16x16x32_bf16 v[108:111], a[20:23], a[32:35], v[108:111]
    v_mfma_f32_16x16x32_bf16 v[112:115], a[20:23], a[36:39], v[112:115]
    s_mov_b32 s28, 18432
    buffer_load_dwordx4 a[0:3], v4, s[4:7], s28 offen
    buffer_load_dwordx4 a[4:7], v5, s[4:7], s28 offen
    buffer_load_dwordx4 a[8:11], v6, s[4:7], s28 offen
    buffer_load_dwordx4 a[12:15], v7, s[4:7], s28 offen
    buffer_load_dwordx4 a[16:19], v8, s[4:7], s28 offen
    buffer_load_dwordx4 a[20:23], v9, s[4:7], s28 offen
    buffer_load_dwordx4 a[24:27], v10, s[4:7], s28 offen
    buffer_load_dwordx4 a[28:31], v11, s[4:7], s28 offen
    buffer_load_dwordx4 a[32:35], v12, s[4:7], s28 offen
    buffer_load_dwordx4 a[36:39], v13, s[4:7], s28 offen
    s_waitcnt vmcnt(50)
    v_mfma_f32_16x16x32_bf16 v[20:23], a[40:43], a[64:67], v[20:23]
    v_mfma_f32_16x16x32_bf16 v[24:27], a[40:43], a[68:71], v[24:27]
    v_mfma_f32_16x16x32_bf16 v[28:31], a[40:43], a[72:75], v[28:31]
    v_mfma_f32_16x16x32_bf16 v[32:35], a[40:43], a[76:79], v[32:35]
    v_mfma_f32_16x16x32_bf16 v[36:39], a[44:47], a[64:67], v[36:39]
    v_mfma_f32_16x16x32_bf16 v[40:43], a[44:47], a[68:71], v[40:43]
    v_mfma_f32_16x16x32_bf16 v[44:47], a[44:47], a[72:75], v[44:47]
    v_mfma_f32_16x16x32_bf16 v[48:51], a[44:47], a[76:79], v[48:51]
    v_mfma_f32_16x16x32_bf16 v[52:55], a[48:51], a[64:67], v[52:55]
    v_mfma_f32_16x16x32_bf16 v[56:59], a[48:51], a[68:71], v[56:59]
    v_mfma_f32_16x16x32_bf16 v[60:63], a[48:51], a[72:75], v[60:63]
    v_mfma_f32_16x16x32_bf16 v[64:67], a[48:51], a[76:79], v[64:67]
    v_mfma_f32_16x16x32_bf16 v[68:71], a[52:55], a[64:67], v[68:71]
    v_mfma_f32_16x16x32_bf16 v[72:75], a[52:55], a[68:71], v[72:75]
    v_mfma_f32_16x16x32_bf16 v[76:79], a[52:55], a[72:75], v[76:79]
    v_mfma_f32_16x16x32_bf16 v[80:83], a[52:55], a[76:79], v[80:83]
    v_mfma_f32_16x16x32_bf16 v[84:87], a[56:59], a[64:67], v[84:87]
    v_mfma_f32_16x16x32_bf16 v[88:91], a[56:59], a[68:71], v[88:91]
    v_mfma_f32_16x16x32_bf16 v[92:95], a[56:59], a[72:75], v[92:95]
    v_mfma_f32_16x16x32_bf16 v[96:99], a[56:59], a[76:79], v[96:99]
    v_mfma_f32_16x16x32_bf16 v[100:103], a[60:63], a[64:67], v[100:103]
    v_mfma_f32_16x16x32_bf16 v[104:107], a[60:63], a[68:71], v[104:107]
    v_mfma_f32_16x16x32_bf16 v[108:111], a[60:63], a[72:75], v[108:111]
    v_mfma_f32_16x16x32_bf16 v[112:115], a[60:63], a[76:79], v[112:115]
    s_mov_b32 s28, 19456
    buffer_load_dwordx4 a[40:43], v4, s[4:7], s28 offen
    buffer_load_dwordx4 a[44:47], v5, s[4:7], s28 offen
    buffer_load_dwordx4 a[48:51], v6, s[4:7], s28 offen
    buffer_load_dwordx4 a[52:55], v7, s[4:7], s28 offen
    buffer_load_dwordx4 a[56:59], v8, s[4:7], s28 offen
    buffer_load_dwordx4 a[60:63], v9, s[4:7], s28 offen
    buffer_load_dwordx4 a[64:67], v10, s[4:7], s28 offen
    buffer_load_dwordx4 a[68:71], v11, s[4:7], s28 offen
    buffer_load_dwordx4 a[72:75], v12, s[4:7], s28 offen
    buffer_load_dwordx4 a[76:79], v13, s[4:7], s28 offen
    s_waitcnt vmcnt(50)
    v_mfma_f32_16x16x32_bf16 v[20:23], a[80:83], a[104:107], v[20:23]
    v_mfma_f32_16x16x32_bf16 v[24:27], a[80:83], a[108:111], v[24:27]
    v_mfma_f32_16x16x32_bf16 v[28:31], a[80:83], a[112:115], v[28:31]
    v_mfma_f32_16x16x32_bf16 v[32:35], a[80:83], a[116:119], v[32:35]
    v_mfma_f32_16x16x32_bf16 v[36:39], a[84:87], a[104:107], v[36:39]
    v_mfma_f32_16x16x32_bf16 v[40:43], a[84:87], a[108:111], v[40:43]
    v_mfma_f32_16x16x32_bf16 v[44:47], a[84:87], a[112:115], v[44:47]
    v_mfma_f32_16x16x32_bf16 v[48:51], a[84:87], a[116:119], v[48:51]
    v_mfma_f32_16x16x32_bf16 v[52:55], a[88:91], a[104:107], v[52:55]
    v_mfma_f32_16x16x32_bf16 v[56:59], a[88:91], a[108:111], v[56:59]
    v_mfma_f32_16x16x32_bf16 v[60:63], a[88:91], a[112:115], v[60:63]
    v_mfma_f32_16x16x32_bf16 v[64:67], a[88:91], a[116:119], v[64:67]
    v_mfma_f32_16x16x32_bf16 v[68:71], a[92:95], a[104:107], v[68:71]
    v_mfma_f32_16x16x32_bf16 v[72:75], a[92:95], a[108:111], v[72:75]
    v_mfma_f32_16x16x32_bf16 v[76:79], a[92:95], a[112:115], v[76:79]
    v_mfma_f32_16x16x32_bf16 v[80:83], a[92:95], a[116:119], v[80:83]
    v_mfma_f32_16x16x32_bf16 v[84:87], a[96:99], a[104:107], v[84:87]
    v_mfma_f32_16x16x32_bf16 v[88:91], a[96:99], a[108:111], v[88:91]
    v_mfma_f32_16x16x32_bf16 v[92:95], a[96:99], a[112:115], v[92:95]
    v_mfma_f32_16x16x32_bf16 v[96:99], a[96:99], a[116:119], v[96:99]
    v_mfma_f32_16x16x32_bf16 v[100:103], a[100:103], a[104:107], v[100:103]
    v_mfma_f32_16x16x32_bf16 v[104:107], a[100:103], a[108:111], v[104:107]
    v_mfma_f32_16x16x32_bf16 v[108:111], a[100:103], a[112:115], v[108:111]
    v_mfma_f32_16x16x32_bf16 v[112:115], a[100:103], a[116:119], v[112:115]
    s_waitcnt vmcnt(40)
    v_mfma_f32_16x16x32_bf16 v[20:23], a[120:123], a[144:147], v[20:23]
    v_mfma_f32_16x16x32_bf16 v[24:27], a[120:123], a[148:151], v[24:27]
    v_mfma_f32_16x16x32_bf16 v[28:31], a[120:123], a[152:155], v[28:31]
    v_mfma_f32_16x16x32_bf16 v[32:35], a[120:123], a[156:159], v[32:35]
    v_mfma_f32_16x16x32_bf16 v[36:39], a[124:127], a[144:147], v[36:39]
    v_mfma_f32_16x16x32_bf16 v[40:43], a[124:127], a[148:151], v[40:43]
    v_mfma_f32_16x16x32_bf16 v[44:47], a[124:127], a[152:155], v[44:47]
    v_mfma_f32_16x16x32_bf16 v[48:51], a[124:127], a[156:159], v[48:51]
    v_mfma_f32_16x16x32_bf16 v[52:55], a[128:131], a[144:147], v[52:55]
    v_mfma_f32_16x16x32_bf16 v[56:59], a[128:131], a[148:151], v[56:59]
    v_mfma_f32_16x16x32_bf16 v[60:63], a[128:131], a[152:155], v[60:63]
    v_mfma_f32_16x16x32_bf16 v[64:67], a[128:131], a[156:159], v[64:67]
    v_mfma_f32_16x16x32_bf16 v[68:71], a[132:135], a[144:147], v[68:71]
    v_mfma_f32_16x16x32_bf16 v[72:75], a[132:135], a[148:151], v[72:75]
    v_mfma_f32_16x16x32_bf16 v[76:79], a[132:135], a[152:155], v[76:79]
    v_mfma_f32_16x16x32_bf16 v[80:83], a[132:135], a[156:159], v[80:83]
    v_mfma_f32_16x16x32_bf16 v[84:87], a[136:139], a[144:147], v[84:87]
    v_mfma_f32_16x16x32_bf16 v[88:91], a[136:139], a[148:151], v[88:91]
    v_mfma_f32_16x16x32_bf16 v[92:95], a[136:139], a[152:155], v[92:95]
    v_mfma_f32_16x16x32_bf16 v[96:99], a[136:139], a[156:159], v[96:99]
    v_mfma_f32_16x16x32_bf16 v[100:103], a[140:143], a[144:147], v[100:103]
    v_mfma_f32_16x16x32_bf16 v[104:107], a[140:143], a[148:151], v[104:107]
    v_mfma_f32_16x16x32_bf16 v[108:111], a[140:143], a[152:155], v[108:111]
    v_mfma_f32_16x16x32_bf16 v[112:115], a[140:143], a[156:159], v[112:115]
    s_waitcnt vmcnt(30)
    v_mfma_f32_16x16x32_bf16 v[20:23], a[160:163], a[184:187], v[20:23]
    v_mfma_f32_16x16x32_bf16 v[24:27], a[160:163], a[188:191], v[24:27]
    v_mfma_f32_16x16x32_bf16 v[28:31], a[160:163], a[192:195], v[28:31]
    v_mfma_f32_16x16x32_bf16 v[32:35], a[160:163], a[196:199], v[32:35]
    v_mfma_f32_16x16x32_bf16 v[36:39], a[164:167], a[184:187], v[36:39]
    v_mfma_f32_16x16x32_bf16 v[40:43], a[164:167], a[188:191], v[40:43]
    v_mfma_f32_16x16x32_bf16 v[44:47], a[164:167], a[192:195], v[44:47]
    v_mfma_f32_16x16x32_bf16 v[48:51], a[164:167], a[196:199], v[48:51]
    v_mfma_f32_16x16x32_bf16 v[52:55], a[168:171], a[184:187], v[52:55]
    v_mfma_f32_16x16x32_bf16 v[56:59], a[168:171], a[188:191], v[56:59]
    v_mfma_f32_16x16x32_bf16 v[60:63], a[168:171], a[192:195], v[60:63]
    v_mfma_f32_16x16x32_bf16 v[64:67], a[168:171], a[196:199], v[64:67]
    v_mfma_f32_16x16x32_bf16 v[68:71], a[172:175], a[184:187], v[68:71]
    v_mfma_f32_16x16x32_bf16 v[72:75], a[172:175], a[188:191], v[72:75]
    v_mfma_f32_16x16x32_bf16 v[76:79], a[172:175], a[192:195], v[76:79]
    v_mfma_f32_16x16x32_bf16 v[80:83], a[172:175], a[196:199], v[80:83]
    v_mfma_f32_16x16x32_bf16 v[84:87], a[176:179], a[184:187], v[84:87]
    v_mfma_f32_16x16x32_bf16 v[88:91], a[176:179], a[188:191], v[88:91]
    v_mfma_f32_16x16x32_bf16 v[92:95], a[176:179], a[192:195], v[92:95]
    v_mfma_f32_16x16x32_bf16 v[96:99], a[176:179], a[196:199], v[96:99]
    v_mfma_f32_16x16x32_bf16 v[100:103], a[180:183], a[184:187], v[100:103]
    v_mfma_f32_16x16x32_bf16 v[104:107], a[180:183], a[188:191], v[104:107]
    v_mfma_f32_16x16x32_bf16 v[108:111], a[180:183], a[192:195], v[108:111]
    v_mfma_f32_16x16x32_bf16 v[112:115], a[180:183], a[196:199], v[112:115]
    s_waitcnt vmcnt(20)
    v_mfma_f32_16x16x32_bf16 v[20:23], a[200:203], a[224:227], v[20:23]
    v_mfma_f32_16x16x32_bf16 v[24:27], a[200:203], a[228:231], v[24:27]
    v_mfma_f32_16x16x32_bf16 v[28:31], a[200:203], a[232:235], v[28:31]
    v_mfma_f32_16x16x32_bf16 v[32:35], a[200:203], a[236:239], v[32:35]
    v_mfma_f32_16x16x32_bf16 v[36:39], a[204:207], a[224:227], v[36:39]
    v_mfma_f32_16x16x32_bf16 v[40:43], a[204:207], a[228:231], v[40:43]
    v_mfma_f32_16x16x32_bf16 v[44:47], a[204:207], a[232:235], v[44:47]
    v_mfma_f32_16x16x32_bf16 v[48:51], a[204:207], a[236:239], v[48:51]
    v_mfma_f32_16x16x32_bf16 v[52:55], a[208:211], a[224:227], v[52:55]
    v_mfma_f32_16x16x32_bf16 v[56:59], a[208:211], a[228:231], v[56:59]
    v_mfma_f32_16x16x32_bf16 v[60:63], a[208:211], a[232:235], v[60:63]
    v_mfma_f32_16x16x32_bf16 v[64:67], a[208:211], a[236:239], v[64:67]
    v_mfma_f32_16x16x32_bf16 v[68:71], a[212:215], a[224:227], v[68:71]
    v_mfma_f32_16x16x32_bf16 v[72:75], a[212:215], a[228:231], v[72:75]
    v_mfma_f32_16x16x32_bf16 v[76:79], a[212:215], a[232:235], v[76:79]
    v_mfma_f32_16x16x32_bf16 v[80:83], a[212:215], a[236:239], v[80:83]
    v_mfma_f32_16x16x32_bf16 v[84:87], a[216:219], a[224:227], v[84:87]
    v_mfma_f32_16x16x32_bf16 v[88:91], a[216:219], a[228:231], v[88:91]
    v_mfma_f32_16x16x32_bf16 v[92:95], a[216:219], a[232:235], v[92:95]
    v_mfma_f32_16x16x32_bf16 v[96:99], a[216:219], a[236:239], v[96:99]
    v_mfma_f32_16x16x32_bf16 v[100:103], a[220:223], a[224:227], v[100:103]
    v_mfma_f32_16x16x32_bf16 v[104:107], a[220:223], a[228:231], v[104:107]
    v_mfma_f32_16x16x32_bf16 v[108:111], a[220:223], a[232:235], v[108:111]
    v_mfma_f32_16x16x32_bf16 v[112:115], a[220:223], a[236:239], v[112:115]
    s_waitcnt vmcnt(10)
    v_mfma_f32_16x16x32_bf16 v[20:23], a[0:3], a[24:27], v[20:23]
    v_mfma_f32_16x16x32_bf16 v[24:27], a[0:3], a[28:31], v[24:27]
    v_mfma_f32_16x16x32_bf16 v[28:31], a[0:3], a[32:35], v[28:31]
    v_mfma_f32_16x16x32_bf16 v[32:35], a[0:3], a[36:39], v[32:35]
    v_mfma_f32_16x16x32_bf16 v[36:39], a[4:7], a[24:27], v[36:39]
    v_mfma_f32_16x16x32_bf16 v[40:43], a[4:7], a[28:31], v[40:43]
    v_mfma_f32_16x16x32_bf16 v[44:47], a[4:7], a[32:35], v[44:47]
    v_mfma_f32_16x16x32_bf16 v[48:51], a[4:7], a[36:39], v[48:51]
    v_mfma_f32_16x16x32_bf16 v[52:55], a[8:11], a[24:27], v[52:55]
    v_mfma_f32_16x16x32_bf16 v[56:59], a[8:11], a[28:31], v[56:59]
    v_mfma_f32_16x16x32_bf16 v[60:63], a[8:11], a[32:35], v[60:63]
    v_mfma_f32_16x16x32_bf16 v[64:67], a[8:11], a[36:39], v[64:67]
    v_mfma_f32_16x16x32_bf16 v[68:71], a[12:15], a[24:27], v[68:71]
    v_mfma_f32_16x16x32_bf16 v[72:75], a[12:15], a[28:31], v[72:75]
    v_mfma_f32_16x16x32_bf16 v[76:79], a[12:15], a[32:35], v[76:79]
    v_mfma_f32_16x16x32_bf16 v[80:83], a[12:15], a[36:39], v[80:83]
    v_mfma_f32_16x16x32_bf16 v[84:87], a[16:19], a[24:27], v[84:87]
    v_mfma_f32_16x16x32_bf16 v[88:91], a[16:19], a[28:31], v[88:91]
    v_mfma_f32_16x16x32_bf16 v[92:95], a[16:19], a[32:35], v[92:95]
    v_mfma_f32_16x16x32_bf16 v[96:99], a[16:19], a[36:39], v[96:99]
    v_mfma_f32_16x16x32_bf16 v[100:103], a[20:23], a[24:27], v[100:103]
    v_mfma_f32_16x16x32_bf16 v[104:107], a[20:23], a[28:31], v[104:107]
    v_mfma_f32_16x16x32_bf16 v[108:111], a[20:23], a[32:35], v[108:111]
    v_mfma_f32_16x16x32_bf16 v[112:115], a[20:23], a[36:39], v[112:115]
    s_waitcnt vmcnt(0)
    v_mfma_f32_16x16x32_bf16 v[20:23], a[40:43], a[64:67], v[20:23]
    v_mfma_f32_16x16x32_bf16 v[24:27], a[40:43], a[68:71], v[24:27]
    v_mfma_f32_16x16x32_bf16 v[28:31], a[40:43], a[72:75], v[28:31]
    v_mfma_f32_16x16x32_bf16 v[32:35], a[40:43], a[76:79], v[32:35]
    v_mfma_f32_16x16x32_bf16 v[36:39], a[44:47], a[64:67], v[36:39]
    v_mfma_f32_16x16x32_bf16 v[40:43], a[44:47], a[68:71], v[40:43]
    v_mfma_f32_16x16x32_bf16 v[44:47], a[44:47], a[72:75], v[44:47]
    v_mfma_f32_16x16x32_bf16 v[48:51], a[44:47], a[76:79], v[48:51]
    v_mfma_f32_16x16x32_bf16 v[52:55], a[48:51], a[64:67], v[52:55]
    v_mfma_f32_16x16x32_bf16 v[56:59], a[48:51], a[68:71], v[56:59]
    v_mfma_f32_16x16x32_bf16 v[60:63], a[48:51], a[72:75], v[60:63]
    v_mfma_f32_16x16x32_bf16 v[64:67], a[48:51], a[76:79], v[64:67]
    v_mfma_f32_16x16x32_bf16 v[68:71], a[52:55], a[64:67], v[68:71]
    v_mfma_f32_16x16x32_bf16 v[72:75], a[52:55], a[68:71], v[72:75]
    v_mfma_f32_16x16x32_bf16 v[76:79], a[52:55], a[72:75], v[76:79]
    v_mfma_f32_16x16x32_bf16 v[80:83], a[52:55], a[76:79], v[80:83]
    v_mfma_f32_16x16x32_bf16 v[84:87], a[56:59], a[64:67], v[84:87]
    v_mfma_f32_16x16x32_bf16 v[88:91], a[56:59], a[68:71], v[88:91]
    v_mfma_f32_16x16x32_bf16 v[92:95], a[56:59], a[72:75], v[92:95]
    v_mfma_f32_16x16x32_bf16 v[96:99], a[56:59], a[76:79], v[96:99]
    v_mfma_f32_16x16x32_bf16 v[100:103], a[60:63], a[64:67], v[100:103]
    v_mfma_f32_16x16x32_bf16 v[104:107], a[60:63], a[68:71], v[104:107]
    v_mfma_f32_16x16x32_bf16 v[108:111], a[60:63], a[72:75], v[108:111]
    v_mfma_f32_16x16x32_bf16 v[112:115], a[60:63], a[76:79], v[112:115]
    s_nop 7
    s_nop 7
    v_cvt_pk_bf16_f32 v132, v20, v21
    v_cvt_pk_bf16_f32 v133, v22, v23
    v_cvt_pk_bf16_f32 v134, v36, v37
    v_cvt_pk_bf16_f32 v135, v38, v39
    v_cvt_pk_bf16_f32 v136, v52, v53
    v_cvt_pk_bf16_f32 v137, v54, v55
    v_cvt_pk_bf16_f32 v138, v68, v69
    v_cvt_pk_bf16_f32 v139, v70, v71
    v_cvt_pk_bf16_f32 v140, v84, v85
    v_cvt_pk_bf16_f32 v141, v86, v87
    v_cvt_pk_bf16_f32 v142, v100, v101
    v_cvt_pk_bf16_f32 v143, v102, v103
    v_cvt_pk_bf16_f32 v144, v24, v25
    v_cvt_pk_bf16_f32 v145, v26, v27
    v_cvt_pk_bf16_f32 v146, v40, v41
    v_cvt_pk_bf16_f32 v147, v42, v43
    v_cvt_pk_bf16_f32 v148, v56, v57
    v_cvt_pk_bf16_f32 v149, v58, v59
    v_cvt_pk_bf16_f32 v150, v72, v73
    v_cvt_pk_bf16_f32 v151, v74, v75
    v_cvt_pk_bf16_f32 v152, v88, v89
    v_cvt_pk_bf16_f32 v153, v90, v91
    v_cvt_pk_bf16_f32 v154, v104, v105
    v_cvt_pk_bf16_f32 v155, v106, v107
    v_cvt_pk_bf16_f32 v156, v28, v29
    v_cvt_pk_bf16_f32 v157, v30, v31
    v_cvt_pk_bf16_f32 v158, v44, v45
    v_cvt_pk_bf16_f32 v159, v46, v47
    v_cvt_pk_bf16_f32 v160, v60, v61
    v_cvt_pk_bf16_f32 v161, v62, v63
    v_cvt_pk_bf16_f32 v162, v76, v77
    v_cvt_pk_bf16_f32 v163, v78, v79
    v_cvt_pk_bf16_f32 v164, v92, v93
    v_cvt_pk_bf16_f32 v165, v94, v95
    v_cvt_pk_bf16_f32 v166, v108, v109
    v_cvt_pk_bf16_f32 v167, v110, v111
    v_cvt_pk_bf16_f32 v168, v32, v33
    v_cvt_pk_bf16_f32 v169, v34, v35
    v_cvt_pk_bf16_f32 v170, v48, v49
    v_cvt_pk_bf16_f32 v171, v50, v51
    v_cvt_pk_bf16_f32 v172, v64, v65
    v_cvt_pk_bf16_f32 v173, v66, v67
    v_cvt_pk_bf16_f32 v174, v80, v81
    v_cvt_pk_bf16_f32 v175, v82, v83
    v_cvt_pk_bf16_f32 v176, v96, v97
    v_cvt_pk_bf16_f32 v177, v98, v99
    v_cvt_pk_bf16_f32 v178, v112, v113
    v_cvt_pk_bf16_f32 v179, v114, v115
    s_mul_i32 s26, s25, 24
    s_mul_i32 s27, s24, 3
    s_add_u32 s26, s26, s27
    s_lshl_b32 s26, s26, 10
    v_add_u32 v4, s26, v2
    ds_write_b128 v4, v[132:135] offset:0
    ds_write_b128 v4, v[136:139] offset:1024
    ds_write_b128 v4, v[140:143] offset:2048
    ds_write_b128 v4, v[144:147] offset:6144
    ds_write_b128 v4, v[148:151] offset:7168
    ds_write_b128 v4, v[152:155] offset:8192
    ds_write_b128 v4, v[156:159] offset:12288
    ds_write_b128 v4, v[160:163] offset:13312
    ds_write_b128 v4, v[164:167] offset:14336
    ds_write_b128 v4, v[168:171] offset:18432
    ds_write_b128 v4, v[172:175] offset:19456
    ds_write_b128 v4, v[176:179] offset:20480
    s_mul_i32 s27, s22, 40
    s_mul_i32 s26, s20, 10
    s_add_u32 s27, s27, s26
    s_mul_i32 s27, s27, 6144
    s_add_u32 s27, s27, 28266496
    s_lshl_b32 s28, s23, 5
    s_add_u32 s28, s28, s22
    s_mul_i32 s28, s28, 40
    s_add_u32 s28, s28, s26
    s_lshl_b32 s28, s28, 10
    s_add_u32 s28, s28, 90394624
    v_add_u32 v3, 4096, v2
    buffer_load_dwordx4 v[20:23], v2, s[4:7], s27 offen offset:0
    buffer_load_dwordx4 v[24:27], v2, s[4:7], s27 offen offset:1024
    buffer_load_dwordx4 v[28:31], v2, s[4:7], s27 offen offset:2048
    buffer_load_dwordx4 v[32:35], v2, s[4:7], s27 offen offset:3072
    buffer_load_dwordx4 v[36:39], v3, s[4:7], s27 offen offset:0
    buffer_load_dwordx4 v[40:43], v3, s[4:7], s27 offen offset:1024
    s_add_u32 s27, s27, 6144
    buffer_load_dwordx4 v[44:47], v2, s[4:7], s27 offen offset:0
    buffer_load_dwordx4 v[48:51], v2, s[4:7], s27 offen offset:1024
    buffer_load_dwordx4 v[52:55], v2, s[4:7], s27 offen offset:2048
    buffer_load_dwordx4 v[56:59], v2, s[4:7], s27 offen offset:3072
    buffer_load_dwordx4 v[60:63], v3, s[4:7], s27 offen offset:0
    buffer_load_dwordx4 v[64:67], v3, s[4:7], s27 offen offset:1024
    s_add_u32 s27, s27, 6144
    buffer_load_dwordx4 v[68:71], v2, s[4:7], s27 offen offset:0
    buffer_load_dwordx4 v[72:75], v2, s[4:7], s27 offen offset:1024
    buffer_load_dwordx4 v[76:79], v2, s[4:7], s27 offen offset:2048
    buffer_load_dwordx4 v[80:83], v2, s[4:7], s27 offen offset:3072
    buffer_load_dwordx4 v[84:87], v3, s[4:7], s27 offen offset:0
    buffer_load_dwordx4 v[88:91], v3, s[4:7], s27 offen offset:1024
    s_add_u32 s27, s27, 6144
    buffer_load_dwordx4 v[92:95], v2, s[4:7], s27 offen offset:0
    buffer_load_dwordx4 v[96:99], v2, s[4:7], s27 offen offset:1024
    buffer_load_dwordx4 v[100:103], v2, s[4:7], s27 offen offset:2048
    buffer_load_dwordx4 v[104:107], v2, s[4:7], s27 offen offset:3072
    buffer_load_dwordx4 v[108:111], v3, s[4:7], s27 offen offset:0
    buffer_load_dwordx4 v[112:115], v3, s[4:7], s27 offen offset:1024
    s_add_u32 s27, s27, 6144
    buffer_load_dwordx4 v[180:183], v2, s[4:7], s27 offen offset:0
    buffer_load_dwordx4 v[184:187], v2, s[4:7], s27 offen offset:1024
    buffer_load_dwordx4 v[188:191], v2, s[4:7], s27 offen offset:2048
    buffer_load_dwordx4 v[192:195], v2, s[4:7], s27 offen offset:3072
    buffer_load_dwordx4 v[196:199], v3, s[4:7], s27 offen offset:0
    buffer_load_dwordx4 v[200:203], v3, s[4:7], s27 offen offset:1024
    s_add_u32 s27, s27, 6144
    buffer_load_dwordx4 v[204:207], v2, s[4:7], s27 offen offset:0
    buffer_load_dwordx4 v[208:211], v2, s[4:7], s27 offen offset:1024
    buffer_load_dwordx4 v[212:215], v2, s[4:7], s27 offen offset:2048
    buffer_load_dwordx4 v[216:219], v2, s[4:7], s27 offen offset:3072
    buffer_load_dwordx4 v[220:223], v3, s[4:7], s27 offen offset:0
    buffer_load_dwordx4 v[224:227], v3, s[4:7], s27 offen offset:1024
    s_add_u32 s27, s27, 6144
    s_waitcnt lgkmcnt(0)
    s_barrier
    v_add_u32 v4, 16384, v2
    v_add_u32 v5, 32768, v2
    ds_read_b128 a[0:3], v2 offset:0
    ds_read_b128 a[4:7], v2 offset:1024
    ds_read_b128 a[8:11], v2 offset:2048
    ds_read_b128 a[12:15], v2 offset:3072
    ds_read_b128 a[16:19], v2 offset:4096
    ds_read_b128 a[20:23], v2 offset:5120
    ds_read_b128 a[24:27], v2 offset:6144
    ds_read_b128 a[28:31], v2 offset:7168
    ds_read_b128 a[32:35], v2 offset:8192
    ds_read_b128 a[36:39], v2 offset:9216
    ds_read_b128 a[40:43], v2 offset:10240
    ds_read_b128 a[44:47], v2 offset:11264
    ds_read_b128 a[48:51], v2 offset:12288
    ds_read_b128 a[52:55], v2 offset:13312
    ds_read_b128 a[56:59], v2 offset:14336
    ds_read_b128 a[60:63], v2 offset:15360
    ds_read_b128 a[64:67], v4 offset:0
    ds_read_b128 a[68:71], v4 offset:1024
    ds_read_b128 a[72:75], v4 offset:2048
    ds_read_b128 a[76:79], v4 offset:3072
    ds_read_b128 a[80:83], v4 offset:4096
    ds_read_b128 a[84:87], v4 offset:5120
    ds_read_b128 a[88:91], v4 offset:6144
    ds_read_b128 a[92:95], v4 offset:7168
    ds_read_b128 a[96:99], v4 offset:8192
    ds_read_b128 a[100:103], v4 offset:9216
    ds_read_b128 a[104:107], v4 offset:10240
    ds_read_b128 a[108:111], v4 offset:11264
    ds_read_b128 a[112:115], v4 offset:12288
    ds_read_b128 a[116:119], v4 offset:13312
    ds_read_b128 a[120:123], v4 offset:14336
    ds_read_b128 a[124:127], v4 offset:15360
    ds_read_b128 a[128:131], v5 offset:0
    ds_read_b128 a[132:135], v5 offset:1024
    ds_read_b128 a[136:139], v5 offset:2048
    ds_read_b128 a[140:143], v5 offset:3072
    ds_read_b128 a[144:147], v5 offset:4096
    ds_read_b128 a[148:151], v5 offset:5120
    ds_read_b128 a[152:155], v5 offset:6144
    ds_read_b128 a[156:159], v5 offset:7168
    ds_read_b128 a[160:163], v5 offset:8192
    ds_read_b128 a[164:167], v5 offset:9216
    ds_read_b128 a[168:171], v5 offset:10240
    ds_read_b128 a[172:175], v5 offset:11264
    ds_read_b128 a[176:179], v5 offset:12288
    ds_read_b128 a[180:183], v5 offset:13312
    ds_read_b128 a[184:187], v5 offset:14336
    ds_read_b128 a[188:191], v5 offset:15360
    s_waitcnt lgkmcnt(0)
    buffer_load_dwordx4 v[228:231], v2, s[4:7], s27 offen offset:0
    buffer_load_dwordx4 v[232:235], v2, s[4:7], s27 offen offset:1024
    buffer_load_dwordx4 v[236:239], v2, s[4:7], s27 offen offset:2048
    buffer_load_dwordx4 v[240:243], v2, s[4:7], s27 offen offset:3072
    buffer_load_dwordx4 v[244:247], v3, s[4:7], s27 offen offset:0
    buffer_load_dwordx4 v[248:251], v3, s[4:7], s27 offen offset:1024
    s_add_u32 s27, s27, 6144
    s_waitcnt vmcnt(36)
    v_mfma_f32_16x16x32_bf16 v[116:119], a[0:3], v[20:23], 0
    v_mfma_f32_16x16x32_bf16 v[116:119], a[4:7], v[24:27], v[116:119]
    v_mfma_f32_16x16x32_bf16 v[116:119], a[8:11], v[28:31], v[116:119]
    v_mfma_f32_16x16x32_bf16 v[116:119], a[12:15], v[32:35], v[116:119]
    v_mfma_f32_16x16x32_bf16 v[116:119], a[16:19], v[36:39], v[116:119]
    v_mfma_f32_16x16x32_bf16 v[116:119], a[20:23], v[40:43], v[116:119]
    v_mfma_f32_16x16x32_bf16 v[120:123], a[24:27], v[20:23], 0
    v_mfma_f32_16x16x32_bf16 v[120:123], a[28:31], v[24:27], v[120:123]
    v_mfma_f32_16x16x32_bf16 v[120:123], a[32:35], v[28:31], v[120:123]
    v_mfma_f32_16x16x32_bf16 v[120:123], a[36:39], v[32:35], v[120:123]
    v_mfma_f32_16x16x32_bf16 v[120:123], a[40:43], v[36:39], v[120:123]
    v_mfma_f32_16x16x32_bf16 v[120:123], a[44:47], v[40:43], v[120:123]
    v_mfma_f32_16x16x32_bf16 v[124:127], a[48:51], v[20:23], 0
    v_mfma_f32_16x16x32_bf16 v[124:127], a[52:55], v[24:27], v[124:127]
    v_mfma_f32_16x16x32_bf16 v[124:127], a[56:59], v[28:31], v[124:127]
    v_mfma_f32_16x16x32_bf16 v[124:127], a[60:63], v[32:35], v[124:127]
    v_mfma_f32_16x16x32_bf16 v[124:127], a[64:67], v[36:39], v[124:127]
    v_mfma_f32_16x16x32_bf16 v[124:127], a[68:71], v[40:43], v[124:127]
    v_mfma_f32_16x16x32_bf16 v[128:131], a[72:75], v[20:23], 0
    v_mfma_f32_16x16x32_bf16 v[128:131], a[76:79], v[24:27], v[128:131]
    v_mfma_f32_16x16x32_bf16 v[128:131], a[80:83], v[28:31], v[128:131]
    v_mfma_f32_16x16x32_bf16 v[128:131], a[84:87], v[32:35], v[128:131]
    v_mfma_f32_16x16x32_bf16 v[128:131], a[88:91], v[36:39], v[128:131]
    v_mfma_f32_16x16x32_bf16 v[128:131], a[92:95], v[40:43], v[128:131]
    v_cvt_pk_bf16_f32 v132, v116, v117
    v_cvt_pk_bf16_f32 v133, v118, v119
    v_cvt_pk_bf16_f32 v134, v120, v121
    v_cvt_pk_bf16_f32 v135, v122, v123
    s_add_u32 s29, s28, 0
    buffer_store_dwordx4 v[132:135], v2, s[4:7], s29 offen sc1
    v_mfma_f32_16x16x32_bf16 v[116:119], a[96:99], v[20:23], 0
    v_mfma_f32_16x16x32_bf16 v[116:119], a[100:103], v[24:27], v[116:119]
    v_mfma_f32_16x16x32_bf16 v[116:119], a[104:107], v[28:31], v[116:119]
    v_mfma_f32_16x16x32_bf16 v[116:119], a[108:111], v[32:35], v[116:119]
    v_mfma_f32_16x16x32_bf16 v[116:119], a[112:115], v[36:39], v[116:119]
    v_mfma_f32_16x16x32_bf16 v[116:119], a[116:119], v[40:43], v[116:119]
    v_mfma_f32_16x16x32_bf16 v[120:123], a[120:123], v[20:23], 0
    v_mfma_f32_16x16x32_bf16 v[120:123], a[124:127], v[24:27], v[120:123]
    v_mfma_f32_16x16x32_bf16 v[120:123], a[128:131], v[28:31], v[120:123]
    v_mfma_f32_16x16x32_bf16 v[120:123], a[132:135], v[32:35], v[120:123]
    v_mfma_f32_16x16x32_bf16 v[120:123], a[136:139], v[36:39], v[120:123]
    v_mfma_f32_16x16x32_bf16 v[120:123], a[140:143], v[40:43], v[120:123]
    v_cvt_pk_bf16_f32 v136, v124, v125
    v_cvt_pk_bf16_f32 v137, v126, v127
    v_cvt_pk_bf16_f32 v138, v128, v129
    v_cvt_pk_bf16_f32 v139, v130, v131
    s_add_u32 s29, s28, 1310720
    buffer_store_dwordx4 v[136:139], v2, s[4:7], s29 offen sc1
    v_mfma_f32_16x16x32_bf16 v[124:127], a[144:147], v[20:23], 0
    v_mfma_f32_16x16x32_bf16 v[124:127], a[148:151], v[24:27], v[124:127]
    v_mfma_f32_16x16x32_bf16 v[124:127], a[152:155], v[28:31], v[124:127]
    v_mfma_f32_16x16x32_bf16 v[124:127], a[156:159], v[32:35], v[124:127]
    v_mfma_f32_16x16x32_bf16 v[124:127], a[160:163], v[36:39], v[124:127]
    v_mfma_f32_16x16x32_bf16 v[124:127], a[164:167], v[40:43], v[124:127]
    v_mfma_f32_16x16x32_bf16 v[128:131], a[168:171], v[20:23], 0
    v_mfma_f32_16x16x32_bf16 v[128:131], a[172:175], v[24:27], v[128:131]
    v_mfma_f32_16x16x32_bf16 v[128:131], a[176:179], v[28:31], v[128:131]
    v_mfma_f32_16x16x32_bf16 v[128:131], a[180:183], v[32:35], v[128:131]
    v_mfma_f32_16x16x32_bf16 v[128:131], a[184:187], v[36:39], v[128:131]
    v_mfma_f32_16x16x32_bf16 v[128:131], a[188:191], v[40:43], v[128:131]
    v_cvt_pk_bf16_f32 v140, v116, v117
    v_cvt_pk_bf16_f32 v141, v118, v119
    v_cvt_pk_bf16_f32 v142, v120, v121
    v_cvt_pk_bf16_f32 v143, v122, v123
    s_add_u32 s29, s28, 2621440
    buffer_store_dwordx4 v[140:143], v2, s[4:7], s29 offen sc1
    buffer_load_dwordx4 v[20:23], v2, s[4:7], s27 offen offset:0
    buffer_load_dwordx4 v[24:27], v2, s[4:7], s27 offen offset:1024
    buffer_load_dwordx4 v[28:31], v2, s[4:7], s27 offen offset:2048
    buffer_load_dwordx4 v[32:35], v2, s[4:7], s27 offen offset:3072
    buffer_load_dwordx4 v[36:39], v3, s[4:7], s27 offen offset:0
    buffer_load_dwordx4 v[40:43], v3, s[4:7], s27 offen offset:1024
    s_add_u32 s27, s27, 6144
    s_waitcnt vmcnt(36)
    v_mfma_f32_16x16x32_bf16 v[116:119], a[0:3], v[44:47], 0
    v_mfma_f32_16x16x32_bf16 v[116:119], a[4:7], v[48:51], v[116:119]
    v_mfma_f32_16x16x32_bf16 v[116:119], a[8:11], v[52:55], v[116:119]
    v_mfma_f32_16x16x32_bf16 v[116:119], a[12:15], v[56:59], v[116:119]
    v_mfma_f32_16x16x32_bf16 v[116:119], a[16:19], v[60:63], v[116:119]
    v_mfma_f32_16x16x32_bf16 v[116:119], a[20:23], v[64:67], v[116:119]
    v_mfma_f32_16x16x32_bf16 v[120:123], a[24:27], v[44:47], 0
    v_mfma_f32_16x16x32_bf16 v[120:123], a[28:31], v[48:51], v[120:123]
    v_mfma_f32_16x16x32_bf16 v[120:123], a[32:35], v[52:55], v[120:123]
    v_mfma_f32_16x16x32_bf16 v[120:123], a[36:39], v[56:59], v[120:123]
    v_mfma_f32_16x16x32_bf16 v[120:123], a[40:43], v[60:63], v[120:123]
    v_mfma_f32_16x16x32_bf16 v[120:123], a[44:47], v[64:67], v[120:123]
    v_cvt_pk_bf16_f32 v144, v124, v125
    v_cvt_pk_bf16_f32 v145, v126, v127
    v_cvt_pk_bf16_f32 v146, v128, v129
    v_cvt_pk_bf16_f32 v147, v130, v131
    s_add_u32 s29, s28, 3932160
    buffer_store_dwordx4 v[144:147], v2, s[4:7], s29 offen sc1
    v_mfma_f32_16x16x32_bf16 v[124:127], a[48:51], v[44:47], 0
    v_mfma_f32_16x16x32_bf16 v[124:127], a[52:55], v[48:51], v[124:127]
    v_mfma_f32_16x16x32_bf16 v[124:127], a[56:59], v[52:55], v[124:127]
    v_mfma_f32_16x16x32_bf16 v[124:127], a[60:63], v[56:59], v[124:127]
    v_mfma_f32_16x16x32_bf16 v[124:127], a[64:67], v[60:63], v[124:127]
    v_mfma_f32_16x16x32_bf16 v[124:127], a[68:71], v[64:67], v[124:127]
    v_mfma_f32_16x16x32_bf16 v[128:131], a[72:75], v[44:47], 0
    v_mfma_f32_16x16x32_bf16 v[128:131], a[76:79], v[48:51], v[128:131]
    v_mfma_f32_16x16x32_bf16 v[128:131], a[80:83], v[52:55], v[128:131]
    v_mfma_f32_16x16x32_bf16 v[128:131], a[84:87], v[56:59], v[128:131]
    v_mfma_f32_16x16x32_bf16 v[128:131], a[88:91], v[60:63], v[128:131]
    v_mfma_f32_16x16x32_bf16 v[128:131], a[92:95], v[64:67], v[128:131]
    v_cvt_pk_bf16_f32 v132, v116, v117
    v_cvt_pk_bf16_f32 v133, v118, v119
    v_cvt_pk_bf16_f32 v134, v120, v121
    v_cvt_pk_bf16_f32 v135, v122, v123
    s_add_u32 s29, s28, 1024
    buffer_store_dwordx4 v[132:135], v2, s[4:7], s29 offen sc1
    v_mfma_f32_16x16x32_bf16 v[116:119], a[96:99], v[44:47], 0
    v_mfma_f32_16x16x32_bf16 v[116:119], a[100:103], v[48:51], v[116:119]
    v_mfma_f32_16x16x32_bf16 v[116:119], a[104:107], v[52:55], v[116:119]
    v_mfma_f32_16x16x32_bf16 v[116:119], a[108:111], v[56:59], v[116:119]
    v_mfma_f32_16x16x32_bf16 v[116:119], a[112:115], v[60:63], v[116:119]
    v_mfma_f32_16x16x32_bf16 v[116:119], a[116:119], v[64:67], v[116:119]
    v_mfma_f32_16x16x32_bf16 v[120:123], a[120:123], v[44:47], 0
    v_mfma_f32_16x16x32_bf16 v[120:123], a[124:127], v[48:51], v[120:123]
    v_mfma_f32_16x16x32_bf16 v[120:123], a[128:131], v[52:55], v[120:123]
    v_mfma_f32_16x16x32_bf16 v[120:123], a[132:135], v[56:59], v[120:123]
    v_mfma_f32_16x16x32_bf16 v[120:123], a[136:139], v[60:63], v[120:123]
    v_mfma_f32_16x16x32_bf16 v[120:123], a[140:143], v[64:67], v[120:123]
    v_cvt_pk_bf16_f32 v136, v124, v125
    v_cvt_pk_bf16_f32 v137, v126, v127
    v_cvt_pk_bf16_f32 v138, v128, v129
    v_cvt_pk_bf16_f32 v139, v130, v131
    s_add_u32 s29, s28, 1311744
    buffer_store_dwordx4 v[136:139], v2, s[4:7], s29 offen sc1
    v_mfma_f32_16x16x32_bf16 v[124:127], a[144:147], v[44:47], 0
    v_mfma_f32_16x16x32_bf16 v[124:127], a[148:151], v[48:51], v[124:127]
    v_mfma_f32_16x16x32_bf16 v[124:127], a[152:155], v[52:55], v[124:127]
    v_mfma_f32_16x16x32_bf16 v[124:127], a[156:159], v[56:59], v[124:127]
    v_mfma_f32_16x16x32_bf16 v[124:127], a[160:163], v[60:63], v[124:127]
    v_mfma_f32_16x16x32_bf16 v[124:127], a[164:167], v[64:67], v[124:127]
    v_mfma_f32_16x16x32_bf16 v[128:131], a[168:171], v[44:47], 0
    v_mfma_f32_16x16x32_bf16 v[128:131], a[172:175], v[48:51], v[128:131]
    v_mfma_f32_16x16x32_bf16 v[128:131], a[176:179], v[52:55], v[128:131]
    v_mfma_f32_16x16x32_bf16 v[128:131], a[180:183], v[56:59], v[128:131]
    v_mfma_f32_16x16x32_bf16 v[128:131], a[184:187], v[60:63], v[128:131]
    v_mfma_f32_16x16x32_bf16 v[128:131], a[188:191], v[64:67], v[128:131]
    v_cvt_pk_bf16_f32 v140, v116, v117
    v_cvt_pk_bf16_f32 v141, v118, v119
    v_cvt_pk_bf16_f32 v142, v120, v121
    v_cvt_pk_bf16_f32 v143, v122, v123
    s_add_u32 s29, s28, 2622464
    buffer_store_dwordx4 v[140:143], v2, s[4:7], s29 offen sc1
    buffer_load_dwordx4 v[44:47], v2, s[4:7], s27 offen offset:0
    buffer_load_dwordx4 v[48:51], v2, s[4:7], s27 offen offset:1024
    buffer_load_dwordx4 v[52:55], v2, s[4:7], s27 offen offset:2048
    buffer_load_dwordx4 v[56:59], v2, s[4:7], s27 offen offset:3072
    buffer_load_dwordx4 v[60:63], v3, s[4:7], s27 offen offset:0
    buffer_load_dwordx4 v[64:67], v3, s[4:7], s27 offen offset:1024
    s_add_u32 s27, s27, 6144
    s_waitcnt vmcnt(36)
    v_mfma_f32_16x16x32_bf16 v[116:119], a[0:3], v[68:71], 0
    v_mfma_f32_16x16x32_bf16 v[116:119], a[4:7], v[72:75], v[116:119]
    v_mfma_f32_16x16x32_bf16 v[116:119], a[8:11], v[76:79], v[116:119]
    v_mfma_f32_16x16x32_bf16 v[116:119], a[12:15], v[80:83], v[116:119]
    v_mfma_f32_16x16x32_bf16 v[116:119], a[16:19], v[84:87], v[116:119]
    v_mfma_f32_16x16x32_bf16 v[116:119], a[20:23], v[88:91], v[116:119]
    v_mfma_f32_16x16x32_bf16 v[120:123], a[24:27], v[68:71], 0
    v_mfma_f32_16x16x32_bf16 v[120:123], a[28:31], v[72:75], v[120:123]
    v_mfma_f32_16x16x32_bf16 v[120:123], a[32:35], v[76:79], v[120:123]
    v_mfma_f32_16x16x32_bf16 v[120:123], a[36:39], v[80:83], v[120:123]
    v_mfma_f32_16x16x32_bf16 v[120:123], a[40:43], v[84:87], v[120:123]
    v_mfma_f32_16x16x32_bf16 v[120:123], a[44:47], v[88:91], v[120:123]
    v_cvt_pk_bf16_f32 v144, v124, v125
    v_cvt_pk_bf16_f32 v145, v126, v127
    v_cvt_pk_bf16_f32 v146, v128, v129
    v_cvt_pk_bf16_f32 v147, v130, v131
    s_add_u32 s29, s28, 3933184
    buffer_store_dwordx4 v[144:147], v2, s[4:7], s29 offen sc1
    v_mfma_f32_16x16x32_bf16 v[124:127], a[48:51], v[68:71], 0
    v_mfma_f32_16x16x32_bf16 v[124:127], a[52:55], v[72:75], v[124:127]
    v_mfma_f32_16x16x32_bf16 v[124:127], a[56:59], v[76:79], v[124:127]
    v_mfma_f32_16x16x32_bf16 v[124:127], a[60:63], v[80:83], v[124:127]
    v_mfma_f32_16x16x32_bf16 v[124:127], a[64:67], v[84:87], v[124:127]
    v_mfma_f32_16x16x32_bf16 v[124:127], a[68:71], v[88:91], v[124:127]
    v_mfma_f32_16x16x32_bf16 v[128:131], a[72:75], v[68:71], 0
    v_mfma_f32_16x16x32_bf16 v[128:131], a[76:79], v[72:75], v[128:131]
    v_mfma_f32_16x16x32_bf16 v[128:131], a[80:83], v[76:79], v[128:131]
    v_mfma_f32_16x16x32_bf16 v[128:131], a[84:87], v[80:83], v[128:131]
    v_mfma_f32_16x16x32_bf16 v[128:131], a[88:91], v[84:87], v[128:131]
    v_mfma_f32_16x16x32_bf16 v[128:131], a[92:95], v[88:91], v[128:131]
    v_cvt_pk_bf16_f32 v132, v116, v117
    v_cvt_pk_bf16_f32 v133, v118, v119
    v_cvt_pk_bf16_f32 v134, v120, v121
    v_cvt_pk_bf16_f32 v135, v122, v123
    s_add_u32 s29, s28, 2048
    buffer_store_dwordx4 v[132:135], v2, s[4:7], s29 offen sc1
    v_mfma_f32_16x16x32_bf16 v[116:119], a[96:99], v[68:71], 0
    v_mfma_f32_16x16x32_bf16 v[116:119], a[100:103], v[72:75], v[116:119]
    v_mfma_f32_16x16x32_bf16 v[116:119], a[104:107], v[76:79], v[116:119]
    v_mfma_f32_16x16x32_bf16 v[116:119], a[108:111], v[80:83], v[116:119]
    v_mfma_f32_16x16x32_bf16 v[116:119], a[112:115], v[84:87], v[116:119]
    v_mfma_f32_16x16x32_bf16 v[116:119], a[116:119], v[88:91], v[116:119]
    v_mfma_f32_16x16x32_bf16 v[120:123], a[120:123], v[68:71], 0
    v_mfma_f32_16x16x32_bf16 v[120:123], a[124:127], v[72:75], v[120:123]
    v_mfma_f32_16x16x32_bf16 v[120:123], a[128:131], v[76:79], v[120:123]
    v_mfma_f32_16x16x32_bf16 v[120:123], a[132:135], v[80:83], v[120:123]
    v_mfma_f32_16x16x32_bf16 v[120:123], a[136:139], v[84:87], v[120:123]
    v_mfma_f32_16x16x32_bf16 v[120:123], a[140:143], v[88:91], v[120:123]
    v_cvt_pk_bf16_f32 v136, v124, v125
    v_cvt_pk_bf16_f32 v137, v126, v127
    v_cvt_pk_bf16_f32 v138, v128, v129
    v_cvt_pk_bf16_f32 v139, v130, v131
    s_add_u32 s29, s28, 1312768
    buffer_store_dwordx4 v[136:139], v2, s[4:7], s29 offen sc1
    v_mfma_f32_16x16x32_bf16 v[124:127], a[144:147], v[68:71], 0
    v_mfma_f32_16x16x32_bf16 v[124:127], a[148:151], v[72:75], v[124:127]
    v_mfma_f32_16x16x32_bf16 v[124:127], a[152:155], v[76:79], v[124:127]
    v_mfma_f32_16x16x32_bf16 v[124:127], a[156:159], v[80:83], v[124:127]
    v_mfma_f32_16x16x32_bf16 v[124:127], a[160:163], v[84:87], v[124:127]
    v_mfma_f32_16x16x32_bf16 v[124:127], a[164:167], v[88:91], v[124:127]
    v_mfma_f32_16x16x32_bf16 v[128:131], a[168:171], v[68:71], 0
    v_mfma_f32_16x16x32_bf16 v[128:131], a[172:175], v[72:75], v[128:131]
    v_mfma_f32_16x16x32_bf16 v[128:131], a[176:179], v[76:79], v[128:131]
    v_mfma_f32_16x16x32_bf16 v[128:131], a[180:183], v[80:83], v[128:131]
    v_mfma_f32_16x16x32_bf16 v[128:131], a[184:187], v[84:87], v[128:131]
    v_mfma_f32_16x16x32_bf16 v[128:131], a[188:191], v[88:91], v[128:131]
    v_cvt_pk_bf16_f32 v140, v116, v117
    v_cvt_pk_bf16_f32 v141, v118, v119
    v_cvt_pk_bf16_f32 v142, v120, v121
    v_cvt_pk_bf16_f32 v143, v122, v123
    s_add_u32 s29, s28, 2623488
    buffer_store_dwordx4 v[140:143], v2, s[4:7], s29 offen sc1
    buffer_load_dwordx4 v[68:71], v2, s[4:7], s27 offen offset:0
    buffer_load_dwordx4 v[72:75], v2, s[4:7], s27 offen offset:1024
    buffer_load_dwordx4 v[76:79], v2, s[4:7], s27 offen offset:2048
    buffer_load_dwordx4 v[80:83], v2, s[4:7], s27 offen offset:3072
    buffer_load_dwordx4 v[84:87], v3, s[4:7], s27 offen offset:0
    buffer_load_dwordx4 v[88:91], v3, s[4:7], s27 offen offset:1024
    s_add_u32 s27, s27, 6144
    s_waitcnt vmcnt(36)
    v_mfma_f32_16x16x32_bf16 v[116:119], a[0:3], v[92:95], 0
    v_mfma_f32_16x16x32_bf16 v[116:119], a[4:7], v[96:99], v[116:119]
    v_mfma_f32_16x16x32_bf16 v[116:119], a[8:11], v[100:103], v[116:119]
    v_mfma_f32_16x16x32_bf16 v[116:119], a[12:15], v[104:107], v[116:119]
    v_mfma_f32_16x16x32_bf16 v[116:119], a[16:19], v[108:111], v[116:119]
    v_mfma_f32_16x16x32_bf16 v[116:119], a[20:23], v[112:115], v[116:119]
    v_mfma_f32_16x16x32_bf16 v[120:123], a[24:27], v[92:95], 0
    v_mfma_f32_16x16x32_bf16 v[120:123], a[28:31], v[96:99], v[120:123]
    v_mfma_f32_16x16x32_bf16 v[120:123], a[32:35], v[100:103], v[120:123]
    v_mfma_f32_16x16x32_bf16 v[120:123], a[36:39], v[104:107], v[120:123]
    v_mfma_f32_16x16x32_bf16 v[120:123], a[40:43], v[108:111], v[120:123]
    v_mfma_f32_16x16x32_bf16 v[120:123], a[44:47], v[112:115], v[120:123]
    v_cvt_pk_bf16_f32 v144, v124, v125
    v_cvt_pk_bf16_f32 v145, v126, v127
    v_cvt_pk_bf16_f32 v146, v128, v129
    v_cvt_pk_bf16_f32 v147, v130, v131
    s_add_u32 s29, s28, 3934208
    buffer_store_dwordx4 v[144:147], v2, s[4:7], s29 offen sc1
    v_mfma_f32_16x16x32_bf16 v[124:127], a[48:51], v[92:95], 0
    v_mfma_f32_16x16x32_bf16 v[124:127], a[52:55], v[96:99], v[124:127]
    v_mfma_f32_16x16x32_bf16 v[124:127], a[56:59], v[100:103], v[124:127]
    v_mfma_f32_16x16x32_bf16 v[124:127], a[60:63], v[104:107], v[124:127]
    v_mfma_f32_16x16x32_bf16 v[124:127], a[64:67], v[108:111], v[124:127]
    v_mfma_f32_16x16x32_bf16 v[124:127], a[68:71], v[112:115], v[124:127]
    v_mfma_f32_16x16x32_bf16 v[128:131], a[72:75], v[92:95], 0
    v_mfma_f32_16x16x32_bf16 v[128:131], a[76:79], v[96:99], v[128:131]
    v_mfma_f32_16x16x32_bf16 v[128:131], a[80:83], v[100:103], v[128:131]
    v_mfma_f32_16x16x32_bf16 v[128:131], a[84:87], v[104:107], v[128:131]
    v_mfma_f32_16x16x32_bf16 v[128:131], a[88:91], v[108:111], v[128:131]
    v_mfma_f32_16x16x32_bf16 v[128:131], a[92:95], v[112:115], v[128:131]
    v_cvt_pk_bf16_f32 v132, v116, v117
    v_cvt_pk_bf16_f32 v133, v118, v119
    v_cvt_pk_bf16_f32 v134, v120, v121
    v_cvt_pk_bf16_f32 v135, v122, v123
    s_add_u32 s29, s28, 3072
    buffer_store_dwordx4 v[132:135], v2, s[4:7], s29 offen sc1
    v_mfma_f32_16x16x32_bf16 v[116:119], a[96:99], v[92:95], 0
    v_mfma_f32_16x16x32_bf16 v[116:119], a[100:103], v[96:99], v[116:119]
    v_mfma_f32_16x16x32_bf16 v[116:119], a[104:107], v[100:103], v[116:119]
    v_mfma_f32_16x16x32_bf16 v[116:119], a[108:111], v[104:107], v[116:119]
    v_mfma_f32_16x16x32_bf16 v[116:119], a[112:115], v[108:111], v[116:119]
    v_mfma_f32_16x16x32_bf16 v[116:119], a[116:119], v[112:115], v[116:119]
    v_mfma_f32_16x16x32_bf16 v[120:123], a[120:123], v[92:95], 0
    v_mfma_f32_16x16x32_bf16 v[120:123], a[124:127], v[96:99], v[120:123]
    v_mfma_f32_16x16x32_bf16 v[120:123], a[128:131], v[100:103], v[120:123]
    v_mfma_f32_16x16x32_bf16 v[120:123], a[132:135], v[104:107], v[120:123]
    v_mfma_f32_16x16x32_bf16 v[120:123], a[136:139], v[108:111], v[120:123]
    v_mfma_f32_16x16x32_bf16 v[120:123], a[140:143], v[112:115], v[120:123]
    v_cvt_pk_bf16_f32 v136, v124, v125
    v_cvt_pk_bf16_f32 v137, v126, v127
    v_cvt_pk_bf16_f32 v138, v128, v129
    v_cvt_pk_bf16_f32 v139, v130, v131
    s_add_u32 s29, s28, 1313792
    buffer_store_dwordx4 v[136:139], v2, s[4:7], s29 offen sc1
    v_mfma_f32_16x16x32_bf16 v[124:127], a[144:147], v[92:95], 0
    v_mfma_f32_16x16x32_bf16 v[124:127], a[148:151], v[96:99], v[124:127]
    v_mfma_f32_16x16x32_bf16 v[124:127], a[152:155], v[100:103], v[124:127]
    v_mfma_f32_16x16x32_bf16 v[124:127], a[156:159], v[104:107], v[124:127]
    v_mfma_f32_16x16x32_bf16 v[124:127], a[160:163], v[108:111], v[124:127]
    v_mfma_f32_16x16x32_bf16 v[124:127], a[164:167], v[112:115], v[124:127]
    v_mfma_f32_16x16x32_bf16 v[128:131], a[168:171], v[92:95], 0
    v_mfma_f32_16x16x32_bf16 v[128:131], a[172:175], v[96:99], v[128:131]
    v_mfma_f32_16x16x32_bf16 v[128:131], a[176:179], v[100:103], v[128:131]
    v_mfma_f32_16x16x32_bf16 v[128:131], a[180:183], v[104:107], v[128:131]
    v_mfma_f32_16x16x32_bf16 v[128:131], a[184:187], v[108:111], v[128:131]
    v_mfma_f32_16x16x32_bf16 v[128:131], a[188:191], v[112:115], v[128:131]
    v_cvt_pk_bf16_f32 v140, v116, v117
    v_cvt_pk_bf16_f32 v141, v118, v119
    v_cvt_pk_bf16_f32 v142, v120, v121
    v_cvt_pk_bf16_f32 v143, v122, v123
    s_add_u32 s29, s28, 2624512
    buffer_store_dwordx4 v[140:143], v2, s[4:7], s29 offen sc1
    s_waitcnt vmcnt(30)
    v_mfma_f32_16x16x32_bf16 v[116:119], a[0:3], v[180:183], 0
    v_mfma_f32_16x16x32_bf16 v[116:119], a[4:7], v[184:187], v[116:119]
    v_mfma_f32_16x16x32_bf16 v[116:119], a[8:11], v[188:191], v[116:119]
    v_mfma_f32_16x16x32_bf16 v[116:119], a[12:15], v[192:195], v[116:119]
    v_mfma_f32_16x16x32_bf16 v[116:119], a[16:19], v[196:199], v[116:119]
    v_mfma_f32_16x16x32_bf16 v[116:119], a[20:23], v[200:203], v[116:119]
    v_mfma_f32_16x16x32_bf16 v[120:123], a[24:27], v[180:183], 0
    v_mfma_f32_16x16x32_bf16 v[120:123], a[28:31], v[184:187], v[120:123]
    v_mfma_f32_16x16x32_bf16 v[120:123], a[32:35], v[188:191], v[120:123]
    v_mfma_f32_16x16x32_bf16 v[120:123], a[36:39], v[192:195], v[120:123]
    v_mfma_f32_16x16x32_bf16 v[120:123], a[40:43], v[196:199], v[120:123]
    v_mfma_f32_16x16x32_bf16 v[120:123], a[44:47], v[200:203], v[120:123]
    v_cvt_pk_bf16_f32 v144, v124, v125
    v_cvt_pk_bf16_f32 v145, v126, v127
    v_cvt_pk_bf16_f32 v146, v128, v129
    v_cvt_pk_bf16_f32 v147, v130, v131
    s_add_u32 s29, s28, 3935232
    buffer_store_dwordx4 v[144:147], v2, s[4:7], s29 offen sc1
    v_mfma_f32_16x16x32_bf16 v[124:127], a[48:51], v[180:183], 0
    v_mfma_f32_16x16x32_bf16 v[124:127], a[52:55], v[184:187], v[124:127]
    v_mfma_f32_16x16x32_bf16 v[124:127], a[56:59], v[188:191], v[124:127]
    v_mfma_f32_16x16x32_bf16 v[124:127], a[60:63], v[192:195], v[124:127]
    v_mfma_f32_16x16x32_bf16 v[124:127], a[64:67], v[196:199], v[124:127]
    v_mfma_f32_16x16x32_bf16 v[124:127], a[68:71], v[200:203], v[124:127]
    v_mfma_f32_16x16x32_bf16 v[128:131], a[72:75], v[180:183], 0
    v_mfma_f32_16x16x32_bf16 v[128:131], a[76:79], v[184:187], v[128:131]
    v_mfma_f32_16x16x32_bf16 v[128:131], a[80:83], v[188:191], v[128:131]
    v_mfma_f32_16x16x32_bf16 v[128:131], a[84:87], v[192:195], v[128:131]
    v_mfma_f32_16x16x32_bf16 v[128:131], a[88:91], v[196:199], v[128:131]
    v_mfma_f32_16x16x32_bf16 v[128:131], a[92:95], v[200:203], v[128:131]
    v_cvt_pk_bf16_f32 v132, v116, v117
    v_cvt_pk_bf16_f32 v133, v118, v119
    v_cvt_pk_bf16_f32 v134, v120, v121
    v_cvt_pk_bf16_f32 v135, v122, v123
    s_add_u32 s29, s28, 4096
    buffer_store_dwordx4 v[132:135], v2, s[4:7], s29 offen sc1
    v_mfma_f32_16x16x32_bf16 v[116:119], a[96:99], v[180:183], 0
    v_mfma_f32_16x16x32_bf16 v[116:119], a[100:103], v[184:187], v[116:119]
    v_mfma_f32_16x16x32_bf16 v[116:119], a[104:107], v[188:191], v[116:119]
    v_mfma_f32_16x16x32_bf16 v[116:119], a[108:111], v[192:195], v[116:119]
    v_mfma_f32_16x16x32_bf16 v[116:119], a[112:115], v[196:199], v[116:119]
    v_mfma_f32_16x16x32_bf16 v[116:119], a[116:119], v[200:203], v[116:119]
    v_mfma_f32_16x16x32_bf16 v[120:123], a[120:123], v[180:183], 0
    v_mfma_f32_16x16x32_bf16 v[120:123], a[124:127], v[184:187], v[120:123]
    v_mfma_f32_16x16x32_bf16 v[120:123], a[128:131], v[188:191], v[120:123]
    v_mfma_f32_16x16x32_bf16 v[120:123], a[132:135], v[192:195], v[120:123]
    v_mfma_f32_16x16x32_bf16 v[120:123], a[136:139], v[196:199], v[120:123]
    v_mfma_f32_16x16x32_bf16 v[120:123], a[140:143], v[200:203], v[120:123]
    v_cvt_pk_bf16_f32 v136, v124, v125
    v_cvt_pk_bf16_f32 v137, v126, v127
    v_cvt_pk_bf16_f32 v138, v128, v129
    v_cvt_pk_bf16_f32 v139, v130, v131
    s_add_u32 s29, s28, 1314816
    buffer_store_dwordx4 v[136:139], v2, s[4:7], s29 offen sc1
    v_mfma_f32_16x16x32_bf16 v[124:127], a[144:147], v[180:183], 0
    v_mfma_f32_16x16x32_bf16 v[124:127], a[148:151], v[184:187], v[124:127]
    v_mfma_f32_16x16x32_bf16 v[124:127], a[152:155], v[188:191], v[124:127]
    v_mfma_f32_16x16x32_bf16 v[124:127], a[156:159], v[192:195], v[124:127]
    v_mfma_f32_16x16x32_bf16 v[124:127], a[160:163], v[196:199], v[124:127]
    v_mfma_f32_16x16x32_bf16 v[124:127], a[164:167], v[200:203], v[124:127]
    v_mfma_f32_16x16x32_bf16 v[128:131], a[168:171], v[180:183], 0
    v_mfma_f32_16x16x32_bf16 v[128:131], a[172:175], v[184:187], v[128:131]
    v_mfma_f32_16x16x32_bf16 v[128:131], a[176:179], v[188:191], v[128:131]
    v_mfma_f32_16x16x32_bf16 v[128:131], a[180:183], v[192:195], v[128:131]
    v_mfma_f32_16x16x32_bf16 v[128:131], a[184:187], v[196:199], v[128:131]
    v_mfma_f32_16x16x32_bf16 v[128:131], a[188:191], v[200:203], v[128:131]
    v_cvt_pk_bf16_f32 v140, v116, v117
    v_cvt_pk_bf16_f32 v141, v118, v119
    v_cvt_pk_bf16_f32 v142, v120, v121
    v_cvt_pk_bf16_f32 v143, v122, v123
    s_add_u32 s29, s28, 2625536
    buffer_store_dwordx4 v[140:143], v2, s[4:7], s29 offen sc1
    s_waitcnt vmcnt(24)
    v_mfma_f32_16x16x32_bf16 v[116:119], a[0:3], v[204:207], 0
    v_mfma_f32_16x16x32_bf16 v[116:119], a[4:7], v[208:211], v[116:119]
    v_mfma_f32_16x16x32_bf16 v[116:119], a[8:11], v[212:215], v[116:119]
    v_mfma_f32_16x16x32_bf16 v[116:119], a[12:15], v[216:219], v[116:119]
    v_mfma_f32_16x16x32_bf16 v[116:119], a[16:19], v[220:223], v[116:119]
    v_mfma_f32_16x16x32_bf16 v[116:119], a[20:23], v[224:227], v[116:119]
    v_mfma_f32_16x16x32_bf16 v[120:123], a[24:27], v[204:207], 0
    v_mfma_f32_16x16x32_bf16 v[120:123], a[28:31], v[208:211], v[120:123]
    v_mfma_f32_16x16x32_bf16 v[120:123], a[32:35], v[212:215], v[120:123]
    v_mfma_f32_16x16x32_bf16 v[120:123], a[36:39], v[216:219], v[120:123]
    v_mfma_f32_16x16x32_bf16 v[120:123], a[40:43], v[220:223], v[120:123]
    v_mfma_f32_16x16x32_bf16 v[120:123], a[44:47], v[224:227], v[120:123]
    v_cvt_pk_bf16_f32 v144, v124, v125
    v_cvt_pk_bf16_f32 v145, v126, v127
    v_cvt_pk_bf16_f32 v146, v128, v129
    v_cvt_pk_bf16_f32 v147, v130, v131
    s_add_u32 s29, s28, 3936256
    buffer_store_dwordx4 v[144:147], v2, s[4:7], s29 offen sc1
    v_mfma_f32_16x16x32_bf16 v[124:127], a[48:51], v[204:207], 0
    v_mfma_f32_16x16x32_bf16 v[124:127], a[52:55], v[208:211], v[124:127]
    v_mfma_f32_16x16x32_bf16 v[124:127], a[56:59], v[212:215], v[124:127]
    v_mfma_f32_16x16x32_bf16 v[124:127], a[60:63], v[216:219], v[124:127]
    v_mfma_f32_16x16x32_bf16 v[124:127], a[64:67], v[220:223], v[124:127]
    v_mfma_f32_16x16x32_bf16 v[124:127], a[68:71], v[224:227], v[124:127]
    v_mfma_f32_16x16x32_bf16 v[128:131], a[72:75], v[204:207], 0
    v_mfma_f32_16x16x32_bf16 v[128:131], a[76:79], v[208:211], v[128:131]
    v_mfma_f32_16x16x32_bf16 v[128:131], a[80:83], v[212:215], v[128:131]
    v_mfma_f32_16x16x32_bf16 v[128:131], a[84:87], v[216:219], v[128:131]
    v_mfma_f32_16x16x32_bf16 v[128:131], a[88:91], v[220:223], v[128:131]
    v_mfma_f32_16x16x32_bf16 v[128:131], a[92:95], v[224:227], v[128:131]
    v_cvt_pk_bf16_f32 v132, v116, v117
    v_cvt_pk_bf16_f32 v133, v118, v119
    v_cvt_pk_bf16_f32 v134, v120, v121
    v_cvt_pk_bf16_f32 v135, v122, v123
    s_add_u32 s29, s28, 5120
    buffer_store_dwordx4 v[132:135], v2, s[4:7], s29 offen sc1
    v_mfma_f32_16x16x32_bf16 v[116:119], a[96:99], v[204:207], 0
    v_mfma_f32_16x16x32_bf16 v[116:119], a[100:103], v[208:211], v[116:119]
    v_mfma_f32_16x16x32_bf16 v[116:119], a[104:107], v[212:215], v[116:119]
    v_mfma_f32_16x16x32_bf16 v[116:119], a[108:111], v[216:219], v[116:119]
    v_mfma_f32_16x16x32_bf16 v[116:119], a[112:115], v[220:223], v[116:119]
    v_mfma_f32_16x16x32_bf16 v[116:119], a[116:119], v[224:227], v[116:119]
    v_mfma_f32_16x16x32_bf16 v[120:123], a[120:123], v[204:207], 0
    v_mfma_f32_16x16x32_bf16 v[120:123], a[124:127], v[208:211], v[120:123]
    v_mfma_f32_16x16x32_bf16 v[120:123], a[128:131], v[212:215], v[120:123]
    v_mfma_f32_16x16x32_bf16 v[120:123], a[132:135], v[216:219], v[120:123]
    v_mfma_f32_16x16x32_bf16 v[120:123], a[136:139], v[220:223], v[120:123]
    v_mfma_f32_16x16x32_bf16 v[120:123], a[140:143], v[224:227], v[120:123]
    v_cvt_pk_bf16_f32 v136, v124, v125
    v_cvt_pk_bf16_f32 v137, v126, v127
    v_cvt_pk_bf16_f32 v138, v128, v129
    v_cvt_pk_bf16_f32 v139, v130, v131
    s_add_u32 s29, s28, 1315840
    buffer_store_dwordx4 v[136:139], v2, s[4:7], s29 offen sc1
    v_mfma_f32_16x16x32_bf16 v[124:127], a[144:147], v[204:207], 0
    v_mfma_f32_16x16x32_bf16 v[124:127], a[148:151], v[208:211], v[124:127]
    v_mfma_f32_16x16x32_bf16 v[124:127], a[152:155], v[212:215], v[124:127]
    v_mfma_f32_16x16x32_bf16 v[124:127], a[156:159], v[216:219], v[124:127]
    v_mfma_f32_16x16x32_bf16 v[124:127], a[160:163], v[220:223], v[124:127]
    v_mfma_f32_16x16x32_bf16 v[124:127], a[164:167], v[224:227], v[124:127]
    v_mfma_f32_16x16x32_bf16 v[128:131], a[168:171], v[204:207], 0
    v_mfma_f32_16x16x32_bf16 v[128:131], a[172:175], v[208:211], v[128:131]
    v_mfma_f32_16x16x32_bf16 v[128:131], a[176:179], v[212:215], v[128:131]
    v_mfma_f32_16x16x32_bf16 v[128:131], a[180:183], v[216:219], v[128:131]
    v_mfma_f32_16x16x32_bf16 v[128:131], a[184:187], v[220:223], v[128:131]
    v_mfma_f32_16x16x32_bf16 v[128:131], a[188:191], v[224:227], v[128:131]
    v_cvt_pk_bf16_f32 v140, v116, v117
    v_cvt_pk_bf16_f32 v141, v118, v119
    v_cvt_pk_bf16_f32 v142, v120, v121
    v_cvt_pk_bf16_f32 v143, v122, v123
    s_add_u32 s29, s28, 2626560
    buffer_store_dwordx4 v[140:143], v2, s[4:7], s29 offen sc1
    s_waitcnt vmcnt(18)
    v_mfma_f32_16x16x32_bf16 v[116:119], a[0:3], v[228:231], 0
    v_mfma_f32_16x16x32_bf16 v[116:119], a[4:7], v[232:235], v[116:119]
    v_mfma_f32_16x16x32_bf16 v[116:119], a[8:11], v[236:239], v[116:119]
    v_mfma_f32_16x16x32_bf16 v[116:119], a[12:15], v[240:243], v[116:119]
    v_mfma_f32_16x16x32_bf16 v[116:119], a[16:19], v[244:247], v[116:119]
    v_mfma_f32_16x16x32_bf16 v[116:119], a[20:23], v[248:251], v[116:119]
    v_mfma_f32_16x16x32_bf16 v[120:123], a[24:27], v[228:231], 0
    v_mfma_f32_16x16x32_bf16 v[120:123], a[28:31], v[232:235], v[120:123]
    v_mfma_f32_16x16x32_bf16 v[120:123], a[32:35], v[236:239], v[120:123]
    v_mfma_f32_16x16x32_bf16 v[120:123], a[36:39], v[240:243], v[120:123]
    v_mfma_f32_16x16x32_bf16 v[120:123], a[40:43], v[244:247], v[120:123]
    v_mfma_f32_16x16x32_bf16 v[120:123], a[44:47], v[248:251], v[120:123]
    v_cvt_pk_bf16_f32 v144, v124, v125
    v_cvt_pk_bf16_f32 v145, v126, v127
    v_cvt_pk_bf16_f32 v146, v128, v129
    v_cvt_pk_bf16_f32 v147, v130, v131
    s_add_u32 s29, s28, 3937280
    buffer_store_dwordx4 v[144:147], v2, s[4:7], s29 offen sc1
    v_mfma_f32_16x16x32_bf16 v[124:127], a[48:51], v[228:231], 0
    v_mfma_f32_16x16x32_bf16 v[124:127], a[52:55], v[232:235], v[124:127]
    v_mfma_f32_16x16x32_bf16 v[124:127], a[56:59], v[236:239], v[124:127]
    v_mfma_f32_16x16x32_bf16 v[124:127], a[60:63], v[240:243], v[124:127]
    v_mfma_f32_16x16x32_bf16 v[124:127], a[64:67], v[244:247], v[124:127]
    v_mfma_f32_16x16x32_bf16 v[124:127], a[68:71], v[248:251], v[124:127]
    v_mfma_f32_16x16x32_bf16 v[128:131], a[72:75], v[228:231], 0
    v_mfma_f32_16x16x32_bf16 v[128:131], a[76:79], v[232:235], v[128:131]
    v_mfma_f32_16x16x32_bf16 v[128:131], a[80:83], v[236:239], v[128:131]
    v_mfma_f32_16x16x32_bf16 v[128:131], a[84:87], v[240:243], v[128:131]
    v_mfma_f32_16x16x32_bf16 v[128:131], a[88:91], v[244:247], v[128:131]
    v_mfma_f32_16x16x32_bf16 v[128:131], a[92:95], v[248:251], v[128:131]
    v_cvt_pk_bf16_f32 v132, v116, v117
    v_cvt_pk_bf16_f32 v133, v118, v119
    v_cvt_pk_bf16_f32 v134, v120, v121
    v_cvt_pk_bf16_f32 v135, v122, v123
    s_add_u32 s29, s28, 6144
    buffer_store_dwordx4 v[132:135], v2, s[4:7], s29 offen sc1
    v_mfma_f32_16x16x32_bf16 v[116:119], a[96:99], v[228:231], 0
    v_mfma_f32_16x16x32_bf16 v[116:119], a[100:103], v[232:235], v[116:119]
    v_mfma_f32_16x16x32_bf16 v[116:119], a[104:107], v[236:239], v[116:119]
    v_mfma_f32_16x16x32_bf16 v[116:119], a[108:111], v[240:243], v[116:119]
    v_mfma_f32_16x16x32_bf16 v[116:119], a[112:115], v[244:247], v[116:119]
    v_mfma_f32_16x16x32_bf16 v[116:119], a[116:119], v[248:251], v[116:119]
    v_mfma_f32_16x16x32_bf16 v[120:123], a[120:123], v[228:231], 0
    v_mfma_f32_16x16x32_bf16 v[120:123], a[124:127], v[232:235], v[120:123]
    v_mfma_f32_16x16x32_bf16 v[120:123], a[128:131], v[236:239], v[120:123]
    v_mfma_f32_16x16x32_bf16 v[120:123], a[132:135], v[240:243], v[120:123]
    v_mfma_f32_16x16x32_bf16 v[120:123], a[136:139], v[244:247], v[120:123]
    v_mfma_f32_16x16x32_bf16 v[120:123], a[140:143], v[248:251], v[120:123]
    v_cvt_pk_bf16_f32 v136, v124, v125
    v_cvt_pk_bf16_f32 v137, v126, v127
    v_cvt_pk_bf16_f32 v138, v128, v129
    v_cvt_pk_bf16_f32 v139, v130, v131
    s_add_u32 s29, s28, 1316864
    buffer_store_dwordx4 v[136:139], v2, s[4:7], s29 offen sc1
    v_mfma_f32_16x16x32_bf16 v[124:127], a[144:147], v[228:231], 0
    v_mfma_f32_16x16x32_bf16 v[124:127], a[148:151], v[232:235], v[124:127]
    v_mfma_f32_16x16x32_bf16 v[124:127], a[152:155], v[236:239], v[124:127]
    v_mfma_f32_16x16x32_bf16 v[124:127], a[156:159], v[240:243], v[124:127]
    v_mfma_f32_16x16x32_bf16 v[124:127], a[160:163], v[244:247], v[124:127]
    v_mfma_f32_16x16x32_bf16 v[124:127], a[164:167], v[248:251], v[124:127]
    v_mfma_f32_16x16x32_bf16 v[128:131], a[168:171], v[228:231], 0
    v_mfma_f32_16x16x32_bf16 v[128:131], a[172:175], v[232:235], v[128:131]
    v_mfma_f32_16x16x32_bf16 v[128:131], a[176:179], v[236:239], v[128:131]
    v_mfma_f32_16x16x32_bf16 v[128:131], a[180:183], v[240:243], v[128:131]
    v_mfma_f32_16x16x32_bf16 v[128:131], a[184:187], v[244:247], v[128:131]
    v_mfma_f32_16x16x32_bf16 v[128:131], a[188:191], v[248:251], v[128:131]
    v_cvt_pk_bf16_f32 v140, v116, v117
    v_cvt_pk_bf16_f32 v141, v118, v119
    v_cvt_pk_bf16_f32 v142, v120, v121
    v_cvt_pk_bf16_f32 v143, v122, v123
    s_add_u32 s29, s28, 2627584
    buffer_store_dwordx4 v[140:143], v2, s[4:7], s29 offen sc1
    s_waitcnt vmcnt(12)
    v_mfma_f32_16x16x32_bf16 v[116:119], a[0:3], v[20:23], 0
    v_mfma_f32_16x16x32_bf16 v[116:119], a[4:7], v[24:27], v[116:119]
    v_mfma_f32_16x16x32_bf16 v[116:119], a[8:11], v[28:31], v[116:119]
    v_mfma_f32_16x16x32_bf16 v[116:119], a[12:15], v[32:35], v[116:119]
    v_mfma_f32_16x16x32_bf16 v[116:119], a[16:19], v[36:39], v[116:119]
    v_mfma_f32_16x16x32_bf16 v[116:119], a[20:23], v[40:43], v[116:119]
    v_mfma_f32_16x16x32_bf16 v[120:123], a[24:27], v[20:23], 0
    v_mfma_f32_16x16x32_bf16 v[120:123], a[28:31], v[24:27], v[120:123]
    v_mfma_f32_16x16x32_bf16 v[120:123], a[32:35], v[28:31], v[120:123]
    v_mfma_f32_16x16x32_bf16 v[120:123], a[36:39], v[32:35], v[120:123]
    v_mfma_f32_16x16x32_bf16 v[120:123], a[40:43], v[36:39], v[120:123]
    v_mfma_f32_16x16x32_bf16 v[120:123], a[44:47], v[40:43], v[120:123]
    v_cvt_pk_bf16_f32 v144, v124, v125
    v_cvt_pk_bf16_f32 v145, v126, v127
    v_cvt_pk_bf16_f32 v146, v128, v129
    v_cvt_pk_bf16_f32 v147, v130, v131
    s_add_u32 s29, s28, 3938304
    buffer_store_dwordx4 v[144:147], v2, s[4:7], s29 offen sc1
    v_mfma_f32_16x16x32_bf16 v[124:127], a[48:51], v[20:23], 0
    v_mfma_f32_16x16x32_bf16 v[124:127], a[52:55], v[24:27], v[124:127]
    v_mfma_f32_16x16x32_bf16 v[124:127], a[56:59], v[28:31], v[124:127]
    v_mfma_f32_16x16x32_bf16 v[124:127], a[60:63], v[32:35], v[124:127]
    v_mfma_f32_16x16x32_bf16 v[124:127], a[64:67], v[36:39], v[124:127]
    v_mfma_f32_16x16x32_bf16 v[124:127], a[68:71], v[40:43], v[124:127]
    v_mfma_f32_16x16x32_bf16 v[128:131], a[72:75], v[20:23], 0
    v_mfma_f32_16x16x32_bf16 v[128:131], a[76:79], v[24:27], v[128:131]
    v_mfma_f32_16x16x32_bf16 v[128:131], a[80:83], v[28:31], v[128:131]
    v_mfma_f32_16x16x32_bf16 v[128:131], a[84:87], v[32:35], v[128:131]
    v_mfma_f32_16x16x32_bf16 v[128:131], a[88:91], v[36:39], v[128:131]
    v_mfma_f32_16x16x32_bf16 v[128:131], a[92:95], v[40:43], v[128:131]
    v_cvt_pk_bf16_f32 v132, v116, v117
    v_cvt_pk_bf16_f32 v133, v118, v119
    v_cvt_pk_bf16_f32 v134, v120, v121
    v_cvt_pk_bf16_f32 v135, v122, v123
    s_add_u32 s29, s28, 7168
    buffer_store_dwordx4 v[132:135], v2, s[4:7], s29 offen sc1
    v_mfma_f32_16x16x32_bf16 v[116:119], a[96:99], v[20:23], 0
    v_mfma_f32_16x16x32_bf16 v[116:119], a[100:103], v[24:27], v[116:119]
    v_mfma_f32_16x16x32_bf16 v[116:119], a[104:107], v[28:31], v[116:119]
    v_mfma_f32_16x16x32_bf16 v[116:119], a[108:111], v[32:35], v[116:119]
    v_mfma_f32_16x16x32_bf16 v[116:119], a[112:115], v[36:39], v[116:119]
    v_mfma_f32_16x16x32_bf16 v[116:119], a[116:119], v[40:43], v[116:119]
    v_mfma_f32_16x16x32_bf16 v[120:123], a[120:123], v[20:23], 0
    v_mfma_f32_16x16x32_bf16 v[120:123], a[124:127], v[24:27], v[120:123]
    v_mfma_f32_16x16x32_bf16 v[120:123], a[128:131], v[28:31], v[120:123]
    v_mfma_f32_16x16x32_bf16 v[120:123], a[132:135], v[32:35], v[120:123]
    v_mfma_f32_16x16x32_bf16 v[120:123], a[136:139], v[36:39], v[120:123]
    v_mfma_f32_16x16x32_bf16 v[120:123], a[140:143], v[40:43], v[120:123]
    v_cvt_pk_bf16_f32 v136, v124, v125
    v_cvt_pk_bf16_f32 v137, v126, v127
    v_cvt_pk_bf16_f32 v138, v128, v129
    v_cvt_pk_bf16_f32 v139, v130, v131
    s_add_u32 s29, s28, 1317888
    buffer_store_dwordx4 v[136:139], v2, s[4:7], s29 offen sc1
    v_mfma_f32_16x16x32_bf16 v[124:127], a[144:147], v[20:23], 0
    v_mfma_f32_16x16x32_bf16 v[124:127], a[148:151], v[24:27], v[124:127]
    v_mfma_f32_16x16x32_bf16 v[124:127], a[152:155], v[28:31], v[124:127]
    v_mfma_f32_16x16x32_bf16 v[124:127], a[156:159], v[32:35], v[124:127]
    v_mfma_f32_16x16x32_bf16 v[124:127], a[160:163], v[36:39], v[124:127]
    v_mfma_f32_16x16x32_bf16 v[124:127], a[164:167], v[40:43], v[124:127]
    v_mfma_f32_16x16x32_bf16 v[128:131], a[168:171], v[20:23], 0
    v_mfma_f32_16x16x32_bf16 v[128:131], a[172:175], v[24:27], v[128:131]
    v_mfma_f32_16x16x32_bf16 v[128:131], a[176:179], v[28:31], v[128:131]
    v_mfma_f32_16x16x32_bf16 v[128:131], a[180:183], v[32:35], v[128:131]
    v_mfma_f32_16x16x32_bf16 v[128:131], a[184:187], v[36:39], v[128:131]
    v_mfma_f32_16x16x32_bf16 v[128:131], a[188:191], v[40:43], v[128:131]
    v_cvt_pk_bf16_f32 v140, v116, v117
    v_cvt_pk_bf16_f32 v141, v118, v119
    v_cvt_pk_bf16_f32 v142, v120, v121
    v_cvt_pk_bf16_f32 v143, v122, v123
    s_add_u32 s29, s28, 2628608
    buffer_store_dwordx4 v[140:143], v2, s[4:7], s29 offen sc1
    s_waitcnt vmcnt(6)
    v_mfma_f32_16x16x32_bf16 v[116:119], a[0:3], v[44:47], 0
    v_mfma_f32_16x16x32_bf16 v[116:119], a[4:7], v[48:51], v[116:119]
    v_mfma_f32_16x16x32_bf16 v[116:119], a[8:11], v[52:55], v[116:119]
    v_mfma_f32_16x16x32_bf16 v[116:119], a[12:15], v[56:59], v[116:119]
    v_mfma_f32_16x16x32_bf16 v[116:119], a[16:19], v[60:63], v[116:119]
    v_mfma_f32_16x16x32_bf16 v[116:119], a[20:23], v[64:67], v[116:119]
    v_mfma_f32_16x16x32_bf16 v[120:123], a[24:27], v[44:47], 0
    v_mfma_f32_16x16x32_bf16 v[120:123], a[28:31], v[48:51], v[120:123]
    v_mfma_f32_16x16x32_bf16 v[120:123], a[32:35], v[52:55], v[120:123]
    v_mfma_f32_16x16x32_bf16 v[120:123], a[36:39], v[56:59], v[120:123]
    v_mfma_f32_16x16x32_bf16 v[120:123], a[40:43], v[60:63], v[120:123]
    v_mfma_f32_16x16x32_bf16 v[120:123], a[44:47], v[64:67], v[120:123]
    v_cvt_pk_bf16_f32 v144, v124, v125
    v_cvt_pk_bf16_f32 v145, v126, v127
    v_cvt_pk_bf16_f32 v146, v128, v129
    v_cvt_pk_bf16_f32 v147, v130, v131
    s_add_u32 s29, s28, 3939328
    buffer_store_dwordx4 v[144:147], v2, s[4:7], s29 offen sc1
    v_mfma_f32_16x16x32_bf16 v[124:127], a[48:51], v[44:47], 0
    v_mfma_f32_16x16x32_bf16 v[124:127], a[52:55], v[48:51], v[124:127]
    v_mfma_f32_16x16x32_bf16 v[124:127], a[56:59], v[52:55], v[124:127]
    v_mfma_f32_16x16x32_bf16 v[124:127], a[60:63], v[56:59], v[124:127]
    v_mfma_f32_16x16x32_bf16 v[124:127], a[64:67], v[60:63], v[124:127]
    v_mfma_f32_16x16x32_bf16 v[124:127], a[68:71], v[64:67], v[124:127]
    v_mfma_f32_16x16x32_bf16 v[128:131], a[72:75], v[44:47], 0
    v_mfma_f32_16x16x32_bf16 v[128:131], a[76:79], v[48:51], v[128:131]
    v_mfma_f32_16x16x32_bf16 v[128:131], a[80:83], v[52:55], v[128:131]
    v_mfma_f32_16x16x32_bf16 v[128:131], a[84:87], v[56:59], v[128:131]
    v_mfma_f32_16x16x32_bf16 v[128:131], a[88:91], v[60:63], v[128:131]
    v_mfma_f32_16x16x32_bf16 v[128:131], a[92:95], v[64:67], v[128:131]
    v_cvt_pk_bf16_f32 v132, v116, v117
    v_cvt_pk_bf16_f32 v133, v118, v119
    v_cvt_pk_bf16_f32 v134, v120, v121
    v_cvt_pk_bf16_f32 v135, v122, v123
    s_add_u32 s29, s28, 8192
    buffer_store_dwordx4 v[132:135], v2, s[4:7], s29 offen sc1
    v_mfma_f32_16x16x32_bf16 v[116:119], a[96:99], v[44:47], 0
    v_mfma_f32_16x16x32_bf16 v[116:119], a[100:103], v[48:51], v[116:119]
    v_mfma_f32_16x16x32_bf16 v[116:119], a[104:107], v[52:55], v[116:119]
    v_mfma_f32_16x16x32_bf16 v[116:119], a[108:111], v[56:59], v[116:119]
    v_mfma_f32_16x16x32_bf16 v[116:119], a[112:115], v[60:63], v[116:119]
    v_mfma_f32_16x16x32_bf16 v[116:119], a[116:119], v[64:67], v[116:119]
    v_mfma_f32_16x16x32_bf16 v[120:123], a[120:123], v[44:47], 0
    v_mfma_f32_16x16x32_bf16 v[120:123], a[124:127], v[48:51], v[120:123]
    v_mfma_f32_16x16x32_bf16 v[120:123], a[128:131], v[52:55], v[120:123]
    v_mfma_f32_16x16x32_bf16 v[120:123], a[132:135], v[56:59], v[120:123]
    v_mfma_f32_16x16x32_bf16 v[120:123], a[136:139], v[60:63], v[120:123]
    v_mfma_f32_16x16x32_bf16 v[120:123], a[140:143], v[64:67], v[120:123]
    v_cvt_pk_bf16_f32 v136, v124, v125
    v_cvt_pk_bf16_f32 v137, v126, v127
    v_cvt_pk_bf16_f32 v138, v128, v129
    v_cvt_pk_bf16_f32 v139, v130, v131
    s_add_u32 s29, s28, 1318912
    buffer_store_dwordx4 v[136:139], v2, s[4:7], s29 offen sc1
    v_mfma_f32_16x16x32_bf16 v[124:127], a[144:147], v[44:47], 0
    v_mfma_f32_16x16x32_bf16 v[124:127], a[148:151], v[48:51], v[124:127]
    v_mfma_f32_16x16x32_bf16 v[124:127], a[152:155], v[52:55], v[124:127]
    v_mfma_f32_16x16x32_bf16 v[124:127], a[156:159], v[56:59], v[124:127]
    v_mfma_f32_16x16x32_bf16 v[124:127], a[160:163], v[60:63], v[124:127]
    v_mfma_f32_16x16x32_bf16 v[124:127], a[164:167], v[64:67], v[124:127]
    v_mfma_f32_16x16x32_bf16 v[128:131], a[168:171], v[44:47], 0
    v_mfma_f32_16x16x32_bf16 v[128:131], a[172:175], v[48:51], v[128:131]
    v_mfma_f32_16x16x32_bf16 v[128:131], a[176:179], v[52:55], v[128:131]
    v_mfma_f32_16x16x32_bf16 v[128:131], a[180:183], v[56:59], v[128:131]
    v_mfma_f32_16x16x32_bf16 v[128:131], a[184:187], v[60:63], v[128:131]
    v_mfma_f32_16x16x32_bf16 v[128:131], a[188:191], v[64:67], v[128:131]
    v_cvt_pk_bf16_f32 v140, v116, v117
    v_cvt_pk_bf16_f32 v141, v118, v119
    v_cvt_pk_bf16_f32 v142, v120, v121
    v_cvt_pk_bf16_f32 v143, v122, v123
    s_add_u32 s29, s28, 2629632
    buffer_store_dwordx4 v[140:143], v2, s[4:7], s29 offen sc1
    s_waitcnt vmcnt(0)
    v_mfma_f32_16x16x32_bf16 v[116:119], a[0:3], v[68:71], 0
    v_mfma_f32_16x16x32_bf16 v[116:119], a[4:7], v[72:75], v[116:119]
    v_mfma_f32_16x16x32_bf16 v[116:119], a[8:11], v[76:79], v[116:119]
    v_mfma_f32_16x16x32_bf16 v[116:119], a[12:15], v[80:83], v[116:119]
    v_mfma_f32_16x16x32_bf16 v[116:119], a[16:19], v[84:87], v[116:119]
    v_mfma_f32_16x16x32_bf16 v[116:119], a[20:23], v[88:91], v[116:119]
    v_mfma_f32_16x16x32_bf16 v[120:123], a[24:27], v[68:71], 0
    v_mfma_f32_16x16x32_bf16 v[120:123], a[28:31], v[72:75], v[120:123]
    v_mfma_f32_16x16x32_bf16 v[120:123], a[32:35], v[76:79], v[120:123]
    v_mfma_f32_16x16x32_bf16 v[120:123], a[36:39], v[80:83], v[120:123]
    v_mfma_f32_16x16x32_bf16 v[120:123], a[40:43], v[84:87], v[120:123]
    v_mfma_f32_16x16x32_bf16 v[120:123], a[44:47], v[88:91], v[120:123]
    v_cvt_pk_bf16_f32 v144, v124, v125
    v_cvt_pk_bf16_f32 v145, v126, v127
    v_cvt_pk_bf16_f32 v146, v128, v129
    v_cvt_pk_bf16_f32 v147, v130, v131
    s_add_u32 s29, s28, 3940352
    buffer_store_dwordx4 v[144:147], v2, s[4:7], s29 offen sc1
    v_mfma_f32_16x16x32_bf16 v[124:127], a[48:51], v[68:71], 0
    v_mfma_f32_16x16x32_bf16 v[124:127], a[52:55], v[72:75], v[124:127]
    v_mfma_f32_16x16x32_bf16 v[124:127], a[56:59], v[76:79], v[124:127]
    v_mfma_f32_16x16x32_bf16 v[124:127], a[60:63], v[80:83], v[124:127]
    v_mfma_f32_16x16x32_bf16 v[124:127], a[64:67], v[84:87], v[124:127]
    v_mfma_f32_16x16x32_bf16 v[124:127], a[68:71], v[88:91], v[124:127]
    v_mfma_f32_16x16x32_bf16 v[128:131], a[72:75], v[68:71], 0
    v_mfma_f32_16x16x32_bf16 v[128:131], a[76:79], v[72:75], v[128:131]
    v_mfma_f32_16x16x32_bf16 v[128:131], a[80:83], v[76:79], v[128:131]
    v_mfma_f32_16x16x32_bf16 v[128:131], a[84:87], v[80:83], v[128:131]
    v_mfma_f32_16x16x32_bf16 v[128:131], a[88:91], v[84:87], v[128:131]
    v_mfma_f32_16x16x32_bf16 v[128:131], a[92:95], v[88:91], v[128:131]
    v_cvt_pk_bf16_f32 v132, v116, v117
    v_cvt_pk_bf16_f32 v133, v118, v119
    v_cvt_pk_bf16_f32 v134, v120, v121
    v_cvt_pk_bf16_f32 v135, v122, v123
    s_add_u32 s29, s28, 9216
    buffer_store_dwordx4 v[132:135], v2, s[4:7], s29 offen sc1
    v_mfma_f32_16x16x32_bf16 v[116:119], a[96:99], v[68:71], 0
    v_mfma_f32_16x16x32_bf16 v[116:119], a[100:103], v[72:75], v[116:119]
    v_mfma_f32_16x16x32_bf16 v[116:119], a[104:107], v[76:79], v[116:119]
    v_mfma_f32_16x16x32_bf16 v[116:119], a[108:111], v[80:83], v[116:119]
    v_mfma_f32_16x16x32_bf16 v[116:119], a[112:115], v[84:87], v[116:119]
    v_mfma_f32_16x16x32_bf16 v[116:119], a[116:119], v[88:91], v[116:119]
    v_mfma_f32_16x16x32_bf16 v[120:123], a[120:123], v[68:71], 0
    v_mfma_f32_16x16x32_bf16 v[120:123], a[124:127], v[72:75], v[120:123]
    v_mfma_f32_16x16x32_bf16 v[120:123], a[128:131], v[76:79], v[120:123]
    v_mfma_f32_16x16x32_bf16 v[120:123], a[132:135], v[80:83], v[120:123]
    v_mfma_f32_16x16x32_bf16 v[120:123], a[136:139], v[84:87], v[120:123]
    v_mfma_f32_16x16x32_bf16 v[120:123], a[140:143], v[88:91], v[120:123]
    v_cvt_pk_bf16_f32 v136, v124, v125
    v_cvt_pk_bf16_f32 v137, v126, v127
    v_cvt_pk_bf16_f32 v138, v128, v129
    v_cvt_pk_bf16_f32 v139, v130, v131
    s_add_u32 s29, s28, 1319936
    buffer_store_dwordx4 v[136:139], v2, s[4:7], s29 offen sc1
    v_mfma_f32_16x16x32_bf16 v[124:127], a[144:147], v[68:71], 0
    v_mfma_f32_16x16x32_bf16 v[124:127], a[148:151], v[72:75], v[124:127]
    v_mfma_f32_16x16x32_bf16 v[124:127], a[152:155], v[76:79], v[124:127]
    v_mfma_f32_16x16x32_bf16 v[124:127], a[156:159], v[80:83], v[124:127]
    v_mfma_f32_16x16x32_bf16 v[124:127], a[160:163], v[84:87], v[124:127]
    v_mfma_f32_16x16x32_bf16 v[124:127], a[164:167], v[88:91], v[124:127]
    v_mfma_f32_16x16x32_bf16 v[128:131], a[168:171], v[68:71], 0
    v_mfma_f32_16x16x32_bf16 v[128:131], a[172:175], v[72:75], v[128:131]
    v_mfma_f32_16x16x32_bf16 v[128:131], a[176:179], v[76:79], v[128:131]
    v_mfma_f32_16x16x32_bf16 v[128:131], a[180:183], v[80:83], v[128:131]
    v_mfma_f32_16x16x32_bf16 v[128:131], a[184:187], v[84:87], v[128:131]
    v_mfma_f32_16x16x32_bf16 v[128:131], a[188:191], v[88:91], v[128:131]
    v_cvt_pk_bf16_f32 v140, v116, v117
    v_cvt_pk_bf16_f32 v141, v118, v119
    v_cvt_pk_bf16_f32 v142, v120, v121
    v_cvt_pk_bf16_f32 v143, v122, v123
    s_add_u32 s29, s28, 2630656
    buffer_store_dwordx4 v[140:143], v2, s[4:7], s29 offen sc1
    s_nop 7
    s_nop 7
    v_cvt_pk_bf16_f32 v144, v124, v125
    v_cvt_pk_bf16_f32 v145, v126, v127
    v_cvt_pk_bf16_f32 v146, v128, v129
    v_cvt_pk_bf16_f32 v147, v130, v131
    s_add_u32 s29, s28, 3941376
    buffer_store_dwordx4 v[144:147], v2, s[4:7], s29 offen sc1
L_w_fin:
    s_waitcnt vmcnt(0)
    s_barrier
    s_cmp_lg_u32 s20, 0
    s_cbranch_scc1 L_w_nofl
    s_lshl_b32 s22, s21, 9
    s_lshl_b32 s23, s71, 2
    s_add_u32 s22, s22, s23
    s_add_u32 s22, s22, 2019328
    v_mov_b32 v4, 1
    v_mov_b32 v5, 0
    s_mov_b64 exec, 1
    buffer_store_dword v4, v5, s[4:7], s22 offen sc1
    s_mov_b64 exec, -1
L_w_nofl:
    s_cmp_lg_u32 s69, 0
    s_cbranch_scc1 L_post_try
    v_and_b32 v22, 63, v0
    v_lshlrev_b32 v22, 3, v22
    s_mov_b32 s68, 2019328
    buffer_load_dwordx2 v[20:21], v22, s[4:7], s68 offen sc1
    buffer_load_dwordx2 v[24:25], v22, s[4:7], s68 offen offset:512 sc1
    buffer_load_dwordx2 v[26:27], v22, s[4:7], s68 offen offset:1024 sc1
    s_waitcnt vmcnt(0)
    v_and_b32 v20, v20, v21
    v_and_b32 v24, v24, v25
    v_and_b32 v26, v26, v27
    v_and_b32 v20, v20, v24
    v_and_b32 v20, v20, v26
    v_cmp_ne_u32 vcc, 1, v20
    s_or_b32 s43, vcc_lo, vcc_hi
    v_mov_b32 v20, s43
    v_mov_b32 v5, 49280
    s_cmp_lg_u32 s20, 0
    s_cbranch_scc1 L_w_r0b
    s_mov_b64 exec, 1
    ds_write_b32 v5, v20
    s_mov_b64 exec, -1
    s_waitcnt lgkmcnt(0)
L_w_r0b:
    s_barrier
    ds_read_b32 v4, v5
    s_waitcnt lgkmcnt(0)
    v_readfirstlane_b32 s69, v4
    s_barrier
    s_cmp_lg_u32 s69, 0
    s_mov_b32 s69, 0
    s_cbranch_scc1 L_w_next
    s_mov_b32 s69, 1
    s_branch L_post_try
L_w_end:
    v_and_b32 v22, 63, v0
    v_lshlrev_b32 v22, 3, v22
    s_mov_b32 s68, 2019328
    s_mov_b32 s42, 0
L_wr0_fl:
    buffer_load_dwordx2 v[20:21], v22, s[4:7], s68 offen sc1
    s_waitcnt vmcnt(0)
    v_and_b32 v20, v20, v21
    v_cmp_ne_u32 vcc, 1, v20
    s_cbranch_vccz L_wr0_flok
    s_add_u32 s42, s42, 1
    s_cmp_lt_u32 s42, s44
    s_cbranch_scc1 L_wr0_fl
    s_mov_b32 s44, 0
L_wr0_flok:
    v_and_b32 v22, 63, v0
    v_lshlrev_b32 v22, 3, v22
    s_mov_b32 s68, 2019840
    s_mov_b32 s42, 0
L_wr1_fl:
    buffer_load_dwordx2 v[20:21], v22, s[4:7], s68 offen sc1
    s_waitcnt vmcnt(0)
    v_and_b32 v20, v20, v21
    v_cmp_ne_u32 vcc, 1, v20
    s_cbranch_vccz L_wr1_flok
    s_add_u32 s42, s42, 1
    s_cmp_lt_u32 s42, s44
    s_cbranch_scc1 L_wr1_fl
    s_mov_b32 s44, 0
L_wr1_flok:
    v_and_b32 v22, 63, v0
    v_lshlrev_b32 v22, 3, v22
    s_mov_b32 s68, 2020352
    s_mov_b32 s42, 0
L_wr2_fl:
    buffer_load_dwordx2 v[20:21], v22, s[4:7], s68 offen sc1
    s_waitcnt vmcnt(0)
    v_and_b32 v20, v20, v21
    v_cmp_ne_u32 vcc, 1, v20
    s_cbranch_vccz L_wr2_flok
    s_add_u32 s42, s42, 1
    s_cmp_lt_u32 s42, s44
    s_cbranch_scc1 L_wr2_fl
    s_mov_b32 s44, 0
L_wr2_flok:
    s_mov_b32 s76, 0
L_post_try:
    s_mov_b32 s78, 1000
L_post_disp:
    s_cmp_ge_u32 s73, 64
    s_cbranch_scc1 L_post_out
    s_cmp_eq_u32 s75, 1
    s_cbranch_scc1 L_pe_1
    s_cmp_eq_u32 s75, 2
    s_cbranch_scc1 L_pe_2
    s_cmp_eq_u32 s75, 3
    s_cbranch_scc1 L_pe_3
    s_cmp_eq_u32 s75, 4
    s_cbranch_scc1 L_pe_4
L_pe_0:
    s_cmp_lg_u32 s20, 0
    s_cbranch_scc1 L_e1_ec
    s_min_u32 s60, s73, 63
    v_lshlrev_b32 v12, 2, v1
    s_lshl_b32 s61, s60, 9
    s_lshl_b32 s62, s74, 6
    s_add_u32 s61, s61, s62
    s_add_u32 s61, s61, 250859520
    v_and_b32 v14, 3, v1
    v_cmp_ne_u32 vcc, 0, v14
    v_cndmask_b32 v14, 0, 1, vcc
    v_cmp_gt_u32 vcc, 16, v1
    v_cndmask_b32 v14, 0, v14, vcc
    v_add_u32 v12, s61, v12
    v_mov_b32 v15, 250890244
    v_cmp_eq_u32 vcc, 62, v1
    v_cndmask_b32 v12, v12, v15, vcc
    buffer_load_dword v13, v12, s[4:7], 0 offen sc1
    s_waitcnt vmcnt(0)
    v_cmp_lt_u32 vcc, v13, v14
    s_cmp_eq_u64 vcc, 0
    s_cselect_b32 s60, 1, 0
    v_mov_b32 v15, s60
    v_mov_b32 v12, 49152
    ds_write_b32 v12, v15
    s_waitcnt lgkmcnt(0)
L_e1_ec:
    s_barrier
    v_mov_b32 v12, 49152
    ds_read_b32 v15, v12
    s_waitcnt lgkmcnt(0)
    v_readfirstlane_b32 s77, v15
L_e1_loop:
    s_cmp_ge_u32 s73, 64
    s_cbranch_scc1 L_post_out
    s_cmp_eq_u32 s76, 0
    s_cbranch_scc1 L_e1_go
    s_cmp_eq_u32 s77, 0
    s_cbranch_scc1 L_w_next
    s_cmp_eq_u32 s78, 0
    s_cbranch_scc1 L_w_next
    s_sub_u32 s78, s78, 1
L_e1_go:
    s_mov_b32 s21, s73
    s_cmp_lg_u32 s77, 0
    s_cbranch_scc1 L_e1_safe
    s_and_b32 s22, s73, 3
    s_cmp_ge_u32 s22, 2
    s_cbranch_scc1 L_e1_safe
    s_cmp_lg_u32 s20, 0
    s_cbranch_scc1 L_e1_sq2
    s_mov_b32 s42, 0
L_e1_sq:
    s_min_u32 s60, s73, 63
    v_lshlrev_b32 v12, 2, v1
    s_lshl_b32 s61, s60, 9
    s_lshl_b32 s62, s74, 6
    s_add_u32 s61, s61, s62
    s_add_u32 s61, s61, 250859520
    v_and_b32 v14, 3, v1
    v_cmp_ne_u32 vcc, 0, v14
    v_cndmask_b32 v14, 0, 1, vcc
    v_cmp_gt_u32 vcc, 16, v1
    v_cndmask_b32 v14, 0, v14, vcc
    v_add_u32 v12, s61, v12
    v_mov_b32 v15, 250890244
    v_cmp_eq_u32 vcc, 62, v1
    v_cndmask_b32 v12, v12, v15, vcc
    buffer_load_dword v13, v12, s[4:7], 0 offen sc1
    s_waitcnt vmcnt(0)
    v_cmp_lt_u32 vcc, v13, v14
    s_cbranch_vccz L_e1_sq2
    v_readlane_b32 s43, v13, 62
    s_cmp_lg_u32 s43, 0
    s_cbranch_scc1 L_e1_sq_nd
    s_mov_b32 s43, 10
L_e1_sq_dl:
    s_nop 15
    s_nop 15
    s_nop 15
    s_nop 15
    s_nop 15
    s_nop 15
    s_nop 15
    s_nop 15
    s_sub_u32 s43, s43, 1
    s_cmp_lg_u32 s43, 0
    s_cbranch_scc1 L_e1_sq_dl
L_e1_sq_nd:
    s_add_u32 s42, s42, 1
    s_cmp_lt_u32 s42, s44
    s_cbranch_scc1 L_e1_sq
    s_mov_b32 s44, 0
L_e1_sq2:
    s_barrier
    s_mov_b32 s77, 1
L_e1_safe:
    s_lshl_b32 s23, s74, 2
    s_add_u32 s23, s23, s20
    v_add_u32 v3, 4096, v2
    s_mul_i32 s25, s21, 384
    s_mul_i32 s26, s23, 6
    s_add_u32 s25, s25, s26
    s_lshl_b32 s25, s25, 10
    s_add_u32 s24, s25, 65228800
    buffer_load_dwordx4 v[40:43], v2, s[4:7], s24 offen offset:0
    buffer_load_dwordx4 v[44:47], v2, s[4:7], s24 offen offset:1024
    buffer_load_dwordx4 v[48:51], v2, s[4:7], s24 offen offset:2048
    buffer_load_dwordx4 v[52:55], v2, s[4:7], s24 offen offset:3072
    buffer_load_dwordx4 v[56:59], v3, s[4:7], s24 offen offset:0
    buffer_load_dwordx4 v[60:63], v3, s[4:7], s24 offen offset:1024
    s_add_u32 s24, s25, 40062976
    buffer_load_dwordx4 v[88:91], v2, s[4:7], s24 offen offset:0
    buffer_load_dwordx4 v[92:95], v2, s[4:7], s24 offen offset:1024
    buffer_load_dwordx4 v[96:99], v2, s[4:7], s24 offen offset:2048
    buffer_load_dwordx4 v[100:103], v2, s[4:7], s24 offen offset:3072
    buffer_load_dwordx4 v[104:107], v3, s[4:7], s24 offen offset:0
    buffer_load_dwordx4 v[108:111], v3, s[4:7], s24 offen offset:1024
    s_add_u32 s24, s25, 65425408
    buffer_load_dwordx4 v[64:67], v2, s[4:7], s24 offen offset:0
    buffer_load_dwordx4 v[68:71], v2, s[4:7], s24 offen offset:1024
    buffer_load_dwordx4 v[72:75], v2, s[4:7], s24 offen offset:2048
    buffer_load_dwordx4 v[76:79], v2, s[4:7], s24 offen offset:3072
    buffer_load_dwordx4 v[80:83], v3, s[4:7], s24 offen offset:0
    buffer_load_dwordx4 v[84:87], v3, s[4:7], s24 offen offset:1024
    s_add_u32 s24, s25, 40259584
    buffer_load_dwordx4 v[112:115], v2, s[4:7], s24 offen offset:0
    buffer_load_dwordx4 v[116:119], v2, s[4:7], s24 offen offset:1024
    buffer_load_dwordx4 v[120:123], v2, s[4:7], s24 offen offset:2048
    buffer_load_dwordx4 v[124:127], v2, s[4:7], s24 offen offset:3072
    buffer_load_dwordx4 v[128:131], v3, s[4:7], s24 offen offset:0
    buffer_load_dwordx4 v[132:135], v3, s[4:7], s24 offen offset:1024
    s_cmp_lg_u32 s77, 0
    s_cbranch_scc1 L_e1_rdy
    s_cmp_lg_u32 s20, 0
    s_cbranch_scc1 L_e1_sp2
    s_mov_b32 s42, 0
L_e1_sp:
    s_min_u32 s60, s73, 63
    v_lshlrev_b32 v12, 2, v1
    s_lshl_b32 s61, s60, 9
    s_lshl_b32 s62, s74, 6
    s_add_u32 s61, s61, s62
    s_add_u32 s61, s61, 250859520
    v_and_b32 v14, 3, v1
    v_cmp_ne_u32 vcc, 0, v14
    v_cndmask_b32 v14, 0, 1, vcc
    v_cmp_gt_u32 vcc, 16, v1
    v_cndmask_b32 v14, 0, v14, vcc
    v_add_u32 v12, s61, v12
    v_mov_b32 v15, 250890244
    v_cmp_eq_u32 vcc, 62, v1
    v_cndmask_b32 v12, v12, v15, vcc
    buffer_load_dword v13, v12, s[4:7], 0 offen sc1
    s_waitcnt vmcnt(0)
    v_cmp_lt_u32 vcc, v13, v14
    s_cbranch_vccz L_e1_sp2
    v_readlane_b32 s43, v13, 62
    s_cmp_lg_u32 s43, 0
    s_cbranch_scc1 L_e1_sp_nd
    s_mov_b32 s43, 10
L_e1_sp_dl:
    s_nop 15
    s_nop 15
    s_nop 15
    s_nop 15
    s_nop 15
    s_nop 15
    s_nop 15
    s_nop 15
    s_sub_u32 s43, s43, 1
    s_cmp_lg_u32 s43, 0
    s_cbranch_scc1 L_e1_sp_dl
L_e1_sp_nd:
    s_add_u32 s42, s42, 1
    s_cmp_lt_u32 s42, s44
    s_cbranch_scc1 L_e1_sp
    s_mov_b32 s44, 0
L_e1_sp2:
    s_barrier
L_e1_rdy:
    s_lshl_b32 s27, s21, 5
    s_add_u32 s27, s27, s23
    s_mul_i32 s24, s27, 6144
    s_add_u32 s24, s24, 200495104
    v_add_u32 v3, 4096, v2
    buffer_load_dwordx4 v[16:19], v2, s[4:7], s24 offen offset:0
    buffer_load_dwordx4 v[20:23], v2, s[4:7], s24 offen offset:1024
    buffer_load_dwordx4 v[24:27], v2, s[4:7], s24 offen offset:2048
    buffer_load_dwordx4 v[28:31], v2, s[4:7], s24 offen offset:3072
    buffer_load_dwordx4 v[32:35], v3, s[4:7], s24 offen offset:0
    buffer_load_dwordx4 v[36:39], v3, s[4:7], s24 offen offset:1024
    v_and_b32 v4, 15, v1
    v_lshrrev_b32 v5, 4, v1
    v_lshlrev_b32 v6, 2, v5
    v_sub_u32 v6, v4, v6
    v_mov_b32 v7, 0xff800000
    s_waitcnt vmcnt(6)
    v_mfma_f32_16x16x32_bf16 v[140:143], v[40:43], v[88:91], 0
    v_mfma_f32_16x16x32_bf16 v[140:143], v[44:47], v[92:95], v[140:143]
    v_mfma_f32_16x16x32_bf16 v[140:143], v[48:51], v[96:99], v[140:143]
    v_mfma_f32_16x16x32_bf16 v[140:143], v[52:55], v[100:103], v[140:143]
    v_mfma_f32_16x16x32_bf16 v[140:143], v[56:59], v[104:107], v[140:143]
    v_mfma_f32_16x16x32_bf16 v[140:143], v[60:63], v[108:111], v[140:143]
    v_mfma_f32_16x16x32_bf16 v[152:155], v[40:43], v[112:115], 0
    v_mfma_f32_16x16x32_bf16 v[152:155], v[44:47], v[116:119], v[152:155]
    v_mfma_f32_16x16x32_bf16 v[152:155], v[48:51], v[120:123], v[152:155]
    v_mfma_f32_16x16x32_bf16 v[152:155], v[52:55], v[124:127], v[152:155]
    v_mfma_f32_16x16x32_bf16 v[152:155], v[56:59], v[128:131], v[152:155]
    v_mfma_f32_16x16x32_bf16 v[152:155], v[60:63], v[132:135], v[152:155]
    v_mfma_f32_16x16x32_bf16 v[156:159], v[64:67], v[112:115], 0
    v_mfma_f32_16x16x32_bf16 v[156:159], v[68:71], v[116:119], v[156:159]
    v_mfma_f32_16x16x32_bf16 v[156:159], v[72:75], v[120:123], v[156:159]
    v_mfma_f32_16x16x32_bf16 v[156:159], v[76:79], v[124:127], v[156:159]
    v_mfma_f32_16x16x32_bf16 v[156:159], v[80:83], v[128:131], v[156:159]
    v_mfma_f32_16x16x32_bf16 v[156:159], v[84:87], v[132:135], v[156:159]
    s_waitcnt vmcnt(0)
    v_mfma_f32_16x16x32_bf16 v[136:139], v[16:19], v[88:91], 0
    v_mfma_f32_16x16x32_bf16 v[136:139], v[20:23], v[92:95], v[136:139]
    v_mfma_f32_16x16x32_bf16 v[136:139], v[24:27], v[96:99], v[136:139]
    v_mfma_f32_16x16x32_bf16 v[136:139], v[28:31], v[100:103], v[136:139]
    v_mfma_f32_16x16x32_bf16 v[136:139], v[32:35], v[104:107], v[136:139]
    v_mfma_f32_16x16x32_bf16 v[136:139], v[36:39], v[108:111], v[136:139]
    v_mfma_f32_16x16x32_bf16 v[148:151], v[16:19], v[112:115], 0
    v_mfma_f32_16x16x32_bf16 v[148:151], v[20:23], v[116:119], v[148:151]
    v_mfma_f32_16x16x32_bf16 v[148:151], v[24:27], v[120:123], v[148:151]
    v_mfma_f32_16x16x32_bf16 v[148:151], v[28:31], v[124:127], v[148:151]
    v_mfma_f32_16x16x32_bf16 v[148:151], v[32:35], v[128:131], v[148:151]
    v_mfma_f32_16x16x32_bf16 v[148:151], v[36:39], v[132:135], v[148:151]
    s_nop 7
    s_nop 7
    v_mov_b32 v160, 1033096506
    v_mov_b32 v161, 1069066811
    s_lshl_b32 s24, s21, 6
    s_add_u32 s24, s24, s23
    s_lshl_b32 s24, s24, 10
    s_add_u32 s24, s24, 234049536
    s_lshl_b32 s25, s21, 4
    s_lshr_b32 s26, s23, 2
    s_add_u32 s25, s25, s26
    s_lshl_b32 s25, s25, 10
    s_and_b32 s26, s23, 3
    s_lshl_b32 s26, s26, 8
    s_add_u32 s25, s25, s26
    s_add_u32 s25, s25, 238243840
    v_lshlrev_b32 v8, 4, v4
    v_lshlrev_b32 v9, 3, v5
    v_add_u32 v8, v8, v9
    v_cvt_pk_bf16_f32 v10, v136, v137
    v_lshlrev_b32 v136, 16, v10
    v_and_b32 v137, 0xffff0000, v10
    v_mul_f32 v136, v136, v160
    v_mul_f32 v137, v137, v160
    v_cvt_pk_bf16_f32 v10, v136, v137
    v_lshlrev_b32 v136, 16, v10
    v_and_b32 v137, 0xffff0000, v10
    v_cvt_pk_bf16_f32 v10, v138, v139
    v_lshlrev_b32 v138, 16, v10
    v_and_b32 v139, 0xffff0000, v10
    v_mul_f32 v138, v138, v160
    v_mul_f32 v139, v139, v160
    v_cvt_pk_bf16_f32 v10, v138, v139
    v_lshlrev_b32 v138, 16, v10
    v_and_b32 v139, 0xffff0000, v10
    v_cvt_pk_bf16_f32 v10, v140, v141
    v_lshlrev_b32 v140, 16, v10
    v_and_b32 v141, 0xffff0000, v10
    v_mul_f32 v140, v140, v160
    v_mul_f32 v141, v141, v160
    v_cvt_pk_bf16_f32 v10, v140, v141
    v_lshlrev_b32 v140, 16, v10
    v_and_b32 v141, 0xffff0000, v10
    v_cvt_pk_bf16_f32 v10, v142, v143
    v_lshlrev_b32 v142, 16, v10
    v_and_b32 v143, 0xffff0000, v10
    v_mul_f32 v142, v142, v160
    v_mul_f32 v143, v143, v160
    v_cvt_pk_bf16_f32 v10, v142, v143
    v_lshlrev_b32 v142, 16, v10
    v_and_b32 v143, 0xffff0000, v10
    v_cmp_gt_u32 vcc, 2, v5
    v_cndmask_b32 v136, v7, v136, vcc
    v_cndmask_b32 v137, v7, v137, vcc
    v_cndmask_b32 v138, v7, v138, vcc
    v_cndmask_b32 v139, v7, v139, vcc
    v_cmp_le_i32 vcc, 0, v6
    v_cndmask_b32 v140, v7, v140, vcc
    v_cmp_le_i32 vcc, 1, v6
    v_cndmask_b32 v141, v7, v141, vcc
    v_cmp_le_i32 vcc, 2, v6
    v_cndmask_b32 v142, v7, v142, vcc
    v_cmp_le_i32 vcc, 3, v6
    v_cndmask_b32 v143, v7, v143, vcc
    v_max3_f32 v11, v136, v137, v138
    v_max3_f32 v11, v11, v139, v140
    v_max3_f32 v11, v11, v141, v142
    v_max_f32 v11, v11, v143
    v_mov_b32 v12, v11
    s_nop 1
    v_permlane16_swap_b32 v11, v12
    s_nop 1
    v_max_f32 v11, v11, v12
    v_mov_b32 v12, v11
    s_nop 1
    v_permlane32_swap_b32 v11, v12
    s_nop 1
    v_max_f32 v11, v11, v12
    v_mul_f32 v11, v11, v161
    v_fma_f32 v136, v136, v161, -v11
    v_exp_f32 v136, v136
    v_fma_f32 v137, v137, v161, -v11
    v_exp_f32 v137, v137
    v_fma_f32 v138, v138, v161, -v11
    v_exp_f32 v138, v138
    v_fma_f32 v139, v139, v161, -v11
    v_exp_f32 v139, v139
    v_fma_f32 v140, v140, v161, -v11
    v_exp_f32 v140, v140
    v_fma_f32 v141, v141, v161, -v11
    v_exp_f32 v141, v141
    v_fma_f32 v142, v142, v161, -v11
    v_exp_f32 v142, v142
    v_fma_f32 v143, v143, v161, -v11
    v_exp_f32 v143, v143
    s_nop 0
    v_add_f32 v12, v136, v137
    v_add_f32 v12, v12, v138
    v_add_f32 v12, v12, v139
    v_add_f32 v12, v12, v140
    v_add_f32 v12, v12, v141
    v_add_f32 v12, v12, v142
    v_add_f32 v12, v12, v143
    v_mov_b32 v13, v12
    s_nop 1
    v_permlane16_swap_b32 v12, v13
    s_nop 1
    v_add_f32 v12, v12, v13
    v_mov_b32 v13, v12
    s_nop 1
    v_permlane32_swap_b32 v12, v13
    s_nop 1
    v_add_f32 v12, v12, v13
    v_rcp_f32 v12, v12
    s_nop 0
    v_mul_f32 v136, v136, v12
    v_mul_f32 v137, v137, v12
    v_mul_f32 v138, v138, v12
    v_mul_f32 v139, v139, v12
    v_mul_f32 v140, v140, v12
    v_mul_f32 v141, v141, v12
    v_mul_f32 v142, v142, v12
    v_mul_f32 v143, v143, v12
    v_cvt_pk_bf16_f32 v164, v140, v141
    v_cvt_pk_bf16_f32 v165, v142, v143
    v_mov_b32 v166, 0
    v_mov_b32 v167, 0
    v_cvt_pk_bf16_f32 v168, v136, v137
    v_cvt_pk_bf16_f32 v169, v138, v139
    buffer_store_dwordx4 v[164:167], v2, s[4:7], s24 offen sc1
    s_mov_b32 exec_hi, 0
    buffer_store_dwordx2 v[168:169], v8, s[4:7], s25 offen sc1
    s_mov_b64 exec, -1
    s_add_u32 s24, s24, 32768
    s_add_u32 s25, s25, 8192
    v_cvt_pk_bf16_f32 v10, v148, v149
    v_lshlrev_b32 v148, 16, v10
    v_and_b32 v149, 0xffff0000, v10
    v_mul_f32 v148, v148, v160
    v_mul_f32 v149, v149, v160
    v_cvt_pk_bf16_f32 v10, v148, v149
    v_lshlrev_b32 v148, 16, v10
    v_and_b32 v149, 0xffff0000, v10
    v_cvt_pk_bf16_f32 v10, v150, v151
    v_lshlrev_b32 v150, 16, v10
    v_and_b32 v151, 0xffff0000, v10
    v_mul_f32 v150, v150, v160
    v_mul_f32 v151, v151, v160
    v_cvt_pk_bf16_f32 v10, v150, v151
    v_lshlrev_b32 v150, 16, v10
    v_and_b32 v151, 0xffff0000, v10
    v_cvt_pk_bf16_f32 v10, v152, v153
    v_lshlrev_b32 v152, 16, v10
    v_and_b32 v153, 0xffff0000, v10
    v_mul_f32 v152, v152, v160
    v_mul_f32 v153, v153, v160
    v_cvt_pk_bf16_f32 v10, v152, v153
    v_lshlrev_b32 v152, 16, v10
    v_and_b32 v153, 0xffff0000, v10
    v_cvt_pk_bf16_f32 v10, v154, v155
    v_lshlrev_b32 v154, 16, v10
    v_and_b32 v155, 0xffff0000, v10
    v_mul_f32 v154, v154, v160
    v_mul_f32 v155, v155, v160
    v_cvt_pk_bf16_f32 v10, v154, v155
    v_lshlrev_b32 v154, 16, v10
    v_and_b32 v155, 0xffff0000, v10
    v_cvt_pk_bf16_f32 v10, v156, v157
    v_lshlrev_b32 v156, 16, v10
    v_and_b32 v157, 0xffff0000, v10
    v_mul_f32 v156, v156, v160
    v_mul_f32 v157, v157, v160
    v_cvt_pk_bf16_f32 v10, v156, v157
    v_lshlrev_b32 v156, 16, v10
    v_and_b32 v157, 0xffff0000, v10
    v_cvt_pk_bf16_f32 v10, v158, v159
    v_lshlrev_b32 v158, 16, v10
    v_and_b32 v159, 0xffff0000, v10
    v_mul_f32 v158, v158, v160
    v_mul_f32 v159, v159, v160
    v_cvt_pk_bf16_f32 v10, v158, v159
    v_lshlrev_b32 v158, 16, v10
    v_and_b32 v159, 0xffff0000, v10
    v_cmp_gt_u32 vcc, 2, v5
    v_cndmask_b32 v148, v7, v148, vcc
    v_cndmask_b32 v149, v7, v149, vcc
    v_cndmask_b32 v150, v7, v150, vcc
    v_cndmask_b32 v151, v7, v151, vcc
    v_cmp_le_i32 vcc, 0, v6
    v_cndmask_b32 v156, v7, v156, vcc
    v_cmp_le_i32 vcc, 1, v6
    v_cndmask_b32 v157, v7, v157, vcc
    v_cmp_le_i32 vcc, 2, v6
    v_cndmask_b32 v158, v7, v158, vcc
    v_cmp_le_i32 vcc, 3, v6
    v_cndmask_b32 v159, v7, v159, vcc
    v_max3_f32 v11, v148, v149, v150
    v_max3_f32 v11, v11, v151, v152
    v_max3_f32 v11, v11, v153, v154
    v_max3_f32 v11, v11, v155, v156
    v_max3_f32 v11, v11, v157, v158
    v_max_f32 v11, v11, v159
    v_mov_b32 v12, v11
    s_nop 1
    v_permlane16_swap_b32 v11, v12
    s_nop 1
    v_max_f32 v11, v11, v12
    v_mov_b32 v12, v11
    s_nop 1
    v_permlane32_swap_b32 v11, v12
    s_nop 1
    v_max_f32 v11, v11, v12
    v_mul_f32 v11, v11, v161
    v_fma_f32 v148, v148, v161, -v11
    v_exp_f32 v148, v148
    v_fma_f32 v149, v149, v161, -v11
    v_exp_f32 v149, v149
    v_fma_f32 v150, v150, v161, -v11
    v_exp_f32 v150, v150
    v_fma_f32 v151, v151, v161, -v11
    v_exp_f32 v151, v151
    v_fma_f32 v152, v152, v161, -v11
    v_exp_f32 v152, v152
    v_fma_f32 v153, v153, v161, -v11
    v_exp_f32 v153, v153
    v_fma_f32 v154, v154, v161, -v11
    v_exp_f32 v154, v154
    v_fma_f32 v155, v155, v161, -v11
    v_exp_f32 v155, v155
    v_fma_f32 v156, v156, v161, -v11
    v_exp_f32 v156, v156
    v_fma_f32 v157, v157, v161, -v11
    v_exp_f32 v157, v157
    v_fma_f32 v158, v158, v161, -v11
    v_exp_f32 v158, v158
    v_fma_f32 v159, v159, v161, -v11
    v_exp_f32 v159, v159
    s_nop 0
    v_add_f32 v12, v148, v149
    v_add_f32 v12, v12, v150
    v_add_f32 v12, v12, v151
    v_add_f32 v12, v12, v152
    v_add_f32 v12, v12, v153
    v_add_f32 v12, v12, v154
    v_add_f32 v12, v12, v155
    v_add_f32 v12, v12, v156
    v_add_f32 v12, v12, v157
    v_add_f32 v12, v12, v158
    v_add_f32 v12, v12, v159
    v_mov_b32 v13, v12
    s_nop 1
    v_permlane16_swap_b32 v12, v13
    s_nop 1
    v_add_f32 v12, v12, v13
    v_mov_b32 v13, v12
    s_nop 1
    v_permlane32_swap_b32 v12, v13
    s_nop 1
    v_add_f32 v12, v12, v13
    v_rcp_f32 v12, v12
    s_nop 0
    v_mul_f32 v148, v148, v12
    v_mul_f32 v149, v149, v12
    v_mul_f32 v150, v150, v12
    v_mul_f32 v151, v151, v12
    v_mul_f32 v152, v152, v12
    v_mul_f32 v153, v153, v12
    v_mul_f32 v154, v154, v12
    v_mul_f32 v155, v155, v12
    v_mul_f32 v156, v156, v12
    v_mul_f32 v157, v157, v12
    v_mul_f32 v158, v158, v12
    v_mul_f32 v159, v159, v12
    v_cvt_pk_bf16_f32 v172, v152, v153
    v_cvt_pk_bf16_f32 v173, v154, v155
    v_cvt_pk_bf16_f32 v174, v156, v157
    v_cvt_pk_bf16_f32 v175, v158, v159
    v_cvt_pk_bf16_f32 v176, v148, v149
    v_cvt_pk_bf16_f32 v177, v150, v151
    buffer_store_dwordx4 v[172:175], v2, s[4:7], s24 offen sc1
    s_mov_b32 exec_hi, 0
    buffer_store_dwordx2 v[176:177], v8, s[4:7], s25 offen sc1
    s_mov_b64 exec, -1
    s_add_u32 s24, s24, 32768
    s_add_u32 s25, s25, 8192
    s_add_u32 s73, s73, 2
    s_cmp_eq_u32 s79, 0
    s_cbranch_scc1 L_e1_nd
    s_cmp_lt_u32 s21, 2
    s_cbranch_scc1 L_e1_nd
    s_sub_u32 s73, s21, 2
    s_mov_b32 s75, 4
L_e1_nd:
    s_cmp_lg_u32 s20, 0
    s_cbranch_scc1 L_e1_f1
    s_min_u32 s60, s73, 63
    v_lshlrev_b32 v12, 2, v1
    s_lshl_b32 s61, s60, 9
    s_lshl_b32 s62, s74, 6
    s_add_u32 s61, s61, s62
    s_add_u32 s61, s61, 250859520
    v_and_b32 v14, 3, v1
    v_cmp_ne_u32 vcc, 0, v14
    v_cndmask_b32 v14, 0, 1, vcc
    v_cmp_gt_u32 vcc, 16, v1
    v_cndmask_b32 v14, 0, v14, vcc
    v_add_u32 v12, s61, v12
    v_mov_b32 v15, 250890244
    v_cmp_eq_u32 vcc, 62, v1
    v_cndmask_b32 v12, v12, v15, vcc
    buffer_load_dword v13, v12, s[4:7], 0 offen sc1
    s_waitcnt vmcnt(0)
    v_cmp_lt_u32 vcc, v13, v14
    s_cmp_eq_u64 vcc, 0
    s_cselect_b32 s60, 1, 0
    v_mov_b32 v15, s60
    v_mov_b32 v12, 49152
    ds_write_b32 v12, v15
    s_waitcnt lgkmcnt(0)
    s_barrier
    s_lshl_b32 s22, s21, 8
    s_lshl_b32 s23, s74, 2
    s_add_u32 s22, s22, s23
    s_add_u32 s22, s22, 250826752
    v_mov_b32 v4, 1
    v_mov_b32 v5, 0
    s_mov_b64 exec, 1
    buffer_store_dword v4, v5, s[4:7], s22 offen sc1
    s_mov_b64 exec, -1
    s_branch L_e1_f2
L_e1_f1:
    s_waitcnt vmcnt(0)
    s_barrier
L_e1_f2:
    s_cmp_lg_u32 s75, 0
    s_cbranch_scc1 L_post_disp2
    v_mov_b32 v12, 49152
    ds_read_b32 v15, v12
    s_waitcnt lgkmcnt(0)
    v_readfirstlane_b32 s77, v15
    s_branch L_e1_loop
L_pe_1:
    s_cmp_lg_u32 s20, 0
    s_cbranch_scc1 L_e2_ec
    s_min_u32 s60, s73, 63
    v_lshlrev_b32 v12, 2, v1
    s_lshl_b32 s61, s60, 8
    s_add_u32 s61, s61, 250826752
    v_subrev_u32 v14, 0, v1
    v_cmp_gt_u32 vcc, 8, v14
    v_cndmask_b32 v14, 0, 1, vcc
    s_add_u32 s62, s60, 1
    s_lshl_b32 s62, s62, 9
    s_add_u32 s62, s62, 250859524
    s_sub_u32 s62, s62, s61
    s_cmp_eq_u32 s60, 63
    s_cselect_b32 s62, 0, s62
    s_cselect_b32 s63, 0, 1
    v_mov_b32 v15, s62
    v_cmp_eq_u32 vcc, 63, v1
    v_cndmask_b32 v12, v12, v15, vcc
    v_mov_b32 v15, s63
    v_cndmask_b32 v14, v14, v15, vcc
    v_add_u32 v12, s61, v12
    v_mov_b32 v15, 250890244
    v_cmp_eq_u32 vcc, 62, v1
    v_cndmask_b32 v12, v12, v15, vcc
    buffer_load_dword v13, v12, s[4:7], 0 offen sc1
    s_waitcnt vmcnt(0)
    v_cmp_lt_u32 vcc, v13, v14
    s_cmp_eq_u64 vcc, 0
    s_cselect_b32 s60, 1, 0
    v_mov_b32 v15, s60
    v_mov_b32 v12, 49152
    ds_write_b32 v12, v15
    s_waitcnt lgkmcnt(0)
L_e2_ec:
    s_barrier
    v_mov_b32 v12, 49152
    ds_read_b32 v15, v12
    s_waitcnt lgkmcnt(0)
    v_readfirstlane_b32 s77, v15
L_e2_loop:
    s_cmp_ge_u32 s73, 64
    s_cbranch_scc1 L_post_out
    s_cmp_eq_u32 s76, 0
    s_cbranch_scc1 L_e2_go
    s_cmp_eq_u32 s77, 0
    s_cbranch_scc1 L_w_next
    s_cmp_eq_u32 s78, 0
    s_cbranch_scc1 L_w_next
    s_sub_u32 s78, s78, 1
L_e2_go:
    s_mov_b32 s21, s73
    s_cmp_lg_u32 s77, 0
    s_cbranch_scc1 L_e2_safe
    s_and_b32 s22, s73, 3
    s_cmp_eq_u32 s73, 1
    s_cselect_b32 s22, 0, s22
    s_cmp_lg_u32 s22, 0
    s_cbranch_scc1 L_e2_safe
    s_cmp_lg_u32 s20, 0
    s_cbranch_scc1 L_e2_sq2
    s_mov_b32 s42, 0
L_e2_sq:
    s_min_u32 s60, s73, 63
    v_lshlrev_b32 v12, 2, v1
    s_lshl_b32 s61, s60, 8
    s_add_u32 s61, s61, 250826752
    v_subrev_u32 v14, 0, v1
    v_cmp_gt_u32 vcc, 8, v14
    v_cndmask_b32 v14, 0, 1, vcc
    s_add_u32 s62, s60, 1
    s_lshl_b32 s62, s62, 9
    s_add_u32 s62, s62, 250859524
    s_sub_u32 s62, s62, s61
    s_cmp_eq_u32 s60, 63
    s_cselect_b32 s62, 0, s62
    s_cselect_b32 s63, 0, 1
    v_mov_b32 v15, s62
    v_cmp_eq_u32 vcc, 63, v1
    v_cndmask_b32 v12, v12, v15, vcc
    v_mov_b32 v15, s63
    v_cndmask_b32 v14, v14, v15, vcc
    v_add_u32 v12, s61, v12
    v_mov_b32 v15, 250890244
    v_cmp_eq_u32 vcc, 62, v1
    v_cndmask_b32 v12, v12, v15, vcc
    buffer_load_dword v13, v12, s[4:7], 0 offen sc1
    s_waitcnt vmcnt(0)
    v_cmp_lt_u32 vcc, v13, v14
    s_cbranch_vccz L_e2_sq2
    v_readlane_b32 s43, v13, 62
    s_cmp_lg_u32 s43, 0
    s_cbranch_scc1 L_e2_sq_nd
    s_mov_b32 s43, 10
L_e2_sq_dl:
    s_nop 15
    s_nop 15
    s_nop 15
    s_nop 15
    s_nop 15
    s_nop 15
    s_nop 15
    s_nop 15
    s_sub_u32 s43, s43, 1
    s_cmp_lg_u32 s43, 0
    s_cbranch_scc1 L_e2_sq_dl
L_e2_sq_nd:
    s_add_u32 s42, s42, 1
    s_cmp_lt_u32 s42, s44
    s_cbranch_scc1 L_e2_sq
    s_mov_b32 s44, 0
L_e2_sq2:
    s_barrier
    s_mov_b32 s77, 1
L_e2_safe:
    s_lshl_b32 s26, s74, 2
    s_lshl_b32 s24, s21, 5
    s_lshl_b32 s25, s20, 3
    s_add_u32 s24, s24, s25
    s_mul_i32 s34, s24, 40
    s_add_u32 s34, s34, s26
    s_lshl_b32 s34, s34, 10
    s_add_u32 s34, s34, 90394624
    s_add_u32 s28, s34, 0
    buffer_load_dwordx4 a[0:3], v2, s[4:7], s28 offen
    s_add_u32 s28, s34, 1024
    buffer_load_dwordx4 a[4:7], v2, s[4:7], s28 offen
    s_add_u32 s28, s34, 2048
    buffer_load_dwordx4 a[8:11], v2, s[4:7], s28 offen
    s_add_u32 s28, s34, 3072
    buffer_load_dwordx4 a[12:15], v2, s[4:7], s28 offen
    s_add_u32 s28, s34, 40960
    buffer_load_dwordx4 a[16:19], v2, s[4:7], s28 offen
    s_add_u32 s28, s34, 41984
    buffer_load_dwordx4 a[20:23], v2, s[4:7], s28 offen
    s_add_u32 s28, s34, 43008
    buffer_load_dwordx4 a[24:27], v2, s[4:7], s28 offen
    s_add_u32 s28, s34, 44032
    buffer_load_dwordx4 a[28:31], v2, s[4:7], s28 offen
    s_add_u32 s28, s34, 81920
    buffer_load_dwordx4 a[32:35], v2, s[4:7], s28 offen
    s_add_u32 s28, s34, 82944
    buffer_load_dwordx4 a[36:39], v2, s[4:7], s28 offen
    s_add_u32 s28, s34, 83968
    buffer_load_dwordx4 a[40:43], v2, s[4:7], s28 offen
    s_add_u32 s28, s34, 84992
    buffer_load_dwordx4 a[44:47], v2, s[4:7], s28 offen
    s_add_u32 s28, s34, 122880
    buffer_load_dwordx4 a[48:51], v2, s[4:7], s28 offen
    s_add_u32 s28, s34, 123904
    buffer_load_dwordx4 a[52:55], v2, s[4:7], s28 offen
    s_add_u32 s28, s34, 124928
    buffer_load_dwordx4 a[56:59], v2, s[4:7], s28 offen
    s_add_u32 s28, s34, 125952
    buffer_load_dwordx4 a[60:63], v2, s[4:7], s28 offen
    s_add_u32 s28, s34, 163840
    buffer_load_dwordx4 a[64:67], v2, s[4:7], s28 offen
    s_add_u32 s28, s34, 164864
    buffer_load_dwordx4 a[68:71], v2, s[4:7], s28 offen
    s_add_u32 s28, s34, 165888
    buffer_load_dwordx4 a[72:75], v2, s[4:7], s28 offen
    s_add_u32 s28, s34, 166912
    buffer_load_dwordx4 a[76:79], v2, s[4:7], s28 offen
    s_add_u32 s28, s34, 204800
    buffer_load_dwordx4 a[80:83], v2, s[4:7], s28 offen
    s_add_u32 s28, s34, 205824
    buffer_load_dwordx4 a[84:87], v2, s[4:7], s28 offen
    s_add_u32 s28, s34, 206848
    buffer_load_dwordx4 a[88:91], v2, s[4:7], s28 offen
    s_add_u32 s28, s34, 207872
    buffer_load_dwordx4 a[92:95], v2, s[4:7], s28 offen
    s_add_u32 s28, s34, 245760
    buffer_load_dwordx4 a[96:99], v2, s[4:7], s28 offen
    s_add_u32 s28, s34, 246784
    buffer_load_dwordx4 a[100:103], v2, s[4:7], s28 offen
    s_add_u32 s28, s34, 247808
    buffer_load_dwordx4 a[104:107], v2, s[4:7], s28 offen
    s_add_u32 s28, s34, 248832
    buffer_load_dwordx4 a[108:111], v2, s[4:7], s28 offen
    s_add_u32 s28, s34, 286720
    buffer_load_dwordx4 a[112:115], v2, s[4:7], s28 offen
    s_add_u32 s28, s34, 287744
    buffer_load_dwordx4 a[116:119], v2, s[4:7], s28 offen
    s_add_u32 s28, s34, 288768
    buffer_load_dwordx4 a[120:123], v2, s[4:7], s28 offen
    s_add_u32 s28, s34, 289792
    buffer_load_dwordx4 a[124:127], v2, s[4:7], s28 offen
    s_add_u32 s30, s26, s20
    s_lshl_b32 s31, s21, 5
    v_and_b32 v9, 15, v1
    v_lshrrev_b32 v8, 4, v1
    v_lshlrev_b32 v8, 3, v8
    s_lshl_b32 s32, s30, 5
    v_add_u32 v8, s32, v8
    v_mul_u32_u24 v9, 1280, v9
    v_add_u32 v9, v9, v8
    s_mul_i32 s33, s31, 1280
    s_mov_b32 s32, 2560
    buffer_load_dwordx2 v[24:25], v8, s[4:7], s32 offen
    buffer_load_dwordx2 v[28:29], v9, s[8:11], s33 offen
    s_add_u32 s32, s33, 20480
    buffer_load_dwordx2 v[36:37], v9, s[8:11], s32 offen
    s_cmp_lg_u32 s21, 63
    s_cbranch_scc1 L_e2_nov
    s_add_u32 s60, s21, 2
    s_min_u32 s60, s60, 64
    s_mul_i32 s61, s60, 10240
    s_add_u32 s61, s61, 8192
    s_mul_i32 s62, s20, 2560
    s_add_u32 s61, s61, s62
    v_mov_b32 v12, 0
    v_mov_b32 v13, 0
    v_mov_b32 v14, 0
    v_mov_b32 v15, 0
    s_mov_b32 s42, 0
L_e2v_m:
    buffer_load_dwordx4 v[4:7], v2, s[4:7], s61 offen sc1
    buffer_load_dwordx4 v[8:11], v2, s[4:7], s61 offen offset:1024 sc1
    s_mov_b32 exec_hi, 0
    buffer_load_dwordx4 v[12:15], v2, s[4:7], s61 offen offset:2048 sc1
    s_mov_b64 exec, -1
    s_waitcnt vmcnt(0)
    v_max3_u32 v3, v4, v5, v6
    v_max3_u32 v3, v3, v7, v8
    v_max3_u32 v3, v3, v9, v10
    v_max3_u32 v3, v3, v11, v12
    v_max3_u32 v3, v3, v13, v14
    v_max_u32 v3, v3, v15
    v_cmp_eq_u32 vcc, -1, v3
    s_cbranch_vccz L_e2v_mok
    s_add_u32 s42, s42, 1
    s_cmp_lt_u32 s42, s44
    s_cbranch_scc1 L_e2v_m
    s_mov_b32 s44, 0
L_e2v_mok:
    s_barrier
L_e2_nov:
    s_cmp_lg_u32 s77, 0
    s_cbranch_scc1 L_e2_rdy
    s_cmp_lg_u32 s20, 0
    s_cbranch_scc1 L_e2_sp2
    s_mov_b32 s42, 0
L_e2_sp:
    s_min_u32 s60, s73, 63
    v_lshlrev_b32 v12, 2, v1
    s_lshl_b32 s61, s60, 8
    s_add_u32 s61, s61, 250826752
    v_subrev_u32 v14, 0, v1
    v_cmp_gt_u32 vcc, 8, v14
    v_cndmask_b32 v14, 0, 1, vcc
    s_add_u32 s62, s60, 1
    s_lshl_b32 s62, s62, 9
    s_add_u32 s62, s62, 250859524
    s_sub_u32 s62, s62, s61
    s_cmp_eq_u32 s60, 63
    s_cselect_b32 s62, 0, s62
    s_cselect_b32 s63, 0, 1
    v_mov_b32 v15, s62
    v_cmp_eq_u32 vcc, 63, v1
    v_cndmask_b32 v12, v12, v15, vcc
    v_mov_b32 v15, s63
    v_cndmask_b32 v14, v14, v15, vcc
    v_add_u32 v12, s61, v12
    v_mov_b32 v15, 250890244
    v_cmp_eq_u32 vcc, 62, v1
    v_cndmask_b32 v12, v12, v15, vcc
    buffer_load_dword v13, v12, s[4:7], 0 offen sc1
    s_waitcnt vmcnt(0)
    v_cmp_lt_u32 vcc, v13, v14
    s_cbranch_vccz L_e2_sp2
    v_readlane_b32 s43, v13, 62
    s_cmp_lg_u32 s43, 0
    s_cbranch_scc1 L_e2_sp_nd
    s_mov_b32 s43, 10
L_e2_sp_dl:
    s_nop 15
    s_nop 15
    s_nop 15
    s_nop 15
    s_nop 15
    s_nop 15
    s_nop 15
    s_nop 15
    s_sub_u32 s43, s43, 1
    s_cmp_lg_u32 s43, 0
    s_cbranch_scc1 L_e2_sp_dl
L_e2_sp_nd:
    s_add_u32 s42, s42, 1
    s_cmp_lt_u32 s42, s44
    s_cbranch_scc1 L_e2_sp
    s_mov_b32 s44, 0
L_e2_sp2:
    s_barrier
L_e2_rdy:
    v_and_b32 v9, 15, v1
    v_lshrrev_b32 v8, 4, v1
    v_lshlrev_b32 v8, 3, v8
    s_lshl_b32 s32, s30, 5
    v_add_u32 v8, s32, v8
    v_mul_u32_u24 v9, 1280, v9
    v_add_u32 v9, v9, v8
    s_mul_i32 s33, s31, 1280
    s_lshl_b32 s35, s21, 6
    s_lshl_b32 s25, s20, 3
    s_add_u32 s35, s35, s25
    s_lshl_b32 s35, s35, 10
    s_add_u32 s35, s35, 234049536
    s_lshl_b32 s37, s21, 4
    s_lshl_b32 s25, s20, 1
    s_add_u32 s37, s37, s25
    s_lshl_b32 s37, s37, 10
    s_add_u32 s37, s37, 238243840
    s_lshl_b32 s24, s21, 3
    s_add_u32 s24, s24, s25
    s_mul_i32 s36, s24, 40
    s_add_u32 s36, s36, s26
    s_lshl_b32 s36, s36, 10
    s_add_u32 s36, s36, 213078016
    s_add_u32 s28, s35, 0
    buffer_load_dwordx4 a[128:131], v2, s[4:7], s28 offen
    s_add_u32 s28, s35, 32768
    buffer_load_dwordx4 a[132:135], v2, s[4:7], s28 offen
    s_add_u32 s28, s35, 1024
    buffer_load_dwordx4 a[136:139], v2, s[4:7], s28 offen
    s_add_u32 s28, s35, 33792
    buffer_load_dwordx4 a[140:143], v2, s[4:7], s28 offen
    s_add_u32 s28, s35, 2048
    buffer_load_dwordx4 a[144:147], v2, s[4:7], s28 offen
    s_add_u32 s28, s35, 34816
    buffer_load_dwordx4 a[148:151], v2, s[4:7], s28 offen
    s_add_u32 s28, s35, 3072
    buffer_load_dwordx4 a[152:155], v2, s[4:7], s28 offen
    s_add_u32 s28, s35, 35840
    buffer_load_dwordx4 a[156:159], v2, s[4:7], s28 offen
    s_add_u32 s28, s35, 4096
    buffer_load_dwordx4 a[160:163], v2, s[4:7], s28 offen
    s_add_u32 s28, s35, 36864
    buffer_load_dwordx4 a[164:167], v2, s[4:7], s28 offen
    s_add_u32 s28, s35, 5120
    buffer_load_dwordx4 a[168:171], v2, s[4:7], s28 offen
    s_add_u32 s28, s35, 37888
    buffer_load_dwordx4 a[172:175], v2, s[4:7], s28 offen
    s_add_u32 s28, s35, 6144
    buffer_load_dwordx4 a[176:179], v2, s[4:7], s28 offen
    s_add_u32 s28, s35, 38912
    buffer_load_dwordx4 a[180:183], v2, s[4:7], s28 offen
    s_add_u32 s28, s35, 7168
    buffer_load_dwordx4 a[184:187], v2, s[4:7], s28 offen
    s_add_u32 s28, s35, 39936
    buffer_load_dwordx4 a[188:191], v2, s[4:7], s28 offen
    s_add_u32 s28, s36, 0
    buffer_load_dwordx4 a[192:195], v2, s[4:7], s28 offen
    s_add_u32 s28, s36, 1024
    buffer_load_dwordx4 a[196:199], v2, s[4:7], s28 offen
    s_add_u32 s28, s36, 2048
    buffer_load_dwordx4 a[200:203], v2, s[4:7], s28 offen
    s_add_u32 s28, s36, 3072
    buffer_load_dwordx4 a[204:207], v2, s[4:7], s28 offen
    s_add_u32 s28, s37, 0
    buffer_load_dwordx4 a[224:227], v2, s[4:7], s28 offen
    s_add_u32 s28, s37, 8192
    buffer_load_dwordx4 a[228:231], v2, s[4:7], s28 offen
    s_add_u32 s28, s36, 40960
    buffer_load_dwordx4 a[208:211], v2, s[4:7], s28 offen
    s_add_u32 s28, s36, 41984
    buffer_load_dwordx4 a[212:215], v2, s[4:7], s28 offen
    s_add_u32 s28, s36, 43008
    buffer_load_dwordx4 a[216:219], v2, s[4:7], s28 offen
    s_add_u32 s28, s36, 44032
    buffer_load_dwordx4 a[220:223], v2, s[4:7], s28 offen
    s_add_u32 s28, s37, 1024
    buffer_load_dwordx4 a[232:235], v2, s[4:7], s28 offen
    s_add_u32 s28, s37, 9216
    buffer_load_dwordx4 a[236:239], v2, s[4:7], s28 offen
    s_waitcnt vmcnt(26)
    v_mfma_f32_16x16x32_bf16 v[64:67], a[0:3], a[128:131], 0
    v_mfma_f32_16x16x32_bf16 v[68:71], a[0:3], a[132:135], 0
    v_mfma_f32_16x16x32_bf16 v[72:75], a[4:7], a[128:131], 0
    v_mfma_f32_16x16x32_bf16 v[76:79], a[4:7], a[132:135], 0
    v_mfma_f32_16x16x32_bf16 v[80:83], a[8:11], a[128:131], 0
    v_mfma_f32_16x16x32_bf16 v[84:87], a[8:11], a[132:135], 0
    v_mfma_f32_16x16x32_bf16 v[88:91], a[12:15], a[128:131], 0
    v_mfma_f32_16x16x32_bf16 v[92:95], a[12:15], a[132:135], 0
    s_waitcnt vmcnt(24)
    v_mfma_f32_16x16x32_bf16 v[64:67], a[16:19], a[136:139], v[64:67]
    v_mfma_f32_16x16x32_bf16 v[68:71], a[16:19], a[140:143], v[68:71]
    v_mfma_f32_16x16x32_bf16 v[72:75], a[20:23], a[136:139], v[72:75]
    v_mfma_f32_16x16x32_bf16 v[76:79], a[20:23], a[140:143], v[76:79]
    v_mfma_f32_16x16x32_bf16 v[80:83], a[24:27], a[136:139], v[80:83]
    v_mfma_f32_16x16x32_bf16 v[84:87], a[24:27], a[140:143], v[84:87]
    v_mfma_f32_16x16x32_bf16 v[88:91], a[28:31], a[136:139], v[88:91]
    v_mfma_f32_16x16x32_bf16 v[92:95], a[28:31], a[140:143], v[92:95]
    s_waitcnt vmcnt(22)
    v_mfma_f32_16x16x32_bf16 v[64:67], a[32:35], a[144:147], v[64:67]
    v_mfma_f32_16x16x32_bf16 v[68:71], a[32:35], a[148:151], v[68:71]
    v_mfma_f32_16x16x32_bf16 v[72:75], a[36:39], a[144:147], v[72:75]
    v_mfma_f32_16x16x32_bf16 v[76:79], a[36:39], a[148:151], v[76:79]
    v_mfma_f32_16x16x32_bf16 v[80:83], a[40:43], a[144:147], v[80:83]
    v_mfma_f32_16x16x32_bf16 v[84:87], a[40:43], a[148:151], v[84:87]
    v_mfma_f32_16x16x32_bf16 v[88:91], a[44:47], a[144:147], v[88:91]
    v_mfma_f32_16x16x32_bf16 v[92:95], a[44:47], a[148:151], v[92:95]
    s_waitcnt vmcnt(20)
    v_mfma_f32_16x16x32_bf16 v[64:67], a[48:51], a[152:155], v[64:67]
    v_mfma_f32_16x16x32_bf16 v[68:71], a[48:51], a[156:159], v[68:71]
    v_mfma_f32_16x16x32_bf16 v[72:75], a[52:55], a[152:155], v[72:75]
    v_mfma_f32_16x16x32_bf16 v[76:79], a[52:55], a[156:159], v[76:79]
    v_mfma_f32_16x16x32_bf16 v[80:83], a[56:59], a[152:155], v[80:83]
    v_mfma_f32_16x16x32_bf16 v[84:87], a[56:59], a[156:159], v[84:87]
    v_mfma_f32_16x16x32_bf16 v[88:91], a[60:63], a[152:155], v[88:91]
    v_mfma_f32_16x16x32_bf16 v[92:95], a[60:63], a[156:159], v[92:95]
    s_waitcnt vmcnt(18)
    v_mfma_f32_16x16x32_bf16 v[64:67], a[64:67], a[160:163], v[64:67]
    v_mfma_f32_16x16x32_bf16 v[68:71], a[64:67], a[164:167], v[68:71]
    v_mfma_f32_16x16x32_bf16 v[72:75], a[68:71], a[160:163], v[72:75]
    v_mfma_f32_16x16x32_bf16 v[76:79], a[68:71], a[164:167], v[76:79]
    v_mfma_f32_16x16x32_bf16 v[80:83], a[72:75], a[160:163], v[80:83]
    v_mfma_f32_16x16x32_bf16 v[84:87], a[72:75], a[164:167], v[84:87]
    v_mfma_f32_16x16x32_bf16 v[88:91], a[76:79], a[160:163], v[88:91]
    v_mfma_f32_16x16x32_bf16 v[92:95], a[76:79], a[164:167], v[92:95]
    s_waitcnt vmcnt(16)
    v_mfma_f32_16x16x32_bf16 v[64:67], a[80:83], a[168:171], v[64:67]
    v_mfma_f32_16x16x32_bf16 v[68:71], a[80:83], a[172:175], v[68:71]
    v_mfma_f32_16x16x32_bf16 v[72:75], a[84:87], a[168:171], v[72:75]
    v_mfma_f32_16x16x32_bf16 v[76:79], a[84:87], a[172:175], v[76:79]
    v_mfma_f32_16x16x32_bf16 v[80:83], a[88:91], a[168:171], v[80:83]
    v_mfma_f32_16x16x32_bf16 v[84:87], a[88:91], a[172:175], v[84:87]
    v_mfma_f32_16x16x32_bf16 v[88:91], a[92:95], a[168:171], v[88:91]
    v_mfma_f32_16x16x32_bf16 v[92:95], a[92:95], a[172:175], v[92:95]
    s_waitcnt vmcnt(14)
    v_mfma_f32_16x16x32_bf16 v[64:67], a[96:99], a[176:179], v[64:67]
    v_mfma_f32_16x16x32_bf16 v[68:71], a[96:99], a[180:183], v[68:71]
    v_mfma_f32_16x16x32_bf16 v[72:75], a[100:103], a[176:179], v[72:75]
    v_mfma_f32_16x16x32_bf16 v[76:79], a[100:103], a[180:183], v[76:79]
    v_mfma_f32_16x16x32_bf16 v[80:83], a[104:107], a[176:179], v[80:83]
    v_mfma_f32_16x16x32_bf16 v[84:87], a[104:107], a[180:183], v[84:87]
    v_mfma_f32_16x16x32_bf16 v[88:91], a[108:111], a[176:179], v[88:91]
    v_mfma_f32_16x16x32_bf16 v[92:95], a[108:111], a[180:183], v[92:95]
    s_waitcnt vmcnt(12)
    v_mfma_f32_16x16x32_bf16 v[64:67], a[112:115], a[184:187], v[64:67]
    v_mfma_f32_16x16x32_bf16 v[68:71], a[112:115], a[188:191], v[68:71]
    v_mfma_f32_16x16x32_bf16 v[72:75], a[116:119], a[184:187], v[72:75]
    v_mfma_f32_16x16x32_bf16 v[76:79], a[116:119], a[188:191], v[76:79]
    v_mfma_f32_16x16x32_bf16 v[80:83], a[120:123], a[184:187], v[80:83]
    v_mfma_f32_16x16x32_bf16 v[84:87], a[120:123], a[188:191], v[84:87]
    v_mfma_f32_16x16x32_bf16 v[88:91], a[124:127], a[184:187], v[88:91]
    v_mfma_f32_16x16x32_bf16 v[92:95], a[124:127], a[188:191], v[92:95]
    s_waitcnt vmcnt(6)
    v_mfma_f32_16x16x32_bf16 v[64:67], a[192:195], a[224:227], v[64:67]
    v_mfma_f32_16x16x32_bf16 v[68:71], a[192:195], a[228:231], v[68:71]
    v_mfma_f32_16x16x32_bf16 v[72:75], a[196:199], a[224:227], v[72:75]
    v_mfma_f32_16x16x32_bf16 v[76:79], a[196:199], a[228:231], v[76:79]
    v_mfma_f32_16x16x32_bf16 v[80:83], a[200:203], a[224:227], v[80:83]
    v_mfma_f32_16x16x32_bf16 v[84:87], a[200:203], a[228:231], v[84:87]
    v_mfma_f32_16x16x32_bf16 v[88:91], a[204:207], a[224:227], v[88:91]
    v_mfma_f32_16x16x32_bf16 v[92:95], a[204:207], a[228:231], v[92:95]
    s_waitcnt vmcnt(0)
    v_mfma_f32_16x16x32_bf16 v[64:67], a[208:211], a[232:235], v[64:67]
    v_mfma_f32_16x16x32_bf16 v[68:71], a[208:211], a[236:239], v[68:71]
    v_mfma_f32_16x16x32_bf16 v[72:75], a[212:215], a[232:235], v[72:75]
    v_mfma_f32_16x16x32_bf16 v[76:79], a[212:215], a[236:239], v[76:79]
    v_mfma_f32_16x16x32_bf16 v[80:83], a[216:219], a[232:235], v[80:83]
    v_mfma_f32_16x16x32_bf16 v[84:87], a[216:219], a[236:239], v[84:87]
    v_mfma_f32_16x16x32_bf16 v[88:91], a[220:223], a[232:235], v[88:91]
    v_mfma_f32_16x16x32_bf16 v[92:95], a[220:223], a[236:239], v[92:95]
    s_nop 7
    s_nop 3
    s_mul_i32 s28, s20, 8192
    v_add_u32 v4, s28, v2
    ds_write_b128 v4, v[64:67] offset:0
    ds_write_b128 v4, v[68:71] offset:1024
    ds_write_b128 v4, v[72:75] offset:2048
    ds_write_b128 v4, v[76:79] offset:3072
    ds_write_b128 v4, v[80:83] offset:4096
    ds_write_b128 v4, v[84:87] offset:5120
    ds_write_b128 v4, v[88:91] offset:6144
    ds_write_b128 v4, v[92:95] offset:7168
    s_waitcnt lgkmcnt(0)
    s_barrier
    s_mul_i32 s28, s20, 2048
    v_add_u32 v4, s28, v2
    ds_read_b128 v[64:67], v4 offset:0
    ds_read_b128 v[68:71], v4 offset:8192
    ds_read_b128 v[72:75], v4 offset:16384
    ds_read_b128 v[76:79], v4 offset:24576
    ds_read_b128 v[80:83], v4 offset:1024
    ds_read_b128 v[84:87], v4 offset:9216
    ds_read_b128 v[88:91], v4 offset:17408
    ds_read_b128 v[92:95], v4 offset:25600
    s_waitcnt lgkmcnt(0)
    v_pk_add_f32 v[64:65], v[64:65], v[68:69]
    v_pk_add_f32 v[66:67], v[66:67], v[70:71]
    v_pk_add_f32 v[72:73], v[72:73], v[76:77]
    v_pk_add_f32 v[74:75], v[74:75], v[78:79]
    v_pk_add_f32 v[16:17], v[64:65], v[72:73]
    v_pk_add_f32 v[18:19], v[66:67], v[74:75]
    v_pk_add_f32 v[80:81], v[80:81], v[84:85]
    v_pk_add_f32 v[82:83], v[82:83], v[86:87]
    v_pk_add_f32 v[88:89], v[88:89], v[92:93]
    v_pk_add_f32 v[90:91], v[90:91], v[94:95]
    v_pk_add_f32 v[20:21], v[80:81], v[88:89]
    v_pk_add_f32 v[22:23], v[82:83], v[90:91]
    v_cvt_pk_bf16_f32 v30, v16, v17
    v_lshlrev_b32 v16, 16, v30
    v_and_b32 v17, 0xffff0000, v30
    v_lshlrev_b32 v31, 16, v24
    v_and_b32 v32, 0xffff0000, v24
    v_mul_f32 v16, v16, v31
    v_mul_f32 v17, v17, v32
    v_cvt_pk_bf16_f32 v30, v16, v17
    v_lshlrev_b32 v16, 16, v30
    v_and_b32 v17, 0xffff0000, v30
    v_lshlrev_b32 v31, 16, v28
    v_and_b32 v32, 0xffff0000, v28
    v_add_f32 v16, v16, v31
    v_add_f32 v17, v17, v32
    v_cvt_pk_bf16_f32 v28, v16, v17
    v_cvt_pk_bf16_f32 v30, v18, v19
    v_lshlrev_b32 v18, 16, v30
    v_and_b32 v19, 0xffff0000, v30
    v_lshlrev_b32 v31, 16, v25
    v_and_b32 v32, 0xffff0000, v25
    v_mul_f32 v18, v18, v31
    v_mul_f32 v19, v19, v32
    v_cvt_pk_bf16_f32 v30, v18, v19
    v_lshlrev_b32 v18, 16, v30
    v_and_b32 v19, 0xffff0000, v30
    v_lshlrev_b32 v31, 16, v29
    v_and_b32 v32, 0xffff0000, v29
    v_add_f32 v18, v18, v31
    v_add_f32 v19, v19, v32
    v_cvt_pk_bf16_f32 v29, v18, v19
    s_add_u32 s32, s33, 239292416
    buffer_store_dwordx2 v[28:29], v9, s[4:7], s32 offen sc1
    v_cvt_pk_bf16_f32 v30, v20, v21
    v_lshlrev_b32 v20, 16, v30
    v_and_b32 v21, 0xffff0000, v30
    v_lshlrev_b32 v31, 16, v24
    v_and_b32 v32, 0xffff0000, v24
    v_mul_f32 v20, v20, v31
    v_mul_f32 v21, v21, v32
    v_cvt_pk_bf16_f32 v30, v20, v21
    v_lshlrev_b32 v20, 16, v30
    v_and_b32 v21, 0xffff0000, v30
    v_lshlrev_b32 v31, 16, v36
    v_and_b32 v32, 0xffff0000, v36
    v_add_f32 v20, v20, v31
    v_add_f32 v21, v21, v32
    v_cvt_pk_bf16_f32 v36, v20, v21
    v_cvt_pk_bf16_f32 v30, v22, v23
    v_lshlrev_b32 v22, 16, v30
    v_and_b32 v23, 0xffff0000, v30
    v_lshlrev_b32 v31, 16, v25
    v_and_b32 v32, 0xffff0000, v25
    v_mul_f32 v22, v22, v31
    v_mul_f32 v23, v23, v32
    v_cvt_pk_bf16_f32 v30, v22, v23
    v_lshlrev_b32 v22, 16, v30
    v_and_b32 v23, 0xffff0000, v30
    v_lshlrev_b32 v31, 16, v37
    v_and_b32 v32, 0xffff0000, v37
    v_add_f32 v22, v22, v31
    v_add_f32 v23, v23, v32
    v_cvt_pk_bf16_f32 v37, v22, v23
    s_add_u32 s32, s33, 239312896
    buffer_store_dwordx2 v[36:37], v9, s[4:7], s32 offen sc1
    s_add_u32 s73, s73, 2
    s_cmp_lg_u32 s20, 0
    s_cbranch_scc1 L_e2_f1
    s_min_u32 s60, s73, 63
    v_lshlrev_b32 v12, 2, v1
    s_lshl_b32 s61, s60, 8
    s_add_u32 s61, s61, 250826752
    v_subrev_u32 v14, 0, v1
    v_cmp_gt_u32 vcc, 8, v14
    v_cndmask_b32 v14, 0, 1, vcc
    s_add_u32 s62, s60, 1
    s_lshl_b32 s62, s62, 9
    s_add_u32 s62, s62, 250859524
    s_sub_u32 s62, s62, s61
    s_cmp_eq_u32 s60, 63
    s_cselect_b32 s62, 0, s62
    s_cselect_b32 s63, 0, 1
    v_mov_b32 v15, s62
    v_cmp_eq_u32 vcc, 63, v1
    v_cndmask_b32 v12, v12, v15, vcc
    v_mov_b32 v15, s63
    v_cndmask_b32 v14, v14, v15, vcc
    v_add_u32 v12, s61, v12
    v_mov_b32 v15, 250890244
    v_cmp_eq_u32 vcc, 62, v1
    v_cndmask_b32 v12, v12, v15, vcc
    buffer_load_dword v13, v12, s[4:7], 0 offen sc1
    s_waitcnt vmcnt(0)
    v_cmp_lt_u32 vcc, v13, v14
    s_cmp_eq_u64 vcc, 0
    s_cselect_b32 s60, 1, 0
    v_mov_b32 v15, s60
    v_mov_b32 v12, 49152
    ds_write_b32 v12, v15
    s_waitcnt lgkmcnt(0)
    s_barrier
    s_lshl_b32 s22, s21, 8
    s_lshl_b32 s23, s74, 2
    s_add_u32 s22, s22, s23
    s_add_u32 s22, s22, 250826784
    v_mov_b32 v4, 1
    v_mov_b32 v5, 0
    s_mov_b64 exec, 1
    buffer_store_dword v4, v5, s[4:7], s22 offen sc1
    s_mov_b64 exec, -1
    s_branch L_e2_f2
L_e2_f1:
    s_waitcnt vmcnt(0)
    s_barrier
L_e2_f2:
    v_mov_b32 v12, 49152
    ds_read_b32 v15, v12
    s_waitcnt lgkmcnt(0)
    v_readfirstlane_b32 s77, v15
    s_branch L_e2_loop
L_pe_2:
    s_cmp_lg_u32 s20, 0
    s_cbranch_scc1 L_f1_ec
    s_min_u32 s60, s73, 63
    v_lshlrev_b32 v12, 2, v1
    s_lshl_b32 s61, s60, 8
    s_add_u32 s61, s61, 250826752
    v_subrev_u32 v14, 52, v1
    v_cmp_gt_u32 vcc, 2, v14
    v_cndmask_b32 v14, 0, 1, vcc
    v_add_u32 v12, s61, v12
    v_mov_b32 v15, 250890244
    v_cmp_eq_u32 vcc, 62, v1
    v_cndmask_b32 v12, v12, v15, vcc
    buffer_load_dword v13, v12, s[4:7], 0 offen sc1
    s_waitcnt vmcnt(0)
    v_cmp_lt_u32 vcc, v13, v14
    s_cmp_eq_u64 vcc, 0
    s_cselect_b32 s60, 1, 0
    v_mov_b32 v15, s60
    v_mov_b32 v12, 49152
    ds_write_b32 v12, v15
    s_waitcnt lgkmcnt(0)
L_f1_ec:
    s_barrier
    v_mov_b32 v12, 49152
    ds_read_b32 v15, v12
    s_waitcnt lgkmcnt(0)
    v_readfirstlane_b32 s77, v15
L_f1_loop:
    s_cmp_ge_u32 s73, 64
    s_cbranch_scc1 L_post_out
    s_cmp_eq_u32 s76, 0
    s_cbranch_scc1 L_f1_go
    s_cmp_eq_u32 s77, 0
    s_cbranch_scc1 L_w_next
    s_cmp_eq_u32 s78, 0
    s_cbranch_scc1 L_w_next
    s_sub_u32 s78, s78, 1
L_f1_go:
    s_mov_b32 s21, s73
    s_mul_i32 s25, s20, 5
    s_lshl_b32 s26, s74, 2
    s_mul_i32 s34, s26, 20
    s_add_u32 s34, s34, s25
    s_lshl_b32 s34, s34, 10
    s_add_u32 s34, s34, 36130816
    s_add_u32 s28, s34, 0
    buffer_load_dwordx4 a[0:3], v2, s[4:7], s28 offen
    s_add_u32 s28, s34, 20480
    buffer_load_dwordx4 a[4:7], v2, s[4:7], s28 offen
    s_add_u32 s28, s34, 40960
    buffer_load_dwordx4 a[8:11], v2, s[4:7], s28 offen
    s_add_u32 s28, s34, 61440
    buffer_load_dwordx4 a[12:15], v2, s[4:7], s28 offen
    s_add_u32 s28, s34, 1024
    buffer_load_dwordx4 a[16:19], v2, s[4:7], s28 offen
    s_add_u32 s28, s34, 21504
    buffer_load_dwordx4 a[20:23], v2, s[4:7], s28 offen
    s_add_u32 s28, s34, 41984
    buffer_load_dwordx4 a[24:27], v2, s[4:7], s28 offen
    s_add_u32 s28, s34, 62464
    buffer_load_dwordx4 a[28:31], v2, s[4:7], s28 offen
    s_add_u32 s28, s34, 2048
    buffer_load_dwordx4 a[32:35], v2, s[4:7], s28 offen
    s_add_u32 s28, s34, 22528
    buffer_load_dwordx4 a[36:39], v2, s[4:7], s28 offen
    s_add_u32 s28, s34, 43008
    buffer_load_dwordx4 a[40:43], v2, s[4:7], s28 offen
    s_add_u32 s28, s34, 63488
    buffer_load_dwordx4 a[44:47], v2, s[4:7], s28 offen
    s_add_u32 s28, s34, 3072
    buffer_load_dwordx4 a[48:51], v2, s[4:7], s28 offen
    s_add_u32 s28, s34, 23552
    buffer_load_dwordx4 a[52:55], v2, s[4:7], s28 offen
    s_add_u32 s28, s34, 44032
    buffer_load_dwordx4 a[56:59], v2, s[4:7], s28 offen
    s_add_u32 s28, s34, 64512
    buffer_load_dwordx4 a[60:63], v2, s[4:7], s28 offen
    s_add_u32 s28, s34, 4096
    buffer_load_dwordx4 a[64:67], v2, s[4:7], s28 offen
    s_add_u32 s28, s34, 24576
    buffer_load_dwordx4 a[68:71], v2, s[4:7], s28 offen
    s_add_u32 s28, s34, 45056
    buffer_load_dwordx4 a[72:75], v2, s[4:7], s28 offen
    s_add_u32 s28, s34, 65536
    buffer_load_dwordx4 a[76:79], v2, s[4:7], s28 offen
    v_lshrrev_b32 v10, 4, v1
    v_lshlrev_b32 v8, 3, v10
    s_add_u32 s30, s26, s20
    s_lshl_b32 s31, s30, 5
    v_add_u32 v8, s31, v8
    buffer_load_dwordx2 v[24:25], v8, s[80:83], 0 offen
    s_cmp_lg_u32 s77, 0
    s_cbranch_scc1 L_f1_rdy
    s_cmp_lg_u32 s20, 0
    s_cbranch_scc1 L_f1_sp2
    s_mov_b32 s42, 0
L_f1_sp:
    s_min_u32 s60, s73, 63
    v_lshlrev_b32 v12, 2, v1
    s_lshl_b32 s61, s60, 8
    s_add_u32 s61, s61, 250826752
    v_subrev_u32 v14, 52, v1
    v_cmp_gt_u32 vcc, 2, v14
    v_cndmask_b32 v14, 0, 1, vcc
    v_add_u32 v12, s61, v12
    v_mov_b32 v15, 250890244
    v_cmp_eq_u32 vcc, 62, v1
    v_cndmask_b32 v12, v12, v15, vcc
    buffer_load_dword v13, v12, s[4:7], 0 offen sc1
    s_waitcnt vmcnt(0)
    v_cmp_lt_u32 vcc, v13, v14
    s_cbranch_vccz L_f1_sp2
    v_readlane_b32 s43, v13, 62
    s_cmp_lg_u32 s43, 0
    s_cbranch_scc1 L_f1_sp_nd
    s_mov_b32 s43, 10
L_f1_sp_dl:
    s_nop 15
    s_nop 15
    s_nop 15
    s_nop 15
    s_nop 15
    s_nop 15
    s_nop 15
    s_nop 15
    s_sub_u32 s43, s43, 1
    s_cmp_lg_u32 s43, 0
    s_cbranch_scc1 L_f1_sp_dl
L_f1_sp_nd:
    s_add_u32 s42, s42, 1
    s_cmp_lt_u32 s42, s44
    s_cbranch_scc1 L_f1_sp
    s_mov_b32 s44, 0
L_f1_sp2:
    s_barrier
L_f1_rdy:
    s_mul_i32 s35, s21, 40
    s_add_u32 s35, s35, s25
    s_lshl_b32 s35, s35, 10
    s_add_u32 s35, s35, 241913856
    s_add_u32 s28, s35, 0
    buffer_load_dwordx4 a[80:83], v2, s[4:7], s28 offen
    s_add_u32 s28, s35, 20480
    buffer_load_dwordx4 a[84:87], v2, s[4:7], s28 offen
    s_add_u32 s28, s35, 1024
    buffer_load_dwordx4 a[88:91], v2, s[4:7], s28 offen
    s_add_u32 s28, s35, 21504
    buffer_load_dwordx4 a[92:95], v2, s[4:7], s28 offen
    s_add_u32 s28, s35, 2048
    buffer_load_dwordx4 a[96:99], v2, s[4:7], s28 offen
    s_add_u32 s28, s35, 22528
    buffer_load_dwordx4 a[100:103], v2, s[4:7], s28 offen
    s_add_u32 s28, s35, 3072
    buffer_load_dwordx4 a[104:107], v2, s[4:7], s28 offen
    s_add_u32 s28, s35, 23552
    buffer_load_dwordx4 a[108:111], v2, s[4:7], s28 offen
    s_add_u32 s28, s35, 4096
    buffer_load_dwordx4 a[112:115], v2, s[4:7], s28 offen
    s_add_u32 s28, s35, 24576
    buffer_load_dwordx4 a[116:119], v2, s[4:7], s28 offen
    s_waitcnt vmcnt(8)
    v_mfma_f32_16x16x32_bf16 v[64:67], a[0:3], a[80:83], 0
    v_mfma_f32_16x16x32_bf16 v[68:71], a[0:3], a[84:87], 0
    v_mfma_f32_16x16x32_bf16 v[72:75], a[4:7], a[80:83], 0
    v_mfma_f32_16x16x32_bf16 v[76:79], a[4:7], a[84:87], 0
    v_mfma_f32_16x16x32_bf16 v[80:83], a[8:11], a[80:83], 0
    v_mfma_f32_16x16x32_bf16 v[84:87], a[8:11], a[84:87], 0
    v_mfma_f32_16x16x32_bf16 v[88:91], a[12:15], a[80:83], 0
    v_mfma_f32_16x16x32_bf16 v[92:95], a[12:15], a[84:87], 0
    s_waitcnt vmcnt(6)
    v_mfma_f32_16x16x32_bf16 v[64:67], a[16:19], a[88:91], v[64:67]
    v_mfma_f32_16x16x32_bf16 v[68:71], a[16:19], a[92:95], v[68:71]
    v_mfma_f32_16x16x32_bf16 v[72:75], a[20:23], a[88:91], v[72:75]
    v_mfma_f32_16x16x32_bf16 v[76:79], a[20:23], a[92:95], v[76:79]
    v_mfma_f32_16x16x32_bf16 v[80:83], a[24:27], a[88:91], v[80:83]
    v_mfma_f32_16x16x32_bf16 v[84:87], a[24:27], a[92:95], v[84:87]
    v_mfma_f32_16x16x32_bf16 v[88:91], a[28:31], a[88:91], v[88:91]
    v_mfma_f32_16x16x32_bf16 v[92:95], a[28:31], a[92:95], v[92:95]
    s_waitcnt vmcnt(4)
    v_mfma_f32_16x16x32_bf16 v[64:67], a[32:35], a[96:99], v[64:67]
    v_mfma_f32_16x16x32_bf16 v[68:71], a[32:35], a[100:103], v[68:71]
    v_mfma_f32_16x16x32_bf16 v[72:75], a[36:39], a[96:99], v[72:75]
    v_mfma_f32_16x16x32_bf16 v[76:79], a[36:39], a[100:103], v[76:79]
    v_mfma_f32_16x16x32_bf16 v[80:83], a[40:43], a[96:99], v[80:83]
    v_mfma_f32_16x16x32_bf16 v[84:87], a[40:43], a[100:103], v[84:87]
    v_mfma_f32_16x16x32_bf16 v[88:91], a[44:47], a[96:99], v[88:91]
    v_mfma_f32_16x16x32_bf16 v[92:95], a[44:47], a[100:103], v[92:95]
    s_waitcnt vmcnt(2)
    v_mfma_f32_16x16x32_bf16 v[64:67], a[48:51], a[104:107], v[64:67]
    v_mfma_f32_16x16x32_bf16 v[68:71], a[48:51], a[108:111], v[68:71]
    v_mfma_f32_16x16x32_bf16 v[72:75], a[52:55], a[104:107], v[72:75]
    v_mfma_f32_16x16x32_bf16 v[76:79], a[52:55], a[108:111], v[76:79]
    v_mfma_f32_16x16x32_bf16 v[80:83], a[56:59], a[104:107], v[80:83]
    v_mfma_f32_16x16x32_bf16 v[84:87], a[56:59], a[108:111], v[84:87]
    v_mfma_f32_16x16x32_bf16 v[88:91], a[60:63], a[104:107], v[88:91]
    v_mfma_f32_16x16x32_bf16 v[92:95], a[60:63], a[108:111], v[92:95]
    s_waitcnt vmcnt(0)
    v_mfma_f32_16x16x32_bf16 v[64:67], a[64:67], a[112:115], v[64:67]
    v_mfma_f32_16x16x32_bf16 v[68:71], a[64:67], a[116:119], v[68:71]
    v_mfma_f32_16x16x32_bf16 v[72:75], a[68:71], a[112:115], v[72:75]
    v_mfma_f32_16x16x32_bf16 v[76:79], a[68:71], a[116:119], v[76:79]
    v_mfma_f32_16x16x32_bf16 v[80:83], a[72:75], a[112:115], v[80:83]
    v_mfma_f32_16x16x32_bf16 v[84:87], a[72:75], a[116:119], v[84:87]
    v_mfma_f32_16x16x32_bf16 v[88:91], a[76:79], a[112:115], v[88:91]
    v_mfma_f32_16x16x32_bf16 v[92:95], a[76:79], a[116:119], v[92:95]
    s_nop 7
    s_nop 3
    s_mul_i32 s28, s20, 8192
    v_add_u32 v4, s28, v2
    ds_write_b128 v4, v[64:67] offset:0
    ds_write_b128 v4, v[68:71] offset:1024
    ds_write_b128 v4, v[72:75] offset:2048
    ds_write_b128 v4, v[76:79] offset:3072
    ds_write_b128 v4, v[80:83] offset:4096
    ds_write_b128 v4, v[84:87] offset:5120
    ds_write_b128 v4, v[88:91] offset:6144
    ds_write_b128 v4, v[92:95] offset:7168
    s_waitcnt lgkmcnt(0)
    s_barrier
    s_mul_i32 s28, s20, 2048
    v_add_u32 v4, s28, v2
    ds_read_b128 v[64:67], v4 offset:0
    ds_read_b128 v[68:71], v4 offset:8192
    ds_read_b128 v[72:75], v4 offset:16384
    ds_read_b128 v[76:79], v4 offset:24576
    ds_read_b128 v[80:83], v4 offset:1024
    ds_read_b128 v[84:87], v4 offset:9216
    ds_read_b128 v[88:91], v4 offset:17408
    ds_read_b128 v[92:95], v4 offset:25600
    s_waitcnt lgkmcnt(0)
    v_pk_add_f32 v[64:65], v[64:65], v[68:69]
    v_pk_add_f32 v[66:67], v[66:67], v[70:71]
    v_pk_add_f32 v[72:73], v[72:73], v[76:77]
    v_pk_add_f32 v[74:75], v[74:75], v[78:79]
    v_pk_add_f32 v[16:17], v[64:65], v[72:73]
    v_pk_add_f32 v[18:19], v[66:67], v[74:75]
    v_pk_add_f32 v[80:81], v[80:81], v[84:85]
    v_pk_add_f32 v[82:83], v[82:83], v[86:87]
    v_pk_add_f32 v[88:89], v[88:89], v[92:93]
    v_pk_add_f32 v[90:91], v[90:91], v[94:95]
    v_pk_add_f32 v[20:21], v[80:81], v[88:89]
    v_pk_add_f32 v[22:23], v[82:83], v[90:91]
    s_mul_i32 s31, s21, 96
    s_lshr_b32 s32, s30, 1
    s_add_u32 s31, s31, s32
    s_lshl_b32 s31, s31, 10
    s_and_b32 s32, s30, 1
    s_lshl_b32 s32, s32, 3
    s_add_u32 s31, s31, s32
    s_add_u32 s31, s31, 244535296
    v_cvt_pk_bf16_f32 v30, v16, v17
    v_lshlrev_b32 v16, 16, v30
    v_and_b32 v17, 0xffff0000, v30
    v_lshlrev_b32 v31, 16, v24
    v_and_b32 v32, 0xffff0000, v24
    v_add_f32 v16, v16, v31
    v_add_f32 v17, v17, v32
    v_cvt_pk_bf16_f32 v30, v16, v17
    v_lshlrev_b32 v16, 16, v30
    v_and_b32 v17, 0xffff0000, v30
    v_max_f32 v16, 0, v16
    v_max_f32 v17, 0, v17
    v_mul_f32 v16, v16, v16
    v_mul_f32 v17, v17, v17
    v_cvt_pk_bf16_f32 v26, v16, v17
    v_cvt_pk_bf16_f32 v30, v18, v19
    v_lshlrev_b32 v18, 16, v30
    v_and_b32 v19, 0xffff0000, v30
    v_lshlrev_b32 v31, 16, v25
    v_and_b32 v32, 0xffff0000, v25
    v_add_f32 v18, v18, v31
    v_add_f32 v19, v19, v32
    v_cvt_pk_bf16_f32 v30, v18, v19
    v_lshlrev_b32 v18, 16, v30
    v_and_b32 v19, 0xffff0000, v30
    v_max_f32 v18, 0, v18
    v_max_f32 v19, 0, v19
    v_mul_f32 v18, v18, v18
    v_mul_f32 v19, v19, v19
    v_cvt_pk_bf16_f32 v27, v18, v19
    s_add_u32 s32, s31, 0
    buffer_store_dwordx2 v[26:27], v2, s[4:7], s32 offen sc1
    v_cvt_pk_bf16_f32 v30, v20, v21
    v_lshlrev_b32 v20, 16, v30
    v_and_b32 v21, 0xffff0000, v30
    v_lshlrev_b32 v31, 16, v24
    v_and_b32 v32, 0xffff0000, v24
    v_add_f32 v20, v20, v31
    v_add_f32 v21, v21, v32
    v_cvt_pk_bf16_f32 v30, v20, v21
    v_lshlrev_b32 v20, 16, v30
    v_and_b32 v21, 0xffff0000, v30
    v_max_f32 v20, 0, v20
    v_max_f32 v21, 0, v21
    v_mul_f32 v20, v20, v20
    v_mul_f32 v21, v21, v21
    v_cvt_pk_bf16_f32 v28, v20, v21
    v_cvt_pk_bf16_f32 v30, v22, v23
    v_lshlrev_b32 v22, 16, v30
    v_and_b32 v23, 0xffff0000, v30
    v_lshlrev_b32 v31, 16, v25
    v_and_b32 v32, 0xffff0000, v25
    v_add_f32 v22, v22, v31
    v_add_f32 v23, v23, v32
    v_cvt_pk_bf16_f32 v30, v22, v23
    v_lshlrev_b32 v22, 16, v30
    v_and_b32 v23, 0xffff0000, v30
    v_max_f32 v22, 0, v22
    v_max_f32 v23, 0, v23
    v_mul_f32 v22, v22, v22
    v_mul_f32 v23, v23, v23
    v_cvt_pk_bf16_f32 v29, v22, v23
    s_add_u32 s32, s31, 49152
    buffer_store_dwordx2 v[28:29], v2, s[4:7], s32 offen sc1
    s_add_u32 s73, s73, 2
    s_cmp_lg_u32 s20, 0
    s_cbranch_scc1 L_f1_f1
    s_min_u32 s60, s73, 63
    v_lshlrev_b32 v12, 2, v1
    s_lshl_b32 s61, s60, 8
    s_add_u32 s61, s61, 250826752
    v_subrev_u32 v14, 52, v1
    v_cmp_gt_u32 vcc, 2, v14
    v_cndmask_b32 v14, 0, 1, vcc
    v_add_u32 v12, s61, v12
    v_mov_b32 v15, 250890244
    v_cmp_eq_u32 vcc, 62, v1
    v_cndmask_b32 v12, v12, v15, vcc
    buffer_load_dword v13, v12, s[4:7], 0 offen sc1
    s_waitcnt vmcnt(0)
    v_cmp_lt_u32 vcc, v13, v14
    s_cmp_eq_u64 vcc, 0
    s_cselect_b32 s60, 1, 0
    v_mov_b32 v15, s60
    v_mov_b32 v12, 49152
    ds_write_b32 v12, v15
    s_waitcnt lgkmcnt(0)
    s_barrier
    s_lshl_b32 s22, s21, 8
    s_lshl_b32 s23, s74, 2
    s_add_u32 s22, s22, s23
    s_add_u32 s22, s22, 250826864
    v_mov_b32 v4, 1
    v_mov_b32 v5, 0
    s_mov_b64 exec, 1
    buffer_store_dword v4, v5, s[4:7], s22 offen sc1
    s_mov_b64 exec, -1
    s_branch L_f1_f2
L_f1_f1:
    s_waitcnt vmcnt(0)
    s_barrier
L_f1_f2:
    v_mov_b32 v12, 49152
    ds_read_b32 v15, v12
    s_waitcnt lgkmcnt(0)
    v_readfirstlane_b32 s77, v15
    s_branch L_f1_loop
L_pe_3:
    s_cmp_lg_u32 s20, 0
    s_cbranch_scc1 L_f2_ec
    s_min_u32 s60, s73, 63
    v_lshlrev_b32 v12, 2, v1
    s_lshl_b32 s61, s60, 8
    s_add_u32 s61, s61, 250826752
    v_subrev_u32 v14, 28, v1
    v_cmp_gt_u32 vcc, 24, v14
    v_cndmask_b32 v14, 0, 1, vcc
    v_add_u32 v12, s61, v12
    v_mov_b32 v15, 250890244
    v_cmp_eq_u32 vcc, 62, v1
    v_cndmask_b32 v12, v12, v15, vcc
    buffer_load_dword v13, v12, s[4:7], 0 offen sc1
    s_waitcnt vmcnt(0)
    v_cmp_lt_u32 vcc, v13, v14
    s_cmp_eq_u64 vcc, 0
    s_cselect_b32 s60, 1, 0
    v_mov_b32 v15, s60
    v_mov_b32 v12, 49152
    ds_write_b32 v12, v15
    s_waitcnt lgkmcnt(0)
L_f2_ec:
    s_barrier
    v_mov_b32 v12, 49152
    ds_read_b32 v15, v12
    s_waitcnt lgkmcnt(0)
    v_readfirstlane_b32 s77, v15
L_f2_loop:
    s_cmp_ge_u32 s73, 64
    s_cbranch_scc1 L_post_out
    s_cmp_eq_u32 s76, 0
    s_cbranch_scc1 L_f2_go
    s_cmp_eq_u32 s77, 0
    s_cbranch_scc1 L_w_next
    s_cmp_eq_u32 s78, 0
    s_cbranch_scc1 L_w_next
    s_sub_u32 s78, s78, 1
L_f2_go:
    s_mov_b32 s21, s73
    s_mul_i32 s25, s20, 12
    s_lshl_b32 s26, s74, 1
    s_mul_i32 s34, s26, 48
    s_add_u32 s34, s34, s25
    s_lshl_b32 s34, s34, 10
    s_add_u32 s34, s34, 38096896
    s_add_u32 s28, s34, 0
    buffer_load_dwordx4 a[0:3], v2, s[4:7], s28 offen
    s_add_u32 s28, s34, 49152
    buffer_load_dwordx4 a[4:7], v2, s[4:7], s28 offen
    s_add_u32 s28, s34, 1024
    buffer_load_dwordx4 a[8:11], v2, s[4:7], s28 offen
    s_add_u32 s28, s34, 50176
    buffer_load_dwordx4 a[12:15], v2, s[4:7], s28 offen
    s_add_u32 s28, s34, 2048
    buffer_load_dwordx4 a[16:19], v2, s[4:7], s28 offen
    s_add_u32 s28, s34, 51200
    buffer_load_dwordx4 a[20:23], v2, s[4:7], s28 offen
    s_add_u32 s28, s34, 3072
    buffer_load_dwordx4 a[24:27], v2, s[4:7], s28 offen
    s_add_u32 s28, s34, 52224
    buffer_load_dwordx4 a[28:31], v2, s[4:7], s28 offen
    s_add_u32 s28, s34, 4096
    buffer_load_dwordx4 a[32:35], v2, s[4:7], s28 offen
    s_add_u32 s28, s34, 53248
    buffer_load_dwordx4 a[36:39], v2, s[4:7], s28 offen
    s_add_u32 s28, s34, 5120
    buffer_load_dwordx4 a[40:43], v2, s[4:7], s28 offen
    s_add_u32 s28, s34, 54272
    buffer_load_dwordx4 a[44:47], v2, s[4:7], s28 offen
    s_add_u32 s28, s34, 6144
    buffer_load_dwordx4 a[48:51], v2, s[4:7], s28 offen
    s_add_u32 s28, s34, 55296
    buffer_load_dwordx4 a[52:55], v2, s[4:7], s28 offen
    s_add_u32 s28, s34, 7168
    buffer_load_dwordx4 a[56:59], v2, s[4:7], s28 offen
    s_add_u32 s28, s34, 56320
    buffer_load_dwordx4 a[60:63], v2, s[4:7], s28 offen
    s_add_u32 s28, s34, 8192
    buffer_load_dwordx4 a[64:67], v2, s[4:7], s28 offen
    s_add_u32 s28, s34, 57344
    buffer_load_dwordx4 a[68:71], v2, s[4:7], s28 offen
    s_add_u32 s28, s34, 9216
    buffer_load_dwordx4 a[72:75], v2, s[4:7], s28 offen
    s_add_u32 s28, s34, 58368
    buffer_load_dwordx4 a[76:79], v2, s[4:7], s28 offen
    s_add_u32 s28, s34, 10240
    buffer_load_dwordx4 a[80:83], v2, s[4:7], s28 offen
    s_add_u32 s28, s34, 59392
    buffer_load_dwordx4 a[84:87], v2, s[4:7], s28 offen
    s_add_u32 s28, s34, 11264
    buffer_load_dwordx4 a[88:91], v2, s[4:7], s28 offen
    s_add_u32 s28, s34, 60416
    buffer_load_dwordx4 a[92:95], v2, s[4:7], s28 offen
    s_lshl_b32 s30, s74, 1
    s_lshr_b32 s32, s20, 1
    s_add_u32 s30, s30, s32
    s_and_b32 s32, s20, 1
    s_lshl_b32 s32, s32, 4
    s_lshl_b32 s31, s21, 5
    s_add_u32 s31, s31, s32
    v_and_b32 v9, 15, v1
    v_lshrrev_b32 v8, 4, v1
    v_lshlrev_b32 v8, 3, v8
    s_lshl_b32 s32, s30, 5
    v_add_u32 v8, s32, v8
    v_mul_u32_u24 v9, 1280, v9
    v_add_u32 v9, v9, v8
    s_mul_i32 s33, s31, 1280
    s_mov_b32 s32, 6400
    buffer_load_dwordx2 v[24:25], v8, s[4:7], s32 offen
    buffer_load_dwordx2 v[26:27], v8, s[84:87], 0 offen
    s_cmp_lg_u32 s77, 0
    s_cbranch_scc1 L_f2_rdy
    s_cmp_lg_u32 s20, 0
    s_cbranch_scc1 L_f2_sp2
    s_mov_b32 s42, 0
L_f2_sp:
    s_min_u32 s60, s73, 63
    v_lshlrev_b32 v12, 2, v1
    s_lshl_b32 s61, s60, 8
    s_add_u32 s61, s61, 250826752
    v_subrev_u32 v14, 28, v1
    v_cmp_gt_u32 vcc, 24, v14
    v_cndmask_b32 v14, 0, 1, vcc
    v_add_u32 v12, s61, v12
    v_mov_b32 v15, 250890244
    v_cmp_eq_u32 vcc, 62, v1
    v_cndmask_b32 v12, v12, v15, vcc
    buffer_load_dword v13, v12, s[4:7], 0 offen sc1
    s_waitcnt vmcnt(0)
    v_cmp_lt_u32 vcc, v13, v14
    s_cbranch_vccz L_f2_sp2
    v_readlane_b32 s43, v13, 62
    s_cmp_lg_u32 s43, 0
    s_cbranch_scc1 L_f2_sp_nd
    s_mov_b32 s43, 10
L_f2_sp_dl:
    s_nop 15
    s_nop 15
    s_nop 15
    s_nop 15
    s_nop 15
    s_nop 15
    s_nop 15
    s_nop 15
    s_sub_u32 s43, s43, 1
    s_cmp_lg_u32 s43, 0
    s_cbranch_scc1 L_f2_sp_dl
L_f2_sp_nd:
    s_add_u32 s42, s42, 1
    s_cmp_lt_u32 s42, s44
    s_cbranch_scc1 L_f2_sp
    s_mov_b32 s44, 0
L_f2_sp2:
    s_barrier
L_f2_rdy:
    s_mul_i32 s35, s21, 96
    s_add_u32 s35, s35, s25
    s_lshl_b32 s35, s35, 10
    s_add_u32 s35, s35, 244535296
    s_add_u32 s32, s33, 239292416
    buffer_load_dwordx2 v[28:29], v9, s[4:7], s32 offen
    s_add_u32 s28, s35, 0
    buffer_load_dwordx4 a[96:99], v2, s[4:7], s28 offen
    s_add_u32 s28, s35, 49152
    buffer_load_dwordx4 a[100:103], v2, s[4:7], s28 offen
    s_add_u32 s28, s35, 1024
    buffer_load_dwordx4 a[104:107], v2, s[4:7], s28 offen
    s_add_u32 s28, s35, 50176
    buffer_load_dwordx4 a[108:111], v2, s[4:7], s28 offen
    s_add_u32 s28, s35, 2048
    buffer_load_dwordx4 a[112:115], v2, s[4:7], s28 offen
    s_add_u32 s28, s35, 51200
    buffer_load_dwordx4 a[116:119], v2, s[4:7], s28 offen
    s_add_u32 s28, s35, 3072
    buffer_load_dwordx4 a[120:123], v2, s[4:7], s28 offen
    s_add_u32 s28, s35, 52224
    buffer_load_dwordx4 a[124:127], v2, s[4:7], s28 offen
    s_add_u32 s28, s35, 4096
    buffer_load_dwordx4 a[128:131], v2, s[4:7], s28 offen
    s_add_u32 s28, s35, 53248
    buffer_load_dwordx4 a[132:135], v2, s[4:7], s28 offen
    s_add_u32 s28, s35, 5120
    buffer_load_dwordx4 a[136:139], v2, s[4:7], s28 offen
    s_add_u32 s28, s35, 54272
    buffer_load_dwordx4 a[140:143], v2, s[4:7], s28 offen
    s_add_u32 s28, s35, 6144
    buffer_load_dwordx4 a[144:147], v2, s[4:7], s28 offen
    s_add_u32 s28, s35, 55296
    buffer_load_dwordx4 a[148:151], v2, s[4:7], s28 offen
    s_add_u32 s28, s35, 7168
    buffer_load_dwordx4 a[152:155], v2, s[4:7], s28 offen
    s_add_u32 s28, s35, 56320
    buffer_load_dwordx4 a[156:159], v2, s[4:7], s28 offen
    s_add_u32 s28, s35, 8192
    buffer_load_dwordx4 a[160:163], v2, s[4:7], s28 offen
    s_add_u32 s28, s35, 57344
    buffer_load_dwordx4 a[164:167], v2, s[4:7], s28 offen
    s_add_u32 s28, s35, 9216
    buffer_load_dwordx4 a[168:171], v2, s[4:7], s28 offen
    s_add_u32 s28, s35, 58368
    buffer_load_dwordx4 a[172:175], v2, s[4:7], s28 offen
    s_add_u32 s28, s35, 10240
    buffer_load_dwordx4 a[176:179], v2, s[4:7], s28 offen
    s_add_u32 s28, s35, 59392
    buffer_load_dwordx4 a[180:183], v2, s[4:7], s28 offen
    s_add_u32 s28, s35, 11264
    buffer_load_dwordx4 a[184:187], v2, s[4:7], s28 offen
    s_add_u32 s28, s35, 60416
    buffer_load_dwordx4 a[188:191], v2, s[4:7], s28 offen
    s_waitcnt vmcnt(22)
    v_mfma_f32_16x16x32_bf16 v[64:67], a[0:3], a[96:99], 0
    v_mfma_f32_16x16x32_bf16 v[68:71], a[0:3], a[100:103], 0
    v_mfma_f32_16x16x32_bf16 v[72:75], a[4:7], a[96:99], 0
    v_mfma_f32_16x16x32_bf16 v[76:79], a[4:7], a[100:103], 0
    s_waitcnt vmcnt(20)
    v_mfma_f32_16x16x32_bf16 v[64:67], a[8:11], a[104:107], v[64:67]
    v_mfma_f32_16x16x32_bf16 v[68:71], a[8:11], a[108:111], v[68:71]
    v_mfma_f32_16x16x32_bf16 v[72:75], a[12:15], a[104:107], v[72:75]
    v_mfma_f32_16x16x32_bf16 v[76:79], a[12:15], a[108:111], v[76:79]
    s_waitcnt vmcnt(18)
    v_mfma_f32_16x16x32_bf16 v[64:67], a[16:19], a[112:115], v[64:67]
    v_mfma_f32_16x16x32_bf16 v[68:71], a[16:19], a[116:119], v[68:71]
    v_mfma_f32_16x16x32_bf16 v[72:75], a[20:23], a[112:115], v[72:75]
    v_mfma_f32_16x16x32_bf16 v[76:79], a[20:23], a[116:119], v[76:79]
    s_waitcnt vmcnt(16)
    v_mfma_f32_16x16x32_bf16 v[64:67], a[24:27], a[120:123], v[64:67]
    v_mfma_f32_16x16x32_bf16 v[68:71], a[24:27], a[124:127], v[68:71]
    v_mfma_f32_16x16x32_bf16 v[72:75], a[28:31], a[120:123], v[72:75]
    v_mfma_f32_16x16x32_bf16 v[76:79], a[28:31], a[124:127], v[76:79]
    s_waitcnt vmcnt(14)
    v_mfma_f32_16x16x32_bf16 v[64:67], a[32:35], a[128:131], v[64:67]
    v_mfma_f32_16x16x32_bf16 v[68:71], a[32:35], a[132:135], v[68:71]
    v_mfma_f32_16x16x32_bf16 v[72:75], a[36:39], a[128:131], v[72:75]
    v_mfma_f32_16x16x32_bf16 v[76:79], a[36:39], a[132:135], v[76:79]
    s_waitcnt vmcnt(12)
    v_mfma_f32_16x16x32_bf16 v[64:67], a[40:43], a[136:139], v[64:67]
    v_mfma_f32_16x16x32_bf16 v[68:71], a[40:43], a[140:143], v[68:71]
    v_mfma_f32_16x16x32_bf16 v[72:75], a[44:47], a[136:139], v[72:75]
    v_mfma_f32_16x16x32_bf16 v[76:79], a[44:47], a[140:143], v[76:79]
    s_waitcnt vmcnt(10)
    v_mfma_f32_16x16x32_bf16 v[64:67], a[48:51], a[144:147], v[64:67]
    v_mfma_f32_16x16x32_bf16 v[68:71], a[48:51], a[148:151], v[68:71]
    v_mfma_f32_16x16x32_bf16 v[72:75], a[52:55], a[144:147], v[72:75]
    v_mfma_f32_16x16x32_bf16 v[76:79], a[52:55], a[148:151], v[76:79]
    s_waitcnt vmcnt(8)
    v_mfma_f32_16x16x32_bf16 v[64:67], a[56:59], a[152:155], v[64:67]
    v_mfma_f32_16x16x32_bf16 v[68:71], a[56:59], a[156:159], v[68:71]
    v_mfma_f32_16x16x32_bf16 v[72:75], a[60:63], a[152:155], v[72:75]
    v_mfma_f32_16x16x32_bf16 v[76:79], a[60:63], a[156:159], v[76:79]
    s_waitcnt vmcnt(6)
    v_mfma_f32_16x16x32_bf16 v[64:67], a[64:67], a[160:163], v[64:67]
    v_mfma_f32_16x16x32_bf16 v[68:71], a[64:67], a[164:167], v[68:71]
    v_mfma_f32_16x16x32_bf16 v[72:75], a[68:71], a[160:163], v[72:75]
    v_mfma_f32_16x16x32_bf16 v[76:79], a[68:71], a[164:167], v[76:79]
    s_waitcnt vmcnt(4)
    v_mfma_f32_16x16x32_bf16 v[64:67], a[72:75], a[168:171], v[64:67]
    v_mfma_f32_16x16x32_bf16 v[68:71], a[72:75], a[172:175], v[68:71]
    v_mfma_f32_16x16x32_bf16 v[72:75], a[76:79], a[168:171], v[72:75]
    v_mfma_f32_16x16x32_bf16 v[76:79], a[76:79], a[172:175], v[76:79]
    s_waitcnt vmcnt(2)
    v_mfma_f32_16x16x32_bf16 v[64:67], a[80:83], a[176:179], v[64:67]
    v_mfma_f32_16x16x32_bf16 v[68:71], a[80:83], a[180:183], v[68:71]
    v_mfma_f32_16x16x32_bf16 v[72:75], a[84:87], a[176:179], v[72:75]
    v_mfma_f32_16x16x32_bf16 v[76:79], a[84:87], a[180:183], v[76:79]
    s_waitcnt vmcnt(0)
    v_mfma_f32_16x16x32_bf16 v[64:67], a[88:91], a[184:187], v[64:67]
    v_mfma_f32_16x16x32_bf16 v[68:71], a[88:91], a[188:191], v[68:71]
    v_mfma_f32_16x16x32_bf16 v[72:75], a[92:95], a[184:187], v[72:75]
    v_mfma_f32_16x16x32_bf16 v[76:79], a[92:95], a[188:191], v[76:79]
    s_nop 7
    s_nop 3
    s_mul_i32 s28, s20, 4096
    v_add_u32 v4, s28, v2
    ds_write_b128 v4, v[64:67] offset:0
    ds_write_b128 v4, v[68:71] offset:1024
    ds_write_b128 v4, v[72:75] offset:2048
    ds_write_b128 v4, v[76:79] offset:3072
    s_waitcnt lgkmcnt(0)
    s_barrier
    s_mul_i32 s28, s20, 1024
    v_add_u32 v4, s28, v2
    ds_read_b128 v[64:67], v4 offset:0
    ds_read_b128 v[68:71], v4 offset:4096
    ds_read_b128 v[72:75], v4 offset:8192
    ds_read_b128 v[76:79], v4 offset:12288
    s_waitcnt lgkmcnt(0)
    v_pk_add_f32 v[64:65], v[64:65], v[68:69]
    v_pk_add_f32 v[66:67], v[66:67], v[70:71]
    v_pk_add_f32 v[72:73], v[72:73], v[76:77]
    v_pk_add_f32 v[74:75], v[74:75], v[78:79]
    v_pk_add_f32 v[16:17], v[64:65], v[72:73]
    v_pk_add_f32 v[18:19], v[66:67], v[74:75]
    v_cvt_pk_bf16_f32 v30, v16, v17
    v_lshlrev_b32 v16, 16, v30
    v_and_b32 v17, 0xffff0000, v30
    v_lshlrev_b32 v31, 16, v26
    v_and_b32 v32, 0xffff0000, v26
    v_add_f32 v16, v16, v31
    v_add_f32 v17, v17, v32
    v_cvt_pk_bf16_f32 v30, v16, v17
    v_lshlrev_b32 v16, 16, v30
    v_and_b32 v17, 0xffff0000, v30
    v_lshlrev_b32 v31, 16, v24
    v_and_b32 v32, 0xffff0000, v24
    v_mul_f32 v16, v16, v31
    v_mul_f32 v17, v17, v32
    v_cvt_pk_bf16_f32 v30, v16, v17
    v_lshlrev_b32 v16, 16, v30
    v_and_b32 v17, 0xffff0000, v30
    v_lshlrev_b32 v31, 16, v28
    v_and_b32 v32, 0xffff0000, v28
    v_add_f32 v16, v16, v31
    v_add_f32 v17, v17, v32
    v_cvt_pk_bf16_f32 v28, v16, v17
    v_cvt_pk_bf16_f32 v30, v18, v19
    v_lshlrev_b32 v18, 16, v30
    v_and_b32 v19, 0xffff0000, v30
    v_lshlrev_b32 v31, 16, v27
    v_and_b32 v32, 0xffff0000, v27
    v_add_f32 v18, v18, v31
    v_add_f32 v19, v19, v32
    v_cvt_pk_bf16_f32 v30, v18, v19
    v_lshlrev_b32 v18, 16, v30
    v_and_b32 v19, 0xffff0000, v30
    v_lshlrev_b32 v31, 16, v25
    v_and_b32 v32, 0xffff0000, v25
    v_mul_f32 v18, v18, v31
    v_mul_f32 v19, v19, v32
    v_cvt_pk_bf16_f32 v30, v18, v19
    v_lshlrev_b32 v18, 16, v30
    v_and_b32 v19, 0xffff0000, v30
    v_lshlrev_b32 v31, 16, v29
    v_and_b32 v32, 0xffff0000, v29
    v_add_f32 v18, v18, v31
    v_add_f32 v19, v19, v32
    v_cvt_pk_bf16_f32 v29, v18, v19
    s_add_u32 s32, s33, 0
    buffer_store_dwordx2 v[28:29], v9, s[88:91], s32 offen
    s_add_u32 s73, s73, 2
    s_cmp_lg_u32 s20, 0
    s_cbranch_scc1 L_f2_f1
    s_min_u32 s60, s73, 63
    v_lshlrev_b32 v12, 2, v1
    s_lshl_b32 s61, s60, 8
    s_add_u32 s61, s61, 250826752
    v_subrev_u32 v14, 28, v1
    v_cmp_gt_u32 vcc, 24, v14
    v_cndmask_b32 v14, 0, 1, vcc
    v_add_u32 v12, s61, v12
    v_mov_b32 v15, 250890244
    v_cmp_eq_u32 vcc, 62, v1
    v_cndmask_b32 v12, v12, v15, vcc
    buffer_load_dword v13, v12, s[4:7], 0 offen sc1
    s_waitcnt vmcnt(0)
    v_cmp_lt_u32 vcc, v13, v14
    s_cmp_eq_u64 vcc, 0
    s_cselect_b32 s60, 1, 0
    v_mov_b32 v15, s60
    v_mov_b32 v12, 49152
    ds_write_b32 v12, v15
    s_waitcnt lgkmcnt(0)
    s_barrier
    s_branch L_f2_f2
L_f2_f1:
    s_waitcnt vmcnt(0)
    s_barrier
L_f2_f2:
    v_mov_b32 v12, 49152
    ds_read_b32 v15, v12
    s_waitcnt lgkmcnt(0)
    v_readfirstlane_b32 s77, v15
    s_branch L_f2_loop
L_pe_4:
    s_cmp_lg_u32 s20, 0
    s_cbranch_scc1 L_ln_ec
    s_min_u32 s60, s73, 63
    v_lshlrev_b32 v12, 2, v1
    s_lshl_b32 s61, s60, 8
    s_add_u32 s61, s61, 250826752
    v_subrev_u32 v14, 8, v1
    v_cmp_gt_u32 vcc, 10, v14
    v_cndmask_b32 v14, 0, 1, vcc
    v_add_u32 v12, s61, v12
    v_mov_b32 v15, 250890244
    v_cmp_eq_u32 vcc, 62, v1
    v_cndmask_b32 v12, v12, v15, vcc
    buffer_load_dword v13, v12, s[4:7], 0 offen sc1
    s_waitcnt vmcnt(0)
    v_cmp_lt_u32 vcc, v13, v14
    s_cmp_eq_u64 vcc, 0
    s_cselect_b32 s60, 1, 0
    v_mov_b32 v15, s60
    v_mov_b32 v12, 49152
    ds_write_b32 v12, v15
    s_waitcnt lgkmcnt(0)
L_ln_ec:
    s_barrier
    v_mov_b32 v12, 49152
    ds_read_b32 v15, v12
    s_waitcnt lgkmcnt(0)
    v_readfirstlane_b32 s77, v15
L_ln_loop:
    s_cmp_ge_u32 s73, 64
    s_cbranch_scc1 L_post_out
    s_cmp_eq_u32 s76, 0
    s_cbranch_scc1 L_ln_go
    s_cmp_eq_u32 s77, 0
    s_cbranch_scc1 L_w_next
    s_cmp_eq_u32 s78, 0
    s_cbranch_scc1 L_w_next
    s_sub_u32 s78, s78, 1
L_ln_go:
    s_mov_b32 s21, s73
    s_mul_i32 s25, s20, 5
    v_lshrrev_b32 v10, 4, v1
    v_lshlrev_b32 v11, 4, v10
    s_lshl_b32 s27, s25, 6
    s_add_u32 s28, s27, 5120
    buffer_load_dwordx4 v[236:239], v11, s[4:7], s28 offen offset:0
    buffer_load_dwordx4 v[240:243], v11, s[4:7], s28 offen offset:64
    buffer_load_dwordx4 v[244:247], v11, s[4:7], s28 offen offset:128
    buffer_load_dwordx4 v[248:251], v11, s[4:7], s28 offen offset:192
    buffer_load_dwordx4 v[252:255], v11, s[4:7], s28 offen offset:256
    s_add_u32 s28, s27, 3840
    buffer_load_dwordx4 v[216:219], v11, s[4:7], s28 offen offset:0
    buffer_load_dwordx4 v[220:223], v11, s[4:7], s28 offen offset:64
    buffer_load_dwordx4 v[224:227], v11, s[4:7], s28 offen offset:128
    buffer_load_dwordx4 v[228:231], v11, s[4:7], s28 offen offset:192
    buffer_load_dwordx4 v[232:235], v11, s[4:7], s28 offen offset:256
    s_waitcnt vmcnt(0)
    v_lshlrev_b32 v4, 16, v236
    v_and_b32 v5, 0xffff0000, v236
    v_add_f32 v4, 1.0, v4
    v_add_f32 v5, 1.0, v5
    v_cvt_pk_bf16_f32 v6, v4, v5
    v_lshlrev_b32 v136, 16, v6
    v_and_b32 v137, 0xffff0000, v6
    v_lshlrev_b32 v176, 16, v216
    v_and_b32 v177, 0xffff0000, v216
    v_lshlrev_b32 v4, 16, v237
    v_and_b32 v5, 0xffff0000, v237
    v_add_f32 v4, 1.0, v4
    v_add_f32 v5, 1.0, v5
    v_cvt_pk_bf16_f32 v6, v4, v5
    v_lshlrev_b32 v138, 16, v6
    v_and_b32 v139, 0xffff0000, v6
    v_lshlrev_b32 v178, 16, v217
    v_and_b32 v179, 0xffff0000, v217
    v_lshlrev_b32 v4, 16, v238
    v_and_b32 v5, 0xffff0000, v238
    v_add_f32 v4, 1.0, v4
    v_add_f32 v5, 1.0, v5
    v_cvt_pk_bf16_f32 v6, v4, v5
    v_lshlrev_b32 v140, 16, v6
    v_and_b32 v141, 0xffff0000, v6
    v_lshlrev_b32 v180, 16, v218
    v_and_b32 v181, 0xffff0000, v218
    v_lshlrev_b32 v4, 16, v239
    v_and_b32 v5, 0xffff0000, v239
    v_add_f32 v4, 1.0, v4
    v_add_f32 v5, 1.0, v5
    v_cvt_pk_bf16_f32 v6, v4, v5
    v_lshlrev_b32 v142, 16, v6
    v_and_b32 v143, 0xffff0000, v6
    v_lshlrev_b32 v182, 16, v219
    v_and_b32 v183, 0xffff0000, v219
    v_lshlrev_b32 v4, 16, v240
    v_and_b32 v5, 0xffff0000, v240
    v_add_f32 v4, 1.0, v4
    v_add_f32 v5, 1.0, v5
    v_cvt_pk_bf16_f32 v6, v4, v5
    v_lshlrev_b32 v144, 16, v6
    v_and_b32 v145, 0xffff0000, v6
    v_lshlrev_b32 v184, 16, v220
    v_and_b32 v185, 0xffff0000, v220
    v_lshlrev_b32 v4, 16, v241
    v_and_b32 v5, 0xffff0000, v241
    v_add_f32 v4, 1.0, v4
    v_add_f32 v5, 1.0, v5
    v_cvt_pk_bf16_f32 v6, v4, v5
    v_lshlrev_b32 v146, 16, v6
    v_and_b32 v147, 0xffff0000, v6
    v_lshlrev_b32 v186, 16, v221
    v_and_b32 v187, 0xffff0000, v221
    v_lshlrev_b32 v4, 16, v242
    v_and_b32 v5, 0xffff0000, v242
    v_add_f32 v4, 1.0, v4
    v_add_f32 v5, 1.0, v5
    v_cvt_pk_bf16_f32 v6, v4, v5
    v_lshlrev_b32 v148, 16, v6
    v_and_b32 v149, 0xffff0000, v6
    v_lshlrev_b32 v188, 16, v222
    v_and_b32 v189, 0xffff0000, v222
    v_lshlrev_b32 v4, 16, v243
    v_and_b32 v5, 0xffff0000, v243
    v_add_f32 v4, 1.0, v4
    v_add_f32 v5, 1.0, v5
    v_cvt_pk_bf16_f32 v6, v4, v5
    v_lshlrev_b32 v150, 16, v6
    v_and_b32 v151, 0xffff0000, v6
    v_lshlrev_b32 v190, 16, v223
    v_and_b32 v191, 0xffff0000, v223
    v_lshlrev_b32 v4, 16, v244
    v_and_b32 v5, 0xffff0000, v244
    v_add_f32 v4, 1.0, v4
    v_add_f32 v5, 1.0, v5
    v_cvt_pk_bf16_f32 v6, v4, v5
    v_lshlrev_b32 v152, 16, v6
    v_and_b32 v153, 0xffff0000, v6
    v_lshlrev_b32 v192, 16, v224
    v_and_b32 v193, 0xffff0000, v224
    v_lshlrev_b32 v4, 16, v245
    v_and_b32 v5, 0xffff0000, v245
    v_add_f32 v4, 1.0, v4
    v_add_f32 v5, 1.0, v5
    v_cvt_pk_bf16_f32 v6, v4, v5
    v_lshlrev_b32 v154, 16, v6
    v_and_b32 v155, 0xffff0000, v6
    v_lshlrev_b32 v194, 16, v225
    v_and_b32 v195, 0xffff0000, v225
    v_lshlrev_b32 v4, 16, v246
    v_and_b32 v5, 0xffff0000, v246
    v_add_f32 v4, 1.0, v4
    v_add_f32 v5, 1.0, v5
    v_cvt_pk_bf16_f32 v6, v4, v5
    v_lshlrev_b32 v156, 16, v6
    v_and_b32 v157, 0xffff0000, v6
    v_lshlrev_b32 v196, 16, v226
    v_and_b32 v197, 0xffff0000, v226
    v_lshlrev_b32 v4, 16, v247
    v_and_b32 v5, 0xffff0000, v247
    v_add_f32 v4, 1.0, v4
    v_add_f32 v5, 1.0, v5
    v_cvt_pk_bf16_f32 v6, v4, v5
    v_lshlrev_b32 v158, 16, v6
    v_and_b32 v159, 0xffff0000, v6
    v_lshlrev_b32 v198, 16, v227
    v_and_b32 v199, 0xffff0000, v227
    v_lshlrev_b32 v4, 16, v248
    v_and_b32 v5, 0xffff0000, v248
    v_add_f32 v4, 1.0, v4
    v_add_f32 v5, 1.0, v5
    v_cvt_pk_bf16_f32 v6, v4, v5
    v_lshlrev_b32 v160, 16, v6
    v_and_b32 v161, 0xffff0000, v6
    v_lshlrev_b32 v200, 16, v228
    v_and_b32 v201, 0xffff0000, v228
    v_lshlrev_b32 v4, 16, v249
    v_and_b32 v5, 0xffff0000, v249
    v_add_f32 v4, 1.0, v4
    v_add_f32 v5, 1.0, v5
    v_cvt_pk_bf16_f32 v6, v4, v5
    v_lshlrev_b32 v162, 16, v6
    v_and_b32 v163, 0xffff0000, v6
    v_lshlrev_b32 v202, 16, v229
    v_and_b32 v203, 0xffff0000, v229
    v_lshlrev_b32 v4, 16, v250
    v_and_b32 v5, 0xffff0000, v250
    v_add_f32 v4, 1.0, v4
    v_add_f32 v5, 1.0, v5
    v_cvt_pk_bf16_f32 v6, v4, v5
    v_lshlrev_b32 v164, 16, v6
    v_and_b32 v165, 0xffff0000, v6
    v_lshlrev_b32 v204, 16, v230
    v_and_b32 v205, 0xffff0000, v230
    v_lshlrev_b32 v4, 16, v251
    v_and_b32 v5, 0xffff0000, v251
    v_add_f32 v4, 1.0, v4
    v_add_f32 v5, 1.0, v5
    v_cvt_pk_bf16_f32 v6, v4, v5
    v_lshlrev_b32 v166, 16, v6
    v_and_b32 v167, 0xffff0000, v6
    v_lshlrev_b32 v206, 16, v231
    v_and_b32 v207, 0xffff0000, v231
    v_lshlrev_b32 v4, 16, v252
    v_and_b32 v5, 0xffff0000, v252
    v_add_f32 v4, 1.0, v4
    v_add_f32 v5, 1.0, v5
    v_cvt_pk_bf16_f32 v6, v4, v5
    v_lshlrev_b32 v168, 16, v6
    v_and_b32 v169, 0xffff0000, v6
    v_lshlrev_b32 v208, 16, v232
    v_and_b32 v209, 0xffff0000, v232
    v_lshlrev_b32 v4, 16, v253
    v_and_b32 v5, 0xffff0000, v253
    v_add_f32 v4, 1.0, v4
    v_add_f32 v5, 1.0, v5
    v_cvt_pk_bf16_f32 v6, v4, v5
    v_lshlrev_b32 v170, 16, v6
    v_and_b32 v171, 0xffff0000, v6
    v_lshlrev_b32 v210, 16, v233
    v_and_b32 v211, 0xffff0000, v233
    v_lshlrev_b32 v4, 16, v254
    v_and_b32 v5, 0xffff0000, v254
    v_add_f32 v4, 1.0, v4
    v_add_f32 v5, 1.0, v5
    v_cvt_pk_bf16_f32 v6, v4, v5
    v_lshlrev_b32 v172, 16, v6
    v_and_b32 v173, 0xffff0000, v6
    v_lshlrev_b32 v212, 16, v234
    v_and_b32 v213, 0xffff0000, v234
    v_lshlrev_b32 v4, 16, v255
    v_and_b32 v5, 0xffff0000, v255
    v_add_f32 v4, 1.0, v4
    v_add_f32 v5, 1.0, v5
    v_cvt_pk_bf16_f32 v6, v4, v5
    v_lshlrev_b32 v174, 16, v6
    v_and_b32 v175, 0xffff0000, v6
    v_lshlrev_b32 v214, 16, v235
    v_and_b32 v215, 0xffff0000, v235
    s_cmp_lg_u32 s77, 0
    s_cbranch_scc1 L_ln_rdy
    s_cmp_lg_u32 s20, 0
    s_cbranch_scc1 L_ln_sp2
    s_mov_b32 s42, 0
L_ln_sp:
    s_min_u32 s60, s73, 63
    v_lshlrev_b32 v12, 2, v1
    s_lshl_b32 s61, s60, 8
    s_add_u32 s61, s61, 250826752
    v_subrev_u32 v14, 8, v1
    v_cmp_gt_u32 vcc, 10, v14
    v_cndmask_b32 v14, 0, 1, vcc
    v_add_u32 v12, s61, v12
    v_mov_b32 v15, 250890244
    v_cmp_eq_u32 vcc, 62, v1
    v_cndmask_b32 v12, v12, v15, vcc
    buffer_load_dword v13, v12, s[4:7], 0 offen sc1
    s_waitcnt vmcnt(0)
    v_cmp_lt_u32 vcc, v13, v14
    s_cbranch_vccz L_ln_sp2
    v_readlane_b32 s43, v13, 62
    s_cmp_lg_u32 s43, 0
    s_cbranch_scc1 L_ln_sp_nd
    s_mov_b32 s43, 10
L_ln_sp_dl:
    s_nop 15
    s_nop 15
    s_nop 15
    s_nop 15
    s_nop 15
    s_nop 15
    s_nop 15
    s_nop 15
    s_sub_u32 s43, s43, 1
    s_cmp_lg_u32 s43, 0
    s_cbranch_scc1 L_ln_sp_dl
L_ln_sp_nd:
    s_add_u32 s42, s42, 1
    s_cmp_lt_u32 s42, s44
    s_cbranch_scc1 L_ln_sp
    s_mov_b32 s44, 0
L_ln_sp2:
    s_barrier
L_ln_rdy:
    v_and_b32 v3, 15, v1
    v_lshrrev_b32 v10, 4, v1
    v_lshlrev_b32 v11, 4, v10
    v_mul_u32_u24 v12, 1280, v3
    v_add_u32 v12, v12, v11
    s_lshl_b32 s36, s21, 1
    s_add_u32 s36, s36, s74
    s_mul_i32 s35, s36, 20480
    s_lshl_b32 s27, s25, 6
    s_add_u32 s35, s35, s27
    s_add_u32 s35, s35, 239292416
    buffer_load_dwordx4 v[16:19], v12, s[4:7], s35 offen offset:0
    buffer_load_dwordx4 v[20:23], v12, s[4:7], s35 offen offset:64
    buffer_load_dwordx4 v[24:27], v12, s[4:7], s35 offen offset:128
    buffer_load_dwordx4 v[28:31], v12, s[4:7], s35 offen offset:192
    buffer_load_dwordx4 v[32:35], v12, s[4:7], s35 offen offset:256
    v_lshlrev_b32 v13, 4, v3
    s_lshl_b32 s28, s20, 2
    v_add_u32 v14, s28, v13
    s_waitcnt vmcnt(4)
    v_lshlrev_b32 v56, 16, v16
    v_and_b32 v57, 0xffff0000, v16
    v_lshlrev_b32 v58, 16, v17
    v_and_b32 v59, 0xffff0000, v17
    v_lshlrev_b32 v60, 16, v18
    v_and_b32 v61, 0xffff0000, v18
    v_pk_add_f32 v[4:5], v[56:57], v[60:61]
    v_lshlrev_b32 v62, 16, v19
    v_and_b32 v63, 0xffff0000, v19
    v_pk_add_f32 v[6:7], v[58:59], v[62:63]
    s_waitcnt vmcnt(3)
    v_lshlrev_b32 v64, 16, v20
    v_and_b32 v65, 0xffff0000, v20
    v_pk_add_f32 v[4:5], v[4:5], v[64:65]
    v_lshlrev_b32 v66, 16, v21
    v_and_b32 v67, 0xffff0000, v21
    v_pk_add_f32 v[6:7], v[6:7], v[66:67]
    v_lshlrev_b32 v68, 16, v22
    v_and_b32 v69, 0xffff0000, v22
    v_pk_add_f32 v[4:5], v[4:5], v[68:69]
    v_lshlrev_b32 v70, 16, v23
    v_and_b32 v71, 0xffff0000, v23
    v_pk_add_f32 v[6:7], v[6:7], v[70:71]
    s_waitcnt vmcnt(2)
    v_lshlrev_b32 v72, 16, v24
    v_and_b32 v73, 0xffff0000, v24
    v_pk_add_f32 v[4:5], v[4:5], v[72:73]
    v_lshlrev_b32 v74, 16, v25
    v_and_b32 v75, 0xffff0000, v25
    v_pk_add_f32 v[6:7], v[6:7], v[74:75]
    v_lshlrev_b32 v76, 16, v26
    v_and_b32 v77, 0xffff0000, v26
    v_pk_add_f32 v[4:5], v[4:5], v[76:77]
    v_lshlrev_b32 v78, 16, v27
    v_and_b32 v79, 0xffff0000, v27
    v_pk_add_f32 v[6:7], v[6:7], v[78:79]
    s_waitcnt vmcnt(1)
    v_lshlrev_b32 v80, 16, v28
    v_and_b32 v81, 0xffff0000, v28
    v_pk_add_f32 v[4:5], v[4:5], v[80:81]
    v_lshlrev_b32 v82, 16, v29
    v_and_b32 v83, 0xffff0000, v29
    v_pk_add_f32 v[6:7], v[6:7], v[82:83]
    v_lshlrev_b32 v84, 16, v30
    v_and_b32 v85, 0xffff0000, v30
    v_pk_add_f32 v[4:5], v[4:5], v[84:85]
    v_lshlrev_b32 v86, 16, v31
    v_and_b32 v87, 0xffff0000, v31
    v_pk_add_f32 v[6:7], v[6:7], v[86:87]
    s_waitcnt vmcnt(0)
    v_lshlrev_b32 v88, 16, v32
    v_and_b32 v89, 0xffff0000, v32
    v_pk_add_f32 v[4:5], v[4:5], v[88:89]
    v_lshlrev_b32 v90, 16, v33
    v_and_b32 v91, 0xffff0000, v33
    v_pk_add_f32 v[6:7], v[6:7], v[90:91]
    v_lshlrev_b32 v92, 16, v34
    v_and_b32 v93, 0xffff0000, v34
    v_pk_add_f32 v[4:5], v[4:5], v[92:93]
    v_lshlrev_b32 v94, 16, v35
    v_and_b32 v95, 0xffff0000, v35
    v_pk_add_f32 v[6:7], v[6:7], v[94:95]
    v_pk_add_f32 v[4:5], v[4:5], v[6:7]
    v_add_f32 v4, v4, v5
    v_mov_b32 v3, v4
    s_nop 1
    v_permlane16_swap_b32 v4, v3
    s_nop 1
    v_add_f32 v4, v4, v3
    v_mov_b32 v3, v4
    s_nop 1
    v_permlane32_swap_b32 v4, v3
    s_nop 1
    v_add_f32 v4, v4, v3
    ds_write_b32 v14, v4 offset:49408
    s_waitcnt lgkmcnt(0)
    s_barrier
    ds_read_b128 v[236:239], v13 offset:49408
    s_waitcnt lgkmcnt(0)
    v_add_f32 v236, v236, v237
    v_add_f32 v238, v238, v239
    v_add_f32 v8, v236, v238
    v_mul_f32 v8, 0x3acccccd, v8
    v_mov_b32 v9, v8
    v_pk_add_f32 v[216:217], v[56:57], v[8:9] neg_lo:[0,1] neg_hi:[0,1]
    v_pk_mul_f32 v[4:5], v[216:217], v[216:217]
    v_pk_add_f32 v[218:219], v[58:59], v[8:9] neg_lo:[0,1] neg_hi:[0,1]
    v_pk_mul_f32 v[6:7], v[218:219], v[218:219]
    v_pk_add_f32 v[220:221], v[60:61], v[8:9] neg_lo:[0,1] neg_hi:[0,1]
    v_pk_fma_f32 v[4:5], v[220:221], v[220:221], v[4:5]
    v_pk_add_f32 v[222:223], v[62:63], v[8:9] neg_lo:[0,1] neg_hi:[0,1]
    v_pk_fma_f32 v[6:7], v[222:223], v[222:223], v[6:7]
    v_pk_add_f32 v[216:217], v[64:65], v[8:9] neg_lo:[0,1] neg_hi:[0,1]
    v_pk_fma_f32 v[4:5], v[216:217], v[216:217], v[4:5]
    v_pk_add_f32 v[218:219], v[66:67], v[8:9] neg_lo:[0,1] neg_hi:[0,1]
    v_pk_fma_f32 v[6:7], v[218:219], v[218:219], v[6:7]
    v_pk_add_f32 v[220:221], v[68:69], v[8:9] neg_lo:[0,1] neg_hi:[0,1]
    v_pk_fma_f32 v[4:5], v[220:221], v[220:221], v[4:5]
    v_pk_add_f32 v[222:223], v[70:71], v[8:9] neg_lo:[0,1] neg_hi:[0,1]
    v_pk_fma_f32 v[6:7], v[222:223], v[222:223], v[6:7]
    v_pk_add_f32 v[216:217], v[72:73], v[8:9] neg_lo:[0,1] neg_hi:[0,1]
    v_pk_fma_f32 v[4:5], v[216:217], v[216:217], v[4:5]
    v_pk_add_f32 v[218:219], v[74:75], v[8:9] neg_lo:[0,1] neg_hi:[0,1]
    v_pk_fma_f32 v[6:7], v[218:219], v[218:219], v[6:7]
    v_pk_add_f32 v[220:221], v[76:77], v[8:9] neg_lo:[0,1] neg_hi:[0,1]
    v_pk_fma_f32 v[4:5], v[220:221], v[220:221], v[4:5]
    v_pk_add_f32 v[222:223], v[78:79], v[8:9] neg_lo:[0,1] neg_hi:[0,1]
    v_pk_fma_f32 v[6:7], v[222:223], v[222:223], v[6:7]
    v_pk_add_f32 v[216:217], v[80:81], v[8:9] neg_lo:[0,1] neg_hi:[0,1]
    v_pk_fma_f32 v[4:5], v[216:217], v[216:217], v[4:5]
    v_pk_add_f32 v[218:219], v[82:83], v[8:9] neg_lo:[0,1] neg_hi:[0,1]
    v_pk_fma_f32 v[6:7], v[218:219], v[218:219], v[6:7]
    v_pk_add_f32 v[220:221], v[84:85], v[8:9] neg_lo:[0,1] neg_hi:[0,1]
    v_pk_fma_f32 v[4:5], v[220:221], v[220:221], v[4:5]
    v_pk_add_f32 v[222:223], v[86:87], v[8:9] neg_lo:[0,1] neg_hi:[0,1]
    v_pk_fma_f32 v[6:7], v[222:223], v[222:223], v[6:7]
    v_pk_add_f32 v[216:217], v[88:89], v[8:9] neg_lo:[0,1] neg_hi:[0,1]
    v_pk_fma_f32 v[4:5], v[216:217], v[216:217], v[4:5]
    v_pk_add_f32 v[218:219], v[90:91], v[8:9] neg_lo:[0,1] neg_hi:[0,1]
    v_pk_fma_f32 v[6:7], v[218:219], v[218:219], v[6:7]
    v_pk_add_f32 v[220:221], v[92:93], v[8:9] neg_lo:[0,1] neg_hi:[0,1]
    v_pk_fma_f32 v[4:5], v[220:221], v[220:221], v[4:5]
    v_pk_add_f32 v[222:223], v[94:95], v[8:9] neg_lo:[0,1] neg_hi:[0,1]
    v_pk_fma_f32 v[6:7], v[222:223], v[222:223], v[6:7]
    v_pk_add_f32 v[4:5], v[4:5], v[6:7]
    v_add_f32 v4, v4, v5
    v_mov_b32 v3, v4
    s_nop 1
    v_permlane16_swap_b32 v4, v3
    s_nop 1
    v_add_f32 v4, v4, v3
    v_mov_b32 v3, v4
    s_nop 1
    v_permlane32_swap_b32 v4, v3
    s_nop 1
    v_add_f32 v4, v4, v3
    ds_write_b32 v14, v4 offset:49920
    s_waitcnt lgkmcnt(0)
    s_barrier
    ds_read_b128 v[236:239], v13 offset:49920
    s_waitcnt lgkmcnt(0)
    v_add_f32 v236, v236, v237
    v_add_f32 v238, v238, v239
    v_add_f32 v4, v236, v238
    v_mul_f32 v4, 0x3acccccd, v4
    v_cvt_pk_bf16_f32 v3, v4, v4
    v_lshlrev_b32 v4, 16, v3
    v_add_f32 v4, 0x3727c5ac, v4
    v_cvt_pk_bf16_f32 v3, v4, v4
    v_lshlrev_b32 v4, 16, v3
    v_sqrt_f32 v4, v4
    s_nop 0
    v_cvt_pk_bf16_f32 v3, v4, v4
    v_lshlrev_b32 v4, 16, v3
    v_rcp_f32 v4, v4
    v_cvt_pk_bf16_f32 v3, v8, v8
    v_lshlrev_b32 v8, 16, v3
    v_mov_b32 v5, v4
    v_mov_b32 v9, v8
    s_mul_i32 s35, s36, 20
    s_add_u32 s35, s35, s25
    s_lshl_b32 s35, s35, 10
    s_add_u32 s35, s35, 241913856
    v_pk_add_f32 v[56:57], v[56:57], v[8:9] neg_lo:[0,1] neg_hi:[0,1]
    v_pk_add_f32 v[58:59], v[58:59], v[8:9] neg_lo:[0,1] neg_hi:[0,1]
    v_pk_add_f32 v[60:61], v[60:61], v[8:9] neg_lo:[0,1] neg_hi:[0,1]
    v_pk_add_f32 v[62:63], v[62:63], v[8:9] neg_lo:[0,1] neg_hi:[0,1]
    v_cvt_pk_bf16_f32 v216, v56, v57
    v_cvt_pk_bf16_f32 v217, v58, v59
    v_cvt_pk_bf16_f32 v218, v60, v61
    v_cvt_pk_bf16_f32 v219, v62, v63
    v_lshlrev_b32 v56, 16, v216
    v_and_b32 v57, 0xffff0000, v216
    v_lshlrev_b32 v58, 16, v217
    v_and_b32 v59, 0xffff0000, v217
    v_lshlrev_b32 v60, 16, v218
    v_and_b32 v61, 0xffff0000, v218
    v_lshlrev_b32 v62, 16, v219
    v_and_b32 v63, 0xffff0000, v219
    v_pk_mul_f32 v[56:57], v[56:57], v[4:5]
    v_pk_mul_f32 v[58:59], v[58:59], v[4:5]
    v_pk_mul_f32 v[60:61], v[60:61], v[4:5]
    v_pk_mul_f32 v[62:63], v[62:63], v[4:5]
    v_cvt_pk_bf16_f32 v216, v56, v57
    v_cvt_pk_bf16_f32 v217, v58, v59
    v_cvt_pk_bf16_f32 v218, v60, v61
    v_cvt_pk_bf16_f32 v219, v62, v63
    v_lshlrev_b32 v56, 16, v216
    v_and_b32 v57, 0xffff0000, v216
    v_lshlrev_b32 v58, 16, v217
    v_and_b32 v59, 0xffff0000, v217
    v_lshlrev_b32 v60, 16, v218
    v_and_b32 v61, 0xffff0000, v218
    v_lshlrev_b32 v62, 16, v219
    v_and_b32 v63, 0xffff0000, v219
    v_pk_mul_f32 v[56:57], v[56:57], v[136:137]
    v_pk_mul_f32 v[58:59], v[58:59], v[138:139]
    v_pk_mul_f32 v[60:61], v[60:61], v[140:141]
    v_pk_mul_f32 v[62:63], v[62:63], v[142:143]
    v_cvt_pk_bf16_f32 v216, v56, v57
    v_cvt_pk_bf16_f32 v217, v58, v59
    v_cvt_pk_bf16_f32 v218, v60, v61
    v_cvt_pk_bf16_f32 v219, v62, v63
    v_lshlrev_b32 v56, 16, v216
    v_and_b32 v57, 0xffff0000, v216
    v_lshlrev_b32 v58, 16, v217
    v_and_b32 v59, 0xffff0000, v217
    v_lshlrev_b32 v60, 16, v218
    v_and_b32 v61, 0xffff0000, v218
    v_lshlrev_b32 v62, 16, v219
    v_and_b32 v63, 0xffff0000, v219
    v_pk_add_f32 v[56:57], v[56:57], v[176:177]
    v_pk_add_f32 v[58:59], v[58:59], v[178:179]
    v_pk_add_f32 v[60:61], v[60:61], v[180:181]
    v_pk_add_f32 v[62:63], v[62:63], v[182:183]
    v_cvt_pk_bf16_f32 v16, v56, v57
    v_cvt_pk_bf16_f32 v17, v58, v59
    v_cvt_pk_bf16_f32 v18, v60, v61
    v_cvt_pk_bf16_f32 v19, v62, v63
    buffer_store_dwordx4 v[16:19], v2, s[4:7], s35 offen offset:0 sc1
    v_pk_add_f32 v[64:65], v[64:65], v[8:9] neg_lo:[0,1] neg_hi:[0,1]
    v_pk_add_f32 v[66:67], v[66:67], v[8:9] neg_lo:[0,1] neg_hi:[0,1]
    v_pk_add_f32 v[68:69], v[68:69], v[8:9] neg_lo:[0,1] neg_hi:[0,1]
    v_pk_add_f32 v[70:71], v[70:71], v[8:9] neg_lo:[0,1] neg_hi:[0,1]
    v_cvt_pk_bf16_f32 v216, v64, v65
    v_cvt_pk_bf16_f32 v217, v66, v67
    v_cvt_pk_bf16_f32 v218, v68, v69
    v_cvt_pk_bf16_f32 v219, v70, v71
    v_lshlrev_b32 v64, 16, v216
    v_and_b32 v65, 0xffff0000, v216
    v_lshlrev_b32 v66, 16, v217
    v_and_b32 v67, 0xffff0000, v217
    v_lshlrev_b32 v68, 16, v218
    v_and_b32 v69, 0xffff0000, v218
    v_lshlrev_b32 v70, 16, v219
    v_and_b32 v71, 0xffff0000, v219
    v_pk_mul_f32 v[64:65], v[64:65], v[4:5]
    v_pk_mul_f32 v[66:67], v[66:67], v[4:5]
    v_pk_mul_f32 v[68:69], v[68:69], v[4:5]
    v_pk_mul_f32 v[70:71], v[70:71], v[4:5]
    v_cvt_pk_bf16_f32 v216, v64, v65
    v_cvt_pk_bf16_f32 v217, v66, v67
    v_cvt_pk_bf16_f32 v218, v68, v69
    v_cvt_pk_bf16_f32 v219, v70, v71
    v_lshlrev_b32 v64, 16, v216
    v_and_b32 v65, 0xffff0000, v216
    v_lshlrev_b32 v66, 16, v217
    v_and_b32 v67, 0xffff0000, v217
    v_lshlrev_b32 v68, 16, v218
    v_and_b32 v69, 0xffff0000, v218
    v_lshlrev_b32 v70, 16, v219
    v_and_b32 v71, 0xffff0000, v219
    v_pk_mul_f32 v[64:65], v[64:65], v[144:145]
    v_pk_mul_f32 v[66:67], v[66:67], v[146:147]
    v_pk_mul_f32 v[68:69], v[68:69], v[148:149]
    v_pk_mul_f32 v[70:71], v[70:71], v[150:151]
    v_cvt_pk_bf16_f32 v216, v64, v65
    v_cvt_pk_bf16_f32 v217, v66, v67
    v_cvt_pk_bf16_f32 v218, v68, v69
    v_cvt_pk_bf16_f32 v219, v70, v71
    v_lshlrev_b32 v64, 16, v216
    v_and_b32 v65, 0xffff0000, v216
    v_lshlrev_b32 v66, 16, v217
    v_and_b32 v67, 0xffff0000, v217
    v_lshlrev_b32 v68, 16, v218
    v_and_b32 v69, 0xffff0000, v218
    v_lshlrev_b32 v70, 16, v219
    v_and_b32 v71, 0xffff0000, v219
    v_pk_add_f32 v[64:65], v[64:65], v[184:185]
    v_pk_add_f32 v[66:67], v[66:67], v[186:187]
    v_pk_add_f32 v[68:69], v[68:69], v[188:189]
    v_pk_add_f32 v[70:71], v[70:71], v[190:191]
    v_cvt_pk_bf16_f32 v20, v64, v65
    v_cvt_pk_bf16_f32 v21, v66, v67
    v_cvt_pk_bf16_f32 v22, v68, v69
    v_cvt_pk_bf16_f32 v23, v70, v71
    buffer_store_dwordx4 v[20:23], v2, s[4:7], s35 offen offset:1024 sc1
    v_pk_add_f32 v[72:73], v[72:73], v[8:9] neg_lo:[0,1] neg_hi:[0,1]
    v_pk_add_f32 v[74:75], v[74:75], v[8:9] neg_lo:[0,1] neg_hi:[0,1]
    v_pk_add_f32 v[76:77], v[76:77], v[8:9] neg_lo:[0,1] neg_hi:[0,1]
    v_pk_add_f32 v[78:79], v[78:79], v[8:9] neg_lo:[0,1] neg_hi:[0,1]
    v_cvt_pk_bf16_f32 v216, v72, v73
    v_cvt_pk_bf16_f32 v217, v74, v75
    v_cvt_pk_bf16_f32 v218, v76, v77
    v_cvt_pk_bf16_f32 v219, v78, v79
    v_lshlrev_b32 v72, 16, v216
    v_and_b32 v73, 0xffff0000, v216
    v_lshlrev_b32 v74, 16, v217
    v_and_b32 v75, 0xffff0000, v217
    v_lshlrev_b32 v76, 16, v218
    v_and_b32 v77, 0xffff0000, v218
    v_lshlrev_b32 v78, 16, v219
    v_and_b32 v79, 0xffff0000, v219
    v_pk_mul_f32 v[72:73], v[72:73], v[4:5]
    v_pk_mul_f32 v[74:75], v[74:75], v[4:5]
    v_pk_mul_f32 v[76:77], v[76:77], v[4:5]
    v_pk_mul_f32 v[78:79], v[78:79], v[4:5]
    v_cvt_pk_bf16_f32 v216, v72, v73
    v_cvt_pk_bf16_f32 v217, v74, v75
    v_cvt_pk_bf16_f32 v218, v76, v77
    v_cvt_pk_bf16_f32 v219, v78, v79
    v_lshlrev_b32 v72, 16, v216
    v_and_b32 v73, 0xffff0000, v216
    v_lshlrev_b32 v74, 16, v217
    v_and_b32 v75, 0xffff0000, v217
    v_lshlrev_b32 v76, 16, v218
    v_and_b32 v77, 0xffff0000, v218
    v_lshlrev_b32 v78, 16, v219
    v_and_b32 v79, 0xffff0000, v219
    v_pk_mul_f32 v[72:73], v[72:73], v[152:153]
    v_pk_mul_f32 v[74:75], v[74:75], v[154:155]
    v_pk_mul_f32 v[76:77], v[76:77], v[156:157]
    v_pk_mul_f32 v[78:79], v[78:79], v[158:159]
    v_cvt_pk_bf16_f32 v216, v72, v73
    v_cvt_pk_bf16_f32 v217, v74, v75
    v_cvt_pk_bf16_f32 v218, v76, v77
    v_cvt_pk_bf16_f32 v219, v78, v79
    v_lshlrev_b32 v72, 16, v216
    v_and_b32 v73, 0xffff0000, v216
    v_lshlrev_b32 v74, 16, v217
    v_and_b32 v75, 0xffff0000, v217
    v_lshlrev_b32 v76, 16, v218
    v_and_b32 v77, 0xffff0000, v218
    v_lshlrev_b32 v78, 16, v219
    v_and_b32 v79, 0xffff0000, v219
    v_pk_add_f32 v[72:73], v[72:73], v[192:193]
    v_pk_add_f32 v[74:75], v[74:75], v[194:195]
    v_pk_add_f32 v[76:77], v[76:77], v[196:197]
    v_pk_add_f32 v[78:79], v[78:79], v[198:199]
    v_cvt_pk_bf16_f32 v24, v72, v73
    v_cvt_pk_bf16_f32 v25, v74, v75
    v_cvt_pk_bf16_f32 v26, v76, v77
    v_cvt_pk_bf16_f32 v27, v78, v79
    buffer_store_dwordx4 v[24:27], v2, s[4:7], s35 offen offset:2048 sc1
    v_pk_add_f32 v[80:81], v[80:81], v[8:9] neg_lo:[0,1] neg_hi:[0,1]
    v_pk_add_f32 v[82:83], v[82:83], v[8:9] neg_lo:[0,1] neg_hi:[0,1]
    v_pk_add_f32 v[84:85], v[84:85], v[8:9] neg_lo:[0,1] neg_hi:[0,1]
    v_pk_add_f32 v[86:87], v[86:87], v[8:9] neg_lo:[0,1] neg_hi:[0,1]
    v_cvt_pk_bf16_f32 v216, v80, v81
    v_cvt_pk_bf16_f32 v217, v82, v83
    v_cvt_pk_bf16_f32 v218, v84, v85
    v_cvt_pk_bf16_f32 v219, v86, v87
    v_lshlrev_b32 v80, 16, v216
    v_and_b32 v81, 0xffff0000, v216
    v_lshlrev_b32 v82, 16, v217
    v_and_b32 v83, 0xffff0000, v217
    v_lshlrev_b32 v84, 16, v218
    v_and_b32 v85, 0xffff0000, v218
    v_lshlrev_b32 v86, 16, v219
    v_and_b32 v87, 0xffff0000, v219
    v_pk_mul_f32 v[80:81], v[80:81], v[4:5]
    v_pk_mul_f32 v[82:83], v[82:83], v[4:5]
    v_pk_mul_f32 v[84:85], v[84:85], v[4:5]
    v_pk_mul_f32 v[86:87], v[86:87], v[4:5]
    v_cvt_pk_bf16_f32 v216, v80, v81
    v_cvt_pk_bf16_f32 v217, v82, v83
    v_cvt_pk_bf16_f32 v218, v84, v85
    v_cvt_pk_bf16_f32 v219, v86, v87
    v_lshlrev_b32 v80, 16, v216
    v_and_b32 v81, 0xffff0000, v216
    v_lshlrev_b32 v82, 16, v217
    v_and_b32 v83, 0xffff0000, v217
    v_lshlrev_b32 v84, 16, v218
    v_and_b32 v85, 0xffff0000, v218
    v_lshlrev_b32 v86, 16, v219
    v_and_b32 v87, 0xffff0000, v219
    v_pk_mul_f32 v[80:81], v[80:81], v[160:161]
    v_pk_mul_f32 v[82:83], v[82:83], v[162:163]
    v_pk_mul_f32 v[84:85], v[84:85], v[164:165]
    v_pk_mul_f32 v[86:87], v[86:87], v[166:167]
    v_cvt_pk_bf16_f32 v216, v80, v81
    v_cvt_pk_bf16_f32 v217, v82, v83
    v_cvt_pk_bf16_f32 v218, v84, v85
    v_cvt_pk_bf16_f32 v219, v86, v87
    v_lshlrev_b32 v80, 16, v216
    v_and_b32 v81, 0xffff0000, v216
    v_lshlrev_b32 v82, 16, v217
    v_and_b32 v83, 0xffff0000, v217
    v_lshlrev_b32 v84, 16, v218
    v_and_b32 v85, 0xffff0000, v218
    v_lshlrev_b32 v86, 16, v219
    v_and_b32 v87, 0xffff0000, v219
    v_pk_add_f32 v[80:81], v[80:81], v[200:201]
    v_pk_add_f32 v[82:83], v[82:83], v[202:203]
    v_pk_add_f32 v[84:85], v[84:85], v[204:205]
    v_pk_add_f32 v[86:87], v[86:87], v[206:207]
    v_cvt_pk_bf16_f32 v28, v80, v81
    v_cvt_pk_bf16_f32 v29, v82, v83
    v_cvt_pk_bf16_f32 v30, v84, v85
    v_cvt_pk_bf16_f32 v31, v86, v87
    buffer_store_dwordx4 v[28:31], v2, s[4:7], s35 offen offset:3072 sc1
    s_add_u32 s35, s35, 4096
    v_pk_add_f32 v[88:89], v[88:89], v[8:9] neg_lo:[0,1] neg_hi:[0,1]
    v_pk_add_f32 v[90:91], v[90:91], v[8:9] neg_lo:[0,1] neg_hi:[0,1]
    v_pk_add_f32 v[92:93], v[92:93], v[8:9] neg_lo:[0,1] neg_hi:[0,1]
    v_pk_add_f32 v[94:95], v[94:95], v[8:9] neg_lo:[0,1] neg_hi:[0,1]
    v_cvt_pk_bf16_f32 v216, v88, v89
    v_cvt_pk_bf16_f32 v217, v90, v91
    v_cvt_pk_bf16_f32 v218, v92, v93
    v_cvt_pk_bf16_f32 v219, v94, v95
    v_lshlrev_b32 v88, 16, v216
    v_and_b32 v89, 0xffff0000, v216
    v_lshlrev_b32 v90, 16, v217
    v_and_b32 v91, 0xffff0000, v217
    v_lshlrev_b32 v92, 16, v218
    v_and_b32 v93, 0xffff0000, v218
    v_lshlrev_b32 v94, 16, v219
    v_and_b32 v95, 0xffff0000, v219
    v_pk_mul_f32 v[88:89], v[88:89], v[4:5]
    v_pk_mul_f32 v[90:91], v[90:91], v[4:5]
    v_pk_mul_f32 v[92:93], v[92:93], v[4:5]
    v_pk_mul_f32 v[94:95], v[94:95], v[4:5]
    v_cvt_pk_bf16_f32 v216, v88, v89
    v_cvt_pk_bf16_f32 v217, v90, v91
    v_cvt_pk_bf16_f32 v218, v92, v93
    v_cvt_pk_bf16_f32 v219, v94, v95
    v_lshlrev_b32 v88, 16, v216
    v_and_b32 v89, 0xffff0000, v216
    v_lshlrev_b32 v90, 16, v217
    v_and_b32 v91, 0xffff0000, v217
    v_lshlrev_b32 v92, 16, v218
    v_and_b32 v93, 0xffff0000, v218
    v_lshlrev_b32 v94, 16, v219
    v_and_b32 v95, 0xffff0000, v219
    v_pk_mul_f32 v[88:89], v[88:89], v[168:169]
    v_pk_mul_f32 v[90:91], v[90:91], v[170:171]
    v_pk_mul_f32 v[92:93], v[92:93], v[172:173]
    v_pk_mul_f32 v[94:95], v[94:95], v[174:175]
    v_cvt_pk_bf16_f32 v216, v88, v89
    v_cvt_pk_bf16_f32 v217, v90, v91
    v_cvt_pk_bf16_f32 v218, v92, v93
    v_cvt_pk_bf16_f32 v219, v94, v95
    v_lshlrev_b32 v88, 16, v216
    v_and_b32 v89, 0xffff0000, v216
    v_lshlrev_b32 v90, 16, v217
    v_and_b32 v91, 0xffff0000, v217
    v_lshlrev_b32 v92, 16, v218
    v_and_b32 v93, 0xffff0000, v218
    v_lshlrev_b32 v94, 16, v219
    v_and_b32 v95, 0xffff0000, v219
    v_pk_add_f32 v[88:89], v[88:89], v[208:209]
    v_pk_add_f32 v[90:91], v[90:91], v[210:211]
    v_pk_add_f32 v[92:93], v[92:93], v[212:213]
    v_pk_add_f32 v[94:95], v[94:95], v[214:215]
    v_cvt_pk_bf16_f32 v32, v88, v89
    v_cvt_pk_bf16_f32 v33, v90, v91
    v_cvt_pk_bf16_f32 v34, v92, v93
    v_cvt_pk_bf16_f32 v35, v94, v95
    buffer_store_dwordx4 v[32:35], v2, s[4:7], s35 offen offset:0 sc1
    s_add_u32 s73, s73, 2
    s_cmp_lg_u32 s20, 0
    s_cbranch_scc1 L_ln_f1
    s_min_u32 s60, s73, 63
    v_lshlrev_b32 v12, 2, v1
    s_lshl_b32 s61, s60, 8
    s_add_u32 s61, s61, 250826752
    v_subrev_u32 v14, 8, v1
    v_cmp_gt_u32 vcc, 10, v14
    v_cndmask_b32 v14, 0, 1, vcc
    v_add_u32 v12, s61, v12
    v_mov_b32 v15, 250890244
    v_cmp_eq_u32 vcc, 62, v1
    v_cndmask_b32 v12, v12, v15, vcc
    buffer_load_dword v13, v12, s[4:7], 0 offen sc1
    s_waitcnt vmcnt(0)
    v_cmp_lt_u32 vcc, v13, v14
    s_cmp_eq_u64 vcc, 0
    s_cselect_b32 s60, 1, 0
    v_mov_b32 v15, s60
    v_mov_b32 v12, 49152
    ds_write_b32 v12, v15
    s_waitcnt lgkmcnt(0)
    s_barrier
    s_lshl_b32 s22, s21, 8
    s_lshl_b32 s23, s74, 2
    s_add_u32 s22, s22, s23
    s_add_u32 s22, s22, 250826960
    v_mov_b32 v4, 1
    v_mov_b32 v5, 0
    s_mov_b64 exec, 1
    buffer_store_dword v4, v5, s[4:7], s22 offen sc1
    s_mov_b64 exec, -1
    s_branch L_ln_f2
L_ln_f1:
    s_waitcnt vmcnt(0)
    s_barrier
L_ln_f2:
    s_cmp_lg_u32 s75, 4
    s_cbranch_scc1 L_post_disp2
    v_mov_b32 v12, 49152
    ds_read_b32 v15, v12
    s_waitcnt lgkmcnt(0)
    v_readfirstlane_b32 s77, v15
    s_branch L_ln_loop
L_post_disp2:
    s_barrier
    s_branch L_post_disp
L_post_out:
    s_cmp_eq_u32 s76, 0
    s_cbranch_scc1 L_post_done
    s_branch L_w_next
L_post_done:
    s_endpgm
L_ch_end:
    s_endpgm
.section .rodata,"a"
.p2align 6
.amdhsa_kernel k_prep_kernel
  .amdhsa_next_free_vgpr 256
  .amdhsa_next_free_sgpr 102
  .amdhsa_accum_offset 256
  .amdhsa_group_segment_fixed_size 0
  .amdhsa_kernarg_size 136
  .amdhsa_user_sgpr_count 2
  .amdhsa_user_sgpr_kernarg_segment_ptr 1
  .amdhsa_system_sgpr_workgroup_id_x 1
.end_amdhsa_kernel
.text
.section .rodata,"a"
.p2align 6
.amdhsa_kernel k_chain_kernel
  .amdhsa_next_free_vgpr 512
  .amdhsa_next_free_sgpr 102
  .amdhsa_accum_offset 256
  .amdhsa_group_segment_fixed_size 0
  .amdhsa_kernarg_size 136
  .amdhsa_user_sgpr_count 2
  .amdhsa_user_sgpr_kernarg_segment_ptr 1
  .amdhsa_system_sgpr_workgroup_id_x 1
.end_amdhsa_kernel
.text
```
